```python
import torch

def _softmax(x, axis=-1):
    return torch.softmax(x, dim=axis)
def _gelu(x):
    return torch.nn.functional.gelu(x, approximate="tanh")
def _silu(x):
    return torch.nn.functional.silu(x)
def _sigmoid(x):
    return torch.sigmoid(x)
def _layernorm(x, axis=-1, eps=1e-5):
    m = x.mean(dim=axis, keepdim=True)
    v = x.var(dim=axis, keepdim=True, unbiased=False)
    return (x - m) / torch.sqrt(v + eps)
def _scatter_add(tgt, idx, src, axis=0):
    return tgt.clone().index_add_(axis, idx, src)
def _segment_sum(src, seg, n):
    out = torch.zeros((n,) + src.shape[1:], dtype=src.dtype)
    return out.index_add_(0, seg, src)
def _pad(x, pw):
    flat = tuple(v for pair in reversed(pw) for v in pair)
    return torch.nn.functional.pad(x, flat)

kernel_name = 'gated_mix__mha_block__compressed_kv_cla__prompt'

def setup_inputs():

    _w = (lambda a: (lambda t: t.to(torch.bfloat16) if t.is_floating_point() else t)(torch.as_tensor(a)))
    def _A_setup():
        B, S, D, H = 1, 2048, 448, 16
        return {
            "x": _w((lambda *s: torch.randn(*s, dtype=torch.bfloat16) * 0.05)(B, S, D)),
            "wqkv": _w((lambda *s: torch.randn(*s, dtype=torch.bfloat16) * 1.6)(D, 3 * D)),
            "wo": _w((lambda *s: torch.randn(*s, dtype=torch.bfloat16) * 0.05)(D, D)),
        }
    _A_in = _A_setup()

    def _B_setup():
        B, H, Sq, Sk, D, M = 1, 16, 2048, 2048, 256, 448
        Dc = 4 * D
        return {
            "x": _w((lambda *s: torch.randn(*s, dtype=torch.bfloat16) * 0.05)(B, Sq, M)),
            "c_kv": _w((lambda *s: torch.randn(*s, dtype=torch.bfloat16) * 1.6)(B, Sk, Dc)),
            "w_q": _w((lambda *s: torch.randn(*s, dtype=torch.bfloat16) * 6.4)(M, H, D) * (M ** -0.5)),
            "w_uk": _w((lambda *s: torch.randn(*s, dtype=torch.bfloat16) * 6.4)(Dc, H, D) * (Dc ** -0.5)),
            "w_uv": _w((lambda *s: torch.randn(*s, dtype=torch.bfloat16) * 1.6)(Dc, H, D) * (Dc ** -0.5)),
            "w_o": _w((lambda *s: torch.randn(*s, dtype=torch.bfloat16) * 1.6)(H, D, M) * ((H * D) ** -0.5)),
        }
    _B_in = _B_setup()

    return {
        "A_x": _A_in["x"],
        "A_wqkv": _A_in["wqkv"],
        "A_wo": _A_in["wo"],
        "B_x": _B_in["x"],
        "B_c_kv": _B_in["c_kv"],
        "B_w_q": _B_in["w_q"],
        "B_w_uk": _B_in["w_uk"],
        "B_w_uv": _B_in["w_uv"],
        "B_w_o": _B_in["w_o"],
        "gate_w": _w((lambda *s: torch.randn(*s, dtype=torch.bfloat16) * 0.05)(448) * 16.0),
    }

def reference(A_x, A_wqkv, A_wo, B_x, B_c_kv, B_w_q, B_w_uk, B_w_uv, B_w_o, gate_w):
    def _A_ref(x, wqkv, wo):
        B, S, D = x.shape
        H = 16
        Dh = D // H
        qkv = (lambda x, *d: x.permute(*d))((x @ wqkv).reshape(B, S, 3, H, Dh), 2, 0, 3, 1, 4)
        q, k, v = qkv[0], qkv[1], qkv[2]
        scores = torch.einsum("bhqd,bhkd->bhqk", q, k) * (Dh ** -0.5)
        p = _softmax(scores, axis=-1)
        o = torch.einsum("bhqk,bhkd->bhqd", p, v)
        return (lambda x, *d: x.permute(*d))(o, 0, 2, 1, 3).reshape(B, S, D) @ wo

    def _B_ref(x, c_kv, w_q, w_uk, w_uv, w_o):
        B, Sq, M = x.shape[0], x.shape[1], x.shape[2]
        Sk = c_kv.shape[1]
        H, D = w_q.shape[1], w_q.shape[2]
        q = torch.einsum("bqm,mhd->bhqd", x, w_q)
        k = torch.einsum("bkc,chd->bhkd", c_kv, w_uk)
        v = torch.einsum("bkc,chd->bhkd", c_kv, w_uv)
        scores = torch.einsum("bhqd,bhkd->bhqk", q, k) * (D ** -0.5)
        off = Sk - Sq
        qi = torch.arange(Sq)[:, None]
        kj = torch.arange(Sk)[None, :]
        cmask = kj <= (qi + off)
        scores = torch.where(cmask[None, None], scores, -1e9)
        p = _softmax(scores, axis=-1)
        ctx = torch.einsum("bhqk,bhkd->bhqd", p, v)
        return torch.einsum("bhqd,hdm->bqm", ctx, w_o)

    x = A_x
    g = _sigmoid((x * gate_w).sum(-1, keepdims=True))
    a = _A_ref(x, A_wqkv, A_wo)
    b = _B_ref(x, B_c_kv, B_w_q, B_w_uk, B_w_uv, B_w_o)
    return g * a + (1 - g) * b
```

```asm
; @launch kernel=k1_proj_kernel grid=(256,1,1) block=(512,1,1) lds=163840
; @launch kernel=k2_attn_kernel grid=(256,1,1) block=(512,1,1) lds=163840
.amdgcn_target "amdgcn-amd-amdhsa--gfx950"
.text
.p2align 8
k1_proj_kernel:
    s_cmp_ge_u32 s2, 256
    s_cbranch_scc1 K1_END
    s_load_dwordx4 s[52:55], s[0:1], 0
    s_load_dwordx4 s[56:59], s[0:1], 32
    s_load_dwordx4 s[60:63], s[0:1], 48
    s_load_dwordx2 s[64:65], s[0:1], 72
    s_load_dwordx2 s[66:67], s[0:1], 96
    v_and_b32 v253, 63, v0
    v_lshrrev_b32 v128, 6, v0
    s_and_b32 s46, s2, 7
    v_readfirstlane_b32 s24, v128
    s_lshr_b32 s47, s2, 3
    s_and_b32 s50, s47, 7
    s_lshr_b32 s35, s47, 3
    s_and_b32 s36, s35, 1
    s_lshl_b32 s48, s46, 1
    s_add_u32 s48, s48, s36
    s_lshr_b32 s49, s35, 1
    s_lshr_b32 s36, s50, 1
    s_add_u32 s42, s35, s36
    s_and_b32 s42, s42, 3
    s_and_b32 s25, s24, 3
    s_lshr_b32 s26, s24, 2
    s_lshl_b32 s32, s24, 12
    s_lshl_b32 s33, s24, 11
    s_mul_i32 s35, s46, 30
    s_add_u32 s35, s35, s47
    s_cmp_ge_u32 s47, 30
    s_cselect_b32 s94, 1, 0
    s_cselect_b32 s35, 0, s35
    s_and_b32 s51, s35, 7
    s_lshr_b32 s35, s35, 3
    s_lshr_b32 s36, s51, 1
    s_add_u32 s43, s35, s36
    s_and_b32 s43, s43, 3
    s_lshl_b32 s43, s43, 1
    s_cmp_ge_u32 s35, 22
    s_cselect_b32 s71, 1, 0
    s_cselect_b32 s69, 28, 32
    s_movk_i32 s70, 8192
    s_cselect_b32 s70, 2688, s70
    s_cselect_b32 s36, 22, 0
    s_sub_u32 s35, s35, s36
    s_mul_i32 s68, s35, 6
    s_lshl_b32 s45, s70, 5
    s_mov_b32 s44, 0x40000
    s_mov_b32 s95, 0x3e8b97f6
    v_lshrrev_b32 v132, 4, v253
    v_and_b32 v129, 7, v253
    v_xor_b32 v129, v129, v132
    v_lshrrev_b32 v128, 3, v253
    s_lshl_b32 s35, s24, 5
    s_lshl_b32 s36, s50, 8
    s_add_u32 s35, s35, s36
    v_add_u32 v128, s35, v128
    v_mul_u32_u24 v128, 2048, v128
    v_lshl_add_u32 v240, v129, 4, v128
    v_add_u32 v241, 15360, v240
    v_xor_b32 v128, 64, v240
    v_add_u32 v242, 32768, v128
    v_add_u32 v243, 15360, v242
    v_lshrrev_b32 v128, 3, v253
    s_lshl_b32 s35, s24, 5
    s_lshl_b32 s36, s51, 8
    s_add_u32 s35, s35, s36
    v_add_u32 v128, s35, v128
    v_mul_u32_u24 v128, 896, v128
    v_lshl_add_u32 v244, v129, 4, v128
    v_add_u32 v245, 6144, v244
    v_xor_b32 v128, 64, v244
    v_add_u32 v246, 14336, v128
    v_add_u32 v247, 6144, v246
    s_bfe_u32 s37, s24, 0x10001
    s_lshl_b32 s38, s48, 9
    v_lshrrev_b32 v128, 5, v253
    v_and_b32 v129, 31, v253
    v_lshlrev_b32 v130, 2, v128
    v_xor_b32 v129, v129, v130
    v_xor_b32 v129, s37, v129
    s_lshl_b32 s35, s24, 2
    v_add_u32 v128, s35, v128
    v_lshlrev_b32 v128, 13, v128
    v_lshl_add_u32 v128, v129, 4, v128
    v_add_u32 v128, s38, v128
    v_subrev_u32 v248, 0, v128
    v_lshrrev_b32 v128, 5, v253
    v_add_u32 v128, 2, v128
    v_and_b32 v129, 31, v253
    v_lshlrev_b32 v130, 2, v128
    v_xor_b32 v129, v129, v130
    v_xor_b32 v129, s37, v129
    s_lshl_b32 s35, s24, 2
    v_add_u32 v128, s35, v128
    v_lshlrev_b32 v128, 13, v128
    v_lshl_add_u32 v128, v129, 4, v128
    v_add_u32 v128, s38, v128
    v_subrev_u32 v249, 1024, v128
    s_movk_i32 s36, 2731
    s_lshl_b32 s35, s24, 7
    v_add_u32 v128, s35, v253
    v_mul_lo_u32 v129, v128, s36
    v_lshrrev_b32 v129, 16, v129
    v_mul_u32_u24 v130, 24, v129
    v_sub_u32 v130, v128, v130
    v_lshlrev_b32 v131, 1, v129
    v_and_b32 v131, 4, v131
    v_xor_b32 v130, v130, v131
    v_bfe_u32 v131, v129, 3, 1
    v_xor_b32 v130, v130, v131
    v_lshrrev_b32 v131, 2, v130
    v_add_u32 v131, s68, v131
    v_mul_lo_u32 v131, v131, s69
    v_and_b32 v130, 3, v130
    v_lshl_add_u32 v131, v130, 3, v131
    v_mul_lo_u32 v129, v129, s70
    v_lshl_add_u32 v129, v131, 1, v129
    v_subrev_u32 v250, 0, v129
    v_add_u32 v128, s35, v253
    v_add_u32 v128, 64, v128
    v_mul_lo_u32 v129, v128, s36
    v_lshrrev_b32 v129, 16, v129
    v_mul_u32_u24 v130, 24, v129
    v_sub_u32 v130, v128, v130
    v_lshlrev_b32 v131, 1, v129
    v_and_b32 v131, 4, v131
    v_xor_b32 v130, v130, v131
    v_bfe_u32 v131, v129, 3, 1
    v_xor_b32 v130, v130, v131
    v_lshrrev_b32 v131, 2, v130
    v_add_u32 v131, s68, v131
    v_mul_lo_u32 v131, v131, s69
    v_and_b32 v130, 3, v130
    v_lshl_add_u32 v131, v130, 3, v131
    v_mul_lo_u32 v129, v129, s70
    v_lshl_add_u32 v129, v131, 1, v129
    v_subrev_u32 v251, 1024, v129
    s_cmp_lt_u32 s24, 6
    s_cbranch_scc1 K1_W2OK
    v_mov_b32 v250, 0x7ff00000
    v_mov_b32 v251, 0x7ff00000
K1_W2OK:
    s_waitcnt lgkmcnt(0)
    s_mov_b32 s4, s56
    s_mov_b32 s5, s57
    s_mov_b32 s6, 0x400000
    s_mov_b32 s7, 0x20000
    s_mov_b32 s12, s52
    s_mov_b32 s13, s53
    s_mov_b32 s14, 0x1c0000
    s_mov_b32 s15, 0x20000
    s_mov_b32 s20, s66
    s_mov_b32 s21, s67
    s_mov_b32 s22, 0x10000000
    s_mov_b32 s23, 0x20000
    s_cmp_eq_u32 s49, 0
    s_cselect_b32 s8, s60, s62
    s_cselect_b32 s9, s61, s63
    s_mov_b32 s10, 8388608
    s_mov_b32 s11, 0x20000
    s_cmp_eq_u32 s71, 0
    s_cselect_b32 s16, s58, s54
    s_cselect_b32 s17, s59, s55
    s_mov_b32 s18, 1204224
    s_cselect_b32 s18, 3670016, s18
    s_mov_b32 s19, 0x20000
    s_mov_b32 s27, 0x10000
    s_mov_b32 s28, 0
    s_bitcmp1_b32 s47, 0
    s_cselect_b32 s35, 1, 0
    s_andn2_b32 s35, s35, s94
    s_cbranch_scc1 K1_ORD21
    s_cmp_lg_u32 s49, 0
    s_cbranch_scc1 K1_12V
    s_mov_b32 s40, 0
    s_add_u32 s31, s40, s42
    s_and_b32 s31, s31, 3
    s_andn2_b32 s37, s40, 3
    s_or_b32 s31, s31, s37
    s_add_u32 s40, s40, 1
    s_add_u32 m0, s27, s32
    s_lshl_b32 s31, s31, 7
    buffer_load_dwordx4 v240, s[4:7], s31 offen offset:0 lds
    buffer_load_dwordx4 v241, s[4:7], s31 offen offset:1024 lds
    s_add_u32 s35, s27, s32
    s_add_u32 m0, s35, 0x800
    s_add_u32 s27, s27, 0x8000
    buffer_load_dwordx4 v242, s[4:7], s31 offen offset:0 lds
    buffer_load_dwordx4 v243, s[4:7], s31 offen offset:1024 lds
    s_cmp_ge_u32 s27, 0x28000
    s_cselect_b32 s27, 0x10000, s27
    s_mov_b32 s41, 0
    s_add_u32 s30, s41, s42
    s_and_b32 s30, s30, 3
    s_andn2_b32 s37, s41, 3
    s_or_b32 s30, s30, s37
    s_add_u32 s41, s41, 1
    s_mul_i32 s30, s30, s44
    s_lshl_b32 s30, s30, 1
    s_add_u32 m0, s33, 0
    s_nop 0
    buffer_load_dwordx4 v248, s[8:11], s30 offen offset:0 lds
    buffer_load_dwordx4 v249, s[8:11], s30 offen offset:1024 lds
    s_add_u32 s30, s30, s44
    s_add_u32 m0, s33, 16384
    s_nop 0
    buffer_load_dwordx4 v248, s[8:11], s30 offen offset:0 lds
    buffer_load_dwordx4 v249, s[8:11], s30 offen offset:1024 lds
    s_add_u32 s31, s40, s42
    s_and_b32 s31, s31, 3
    s_andn2_b32 s37, s40, 3
    s_or_b32 s31, s31, s37
    s_add_u32 s40, s40, 1
    s_add_u32 m0, s27, s32
    s_lshl_b32 s31, s31, 7
    buffer_load_dwordx4 v240, s[4:7], s31 offen offset:0 lds
    buffer_load_dwordx4 v241, s[4:7], s31 offen offset:1024 lds
    s_add_u32 s35, s27, s32
    s_add_u32 m0, s35, 0x800
    s_add_u32 s27, s27, 0x8000
    buffer_load_dwordx4 v242, s[4:7], s31 offen offset:0 lds
    buffer_load_dwordx4 v243, s[4:7], s31 offen offset:1024 lds
    s_cmp_ge_u32 s27, 0x28000
    s_cselect_b32 s27, 0x10000, s27
    s_add_u32 s30, s41, s42
    s_and_b32 s30, s30, 3
    s_andn2_b32 s37, s41, 3
    s_or_b32 s30, s30, s37
    s_add_u32 s41, s41, 1
    s_mul_i32 s30, s30, s44
    s_lshl_b32 s30, s30, 1
    s_add_u32 m0, s33, 32768
    s_nop 0
    buffer_load_dwordx4 v248, s[8:11], s30 offen offset:0 lds
    buffer_load_dwordx4 v249, s[8:11], s30 offen offset:1024 lds
    s_add_u32 s30, s30, s44
    v_lshrrev_b32 v132, 4, v253
    v_bfe_u32 v128, v253, 3, 1
    v_and_b32 v129, 7, v253
    v_lshl_add_u32 v133, v128, 4, v129
    v_bfe_u32 v131, v253, 1, 2
    v_lshl_add_u32 v131, v128, 2, v131
    v_xor_b32 v131, v131, v132
    v_lshlrev_b32 v131, 4, v131
    s_lshl_b32 s35, s25, 6
    v_add_u32 v130, s35, v133
    v_lshl_add_u32 v130, v130, 7, v131
    v_add_u32 v224, 0x10000, v130
    v_xor_b32 v225, 64, v224
    v_bfe_u32 v128, v253, 2, 2
    v_lshl_add_u32 v134, v132, 3, v128
    v_bfe_u32 v130, v253, 1, 1
    v_bfe_u32 v131, v253, 4, 1
    v_lshl_add_u32 v130, v130, 1, v131
    v_lshlrev_b32 v130, 4, v130
    v_and_b32 v129, 1, v253
    v_lshl_add_u32 v135, v129, 3, v130
    v_lshl_add_u32 v129, v134, 9, v135
    s_lshl_b32 s35, s26, 2
    s_add_u32 s36, s35, 0
    v_xor_b32 v130, s36, v128
    v_lshl_add_u32 v226, v130, 6, v129
    v_xor_b32 v227, 16, v226
    s_add_u32 s36, s35, 1
    v_xor_b32 v130, s36, v128
    v_lshl_add_u32 v228, v130, 6, v129
    v_xor_b32 v229, 16, v228
    s_add_u32 s36, s35, 2
    v_xor_b32 v130, s36, v128
    v_lshl_add_u32 v230, v130, 6, v129
    v_xor_b32 v231, 16, v230
    s_add_u32 s36, s35, 3
    v_xor_b32 v130, s36, v128
    v_lshl_add_u32 v232, v130, 6, v129
    v_xor_b32 v233, 16, v232
    v_mul_u32_u24 v129, 384, v134
    v_add_u32 v129, v129, v135
    v_bfe_u32 v128, v253, 3, 1
    s_mul_i32 s35, s26, 3
    s_add_u32 s36, s35, 0
    v_xor_b32 v130, s36, v128
    v_lshl_add_u32 v234, v130, 6, v129
    v_xor_b32 v235, 16, v234
    s_add_u32 s36, s35, 1
    v_xor_b32 v130, s36, v128
    v_lshl_add_u32 v236, v130, 6, v129
    v_xor_b32 v237, 16, v236
    s_add_u32 s36, s35, 2
    v_xor_b32 v130, s36, v128
    v_lshl_add_u32 v238, v130, 6, v129
    v_xor_b32 v239, 16, v238
    v_lshrrev_b32 v130, 5, v253
    v_lshl_add_u32 v129, v131, 5, v133
    v_lshlrev_b32 v129, 4, v129
    v_lshl_add_u32 v252, v130, 10, v129
    s_waitcnt vmcnt(8) lgkmcnt(0)
    s_barrier
    ds_read_b128 v[128:131], v224 offset:0
    ds_read_b64_tr_b16 v[144:145], v226 offset:0
    ds_read_b64_tr_b16 v[146:147], v226 offset:2048
    ds_read_b64_tr_b16 v[148:149], v227 offset:0
    ds_read_b64_tr_b16 v[150:151], v227 offset:2048
    ds_read_b128 v[132:135], v224 offset:1024
    ds_read_b64_tr_b16 v[152:153], v228 offset:0
    ds_read_b64_tr_b16 v[154:155], v228 offset:2048
    ds_read_b64_tr_b16 v[156:157], v229 offset:0
    ds_read_b64_tr_b16 v[158:159], v229 offset:2048
    ds_read_b64_tr_b16 v[160:161], v230 offset:0
    ds_read_b64_tr_b16 v[162:163], v230 offset:2048
    ds_read_b64_tr_b16 v[164:165], v231 offset:0
    ds_read_b64_tr_b16 v[166:167], v231 offset:2048
    ds_read_b64_tr_b16 v[168:169], v232 offset:0
    ds_read_b64_tr_b16 v[170:171], v232 offset:2048
    ds_read_b64_tr_b16 v[172:173], v233 offset:0
    ds_read_b64_tr_b16 v[174:175], v233 offset:2048
    ds_read_b128 v[136:139], v224 offset:4096
    ds_read_b128 v[140:143], v224 offset:5120
    s_add_u32 m0, s33, 49152
    s_nop 0
    buffer_load_dwordx4 v248, s[8:11], s30 offen offset:0 lds
    buffer_load_dwordx4 v249, s[8:11], s30 offen offset:1024 lds
    s_add_u32 s31, s40, s42
    s_and_b32 s31, s31, 3
    s_andn2_b32 s37, s40, 3
    s_or_b32 s31, s31, s37
    s_add_u32 s40, s40, 1
    s_add_u32 m0, s27, s32
    s_lshl_b32 s31, s31, 7
    buffer_load_dwordx4 v240, s[4:7], s31 offen offset:0 lds
    buffer_load_dwordx4 v241, s[4:7], s31 offen offset:1024 lds
    s_waitcnt vmcnt(10) lgkmcnt(0)
    s_barrier
    v_mfma_f32_16x16x32_bf16 v[0:3], v[144:147], v[128:131], 0
    ds_read_b128 v[176:179], v225 offset:0
    ds_read_b64_tr_b16 v[192:193], v226 offset:16384
    v_mfma_f32_16x16x32_bf16 v[4:7], v[148:151], v[128:131], 0
    ds_read_b64_tr_b16 v[194:195], v226 offset:18432
    v_mfma_f32_16x16x32_bf16 v[8:11], v[152:155], v[128:131], 0
    ds_read_b64_tr_b16 v[196:197], v227 offset:16384
    ds_read_b64_tr_b16 v[198:199], v227 offset:18432
    v_mfma_f32_16x16x32_bf16 v[12:15], v[156:159], v[128:131], 0
    ds_read_b128 v[180:183], v225 offset:1024
    v_mfma_f32_16x16x32_bf16 v[16:19], v[160:163], v[128:131], 0
    ds_read_b64_tr_b16 v[200:201], v228 offset:16384
    ds_read_b64_tr_b16 v[202:203], v228 offset:18432
    v_mfma_f32_16x16x32_bf16 v[20:23], v[164:167], v[128:131], 0
    ds_read_b64_tr_b16 v[204:205], v229 offset:16384
    v_mfma_f32_16x16x32_bf16 v[24:27], v[168:171], v[128:131], 0
    ds_read_b64_tr_b16 v[206:207], v229 offset:18432
    ds_read_b64_tr_b16 v[208:209], v230 offset:16384
    v_mfma_f32_16x16x32_bf16 v[28:31], v[172:175], v[128:131], 0
    ds_read_b64_tr_b16 v[210:211], v230 offset:18432
    v_mfma_f32_16x16x32_bf16 v[32:35], v[144:147], v[132:135], 0
    ds_read_b64_tr_b16 v[212:213], v231 offset:16384
    v_mfma_f32_16x16x32_bf16 v[36:39], v[148:151], v[132:135], 0
    ds_read_b64_tr_b16 v[214:215], v231 offset:18432
    ds_read_b64_tr_b16 v[216:217], v232 offset:16384
    v_mfma_f32_16x16x32_bf16 v[40:43], v[152:155], v[132:135], 0
    ds_read_b64_tr_b16 v[218:219], v232 offset:18432
    v_mfma_f32_16x16x32_bf16 v[44:47], v[156:159], v[132:135], 0
    ds_read_b64_tr_b16 v[220:221], v233 offset:16384
    ds_read_b64_tr_b16 v[222:223], v233 offset:18432
    v_mfma_f32_16x16x32_bf16 v[48:51], v[160:163], v[132:135], 0
    ds_read_b128 v[184:187], v225 offset:4096
    v_mfma_f32_16x16x32_bf16 v[52:55], v[164:167], v[132:135], 0
    ds_read_b128 v[188:191], v225 offset:5120
    s_add_u32 s30, s41, s42
    v_mfma_f32_16x16x32_bf16 v[56:59], v[168:171], v[132:135], 0
    s_and_b32 s30, s30, 3
    v_mfma_f32_16x16x32_bf16 v[60:63], v[172:175], v[132:135], 0
    s_andn2_b32 s37, s41, 3
    v_mfma_f32_16x16x32_bf16 v[64:67], v[144:147], v[136:139], 0
    s_or_b32 s30, s30, s37
    s_add_u32 s41, s41, 1
    v_mfma_f32_16x16x32_bf16 v[68:71], v[148:151], v[136:139], 0
    s_mul_i32 s30, s30, s44
    v_mfma_f32_16x16x32_bf16 v[72:75], v[152:155], v[136:139], 0
    s_lshl_b32 s30, s30, 1
    s_add_u32 m0, s33, 0
    v_mfma_f32_16x16x32_bf16 v[76:79], v[156:159], v[136:139], 0
    s_nop 0
    v_mfma_f32_16x16x32_bf16 v[80:83], v[160:163], v[136:139], 0
    buffer_load_dwordx4 v248, s[8:11], s30 offen offset:0 lds
    buffer_load_dwordx4 v249, s[8:11], s30 offen offset:1024 lds
    v_mfma_f32_16x16x32_bf16 v[84:87], v[164:167], v[136:139], 0
    s_add_u32 s30, s30, s44
    v_mfma_f32_16x16x32_bf16 v[88:91], v[168:171], v[136:139], 0
    s_add_u32 s35, s27, s32
    s_add_u32 m0, s35, 0x800
    v_mfma_f32_16x16x32_bf16 v[92:95], v[172:175], v[136:139], 0
    s_add_u32 s27, s27, 0x8000
    v_mfma_f32_16x16x32_bf16 v[96:99], v[144:147], v[140:143], 0
    buffer_load_dwordx4 v242, s[4:7], s31 offen offset:0 lds
    v_mfma_f32_16x16x32_bf16 v[100:103], v[148:151], v[140:143], 0
    buffer_load_dwordx4 v243, s[4:7], s31 offen offset:1024 lds
    s_cmp_ge_u32 s27, 0x28000
    v_mfma_f32_16x16x32_bf16 v[104:107], v[152:155], v[140:143], 0
    s_cselect_b32 s27, 0x10000, s27
    v_mfma_f32_16x16x32_bf16 v[108:111], v[156:159], v[140:143], 0
    s_add_u32 s36, s28, 0x8000
    s_cmp_ge_u32 s36, 0x18000
    v_mfma_f32_16x16x32_bf16 v[112:115], v[160:163], v[140:143], 0
    s_cselect_b32 s36, 0, s36
    v_mfma_f32_16x16x32_bf16 v[116:119], v[164:167], v[140:143], 0
    s_sub_u32 s29, s36, s28
    s_mov_b32 s28, s36
    v_mfma_f32_16x16x32_bf16 v[120:123], v[168:171], v[140:143], 0
    v_add_u32 v224, s29, v224
    v_mfma_f32_16x16x32_bf16 v[124:127], v[172:175], v[140:143], 0
    v_add_u32 v225, s29, v225
    s_waitcnt vmcnt(8) lgkmcnt(0)
    s_barrier
    v_mfma_f32_16x16x32_bf16 v[0:3], v[192:195], v[176:179], v[0:3]
    ds_read_b128 v[128:131], v224 offset:0
    ds_read_b64_tr_b16 v[144:145], v226 offset:32768
    v_mfma_f32_16x16x32_bf16 v[4:7], v[196:199], v[176:179], v[4:7]
    ds_read_b64_tr_b16 v[146:147], v226 offset:34816
    v_mfma_f32_16x16x32_bf16 v[8:11], v[200:203], v[176:179], v[8:11]
    ds_read_b64_tr_b16 v[148:149], v227 offset:32768
    v_mfma_f32_16x16x32_bf16 v[12:15], v[204:207], v[176:179], v[12:15]
    ds_read_b64_tr_b16 v[150:151], v227 offset:34816
    v_mfma_f32_16x16x32_bf16 v[16:19], v[208:211], v[176:179], v[16:19]
    ds_read_b128 v[132:135], v224 offset:1024
    v_mfma_f32_16x16x32_bf16 v[20:23], v[212:215], v[176:179], v[20:23]
    ds_read_b64_tr_b16 v[152:153], v228 offset:32768
    v_mfma_f32_16x16x32_bf16 v[24:27], v[216:219], v[176:179], v[24:27]
    ds_read_b64_tr_b16 v[154:155], v228 offset:34816
    v_mfma_f32_16x16x32_bf16 v[28:31], v[220:223], v[176:179], v[28:31]
    ds_read_b64_tr_b16 v[156:157], v229 offset:32768
    v_mfma_f32_16x16x32_bf16 v[32:35], v[192:195], v[180:183], v[32:35]
    ds_read_b64_tr_b16 v[158:159], v229 offset:34816
    v_mfma_f32_16x16x32_bf16 v[36:39], v[196:199], v[180:183], v[36:39]
    ds_read_b64_tr_b16 v[160:161], v230 offset:32768
    v_mfma_f32_16x16x32_bf16 v[40:43], v[200:203], v[180:183], v[40:43]
    ds_read_b64_tr_b16 v[162:163], v230 offset:34816
    v_mfma_f32_16x16x32_bf16 v[44:47], v[204:207], v[180:183], v[44:47]
    ds_read_b64_tr_b16 v[164:165], v231 offset:32768
    v_mfma_f32_16x16x32_bf16 v[48:51], v[208:211], v[180:183], v[48:51]
    ds_read_b64_tr_b16 v[166:167], v231 offset:34816
    v_mfma_f32_16x16x32_bf16 v[52:55], v[212:215], v[180:183], v[52:55]
    ds_read_b64_tr_b16 v[168:169], v232 offset:32768
    v_mfma_f32_16x16x32_bf16 v[56:59], v[216:219], v[180:183], v[56:59]
    ds_read_b64_tr_b16 v[170:171], v232 offset:34816
    v_mfma_f32_16x16x32_bf16 v[60:63], v[220:223], v[180:183], v[60:63]
    ds_read_b64_tr_b16 v[172:173], v233 offset:32768
    v_mfma_f32_16x16x32_bf16 v[64:67], v[192:195], v[184:187], v[64:67]
    ds_read_b64_tr_b16 v[174:175], v233 offset:34816
    v_mfma_f32_16x16x32_bf16 v[68:71], v[196:199], v[184:187], v[68:71]
    ds_read_b128 v[136:139], v224 offset:4096
    v_mfma_f32_16x16x32_bf16 v[72:75], v[200:203], v[184:187], v[72:75]
    ds_read_b128 v[140:143], v224 offset:5120
    v_mfma_f32_16x16x32_bf16 v[76:79], v[204:207], v[184:187], v[76:79]
    s_add_u32 m0, s33, 16384
    v_mfma_f32_16x16x32_bf16 v[80:83], v[208:211], v[184:187], v[80:83]
    s_nop 0
    v_mfma_f32_16x16x32_bf16 v[84:87], v[212:215], v[184:187], v[84:87]
    buffer_load_dwordx4 v248, s[8:11], s30 offen offset:0 lds
    v_mfma_f32_16x16x32_bf16 v[88:91], v[216:219], v[184:187], v[88:91]
    buffer_load_dwordx4 v249, s[8:11], s30 offen offset:1024 lds
    v_mfma_f32_16x16x32_bf16 v[92:95], v[220:223], v[184:187], v[92:95]
    s_add_u32 s31, s40, s42
    v_mfma_f32_16x16x32_bf16 v[96:99], v[192:195], v[188:191], v[96:99]
    s_and_b32 s31, s31, 3
    v_mfma_f32_16x16x32_bf16 v[100:103], v[196:199], v[188:191], v[100:103]
    s_andn2_b32 s37, s40, 3
    v_mfma_f32_16x16x32_bf16 v[104:107], v[200:203], v[188:191], v[104:107]
    s_or_b32 s31, s31, s37
    v_mfma_f32_16x16x32_bf16 v[108:111], v[204:207], v[188:191], v[108:111]
    s_add_u32 s40, s40, 1
    v_mfma_f32_16x16x32_bf16 v[112:115], v[208:211], v[188:191], v[112:115]
    s_add_u32 m0, s27, s32
    v_mfma_f32_16x16x32_bf16 v[116:119], v[212:215], v[188:191], v[116:119]
    s_lshl_b32 s31, s31, 7
    v_mfma_f32_16x16x32_bf16 v[120:123], v[216:219], v[188:191], v[120:123]
    buffer_load_dwordx4 v240, s[4:7], s31 offen offset:0 lds
    v_mfma_f32_16x16x32_bf16 v[124:127], v[220:223], v[188:191], v[124:127]
    buffer_load_dwordx4 v241, s[4:7], s31 offen offset:1024 lds
    s_waitcnt vmcnt(10) lgkmcnt(0)
    s_barrier
    v_mfma_f32_16x16x32_bf16 v[0:3], v[144:147], v[128:131], v[0:3]
    ds_read_b128 v[176:179], v225 offset:0
    ds_read_b64_tr_b16 v[192:193], v226 offset:49152
    v_mfma_f32_16x16x32_bf16 v[4:7], v[148:151], v[128:131], v[4:7]
    ds_read_b64_tr_b16 v[194:195], v226 offset:51200
    v_mfma_f32_16x16x32_bf16 v[8:11], v[152:155], v[128:131], v[8:11]
    ds_read_b64_tr_b16 v[196:197], v227 offset:49152
    ds_read_b64_tr_b16 v[198:199], v227 offset:51200
    v_mfma_f32_16x16x32_bf16 v[12:15], v[156:159], v[128:131], v[12:15]
    ds_read_b128 v[180:183], v225 offset:1024
    v_mfma_f32_16x16x32_bf16 v[16:19], v[160:163], v[128:131], v[16:19]
    ds_read_b64_tr_b16 v[200:201], v228 offset:49152
    ds_read_b64_tr_b16 v[202:203], v228 offset:51200
    v_mfma_f32_16x16x32_bf16 v[20:23], v[164:167], v[128:131], v[20:23]
    ds_read_b64_tr_b16 v[204:205], v229 offset:49152
    v_mfma_f32_16x16x32_bf16 v[24:27], v[168:171], v[128:131], v[24:27]
    ds_read_b64_tr_b16 v[206:207], v229 offset:51200
    ds_read_b64_tr_b16 v[208:209], v230 offset:49152
    v_mfma_f32_16x16x32_bf16 v[28:31], v[172:175], v[128:131], v[28:31]
    ds_read_b64_tr_b16 v[210:211], v230 offset:51200
    v_mfma_f32_16x16x32_bf16 v[32:35], v[144:147], v[132:135], v[32:35]
    ds_read_b64_tr_b16 v[212:213], v231 offset:49152
    v_mfma_f32_16x16x32_bf16 v[36:39], v[148:151], v[132:135], v[36:39]
    ds_read_b64_tr_b16 v[214:215], v231 offset:51200
    ds_read_b64_tr_b16 v[216:217], v232 offset:49152
    v_mfma_f32_16x16x32_bf16 v[40:43], v[152:155], v[132:135], v[40:43]
    ds_read_b64_tr_b16 v[218:219], v232 offset:51200
    v_mfma_f32_16x16x32_bf16 v[44:47], v[156:159], v[132:135], v[44:47]
    ds_read_b64_tr_b16 v[220:221], v233 offset:49152
    ds_read_b64_tr_b16 v[222:223], v233 offset:51200
    v_mfma_f32_16x16x32_bf16 v[48:51], v[160:163], v[132:135], v[48:51]
    ds_read_b128 v[184:187], v225 offset:4096
    v_mfma_f32_16x16x32_bf16 v[52:55], v[164:167], v[132:135], v[52:55]
    ds_read_b128 v[188:191], v225 offset:5120
    s_add_u32 s30, s41, s42
    v_mfma_f32_16x16x32_bf16 v[56:59], v[168:171], v[132:135], v[56:59]
    s_and_b32 s30, s30, 3
    v_mfma_f32_16x16x32_bf16 v[60:63], v[172:175], v[132:135], v[60:63]
    s_andn2_b32 s37, s41, 3
    v_mfma_f32_16x16x32_bf16 v[64:67], v[144:147], v[136:139], v[64:67]
    s_or_b32 s30, s30, s37
    s_add_u32 s41, s41, 1
    v_mfma_f32_16x16x32_bf16 v[68:71], v[148:151], v[136:139], v[68:71]
    s_mul_i32 s30, s30, s44
    v_mfma_f32_16x16x32_bf16 v[72:75], v[152:155], v[136:139], v[72:75]
    s_lshl_b32 s30, s30, 1
    s_add_u32 m0, s33, 32768
    v_mfma_f32_16x16x32_bf16 v[76:79], v[156:159], v[136:139], v[76:79]
    s_nop 0
    v_mfma_f32_16x16x32_bf16 v[80:83], v[160:163], v[136:139], v[80:83]
    buffer_load_dwordx4 v248, s[8:11], s30 offen offset:0 lds
    buffer_load_dwordx4 v249, s[8:11], s30 offen offset:1024 lds
    v_mfma_f32_16x16x32_bf16 v[84:87], v[164:167], v[136:139], v[84:87]
    s_add_u32 s30, s30, s44
    v_mfma_f32_16x16x32_bf16 v[88:91], v[168:171], v[136:139], v[88:91]
    s_add_u32 s35, s27, s32
    s_add_u32 m0, s35, 0x800
    v_mfma_f32_16x16x32_bf16 v[92:95], v[172:175], v[136:139], v[92:95]
    s_add_u32 s27, s27, 0x8000
    v_mfma_f32_16x16x32_bf16 v[96:99], v[144:147], v[140:143], v[96:99]
    buffer_load_dwordx4 v242, s[4:7], s31 offen offset:0 lds
    v_mfma_f32_16x16x32_bf16 v[100:103], v[148:151], v[140:143], v[100:103]
    buffer_load_dwordx4 v243, s[4:7], s31 offen offset:1024 lds
    s_cmp_ge_u32 s27, 0x28000
    v_mfma_f32_16x16x32_bf16 v[104:107], v[152:155], v[140:143], v[104:107]
    s_cselect_b32 s27, 0x10000, s27
    v_mfma_f32_16x16x32_bf16 v[108:111], v[156:159], v[140:143], v[108:111]
    s_add_u32 s36, s28, 0x8000
    s_cmp_ge_u32 s36, 0x18000
    v_mfma_f32_16x16x32_bf16 v[112:115], v[160:163], v[140:143], v[112:115]
    s_cselect_b32 s36, 0, s36
    v_mfma_f32_16x16x32_bf16 v[116:119], v[164:167], v[140:143], v[116:119]
    s_sub_u32 s29, s36, s28
    s_mov_b32 s28, s36
    v_mfma_f32_16x16x32_bf16 v[120:123], v[168:171], v[140:143], v[120:123]
    v_add_u32 v224, s29, v224
    v_mfma_f32_16x16x32_bf16 v[124:127], v[172:175], v[140:143], v[124:127]
    v_add_u32 v225, s29, v225
    s_mov_b32 s34, 6
K1_LOOP_12k:
    s_waitcnt vmcnt(8) lgkmcnt(0)
    s_barrier
    v_mfma_f32_16x16x32_bf16 v[0:3], v[192:195], v[176:179], v[0:3]
    ds_read_b128 v[128:131], v224 offset:0
    ds_read_b64_tr_b16 v[144:145], v226 offset:0
    v_mfma_f32_16x16x32_bf16 v[4:7], v[196:199], v[176:179], v[4:7]
    ds_read_b64_tr_b16 v[146:147], v226 offset:2048
    v_mfma_f32_16x16x32_bf16 v[8:11], v[200:203], v[176:179], v[8:11]
    ds_read_b64_tr_b16 v[148:149], v227 offset:0
    v_mfma_f32_16x16x32_bf16 v[12:15], v[204:207], v[176:179], v[12:15]
    ds_read_b64_tr_b16 v[150:151], v227 offset:2048
    v_mfma_f32_16x16x32_bf16 v[16:19], v[208:211], v[176:179], v[16:19]
    ds_read_b128 v[132:135], v224 offset:1024
    v_mfma_f32_16x16x32_bf16 v[20:23], v[212:215], v[176:179], v[20:23]
    ds_read_b64_tr_b16 v[152:153], v228 offset:0
    v_mfma_f32_16x16x32_bf16 v[24:27], v[216:219], v[176:179], v[24:27]
    ds_read_b64_tr_b16 v[154:155], v228 offset:2048
    v_mfma_f32_16x16x32_bf16 v[28:31], v[220:223], v[176:179], v[28:31]
    ds_read_b64_tr_b16 v[156:157], v229 offset:0
    v_mfma_f32_16x16x32_bf16 v[32:35], v[192:195], v[180:183], v[32:35]
    ds_read_b64_tr_b16 v[158:159], v229 offset:2048
    v_mfma_f32_16x16x32_bf16 v[36:39], v[196:199], v[180:183], v[36:39]
    ds_read_b64_tr_b16 v[160:161], v230 offset:0
    v_mfma_f32_16x16x32_bf16 v[40:43], v[200:203], v[180:183], v[40:43]
    ds_read_b64_tr_b16 v[162:163], v230 offset:2048
    v_mfma_f32_16x16x32_bf16 v[44:47], v[204:207], v[180:183], v[44:47]
    ds_read_b64_tr_b16 v[164:165], v231 offset:0
    v_mfma_f32_16x16x32_bf16 v[48:51], v[208:211], v[180:183], v[48:51]
    ds_read_b64_tr_b16 v[166:167], v231 offset:2048
    v_mfma_f32_16x16x32_bf16 v[52:55], v[212:215], v[180:183], v[52:55]
    ds_read_b64_tr_b16 v[168:169], v232 offset:0
    v_mfma_f32_16x16x32_bf16 v[56:59], v[216:219], v[180:183], v[56:59]
    ds_read_b64_tr_b16 v[170:171], v232 offset:2048
    v_mfma_f32_16x16x32_bf16 v[60:63], v[220:223], v[180:183], v[60:63]
    ds_read_b64_tr_b16 v[172:173], v233 offset:0
    v_mfma_f32_16x16x32_bf16 v[64:67], v[192:195], v[184:187], v[64:67]
    ds_read_b64_tr_b16 v[174:175], v233 offset:2048
    v_mfma_f32_16x16x32_bf16 v[68:71], v[196:199], v[184:187], v[68:71]
    ds_read_b128 v[136:139], v224 offset:4096
    v_mfma_f32_16x16x32_bf16 v[72:75], v[200:203], v[184:187], v[72:75]
    ds_read_b128 v[140:143], v224 offset:5120
    v_mfma_f32_16x16x32_bf16 v[76:79], v[204:207], v[184:187], v[76:79]
    s_add_u32 m0, s33, 49152
    v_mfma_f32_16x16x32_bf16 v[80:83], v[208:211], v[184:187], v[80:83]
    s_nop 0
    v_mfma_f32_16x16x32_bf16 v[84:87], v[212:215], v[184:187], v[84:87]
    buffer_load_dwordx4 v248, s[8:11], s30 offen offset:0 lds
    v_mfma_f32_16x16x32_bf16 v[88:91], v[216:219], v[184:187], v[88:91]
    buffer_load_dwordx4 v249, s[8:11], s30 offen offset:1024 lds
    v_mfma_f32_16x16x32_bf16 v[92:95], v[220:223], v[184:187], v[92:95]
    s_add_u32 s31, s40, s42
    v_mfma_f32_16x16x32_bf16 v[96:99], v[192:195], v[188:191], v[96:99]
    s_and_b32 s31, s31, 3
    v_mfma_f32_16x16x32_bf16 v[100:103], v[196:199], v[188:191], v[100:103]
    s_andn2_b32 s37, s40, 3
    v_mfma_f32_16x16x32_bf16 v[104:107], v[200:203], v[188:191], v[104:107]
    s_or_b32 s31, s31, s37
    v_mfma_f32_16x16x32_bf16 v[108:111], v[204:207], v[188:191], v[108:111]
    s_add_u32 s40, s40, 1
    v_mfma_f32_16x16x32_bf16 v[112:115], v[208:211], v[188:191], v[112:115]
    s_add_u32 m0, s27, s32
    v_mfma_f32_16x16x32_bf16 v[116:119], v[212:215], v[188:191], v[116:119]
    s_lshl_b32 s31, s31, 7
    v_mfma_f32_16x16x32_bf16 v[120:123], v[216:219], v[188:191], v[120:123]
    buffer_load_dwordx4 v240, s[4:7], s31 offen offset:0 lds
    v_mfma_f32_16x16x32_bf16 v[124:127], v[220:223], v[188:191], v[124:127]
    buffer_load_dwordx4 v241, s[4:7], s31 offen offset:1024 lds
    s_waitcnt vmcnt(10) lgkmcnt(0)
    s_barrier
    v_mfma_f32_16x16x32_bf16 v[0:3], v[144:147], v[128:131], v[0:3]
    ds_read_b128 v[176:179], v225 offset:0
    ds_read_b64_tr_b16 v[192:193], v226 offset:16384
    v_mfma_f32_16x16x32_bf16 v[4:7], v[148:151], v[128:131], v[4:7]
    ds_read_b64_tr_b16 v[194:195], v226 offset:18432
    v_mfma_f32_16x16x32_bf16 v[8:11], v[152:155], v[128:131], v[8:11]
    ds_read_b64_tr_b16 v[196:197], v227 offset:16384
    ds_read_b64_tr_b16 v[198:199], v227 offset:18432
    v_mfma_f32_16x16x32_bf16 v[12:15], v[156:159], v[128:131], v[12:15]
    ds_read_b128 v[180:183], v225 offset:1024
    v_mfma_f32_16x16x32_bf16 v[16:19], v[160:163], v[128:131], v[16:19]
    ds_read_b64_tr_b16 v[200:201], v228 offset:16384
    ds_read_b64_tr_b16 v[202:203], v228 offset:18432
    v_mfma_f32_16x16x32_bf16 v[20:23], v[164:167], v[128:131], v[20:23]
    ds_read_b64_tr_b16 v[204:205], v229 offset:16384
    v_mfma_f32_16x16x32_bf16 v[24:27], v[168:171], v[128:131], v[24:27]
    ds_read_b64_tr_b16 v[206:207], v229 offset:18432
    ds_read_b64_tr_b16 v[208:209], v230 offset:16384
    v_mfma_f32_16x16x32_bf16 v[28:31], v[172:175], v[128:131], v[28:31]
    ds_read_b64_tr_b16 v[210:211], v230 offset:18432
    v_mfma_f32_16x16x32_bf16 v[32:35], v[144:147], v[132:135], v[32:35]
    ds_read_b64_tr_b16 v[212:213], v231 offset:16384
    v_mfma_f32_16x16x32_bf16 v[36:39], v[148:151], v[132:135], v[36:39]
    ds_read_b64_tr_b16 v[214:215], v231 offset:18432
    ds_read_b64_tr_b16 v[216:217], v232 offset:16384
    v_mfma_f32_16x16x32_bf16 v[40:43], v[152:155], v[132:135], v[40:43]
    ds_read_b64_tr_b16 v[218:219], v232 offset:18432
    v_mfma_f32_16x16x32_bf16 v[44:47], v[156:159], v[132:135], v[44:47]
    ds_read_b64_tr_b16 v[220:221], v233 offset:16384
    ds_read_b64_tr_b16 v[222:223], v233 offset:18432
    v_mfma_f32_16x16x32_bf16 v[48:51], v[160:163], v[132:135], v[48:51]
    ds_read_b128 v[184:187], v225 offset:4096
    v_mfma_f32_16x16x32_bf16 v[52:55], v[164:167], v[132:135], v[52:55]
    ds_read_b128 v[188:191], v225 offset:5120
    s_add_u32 s30, s41, s42
    v_mfma_f32_16x16x32_bf16 v[56:59], v[168:171], v[132:135], v[56:59]
    s_and_b32 s30, s30, 3
    v_mfma_f32_16x16x32_bf16 v[60:63], v[172:175], v[132:135], v[60:63]
    s_andn2_b32 s37, s41, 3
    v_mfma_f32_16x16x32_bf16 v[64:67], v[144:147], v[136:139], v[64:67]
    s_or_b32 s30, s30, s37
    s_add_u32 s41, s41, 1
    v_mfma_f32_16x16x32_bf16 v[68:71], v[148:151], v[136:139], v[68:71]
    s_mul_i32 s30, s30, s44
    v_mfma_f32_16x16x32_bf16 v[72:75], v[152:155], v[136:139], v[72:75]
    s_lshl_b32 s30, s30, 1
    s_add_u32 m0, s33, 0
    v_mfma_f32_16x16x32_bf16 v[76:79], v[156:159], v[136:139], v[76:79]
    s_nop 0
    v_mfma_f32_16x16x32_bf16 v[80:83], v[160:163], v[136:139], v[80:83]
    buffer_load_dwordx4 v248, s[8:11], s30 offen offset:0 lds
    buffer_load_dwordx4 v249, s[8:11], s30 offen offset:1024 lds
    v_mfma_f32_16x16x32_bf16 v[84:87], v[164:167], v[136:139], v[84:87]
    s_add_u32 s30, s30, s44
    v_mfma_f32_16x16x32_bf16 v[88:91], v[168:171], v[136:139], v[88:91]
    s_add_u32 s35, s27, s32
    s_add_u32 m0, s35, 0x800
    v_mfma_f32_16x16x32_bf16 v[92:95], v[172:175], v[136:139], v[92:95]
    s_add_u32 s27, s27, 0x8000
    v_mfma_f32_16x16x32_bf16 v[96:99], v[144:147], v[140:143], v[96:99]
    buffer_load_dwordx4 v242, s[4:7], s31 offen offset:0 lds
    v_mfma_f32_16x16x32_bf16 v[100:103], v[148:151], v[140:143], v[100:103]
    buffer_load_dwordx4 v243, s[4:7], s31 offen offset:1024 lds
    s_cmp_ge_u32 s27, 0x28000
    v_mfma_f32_16x16x32_bf16 v[104:107], v[152:155], v[140:143], v[104:107]
    s_cselect_b32 s27, 0x10000, s27
    v_mfma_f32_16x16x32_bf16 v[108:111], v[156:159], v[140:143], v[108:111]
    s_add_u32 s36, s28, 0x8000
    s_cmp_ge_u32 s36, 0x18000
    v_mfma_f32_16x16x32_bf16 v[112:115], v[160:163], v[140:143], v[112:115]
    s_cselect_b32 s36, 0, s36
    v_mfma_f32_16x16x32_bf16 v[116:119], v[164:167], v[140:143], v[116:119]
    s_sub_u32 s29, s36, s28
    s_mov_b32 s28, s36
    v_mfma_f32_16x16x32_bf16 v[120:123], v[168:171], v[140:143], v[120:123]
    v_add_u32 v224, s29, v224
    v_mfma_f32_16x16x32_bf16 v[124:127], v[172:175], v[140:143], v[124:127]
    v_add_u32 v225, s29, v225
    s_waitcnt vmcnt(8) lgkmcnt(0)
    s_barrier
    v_mfma_f32_16x16x32_bf16 v[0:3], v[192:195], v[176:179], v[0:3]
    ds_read_b128 v[128:131], v224 offset:0
    ds_read_b64_tr_b16 v[144:145], v226 offset:32768
    v_mfma_f32_16x16x32_bf16 v[4:7], v[196:199], v[176:179], v[4:7]
    ds_read_b64_tr_b16 v[146:147], v226 offset:34816
    v_mfma_f32_16x16x32_bf16 v[8:11], v[200:203], v[176:179], v[8:11]
    ds_read_b64_tr_b16 v[148:149], v227 offset:32768
    v_mfma_f32_16x16x32_bf16 v[12:15], v[204:207], v[176:179], v[12:15]
    ds_read_b64_tr_b16 v[150:151], v227 offset:34816
    v_mfma_f32_16x16x32_bf16 v[16:19], v[208:211], v[176:179], v[16:19]
    ds_read_b128 v[132:135], v224 offset:1024
    v_mfma_f32_16x16x32_bf16 v[20:23], v[212:215], v[176:179], v[20:23]
    ds_read_b64_tr_b16 v[152:153], v228 offset:32768
    v_mfma_f32_16x16x32_bf16 v[24:27], v[216:219], v[176:179], v[24:27]
    ds_read_b64_tr_b16 v[154:155], v228 offset:34816
    v_mfma_f32_16x16x32_bf16 v[28:31], v[220:223], v[176:179], v[28:31]
    ds_read_b64_tr_b16 v[156:157], v229 offset:32768
    v_mfma_f32_16x16x32_bf16 v[32:35], v[192:195], v[180:183], v[32:35]
    ds_read_b64_tr_b16 v[158:159], v229 offset:34816
    v_mfma_f32_16x16x32_bf16 v[36:39], v[196:199], v[180:183], v[36:39]
    ds_read_b64_tr_b16 v[160:161], v230 offset:32768
    v_mfma_f32_16x16x32_bf16 v[40:43], v[200:203], v[180:183], v[40:43]
    ds_read_b64_tr_b16 v[162:163], v230 offset:34816
    v_mfma_f32_16x16x32_bf16 v[44:47], v[204:207], v[180:183], v[44:47]
    ds_read_b64_tr_b16 v[164:165], v231 offset:32768
    v_mfma_f32_16x16x32_bf16 v[48:51], v[208:211], v[180:183], v[48:51]
    ds_read_b64_tr_b16 v[166:167], v231 offset:34816
    v_mfma_f32_16x16x32_bf16 v[52:55], v[212:215], v[180:183], v[52:55]
    ds_read_b64_tr_b16 v[168:169], v232 offset:32768
    v_mfma_f32_16x16x32_bf16 v[56:59], v[216:219], v[180:183], v[56:59]
    ds_read_b64_tr_b16 v[170:171], v232 offset:34816
    v_mfma_f32_16x16x32_bf16 v[60:63], v[220:223], v[180:183], v[60:63]
    ds_read_b64_tr_b16 v[172:173], v233 offset:32768
    v_mfma_f32_16x16x32_bf16 v[64:67], v[192:195], v[184:187], v[64:67]
    ds_read_b64_tr_b16 v[174:175], v233 offset:34816
    v_mfma_f32_16x16x32_bf16 v[68:71], v[196:199], v[184:187], v[68:71]
    ds_read_b128 v[136:139], v224 offset:4096
    v_mfma_f32_16x16x32_bf16 v[72:75], v[200:203], v[184:187], v[72:75]
    ds_read_b128 v[140:143], v224 offset:5120
    v_mfma_f32_16x16x32_bf16 v[76:79], v[204:207], v[184:187], v[76:79]
    s_add_u32 m0, s33, 16384
    v_mfma_f32_16x16x32_bf16 v[80:83], v[208:211], v[184:187], v[80:83]
    s_nop 0
    v_mfma_f32_16x16x32_bf16 v[84:87], v[212:215], v[184:187], v[84:87]
    buffer_load_dwordx4 v248, s[8:11], s30 offen offset:0 lds
    v_mfma_f32_16x16x32_bf16 v[88:91], v[216:219], v[184:187], v[88:91]
    buffer_load_dwordx4 v249, s[8:11], s30 offen offset:1024 lds
    v_mfma_f32_16x16x32_bf16 v[92:95], v[220:223], v[184:187], v[92:95]
    s_add_u32 s31, s40, s42
    v_mfma_f32_16x16x32_bf16 v[96:99], v[192:195], v[188:191], v[96:99]
    s_and_b32 s31, s31, 3
    v_mfma_f32_16x16x32_bf16 v[100:103], v[196:199], v[188:191], v[100:103]
    s_andn2_b32 s37, s40, 3
    v_mfma_f32_16x16x32_bf16 v[104:107], v[200:203], v[188:191], v[104:107]
    s_or_b32 s31, s31, s37
    v_mfma_f32_16x16x32_bf16 v[108:111], v[204:207], v[188:191], v[108:111]
    s_add_u32 s40, s40, 1
    v_mfma_f32_16x16x32_bf16 v[112:115], v[208:211], v[188:191], v[112:115]
    s_add_u32 m0, s27, s32
    v_mfma_f32_16x16x32_bf16 v[116:119], v[212:215], v[188:191], v[116:119]
    s_lshl_b32 s31, s31, 7
    v_mfma_f32_16x16x32_bf16 v[120:123], v[216:219], v[188:191], v[120:123]
    buffer_load_dwordx4 v240, s[4:7], s31 offen offset:0 lds
    v_mfma_f32_16x16x32_bf16 v[124:127], v[220:223], v[188:191], v[124:127]
    buffer_load_dwordx4 v241, s[4:7], s31 offen offset:1024 lds
    s_waitcnt vmcnt(10) lgkmcnt(0)
    s_barrier
    v_mfma_f32_16x16x32_bf16 v[0:3], v[144:147], v[128:131], v[0:3]
    ds_read_b128 v[176:179], v225 offset:0
    ds_read_b64_tr_b16 v[192:193], v226 offset:49152
    v_mfma_f32_16x16x32_bf16 v[4:7], v[148:151], v[128:131], v[4:7]
    ds_read_b64_tr_b16 v[194:195], v226 offset:51200
    v_mfma_f32_16x16x32_bf16 v[8:11], v[152:155], v[128:131], v[8:11]
    ds_read_b64_tr_b16 v[196:197], v227 offset:49152
    ds_read_b64_tr_b16 v[198:199], v227 offset:51200
    v_mfma_f32_16x16x32_bf16 v[12:15], v[156:159], v[128:131], v[12:15]
    ds_read_b128 v[180:183], v225 offset:1024
    v_mfma_f32_16x16x32_bf16 v[16:19], v[160:163], v[128:131], v[16:19]
    ds_read_b64_tr_b16 v[200:201], v228 offset:49152
    ds_read_b64_tr_b16 v[202:203], v228 offset:51200
    v_mfma_f32_16x16x32_bf16 v[20:23], v[164:167], v[128:131], v[20:23]
    ds_read_b64_tr_b16 v[204:205], v229 offset:49152
    v_mfma_f32_16x16x32_bf16 v[24:27], v[168:171], v[128:131], v[24:27]
    ds_read_b64_tr_b16 v[206:207], v229 offset:51200
    ds_read_b64_tr_b16 v[208:209], v230 offset:49152
    v_mfma_f32_16x16x32_bf16 v[28:31], v[172:175], v[128:131], v[28:31]
    ds_read_b64_tr_b16 v[210:211], v230 offset:51200
    v_mfma_f32_16x16x32_bf16 v[32:35], v[144:147], v[132:135], v[32:35]
    ds_read_b64_tr_b16 v[212:213], v231 offset:49152
    v_mfma_f32_16x16x32_bf16 v[36:39], v[148:151], v[132:135], v[36:39]
    ds_read_b64_tr_b16 v[214:215], v231 offset:51200
    ds_read_b64_tr_b16 v[216:217], v232 offset:49152
    v_mfma_f32_16x16x32_bf16 v[40:43], v[152:155], v[132:135], v[40:43]
    ds_read_b64_tr_b16 v[218:219], v232 offset:51200
    v_mfma_f32_16x16x32_bf16 v[44:47], v[156:159], v[132:135], v[44:47]
    ds_read_b64_tr_b16 v[220:221], v233 offset:49152
    ds_read_b64_tr_b16 v[222:223], v233 offset:51200
    v_mfma_f32_16x16x32_bf16 v[48:51], v[160:163], v[132:135], v[48:51]
    ds_read_b128 v[184:187], v225 offset:4096
    v_mfma_f32_16x16x32_bf16 v[52:55], v[164:167], v[132:135], v[52:55]
    ds_read_b128 v[188:191], v225 offset:5120
    s_add_u32 s30, s41, s42
    v_mfma_f32_16x16x32_bf16 v[56:59], v[168:171], v[132:135], v[56:59]
    s_and_b32 s30, s30, 3
    v_mfma_f32_16x16x32_bf16 v[60:63], v[172:175], v[132:135], v[60:63]
    s_andn2_b32 s37, s41, 3
    v_mfma_f32_16x16x32_bf16 v[64:67], v[144:147], v[136:139], v[64:67]
    s_or_b32 s30, s30, s37
    s_add_u32 s41, s41, 1
    v_mfma_f32_16x16x32_bf16 v[68:71], v[148:151], v[136:139], v[68:71]
    s_mul_i32 s30, s30, s44
    v_mfma_f32_16x16x32_bf16 v[72:75], v[152:155], v[136:139], v[72:75]
    s_lshl_b32 s30, s30, 1
    s_add_u32 m0, s33, 32768
    v_mfma_f32_16x16x32_bf16 v[76:79], v[156:159], v[136:139], v[76:79]
    s_nop 0
    v_mfma_f32_16x16x32_bf16 v[80:83], v[160:163], v[136:139], v[80:83]
    buffer_load_dwordx4 v248, s[8:11], s30 offen offset:0 lds
    buffer_load_dwordx4 v249, s[8:11], s30 offen offset:1024 lds
    v_mfma_f32_16x16x32_bf16 v[84:87], v[164:167], v[136:139], v[84:87]
    s_add_u32 s30, s30, s44
    v_mfma_f32_16x16x32_bf16 v[88:91], v[168:171], v[136:139], v[88:91]
    s_add_u32 s35, s27, s32
    s_add_u32 m0, s35, 0x800
    v_mfma_f32_16x16x32_bf16 v[92:95], v[172:175], v[136:139], v[92:95]
    s_add_u32 s27, s27, 0x8000
    v_mfma_f32_16x16x32_bf16 v[96:99], v[144:147], v[140:143], v[96:99]
    buffer_load_dwordx4 v242, s[4:7], s31 offen offset:0 lds
    v_mfma_f32_16x16x32_bf16 v[100:103], v[148:151], v[140:143], v[100:103]
    buffer_load_dwordx4 v243, s[4:7], s31 offen offset:1024 lds
    s_cmp_ge_u32 s27, 0x28000
    v_mfma_f32_16x16x32_bf16 v[104:107], v[152:155], v[140:143], v[104:107]
    s_cselect_b32 s27, 0x10000, s27
    v_mfma_f32_16x16x32_bf16 v[108:111], v[156:159], v[140:143], v[108:111]
    s_add_u32 s36, s28, 0x8000
    s_cmp_ge_u32 s36, 0x18000
    v_mfma_f32_16x16x32_bf16 v[112:115], v[160:163], v[140:143], v[112:115]
    s_cselect_b32 s36, 0, s36
    v_mfma_f32_16x16x32_bf16 v[116:119], v[164:167], v[140:143], v[116:119]
    s_sub_u32 s29, s36, s28
    s_mov_b32 s28, s36
    v_mfma_f32_16x16x32_bf16 v[120:123], v[168:171], v[140:143], v[120:123]
    v_add_u32 v224, s29, v224
    v_mfma_f32_16x16x32_bf16 v[124:127], v[172:175], v[140:143], v[124:127]
    v_add_u32 v225, s29, v225
    s_sub_u32 s34, s34, 1
    s_cmp_lg_u32 s34, 0
    s_cbranch_scc1 K1_LOOP_12k
    s_waitcnt vmcnt(8) lgkmcnt(0)
    s_barrier
    v_mfma_f32_16x16x32_bf16 v[0:3], v[192:195], v[176:179], v[0:3]
    ds_read_b128 v[128:131], v224 offset:0
    ds_read_b64_tr_b16 v[144:145], v226 offset:0
    v_mfma_f32_16x16x32_bf16 v[4:7], v[196:199], v[176:179], v[4:7]
    ds_read_b64_tr_b16 v[146:147], v226 offset:2048
    v_mfma_f32_16x16x32_bf16 v[8:11], v[200:203], v[176:179], v[8:11]
    ds_read_b64_tr_b16 v[148:149], v227 offset:0
    v_mfma_f32_16x16x32_bf16 v[12:15], v[204:207], v[176:179], v[12:15]
    ds_read_b64_tr_b16 v[150:151], v227 offset:2048
    v_mfma_f32_16x16x32_bf16 v[16:19], v[208:211], v[176:179], v[16:19]
    ds_read_b128 v[132:135], v224 offset:1024
    v_mfma_f32_16x16x32_bf16 v[20:23], v[212:215], v[176:179], v[20:23]
    ds_read_b64_tr_b16 v[152:153], v228 offset:0
    v_mfma_f32_16x16x32_bf16 v[24:27], v[216:219], v[176:179], v[24:27]
    ds_read_b64_tr_b16 v[154:155], v228 offset:2048
    v_mfma_f32_16x16x32_bf16 v[28:31], v[220:223], v[176:179], v[28:31]
    ds_read_b64_tr_b16 v[156:157], v229 offset:0
    v_mfma_f32_16x16x32_bf16 v[32:35], v[192:195], v[180:183], v[32:35]
    ds_read_b64_tr_b16 v[158:159], v229 offset:2048
    v_mfma_f32_16x16x32_bf16 v[36:39], v[196:199], v[180:183], v[36:39]
    ds_read_b64_tr_b16 v[160:161], v230 offset:0
    v_mfma_f32_16x16x32_bf16 v[40:43], v[200:203], v[180:183], v[40:43]
    ds_read_b64_tr_b16 v[162:163], v230 offset:2048
    v_mfma_f32_16x16x32_bf16 v[44:47], v[204:207], v[180:183], v[44:47]
    ds_read_b64_tr_b16 v[164:165], v231 offset:0
    v_mfma_f32_16x16x32_bf16 v[48:51], v[208:211], v[180:183], v[48:51]
    ds_read_b64_tr_b16 v[166:167], v231 offset:2048
    v_mfma_f32_16x16x32_bf16 v[52:55], v[212:215], v[180:183], v[52:55]
    ds_read_b64_tr_b16 v[168:169], v232 offset:0
    v_mfma_f32_16x16x32_bf16 v[56:59], v[216:219], v[180:183], v[56:59]
    ds_read_b64_tr_b16 v[170:171], v232 offset:2048
    v_mfma_f32_16x16x32_bf16 v[60:63], v[220:223], v[180:183], v[60:63]
    ds_read_b64_tr_b16 v[172:173], v233 offset:0
    v_mfma_f32_16x16x32_bf16 v[64:67], v[192:195], v[184:187], v[64:67]
    ds_read_b64_tr_b16 v[174:175], v233 offset:2048
    ds_read_b128 v[136:139], v224 offset:4096
    v_mfma_f32_16x16x32_bf16 v[68:71], v[196:199], v[184:187], v[68:71]
    ds_read_b128 v[140:143], v224 offset:5120
    v_mfma_f32_16x16x32_bf16 v[72:75], v[200:203], v[184:187], v[72:75]
    s_add_u32 m0, s33, 49152
    v_mfma_f32_16x16x32_bf16 v[76:79], v[204:207], v[184:187], v[76:79]
    s_nop 0
    v_mfma_f32_16x16x32_bf16 v[80:83], v[208:211], v[184:187], v[80:83]
    buffer_load_dwordx4 v248, s[8:11], s30 offen offset:0 lds
    v_mfma_f32_16x16x32_bf16 v[84:87], v[212:215], v[184:187], v[84:87]
    buffer_load_dwordx4 v249, s[8:11], s30 offen offset:1024 lds
    v_mfma_f32_16x16x32_bf16 v[88:91], v[216:219], v[184:187], v[88:91]
    s_mov_b32 s40, 0
    v_mfma_f32_16x16x32_bf16 v[92:95], v[220:223], v[184:187], v[92:95]
    s_add_u32 s31, s40, s43
    v_mfma_f32_16x16x32_bf16 v[96:99], v[192:195], v[188:191], v[96:99]
    s_sub_u32 s37, s31, 7
    v_mfma_f32_16x16x32_bf16 v[100:103], v[196:199], v[188:191], v[100:103]
    s_cmp_ge_u32 s31, 7
    v_mfma_f32_16x16x32_bf16 v[104:107], v[200:203], v[188:191], v[104:107]
    s_cselect_b32 s31, s37, s31
    v_mfma_f32_16x16x32_bf16 v[108:111], v[204:207], v[188:191], v[108:111]
    s_add_u32 s40, s40, 1
    v_mfma_f32_16x16x32_bf16 v[112:115], v[208:211], v[188:191], v[112:115]
    s_add_u32 m0, s27, s32
    v_mfma_f32_16x16x32_bf16 v[116:119], v[212:215], v[188:191], v[116:119]
    s_lshl_b32 s31, s31, 7
    v_mfma_f32_16x16x32_bf16 v[120:123], v[216:219], v[188:191], v[120:123]
    buffer_load_dwordx4 v244, s[12:15], s31 offen offset:0 lds
    v_mfma_f32_16x16x32_bf16 v[124:127], v[220:223], v[188:191], v[124:127]
    buffer_load_dwordx4 v245, s[12:15], s31 offen offset:1024 lds
    s_waitcnt vmcnt(10) lgkmcnt(0)
    s_barrier
    v_mfma_f32_16x16x32_bf16 v[0:3], v[144:147], v[128:131], v[0:3]
    ds_read_b128 v[176:179], v225 offset:0
    ds_read_b64_tr_b16 v[192:193], v226 offset:16384
    v_mfma_f32_16x16x32_bf16 v[4:7], v[148:151], v[128:131], v[4:7]
    ds_read_b64_tr_b16 v[194:195], v226 offset:18432
    v_mfma_f32_16x16x32_bf16 v[8:11], v[152:155], v[128:131], v[8:11]
    ds_read_b64_tr_b16 v[196:197], v227 offset:16384
    ds_read_b64_tr_b16 v[198:199], v227 offset:18432
    v_mfma_f32_16x16x32_bf16 v[12:15], v[156:159], v[128:131], v[12:15]
    ds_read_b128 v[180:183], v225 offset:1024
    v_mfma_f32_16x16x32_bf16 v[16:19], v[160:163], v[128:131], v[16:19]
    ds_read_b64_tr_b16 v[200:201], v228 offset:16384
    ds_read_b64_tr_b16 v[202:203], v228 offset:18432
    v_mfma_f32_16x16x32_bf16 v[20:23], v[164:167], v[128:131], v[20:23]
    ds_read_b64_tr_b16 v[204:205], v229 offset:16384
    v_mfma_f32_16x16x32_bf16 v[24:27], v[168:171], v[128:131], v[24:27]
    ds_read_b64_tr_b16 v[206:207], v229 offset:18432
    ds_read_b64_tr_b16 v[208:209], v230 offset:16384
    v_mfma_f32_16x16x32_bf16 v[28:31], v[172:175], v[128:131], v[28:31]
    ds_read_b64_tr_b16 v[210:211], v230 offset:18432
    v_mfma_f32_16x16x32_bf16 v[32:35], v[144:147], v[132:135], v[32:35]
    ds_read_b64_tr_b16 v[212:213], v231 offset:16384
    ds_read_b64_tr_b16 v[214:215], v231 offset:18432
    v_mfma_f32_16x16x32_bf16 v[36:39], v[148:151], v[132:135], v[36:39]
    ds_read_b64_tr_b16 v[216:217], v232 offset:16384
    v_mfma_f32_16x16x32_bf16 v[40:43], v[152:155], v[132:135], v[40:43]
    ds_read_b64_tr_b16 v[218:219], v232 offset:18432
    ds_read_b64_tr_b16 v[220:221], v233 offset:16384
    v_mfma_f32_16x16x32_bf16 v[44:47], v[156:159], v[132:135], v[44:47]
    ds_read_b64_tr_b16 v[222:223], v233 offset:18432
    v_mfma_f32_16x16x32_bf16 v[48:51], v[160:163], v[132:135], v[48:51]
    ds_read_b128 v[184:187], v225 offset:4096
    ds_read_b128 v[188:191], v225 offset:5120
    v_mfma_f32_16x16x32_bf16 v[52:55], v[164:167], v[132:135], v[52:55]
    s_mov_b32 s41, 0
    v_mfma_f32_16x16x32_bf16 v[56:59], v[168:171], v[132:135], v[56:59]
    s_add_u32 s30, s41, s43
    s_sub_u32 s37, s30, 7
    v_mfma_f32_16x16x32_bf16 v[60:63], v[172:175], v[132:135], v[60:63]
    s_cmp_ge_u32 s30, 7
    v_mfma_f32_16x16x32_bf16 v[64:67], v[144:147], v[136:139], v[64:67]
    s_cselect_b32 s30, s37, s30
    v_mfma_f32_16x16x32_bf16 v[68:71], v[148:151], v[136:139], v[68:71]
    s_add_u32 s41, s41, 1
    s_mul_i32 s30, s30, s45
    v_mfma_f32_16x16x32_bf16 v[72:75], v[152:155], v[136:139], v[72:75]
    s_lshl_b32 s30, s30, 1
    v_mfma_f32_16x16x32_bf16 v[76:79], v[156:159], v[136:139], v[76:79]
    s_add_u32 m0, s33, 0
    s_nop 0
    v_mfma_f32_16x16x32_bf16 v[80:83], v[160:163], v[136:139], v[80:83]
    buffer_load_dwordx4 v250, s[16:19], s30 offen offset:0 lds
    v_mfma_f32_16x16x32_bf16 v[84:87], v[164:167], v[136:139], v[84:87]
    buffer_load_dwordx4 v251, s[16:19], s30 offen offset:1024 lds
    s_add_u32 s30, s30, s45
    v_mfma_f32_16x16x32_bf16 v[88:91], v[168:171], v[136:139], v[88:91]
    s_add_u32 s35, s27, s32
    v_mfma_f32_16x16x32_bf16 v[92:95], v[172:175], v[136:139], v[92:95]
    s_add_u32 m0, s35, 0x800
    s_add_u32 s27, s27, 0x8000
    v_mfma_f32_16x16x32_bf16 v[96:99], v[144:147], v[140:143], v[96:99]
    buffer_load_dwordx4 v246, s[12:15], s31 offen offset:0 lds
    v_mfma_f32_16x16x32_bf16 v[100:103], v[148:151], v[140:143], v[100:103]
    buffer_load_dwordx4 v247, s[12:15], s31 offen offset:1024 lds
    s_cmp_ge_u32 s27, 0x28000
    v_mfma_f32_16x16x32_bf16 v[104:107], v[152:155], v[140:143], v[104:107]
    s_cselect_b32 s27, 0x10000, s27
    v_mfma_f32_16x16x32_bf16 v[108:111], v[156:159], v[140:143], v[108:111]
    s_add_u32 s36, s28, 0x8000
    s_cmp_ge_u32 s36, 0x18000
    v_mfma_f32_16x16x32_bf16 v[112:115], v[160:163], v[140:143], v[112:115]
    s_cselect_b32 s36, 0, s36
    v_mfma_f32_16x16x32_bf16 v[116:119], v[164:167], v[140:143], v[116:119]
    s_sub_u32 s29, s36, s28
    s_mov_b32 s28, s36
    v_mfma_f32_16x16x32_bf16 v[120:123], v[168:171], v[140:143], v[120:123]
    v_add_u32 v224, s29, v224
    v_mfma_f32_16x16x32_bf16 v[124:127], v[172:175], v[140:143], v[124:127]
    v_add_u32 v225, s29, v225
    s_waitcnt vmcnt(8) lgkmcnt(0)
    s_barrier
    v_mfma_f32_16x16x32_bf16 v[0:3], v[192:195], v[176:179], v[0:3]
    ds_read_b128 v[128:131], v224 offset:0
    ds_read_b64_tr_b16 v[144:145], v226 offset:32768
    v_mfma_f32_16x16x32_bf16 v[4:7], v[196:199], v[176:179], v[4:7]
    ds_read_b64_tr_b16 v[146:147], v226 offset:34816
    v_mfma_f32_16x16x32_bf16 v[8:11], v[200:203], v[176:179], v[8:11]
    ds_read_b64_tr_b16 v[148:149], v227 offset:32768
    v_mfma_f32_16x16x32_bf16 v[12:15], v[204:207], v[176:179], v[12:15]
    ds_read_b64_tr_b16 v[150:151], v227 offset:34816
    v_mfma_f32_16x16x32_bf16 v[16:19], v[208:211], v[176:179], v[16:19]
    ds_read_b128 v[132:135], v224 offset:1024
    v_mfma_f32_16x16x32_bf16 v[20:23], v[212:215], v[176:179], v[20:23]
    ds_read_b64_tr_b16 v[152:153], v228 offset:32768
    v_mfma_f32_16x16x32_bf16 v[24:27], v[216:219], v[176:179], v[24:27]
    ds_read_b64_tr_b16 v[154:155], v228 offset:34816
    v_mfma_f32_16x16x32_bf16 v[28:31], v[220:223], v[176:179], v[28:31]
    ds_read_b64_tr_b16 v[156:157], v229 offset:32768
    v_mfma_f32_16x16x32_bf16 v[32:35], v[192:195], v[180:183], v[32:35]
    ds_read_b64_tr_b16 v[158:159], v229 offset:34816
    v_mfma_f32_16x16x32_bf16 v[36:39], v[196:199], v[180:183], v[36:39]
    ds_read_b64_tr_b16 v[160:161], v230 offset:32768
    v_mfma_f32_16x16x32_bf16 v[40:43], v[200:203], v[180:183], v[40:43]
    ds_read_b64_tr_b16 v[162:163], v230 offset:34816
    v_mfma_f32_16x16x32_bf16 v[44:47], v[204:207], v[180:183], v[44:47]
    ds_read_b64_tr_b16 v[164:165], v231 offset:32768
    v_mfma_f32_16x16x32_bf16 v[48:51], v[208:211], v[180:183], v[48:51]
    ds_read_b64_tr_b16 v[166:167], v231 offset:34816
    v_mfma_f32_16x16x32_bf16 v[52:55], v[212:215], v[180:183], v[52:55]
    ds_read_b64_tr_b16 v[168:169], v232 offset:32768
    v_mfma_f32_16x16x32_bf16 v[56:59], v[216:219], v[180:183], v[56:59]
    ds_read_b64_tr_b16 v[170:171], v232 offset:34816
    v_mfma_f32_16x16x32_bf16 v[60:63], v[220:223], v[180:183], v[60:63]
    ds_read_b64_tr_b16 v[172:173], v233 offset:32768
    v_mfma_f32_16x16x32_bf16 v[64:67], v[192:195], v[184:187], v[64:67]
    ds_read_b64_tr_b16 v[174:175], v233 offset:34816
    v_mfma_f32_16x16x32_bf16 v[68:71], v[196:199], v[184:187], v[68:71]
    ds_read_b128 v[136:139], v224 offset:4096
    v_mfma_f32_16x16x32_bf16 v[72:75], v[200:203], v[184:187], v[72:75]
    ds_read_b128 v[140:143], v224 offset:5120
    v_mfma_f32_16x16x32_bf16 v[76:79], v[204:207], v[184:187], v[76:79]
    s_add_u32 m0, s33, 16384
    v_mfma_f32_16x16x32_bf16 v[80:83], v[208:211], v[184:187], v[80:83]
    s_nop 0
    v_mfma_f32_16x16x32_bf16 v[84:87], v[212:215], v[184:187], v[84:87]
    buffer_load_dwordx4 v250, s[16:19], s30 offen offset:0 lds
    v_mfma_f32_16x16x32_bf16 v[88:91], v[216:219], v[184:187], v[88:91]
    buffer_load_dwordx4 v251, s[16:19], s30 offen offset:1024 lds
    v_mfma_f32_16x16x32_bf16 v[92:95], v[220:223], v[184:187], v[92:95]
    s_add_u32 s31, s40, s43
    v_mfma_f32_16x16x32_bf16 v[96:99], v[192:195], v[188:191], v[96:99]
    s_sub_u32 s37, s31, 7
    v_mfma_f32_16x16x32_bf16 v[100:103], v[196:199], v[188:191], v[100:103]
    s_cmp_ge_u32 s31, 7
    v_mfma_f32_16x16x32_bf16 v[104:107], v[200:203], v[188:191], v[104:107]
    s_cselect_b32 s31, s37, s31
    v_mfma_f32_16x16x32_bf16 v[108:111], v[204:207], v[188:191], v[108:111]
    s_add_u32 s40, s40, 1
    v_mfma_f32_16x16x32_bf16 v[112:115], v[208:211], v[188:191], v[112:115]
    s_add_u32 m0, s27, s32
    v_mfma_f32_16x16x32_bf16 v[116:119], v[212:215], v[188:191], v[116:119]
    s_lshl_b32 s31, s31, 7
    v_mfma_f32_16x16x32_bf16 v[120:123], v[216:219], v[188:191], v[120:123]
    buffer_load_dwordx4 v244, s[12:15], s31 offen offset:0 lds
    v_mfma_f32_16x16x32_bf16 v[124:127], v[220:223], v[188:191], v[124:127]
    buffer_load_dwordx4 v245, s[12:15], s31 offen offset:1024 lds
    s_waitcnt vmcnt(10) lgkmcnt(0)
    s_barrier
    v_mfma_f32_16x16x32_bf16 v[0:3], v[144:147], v[128:131], v[0:3]
    ds_read_b128 v[176:179], v225 offset:0
    ds_read_b64_tr_b16 v[192:193], v226 offset:49152
    v_mfma_f32_16x16x32_bf16 v[4:7], v[148:151], v[128:131], v[4:7]
    ds_read_b64_tr_b16 v[194:195], v226 offset:51200
    v_mfma_f32_16x16x32_bf16 v[8:11], v[152:155], v[128:131], v[8:11]
    ds_read_b64_tr_b16 v[196:197], v227 offset:49152
    ds_read_b64_tr_b16 v[198:199], v227 offset:51200
    v_mfma_f32_16x16x32_bf16 v[12:15], v[156:159], v[128:131], v[12:15]
    ds_read_b128 v[180:183], v225 offset:1024
    v_mfma_f32_16x16x32_bf16 v[16:19], v[160:163], v[128:131], v[16:19]
    ds_read_b64_tr_b16 v[200:201], v228 offset:49152
    ds_read_b64_tr_b16 v[202:203], v228 offset:51200
    v_mfma_f32_16x16x32_bf16 v[20:23], v[164:167], v[128:131], v[20:23]
    ds_read_b64_tr_b16 v[204:205], v229 offset:49152
    v_mfma_f32_16x16x32_bf16 v[24:27], v[168:171], v[128:131], v[24:27]
    ds_read_b64_tr_b16 v[206:207], v229 offset:51200
    ds_read_b64_tr_b16 v[208:209], v230 offset:49152
    v_mfma_f32_16x16x32_bf16 v[28:31], v[172:175], v[128:131], v[28:31]
    ds_read_b64_tr_b16 v[210:211], v230 offset:51200
    v_mfma_f32_16x16x32_bf16 v[32:35], v[144:147], v[132:135], v[32:35]
    ds_read_b64_tr_b16 v[212:213], v231 offset:49152
    v_mfma_f32_16x16x32_bf16 v[36:39], v[148:151], v[132:135], v[36:39]
    ds_read_b64_tr_b16 v[214:215], v231 offset:51200
    ds_read_b64_tr_b16 v[216:217], v232 offset:49152
    v_mfma_f32_16x16x32_bf16 v[40:43], v[152:155], v[132:135], v[40:43]
    ds_read_b64_tr_b16 v[218:219], v232 offset:51200
    v_mfma_f32_16x16x32_bf16 v[44:47], v[156:159], v[132:135], v[44:47]
    ds_read_b64_tr_b16 v[220:221], v233 offset:49152
    ds_read_b64_tr_b16 v[222:223], v233 offset:51200
    v_mfma_f32_16x16x32_bf16 v[48:51], v[160:163], v[132:135], v[48:51]
    ds_read_b128 v[184:187], v225 offset:4096
    v_mfma_f32_16x16x32_bf16 v[52:55], v[164:167], v[132:135], v[52:55]
    ds_read_b128 v[188:191], v225 offset:5120
    s_add_u32 s30, s41, s43
    v_mfma_f32_16x16x32_bf16 v[56:59], v[168:171], v[132:135], v[56:59]
    s_sub_u32 s37, s30, 7
    v_mfma_f32_16x16x32_bf16 v[60:63], v[172:175], v[132:135], v[60:63]
    s_cmp_ge_u32 s30, 7
    v_mfma_f32_16x16x32_bf16 v[64:67], v[144:147], v[136:139], v[64:67]
    s_cselect_b32 s30, s37, s30
    s_add_u32 s41, s41, 1
    v_mfma_f32_16x16x32_bf16 v[68:71], v[148:151], v[136:139], v[68:71]
    s_mul_i32 s30, s30, s45
    v_mfma_f32_16x16x32_bf16 v[72:75], v[152:155], v[136:139], v[72:75]
    s_lshl_b32 s30, s30, 1
    s_add_u32 m0, s33, 32768
    v_mfma_f32_16x16x32_bf16 v[76:79], v[156:159], v[136:139], v[76:79]
    s_nop 0
    v_mfma_f32_16x16x32_bf16 v[80:83], v[160:163], v[136:139], v[80:83]
    buffer_load_dwordx4 v250, s[16:19], s30 offen offset:0 lds
    buffer_load_dwordx4 v251, s[16:19], s30 offen offset:1024 lds
    v_mfma_f32_16x16x32_bf16 v[84:87], v[164:167], v[136:139], v[84:87]
    s_add_u32 s30, s30, s45
    v_mfma_f32_16x16x32_bf16 v[88:91], v[168:171], v[136:139], v[88:91]
    s_add_u32 s35, s27, s32
    s_add_u32 m0, s35, 0x800
    v_mfma_f32_16x16x32_bf16 v[92:95], v[172:175], v[136:139], v[92:95]
    s_add_u32 s27, s27, 0x8000
    v_mfma_f32_16x16x32_bf16 v[96:99], v[144:147], v[140:143], v[96:99]
    buffer_load_dwordx4 v246, s[12:15], s31 offen offset:0 lds
    v_mfma_f32_16x16x32_bf16 v[100:103], v[148:151], v[140:143], v[100:103]
    buffer_load_dwordx4 v247, s[12:15], s31 offen offset:1024 lds
    s_cmp_ge_u32 s27, 0x28000
    v_mfma_f32_16x16x32_bf16 v[104:107], v[152:155], v[140:143], v[104:107]
    s_cselect_b32 s27, 0x10000, s27
    v_mfma_f32_16x16x32_bf16 v[108:111], v[156:159], v[140:143], v[108:111]
    s_add_u32 s36, s28, 0x8000
    s_cmp_ge_u32 s36, 0x18000
    v_mfma_f32_16x16x32_bf16 v[112:115], v[160:163], v[140:143], v[112:115]
    s_cselect_b32 s36, 0, s36
    v_mfma_f32_16x16x32_bf16 v[116:119], v[164:167], v[140:143], v[116:119]
    s_sub_u32 s29, s36, s28
    s_mov_b32 s28, s36
    v_mfma_f32_16x16x32_bf16 v[120:123], v[168:171], v[140:143], v[120:123]
    v_add_u32 v224, s29, v224
    v_mfma_f32_16x16x32_bf16 v[124:127], v[172:175], v[140:143], v[124:127]
    v_add_u32 v225, s29, v225
    s_waitcnt vmcnt(8) lgkmcnt(0)
    s_barrier
    v_mfma_f32_16x16x32_bf16 v[0:3], v[192:195], v[176:179], v[0:3]
    ds_read_b128 v[128:131], v224 offset:0
    v_mfma_f32_16x16x32_bf16 v[4:7], v[196:199], v[176:179], v[4:7]
    ds_read_b64_tr_b16 v[144:145], v234 offset:0
    v_mfma_f32_16x16x32_bf16 v[8:11], v[200:203], v[176:179], v[8:11]
    ds_read_b64_tr_b16 v[146:147], v234 offset:1536
    v_mfma_f32_16x16x32_bf16 v[12:15], v[204:207], v[176:179], v[12:15]
    ds_read_b64_tr_b16 v[148:149], v235 offset:0
    v_mfma_f32_16x16x32_bf16 v[16:19], v[208:211], v[176:179], v[16:19]
    ds_read_b64_tr_b16 v[150:151], v235 offset:1536
    v_mfma_f32_16x16x32_bf16 v[20:23], v[212:215], v[176:179], v[20:23]
    ds_read_b128 v[132:135], v224 offset:1024
    v_mfma_f32_16x16x32_bf16 v[24:27], v[216:219], v[176:179], v[24:27]
    ds_read_b64_tr_b16 v[152:153], v236 offset:0
    v_mfma_f32_16x16x32_bf16 v[28:31], v[220:223], v[176:179], v[28:31]
    ds_read_b64_tr_b16 v[154:155], v236 offset:1536
    v_mfma_f32_16x16x32_bf16 v[32:35], v[192:195], v[180:183], v[32:35]
    ds_read_b64_tr_b16 v[156:157], v237 offset:0
    v_mfma_f32_16x16x32_bf16 v[36:39], v[196:199], v[180:183], v[36:39]
    ds_read_b64_tr_b16 v[158:159], v237 offset:1536
    v_mfma_f32_16x16x32_bf16 v[40:43], v[200:203], v[180:183], v[40:43]
    v_mfma_f32_16x16x32_bf16 v[44:47], v[204:207], v[180:183], v[44:47]
    ds_read_b64_tr_b16 v[160:161], v238 offset:0
    v_mfma_f32_16x16x32_bf16 v[48:51], v[208:211], v[180:183], v[48:51]
    ds_read_b64_tr_b16 v[162:163], v238 offset:1536
    v_mfma_f32_16x16x32_bf16 v[52:55], v[212:215], v[180:183], v[52:55]
    ds_read_b64_tr_b16 v[164:165], v239 offset:0
    v_mfma_f32_16x16x32_bf16 v[56:59], v[216:219], v[180:183], v[56:59]
    ds_read_b64_tr_b16 v[166:167], v239 offset:1536
    v_mfma_f32_16x16x32_bf16 v[60:63], v[220:223], v[180:183], v[60:63]
    ds_read_b128 v[136:139], v224 offset:4096
    v_mfma_f32_16x16x32_bf16 v[64:67], v[192:195], v[184:187], v[64:67]
    ds_read_b128 v[140:143], v224 offset:5120
    v_mfma_f32_16x16x32_bf16 v[68:71], v[196:199], v[184:187], v[68:71]
    s_add_u32 m0, s33, 49152
    v_mfma_f32_16x16x32_bf16 v[72:75], v[200:203], v[184:187], v[72:75]
    s_nop 0
    v_mfma_f32_16x16x32_bf16 v[76:79], v[204:207], v[184:187], v[76:79]
    buffer_load_dwordx4 v250, s[16:19], s30 offen offset:0 lds
    v_mfma_f32_16x16x32_bf16 v[80:83], v[208:211], v[184:187], v[80:83]
    buffer_load_dwordx4 v251, s[16:19], s30 offen offset:1024 lds
    v_mfma_f32_16x16x32_bf16 v[84:87], v[212:215], v[184:187], v[84:87]
    v_mfma_f32_16x16x32_bf16 v[88:91], v[216:219], v[184:187], v[88:91]
    s_add_u32 s31, s40, s43
    v_mfma_f32_16x16x32_bf16 v[92:95], v[220:223], v[184:187], v[92:95]
    s_sub_u32 s37, s31, 7
    v_mfma_f32_16x16x32_bf16 v[96:99], v[192:195], v[188:191], v[96:99]
    s_cmp_ge_u32 s31, 7
    v_mfma_f32_16x16x32_bf16 v[100:103], v[196:199], v[188:191], v[100:103]
    s_cselect_b32 s31, s37, s31
    v_mfma_f32_16x16x32_bf16 v[104:107], v[200:203], v[188:191], v[104:107]
    s_add_u32 s40, s40, 1
    v_mfma_f32_16x16x32_bf16 v[108:111], v[204:207], v[188:191], v[108:111]
    s_add_u32 m0, s27, s32
    v_mfma_f32_16x16x32_bf16 v[112:115], v[208:211], v[188:191], v[112:115]
    s_lshl_b32 s31, s31, 7
    v_mfma_f32_16x16x32_bf16 v[116:119], v[212:215], v[188:191], v[116:119]
    buffer_load_dwordx4 v244, s[12:15], s31 offen offset:0 lds
    v_mfma_f32_16x16x32_bf16 v[120:123], v[216:219], v[188:191], v[120:123]
    buffer_load_dwordx4 v245, s[12:15], s31 offen offset:1024 lds
    v_mfma_f32_16x16x32_bf16 v[124:127], v[220:223], v[188:191], v[124:127]
    s_nop 7
    s_lshl_b32 s35, s48, 6
    s_lshl_b32 s36, s50, 3
    s_add_u32 s35, s35, s36
    s_lshl_b32 s36, s25, 1
    s_add_u32 s35, s35, s36
    s_lshl_b32 s35, s35, 5
    s_lshl_b32 s36, s49, 4
    s_add_u32 s35, s35, s36
    s_lshl_b32 s36, s26, 3
    s_add_u32 s35, s35, s36
    s_lshl_b32 s39, s35, 10
    v_cvt_pk_bf16_f32 v176, v0, v1
    v_cvt_pk_bf16_f32 v177, v2, v3
    v_cvt_pk_bf16_f32 v178, v4, v5
    v_cvt_pk_bf16_f32 v179, v6, v7
    buffer_store_dwordx4 v[176:179], v252, s[20:23], s39 offen offset:0 sc1
    v_cvt_pk_bf16_f32 v180, v32, v33
    v_cvt_pk_bf16_f32 v181, v34, v35
    v_cvt_pk_bf16_f32 v182, v36, v37
    v_cvt_pk_bf16_f32 v183, v38, v39
    buffer_store_dwordx4 v[180:183], v252, s[20:23], s39 offen offset:128 sc1
    v_cvt_pk_bf16_f32 v184, v8, v9
    v_cvt_pk_bf16_f32 v185, v10, v11
    v_cvt_pk_bf16_f32 v186, v12, v13
    v_cvt_pk_bf16_f32 v187, v14, v15
    buffer_store_dwordx4 v[184:187], v252, s[20:23], s39 offen offset:2048 sc1
    v_cvt_pk_bf16_f32 v188, v40, v41
    v_cvt_pk_bf16_f32 v189, v42, v43
    v_cvt_pk_bf16_f32 v190, v44, v45
    v_cvt_pk_bf16_f32 v191, v46, v47
    buffer_store_dwordx4 v[188:191], v252, s[20:23], s39 offen offset:2176 sc1
    s_add_u32 s39, s39, 4096
    v_cvt_pk_bf16_f32 v192, v16, v17
    v_cvt_pk_bf16_f32 v193, v18, v19
    v_cvt_pk_bf16_f32 v194, v20, v21
    v_cvt_pk_bf16_f32 v195, v22, v23
    buffer_store_dwordx4 v[192:195], v252, s[20:23], s39 offen offset:0 sc1
    v_cvt_pk_bf16_f32 v196, v48, v49
    v_cvt_pk_bf16_f32 v197, v50, v51
    v_cvt_pk_bf16_f32 v198, v52, v53
    v_cvt_pk_bf16_f32 v199, v54, v55
    buffer_store_dwordx4 v[196:199], v252, s[20:23], s39 offen offset:128 sc1
    v_cvt_pk_bf16_f32 v200, v24, v25
    v_cvt_pk_bf16_f32 v201, v26, v27
    v_cvt_pk_bf16_f32 v202, v28, v29
    v_cvt_pk_bf16_f32 v203, v30, v31
    buffer_store_dwordx4 v[200:203], v252, s[20:23], s39 offen offset:2048 sc1
    v_cvt_pk_bf16_f32 v204, v56, v57
    v_cvt_pk_bf16_f32 v205, v58, v59
    v_cvt_pk_bf16_f32 v206, v60, v61
    v_cvt_pk_bf16_f32 v207, v62, v63
    buffer_store_dwordx4 v[204:207], v252, s[20:23], s39 offen offset:2176 sc1
    s_add_u32 s39, s39, 28672
    v_cvt_pk_bf16_f32 v208, v64, v65
    v_cvt_pk_bf16_f32 v209, v66, v67
    v_cvt_pk_bf16_f32 v210, v68, v69
    v_cvt_pk_bf16_f32 v211, v70, v71
    buffer_store_dwordx4 v[208:211], v252, s[20:23], s39 offen offset:0 sc1
    v_cvt_pk_bf16_f32 v212, v96, v97
    v_cvt_pk_bf16_f32 v213, v98, v99
    v_cvt_pk_bf16_f32 v214, v100, v101
    v_cvt_pk_bf16_f32 v215, v102, v103
    buffer_store_dwordx4 v[212:215], v252, s[20:23], s39 offen offset:128 sc1
    v_cvt_pk_bf16_f32 v216, v72, v73
    v_cvt_pk_bf16_f32 v217, v74, v75
    v_cvt_pk_bf16_f32 v218, v76, v77
    v_cvt_pk_bf16_f32 v219, v78, v79
    buffer_store_dwordx4 v[216:219], v252, s[20:23], s39 offen offset:2048 sc1
    v_cvt_pk_bf16_f32 v220, v104, v105
    v_cvt_pk_bf16_f32 v221, v106, v107
    v_cvt_pk_bf16_f32 v222, v108, v109
    v_cvt_pk_bf16_f32 v223, v110, v111
    buffer_store_dwordx4 v[220:223], v252, s[20:23], s39 offen offset:2176 sc1
    s_add_u32 s39, s39, 4096
    v_cvt_pk_bf16_f32 v176, v80, v81
    v_cvt_pk_bf16_f32 v177, v82, v83
    v_cvt_pk_bf16_f32 v178, v84, v85
    v_cvt_pk_bf16_f32 v179, v86, v87
    buffer_store_dwordx4 v[176:179], v252, s[20:23], s39 offen offset:0 sc1
    v_cvt_pk_bf16_f32 v180, v112, v113
    v_cvt_pk_bf16_f32 v181, v114, v115
    v_cvt_pk_bf16_f32 v182, v116, v117
    v_cvt_pk_bf16_f32 v183, v118, v119
    buffer_store_dwordx4 v[180:183], v252, s[20:23], s39 offen offset:128 sc1
    v_cvt_pk_bf16_f32 v184, v88, v89
    v_cvt_pk_bf16_f32 v185, v90, v91
    v_cvt_pk_bf16_f32 v186, v92, v93
    v_cvt_pk_bf16_f32 v187, v94, v95
    buffer_store_dwordx4 v[184:187], v252, s[20:23], s39 offen offset:2048 sc1
    v_cvt_pk_bf16_f32 v188, v120, v121
    v_cvt_pk_bf16_f32 v189, v122, v123
    v_cvt_pk_bf16_f32 v190, v124, v125
    v_cvt_pk_bf16_f32 v191, v126, v127
    buffer_store_dwordx4 v[188:191], v252, s[20:23], s39 offen offset:2176 sc1
    s_add_u32 s39, s39, 28672
    s_cmp_lg_u32 s94, 0
    s_cbranch_scc1 K1_GATE
    s_waitcnt vmcnt(26) lgkmcnt(0)
    s_barrier
    v_mfma_f32_16x16x32_bf16 v[0:3], v[144:147], v[128:131], 0
    ds_read_b128 v[176:179], v225 offset:0
    ds_read_b64_tr_b16 v[192:193], v234 offset:16384
    v_mfma_f32_16x16x32_bf16 v[4:7], v[148:151], v[128:131], 0
    ds_read_b64_tr_b16 v[194:195], v234 offset:17920
    ds_read_b64_tr_b16 v[196:197], v235 offset:16384
    v_mfma_f32_16x16x32_bf16 v[8:11], v[152:155], v[128:131], 0
    ds_read_b64_tr_b16 v[198:199], v235 offset:17920
    ds_read_b128 v[180:183], v225 offset:1024
    v_mfma_f32_16x16x32_bf16 v[12:15], v[156:159], v[128:131], 0
    ds_read_b64_tr_b16 v[200:201], v236 offset:16384
    v_mfma_f32_16x16x32_bf16 v[16:19], v[160:163], v[128:131], 0
    ds_read_b64_tr_b16 v[202:203], v236 offset:17920
    ds_read_b64_tr_b16 v[204:205], v237 offset:16384
    v_mfma_f32_16x16x32_bf16 v[20:23], v[164:167], v[128:131], 0
    ds_read_b64_tr_b16 v[206:207], v237 offset:17920
    ds_read_b64_tr_b16 v[208:209], v238 offset:16384
    v_mfma_f32_16x16x32_bf16 v[32:35], v[144:147], v[132:135], 0
    ds_read_b64_tr_b16 v[210:211], v238 offset:17920
    ds_read_b64_tr_b16 v[212:213], v239 offset:16384
    v_mfma_f32_16x16x32_bf16 v[36:39], v[148:151], v[132:135], 0
    ds_read_b64_tr_b16 v[214:215], v239 offset:17920
    v_mfma_f32_16x16x32_bf16 v[40:43], v[152:155], v[132:135], 0
    ds_read_b128 v[184:187], v225 offset:4096
    ds_read_b128 v[188:191], v225 offset:5120
    v_mfma_f32_16x16x32_bf16 v[44:47], v[156:159], v[132:135], 0
    s_add_u32 s30, s41, s43
    s_sub_u32 s37, s30, 7
    v_mfma_f32_16x16x32_bf16 v[48:51], v[160:163], v[132:135], 0
    s_cmp_ge_u32 s30, 7
    s_cselect_b32 s30, s37, s30
    v_mfma_f32_16x16x32_bf16 v[52:55], v[164:167], v[132:135], 0
    s_add_u32 s41, s41, 1
    v_mfma_f32_16x16x32_bf16 v[64:67], v[144:147], v[136:139], 0
    s_mul_i32 s30, s30, s45
    s_lshl_b32 s30, s30, 1
    v_mfma_f32_16x16x32_bf16 v[68:71], v[148:151], v[136:139], 0
    s_add_u32 m0, s33, 0
    s_nop 0
    v_mfma_f32_16x16x32_bf16 v[72:75], v[152:155], v[136:139], 0
    buffer_load_dwordx4 v250, s[16:19], s30 offen offset:0 lds
    buffer_load_dwordx4 v251, s[16:19], s30 offen offset:1024 lds
    v_mfma_f32_16x16x32_bf16 v[76:79], v[156:159], v[136:139], 0
    s_add_u32 s30, s30, s45
    v_mfma_f32_16x16x32_bf16 v[80:83], v[160:163], v[136:139], 0
    s_add_u32 s35, s27, s32
    s_add_u32 m0, s35, 0x800
    v_mfma_f32_16x16x32_bf16 v[84:87], v[164:167], v[136:139], 0
    s_add_u32 s27, s27, 0x8000
    buffer_load_dwordx4 v246, s[12:15], s31 offen offset:0 lds
    v_mfma_f32_16x16x32_bf16 v[96:99], v[144:147], v[140:143], 0
    buffer_load_dwordx4 v247, s[12:15], s31 offen offset:1024 lds
    s_cmp_ge_u32 s27, 0x28000
    v_mfma_f32_16x16x32_bf16 v[100:103], v[148:151], v[140:143], 0
    s_cselect_b32 s27, 0x10000, s27
    v_mfma_f32_16x16x32_bf16 v[104:107], v[152:155], v[140:143], 0
    s_add_u32 s36, s28, 0x8000
    s_cmp_ge_u32 s36, 0x18000
    v_mfma_f32_16x16x32_bf16 v[108:111], v[156:159], v[140:143], 0
    s_cselect_b32 s36, 0, s36
    s_sub_u32 s29, s36, s28
    v_mfma_f32_16x16x32_bf16 v[112:115], v[160:163], v[140:143], 0
    s_mov_b32 s28, s36
    v_add_u32 v224, s29, v224
    v_mfma_f32_16x16x32_bf16 v[116:119], v[164:167], v[140:143], 0
    v_add_u32 v225, s29, v225
    s_waitcnt vmcnt(24) lgkmcnt(0)
    s_barrier
    v_mfma_f32_16x16x32_bf16 v[0:3], v[192:195], v[176:179], v[0:3]
    ds_read_b128 v[128:131], v224 offset:0
    ds_read_b64_tr_b16 v[144:145], v234 offset:32768
    v_mfma_f32_16x16x32_bf16 v[4:7], v[196:199], v[176:179], v[4:7]
    ds_read_b64_tr_b16 v[146:147], v234 offset:34304
    v_mfma_f32_16x16x32_bf16 v[8:11], v[200:203], v[176:179], v[8:11]
    ds_read_b64_tr_b16 v[148:149], v235 offset:32768
    v_mfma_f32_16x16x32_bf16 v[12:15], v[204:207], v[176:179], v[12:15]
    ds_read_b64_tr_b16 v[150:151], v235 offset:34304
    v_mfma_f32_16x16x32_bf16 v[16:19], v[208:211], v[176:179], v[16:19]
    ds_read_b128 v[132:135], v224 offset:1024
    ds_read_b64_tr_b16 v[152:153], v236 offset:32768
    v_mfma_f32_16x16x32_bf16 v[20:23], v[212:215], v[176:179], v[20:23]
    ds_read_b64_tr_b16 v[154:155], v236 offset:34304
    v_mfma_f32_16x16x32_bf16 v[32:35], v[192:195], v[180:183], v[32:35]
    ds_read_b64_tr_b16 v[156:157], v237 offset:32768
    v_mfma_f32_16x16x32_bf16 v[36:39], v[196:199], v[180:183], v[36:39]
    ds_read_b64_tr_b16 v[158:159], v237 offset:34304
    v_mfma_f32_16x16x32_bf16 v[40:43], v[200:203], v[180:183], v[40:43]
    ds_read_b64_tr_b16 v[160:161], v238 offset:32768
    v_mfma_f32_16x16x32_bf16 v[44:47], v[204:207], v[180:183], v[44:47]
    ds_read_b64_tr_b16 v[162:163], v238 offset:34304
    ds_read_b64_tr_b16 v[164:165], v239 offset:32768
    v_mfma_f32_16x16x32_bf16 v[48:51], v[208:211], v[180:183], v[48:51]
    ds_read_b64_tr_b16 v[166:167], v239 offset:34304
    v_mfma_f32_16x16x32_bf16 v[52:55], v[212:215], v[180:183], v[52:55]
    ds_read_b128 v[136:139], v224 offset:4096
    v_mfma_f32_16x16x32_bf16 v[64:67], v[192:195], v[184:187], v[64:67]
    ds_read_b128 v[140:143], v224 offset:5120
    v_mfma_f32_16x16x32_bf16 v[68:71], v[196:199], v[184:187], v[68:71]
    s_add_u32 m0, s33, 16384
    v_mfma_f32_16x16x32_bf16 v[72:75], v[200:203], v[184:187], v[72:75]
    s_nop 0
    buffer_load_dwordx4 v250, s[16:19], s30 offen offset:0 lds
    v_mfma_f32_16x16x32_bf16 v[76:79], v[204:207], v[184:187], v[76:79]
    buffer_load_dwordx4 v251, s[16:19], s30 offen offset:1024 lds
    v_mfma_f32_16x16x32_bf16 v[80:83], v[208:211], v[184:187], v[80:83]
    s_add_u32 s31, s40, s43
    v_mfma_f32_16x16x32_bf16 v[84:87], v[212:215], v[184:187], v[84:87]
    s_sub_u32 s37, s31, 7
    v_mfma_f32_16x16x32_bf16 v[96:99], v[192:195], v[188:191], v[96:99]
    s_cmp_ge_u32 s31, 7
    v_mfma_f32_16x16x32_bf16 v[100:103], v[196:199], v[188:191], v[100:103]
    s_cselect_b32 s31, s37, s31
    s_add_u32 s40, s40, 1
    v_mfma_f32_16x16x32_bf16 v[104:107], v[200:203], v[188:191], v[104:107]
    s_add_u32 m0, s27, s32
    v_mfma_f32_16x16x32_bf16 v[108:111], v[204:207], v[188:191], v[108:111]
    s_lshl_b32 s31, s31, 7
    v_mfma_f32_16x16x32_bf16 v[112:115], v[208:211], v[188:191], v[112:115]
    buffer_load_dwordx4 v244, s[12:15], s31 offen offset:0 lds
    v_mfma_f32_16x16x32_bf16 v[116:119], v[212:215], v[188:191], v[116:119]
    buffer_load_dwordx4 v245, s[12:15], s31 offen offset:1024 lds
    s_waitcnt vmcnt(26) lgkmcnt(0)
    s_barrier
    v_mfma_f32_16x16x32_bf16 v[0:3], v[144:147], v[128:131], v[0:3]
    ds_read_b128 v[176:179], v225 offset:0
    ds_read_b64_tr_b16 v[192:193], v234 offset:49152
    v_mfma_f32_16x16x32_bf16 v[4:7], v[148:151], v[128:131], v[4:7]
    ds_read_b64_tr_b16 v[194:195], v234 offset:50688
    ds_read_b64_tr_b16 v[196:197], v235 offset:49152
    v_mfma_f32_16x16x32_bf16 v[8:11], v[152:155], v[128:131], v[8:11]
    ds_read_b64_tr_b16 v[198:199], v235 offset:50688
    ds_read_b128 v[180:183], v225 offset:1024
    v_mfma_f32_16x16x32_bf16 v[12:15], v[156:159], v[128:131], v[12:15]
    ds_read_b64_tr_b16 v[200:201], v236 offset:49152
    v_mfma_f32_16x16x32_bf16 v[16:19], v[160:163], v[128:131], v[16:19]
    ds_read_b64_tr_b16 v[202:203], v236 offset:50688
    ds_read_b64_tr_b16 v[204:205], v237 offset:49152
    v_mfma_f32_16x16x32_bf16 v[20:23], v[164:167], v[128:131], v[20:23]
    ds_read_b64_tr_b16 v[206:207], v237 offset:50688
    ds_read_b64_tr_b16 v[208:209], v238 offset:49152
    v_mfma_f32_16x16x32_bf16 v[32:35], v[144:147], v[132:135], v[32:35]
    ds_read_b64_tr_b16 v[210:211], v238 offset:50688
    ds_read_b64_tr_b16 v[212:213], v239 offset:49152
    v_mfma_f32_16x16x32_bf16 v[36:39], v[148:151], v[132:135], v[36:39]
    ds_read_b64_tr_b16 v[214:215], v239 offset:50688
    v_mfma_f32_16x16x32_bf16 v[40:43], v[152:155], v[132:135], v[40:43]
    ds_read_b128 v[184:187], v225 offset:4096
    ds_read_b128 v[188:191], v225 offset:5120
    v_mfma_f32_16x16x32_bf16 v[44:47], v[156:159], v[132:135], v[44:47]
    s_add_u32 s30, s41, s43
    s_sub_u32 s37, s30, 7
    v_mfma_f32_16x16x32_bf16 v[48:51], v[160:163], v[132:135], v[48:51]
    s_cmp_ge_u32 s30, 7
    s_cselect_b32 s30, s37, s30
    v_mfma_f32_16x16x32_bf16 v[52:55], v[164:167], v[132:135], v[52:55]
    s_add_u32 s41, s41, 1
    v_mfma_f32_16x16x32_bf16 v[64:67], v[144:147], v[136:139], v[64:67]
    s_mul_i32 s30, s30, s45
    s_lshl_b32 s30, s30, 1
    v_mfma_f32_16x16x32_bf16 v[68:71], v[148:151], v[136:139], v[68:71]
    s_add_u32 m0, s33, 32768
    s_nop 0
    v_mfma_f32_16x16x32_bf16 v[72:75], v[152:155], v[136:139], v[72:75]
    buffer_load_dwordx4 v250, s[16:19], s30 offen offset:0 lds
    buffer_load_dwordx4 v251, s[16:19], s30 offen offset:1024 lds
    v_mfma_f32_16x16x32_bf16 v[76:79], v[156:159], v[136:139], v[76:79]
    s_add_u32 s30, s30, s45
    v_mfma_f32_16x16x32_bf16 v[80:83], v[160:163], v[136:139], v[80:83]
    s_add_u32 s35, s27, s32
    s_add_u32 m0, s35, 0x800
    v_mfma_f32_16x16x32_bf16 v[84:87], v[164:167], v[136:139], v[84:87]
    s_add_u32 s27, s27, 0x8000
    buffer_load_dwordx4 v246, s[12:15], s31 offen offset:0 lds
    v_mfma_f32_16x16x32_bf16 v[96:99], v[144:147], v[140:143], v[96:99]
    buffer_load_dwordx4 v247, s[12:15], s31 offen offset:1024 lds
    s_cmp_ge_u32 s27, 0x28000
    v_mfma_f32_16x16x32_bf16 v[100:103], v[148:151], v[140:143], v[100:103]
    s_cselect_b32 s27, 0x10000, s27
    v_mfma_f32_16x16x32_bf16 v[104:107], v[152:155], v[140:143], v[104:107]
    s_add_u32 s36, s28, 0x8000
    s_cmp_ge_u32 s36, 0x18000
    v_mfma_f32_16x16x32_bf16 v[108:111], v[156:159], v[140:143], v[108:111]
    s_cselect_b32 s36, 0, s36
    s_sub_u32 s29, s36, s28
    v_mfma_f32_16x16x32_bf16 v[112:115], v[160:163], v[140:143], v[112:115]
    s_mov_b32 s28, s36
    v_add_u32 v224, s29, v224
    v_mfma_f32_16x16x32_bf16 v[116:119], v[164:167], v[140:143], v[116:119]
    v_add_u32 v225, s29, v225
    s_waitcnt vmcnt(8) lgkmcnt(0)
    s_barrier
    v_mfma_f32_16x16x32_bf16 v[0:3], v[192:195], v[176:179], v[0:3]
    ds_read_b128 v[128:131], v224 offset:0
    ds_read_b64_tr_b16 v[144:145], v234 offset:0
    v_mfma_f32_16x16x32_bf16 v[4:7], v[196:199], v[176:179], v[4:7]
    ds_read_b64_tr_b16 v[146:147], v234 offset:1536
    v_mfma_f32_16x16x32_bf16 v[8:11], v[200:203], v[176:179], v[8:11]
    ds_read_b64_tr_b16 v[148:149], v235 offset:0
    v_mfma_f32_16x16x32_bf16 v[12:15], v[204:207], v[176:179], v[12:15]
    ds_read_b64_tr_b16 v[150:151], v235 offset:1536
    v_mfma_f32_16x16x32_bf16 v[16:19], v[208:211], v[176:179], v[16:19]
    ds_read_b128 v[132:135], v224 offset:1024
    ds_read_b64_tr_b16 v[152:153], v236 offset:0
    v_mfma_f32_16x16x32_bf16 v[20:23], v[212:215], v[176:179], v[20:23]
    ds_read_b64_tr_b16 v[154:155], v236 offset:1536
    v_mfma_f32_16x16x32_bf16 v[32:35], v[192:195], v[180:183], v[32:35]
    ds_read_b64_tr_b16 v[156:157], v237 offset:0
    v_mfma_f32_16x16x32_bf16 v[36:39], v[196:199], v[180:183], v[36:39]
    ds_read_b64_tr_b16 v[158:159], v237 offset:1536
    v_mfma_f32_16x16x32_bf16 v[40:43], v[200:203], v[180:183], v[40:43]
    ds_read_b64_tr_b16 v[160:161], v238 offset:0
    v_mfma_f32_16x16x32_bf16 v[44:47], v[204:207], v[180:183], v[44:47]
    ds_read_b64_tr_b16 v[162:163], v238 offset:1536
    ds_read_b64_tr_b16 v[164:165], v239 offset:0
    v_mfma_f32_16x16x32_bf16 v[48:51], v[208:211], v[180:183], v[48:51]
    ds_read_b64_tr_b16 v[166:167], v239 offset:1536
    v_mfma_f32_16x16x32_bf16 v[52:55], v[212:215], v[180:183], v[52:55]
    ds_read_b128 v[136:139], v224 offset:4096
    v_mfma_f32_16x16x32_bf16 v[64:67], v[192:195], v[184:187], v[64:67]
    ds_read_b128 v[140:143], v224 offset:5120
    v_mfma_f32_16x16x32_bf16 v[68:71], v[196:199], v[184:187], v[68:71]
    s_add_u32 m0, s33, 49152
    v_mfma_f32_16x16x32_bf16 v[72:75], v[200:203], v[184:187], v[72:75]
    s_nop 0
    buffer_load_dwordx4 v250, s[16:19], s30 offen offset:0 lds
    v_mfma_f32_16x16x32_bf16 v[76:79], v[204:207], v[184:187], v[76:79]
    buffer_load_dwordx4 v251, s[16:19], s30 offen offset:1024 lds
    v_mfma_f32_16x16x32_bf16 v[80:83], v[208:211], v[184:187], v[80:83]
    s_add_u32 s31, s40, s43
    v_mfma_f32_16x16x32_bf16 v[84:87], v[212:215], v[184:187], v[84:87]
    s_sub_u32 s37, s31, 7
    v_mfma_f32_16x16x32_bf16 v[96:99], v[192:195], v[188:191], v[96:99]
    s_cmp_ge_u32 s31, 7
    v_mfma_f32_16x16x32_bf16 v[100:103], v[196:199], v[188:191], v[100:103]
    s_cselect_b32 s31, s37, s31
    s_add_u32 s40, s40, 1
    v_mfma_f32_16x16x32_bf16 v[104:107], v[200:203], v[188:191], v[104:107]
    s_add_u32 m0, s27, s32
    v_mfma_f32_16x16x32_bf16 v[108:111], v[204:207], v[188:191], v[108:111]
    s_lshl_b32 s31, s31, 7
    v_mfma_f32_16x16x32_bf16 v[112:115], v[208:211], v[188:191], v[112:115]
    buffer_load_dwordx4 v244, s[12:15], s31 offen offset:0 lds
    v_mfma_f32_16x16x32_bf16 v[116:119], v[212:215], v[188:191], v[116:119]
    buffer_load_dwordx4 v245, s[12:15], s31 offen offset:1024 lds
    s_waitcnt vmcnt(10) lgkmcnt(0)
    s_barrier
    v_mfma_f32_16x16x32_bf16 v[0:3], v[144:147], v[128:131], v[0:3]
    ds_read_b128 v[176:179], v225 offset:0
    ds_read_b64_tr_b16 v[192:193], v234 offset:16384
    v_mfma_f32_16x16x32_bf16 v[4:7], v[148:151], v[128:131], v[4:7]
    ds_read_b64_tr_b16 v[194:195], v234 offset:17920
    ds_read_b64_tr_b16 v[196:197], v235 offset:16384
    v_mfma_f32_16x16x32_bf16 v[8:11], v[152:155], v[128:131], v[8:11]
    ds_read_b64_tr_b16 v[198:199], v235 offset:17920
    ds_read_b128 v[180:183], v225 offset:1024
    v_mfma_f32_16x16x32_bf16 v[12:15], v[156:159], v[128:131], v[12:15]
    ds_read_b64_tr_b16 v[200:201], v236 offset:16384
    v_mfma_f32_16x16x32_bf16 v[16:19], v[160:163], v[128:131], v[16:19]
    ds_read_b64_tr_b16 v[202:203], v236 offset:17920
    ds_read_b64_tr_b16 v[204:205], v237 offset:16384
    v_mfma_f32_16x16x32_bf16 v[20:23], v[164:167], v[128:131], v[20:23]
    ds_read_b64_tr_b16 v[206:207], v237 offset:17920
    ds_read_b64_tr_b16 v[208:209], v238 offset:16384
    v_mfma_f32_16x16x32_bf16 v[32:35], v[144:147], v[132:135], v[32:35]
    ds_read_b64_tr_b16 v[210:211], v238 offset:17920
    ds_read_b64_tr_b16 v[212:213], v239 offset:16384
    v_mfma_f32_16x16x32_bf16 v[36:39], v[148:151], v[132:135], v[36:39]
    ds_read_b64_tr_b16 v[214:215], v239 offset:17920
    v_mfma_f32_16x16x32_bf16 v[40:43], v[152:155], v[132:135], v[40:43]
    ds_read_b128 v[184:187], v225 offset:4096
    ds_read_b128 v[188:191], v225 offset:5120
    v_mfma_f32_16x16x32_bf16 v[44:47], v[156:159], v[132:135], v[44:47]
    s_add_u32 s30, s41, s43
    s_sub_u32 s37, s30, 7
    v_mfma_f32_16x16x32_bf16 v[48:51], v[160:163], v[132:135], v[48:51]
    s_cmp_ge_u32 s30, 7
    s_cselect_b32 s30, s37, s30
    v_mfma_f32_16x16x32_bf16 v[52:55], v[164:167], v[132:135], v[52:55]
    s_add_u32 s41, s41, 1
    v_mfma_f32_16x16x32_bf16 v[64:67], v[144:147], v[136:139], v[64:67]
    s_mul_i32 s30, s30, s45
    s_lshl_b32 s30, s30, 1
    v_mfma_f32_16x16x32_bf16 v[68:71], v[148:151], v[136:139], v[68:71]
    s_add_u32 m0, s33, 0
    s_nop 0
    v_mfma_f32_16x16x32_bf16 v[72:75], v[152:155], v[136:139], v[72:75]
    buffer_load_dwordx4 v250, s[16:19], s30 offen offset:0 lds
    buffer_load_dwordx4 v251, s[16:19], s30 offen offset:1024 lds
    v_mfma_f32_16x16x32_bf16 v[76:79], v[156:159], v[136:139], v[76:79]
    s_add_u32 s30, s30, s45
    v_mfma_f32_16x16x32_bf16 v[80:83], v[160:163], v[136:139], v[80:83]
    s_add_u32 s35, s27, s32
    s_add_u32 m0, s35, 0x800
    v_mfma_f32_16x16x32_bf16 v[84:87], v[164:167], v[136:139], v[84:87]
    s_add_u32 s27, s27, 0x8000
    buffer_load_dwordx4 v246, s[12:15], s31 offen offset:0 lds
    v_mfma_f32_16x16x32_bf16 v[96:99], v[144:147], v[140:143], v[96:99]
    buffer_load_dwordx4 v247, s[12:15], s31 offen offset:1024 lds
    s_cmp_ge_u32 s27, 0x28000
    v_mfma_f32_16x16x32_bf16 v[100:103], v[148:151], v[140:143], v[100:103]
    s_cselect_b32 s27, 0x10000, s27
    v_mfma_f32_16x16x32_bf16 v[104:107], v[152:155], v[140:143], v[104:107]
    s_add_u32 s36, s28, 0x8000
    s_cmp_ge_u32 s36, 0x18000
    v_mfma_f32_16x16x32_bf16 v[108:111], v[156:159], v[140:143], v[108:111]
    s_cselect_b32 s36, 0, s36
    s_sub_u32 s29, s36, s28
    v_mfma_f32_16x16x32_bf16 v[112:115], v[160:163], v[140:143], v[112:115]
    s_mov_b32 s28, s36
    v_add_u32 v224, s29, v224
    v_mfma_f32_16x16x32_bf16 v[116:119], v[164:167], v[140:143], v[116:119]
    v_add_u32 v225, s29, v225
    s_waitcnt vmcnt(8) lgkmcnt(0)
    s_barrier
    v_mfma_f32_16x16x32_bf16 v[0:3], v[192:195], v[176:179], v[0:3]
    ds_read_b128 v[128:131], v224 offset:0
    ds_read_b64_tr_b16 v[144:145], v234 offset:32768
    v_mfma_f32_16x16x32_bf16 v[4:7], v[196:199], v[176:179], v[4:7]
    ds_read_b64_tr_b16 v[146:147], v234 offset:34304
    v_mfma_f32_16x16x32_bf16 v[8:11], v[200:203], v[176:179], v[8:11]
    ds_read_b64_tr_b16 v[148:149], v235 offset:32768
    v_mfma_f32_16x16x32_bf16 v[12:15], v[204:207], v[176:179], v[12:15]
    ds_read_b64_tr_b16 v[150:151], v235 offset:34304
    v_mfma_f32_16x16x32_bf16 v[16:19], v[208:211], v[176:179], v[16:19]
    ds_read_b128 v[132:135], v224 offset:1024
    ds_read_b64_tr_b16 v[152:153], v236 offset:32768
    v_mfma_f32_16x16x32_bf16 v[20:23], v[212:215], v[176:179], v[20:23]
    ds_read_b64_tr_b16 v[154:155], v236 offset:34304
    v_mfma_f32_16x16x32_bf16 v[32:35], v[192:195], v[180:183], v[32:35]
    ds_read_b64_tr_b16 v[156:157], v237 offset:32768
    v_mfma_f32_16x16x32_bf16 v[36:39], v[196:199], v[180:183], v[36:39]
    ds_read_b64_tr_b16 v[158:159], v237 offset:34304
    v_mfma_f32_16x16x32_bf16 v[40:43], v[200:203], v[180:183], v[40:43]
    ds_read_b64_tr_b16 v[160:161], v238 offset:32768
    v_mfma_f32_16x16x32_bf16 v[44:47], v[204:207], v[180:183], v[44:47]
    ds_read_b64_tr_b16 v[162:163], v238 offset:34304
    ds_read_b64_tr_b16 v[164:165], v239 offset:32768
    v_mfma_f32_16x16x32_bf16 v[48:51], v[208:211], v[180:183], v[48:51]
    ds_read_b64_tr_b16 v[166:167], v239 offset:34304
    v_mfma_f32_16x16x32_bf16 v[52:55], v[212:215], v[180:183], v[52:55]
    ds_read_b128 v[136:139], v224 offset:4096
    v_mfma_f32_16x16x32_bf16 v[64:67], v[192:195], v[184:187], v[64:67]
    ds_read_b128 v[140:143], v224 offset:5120
    v_mfma_f32_16x16x32_bf16 v[68:71], v[196:199], v[184:187], v[68:71]
    s_add_u32 m0, s33, 16384
    v_mfma_f32_16x16x32_bf16 v[72:75], v[200:203], v[184:187], v[72:75]
    s_nop 0
    buffer_load_dwordx4 v250, s[16:19], s30 offen offset:0 lds
    v_mfma_f32_16x16x32_bf16 v[76:79], v[204:207], v[184:187], v[76:79]
    buffer_load_dwordx4 v251, s[16:19], s30 offen offset:1024 lds
    v_mfma_f32_16x16x32_bf16 v[80:83], v[208:211], v[184:187], v[80:83]
    s_add_u32 s31, s40, s43
    v_mfma_f32_16x16x32_bf16 v[84:87], v[212:215], v[184:187], v[84:87]
    s_sub_u32 s37, s31, 7
    v_mfma_f32_16x16x32_bf16 v[96:99], v[192:195], v[188:191], v[96:99]
    s_cmp_ge_u32 s31, 7
    v_mfma_f32_16x16x32_bf16 v[100:103], v[196:199], v[188:191], v[100:103]
    s_cselect_b32 s31, s37, s31
    s_add_u32 s40, s40, 1
    v_mfma_f32_16x16x32_bf16 v[104:107], v[200:203], v[188:191], v[104:107]
    s_add_u32 m0, s27, s32
    v_mfma_f32_16x16x32_bf16 v[108:111], v[204:207], v[188:191], v[108:111]
    s_lshl_b32 s31, s31, 7
    v_mfma_f32_16x16x32_bf16 v[112:115], v[208:211], v[188:191], v[112:115]
    buffer_load_dwordx4 v244, s[12:15], s31 offen offset:0 lds
    v_mfma_f32_16x16x32_bf16 v[116:119], v[212:215], v[188:191], v[116:119]
    buffer_load_dwordx4 v245, s[12:15], s31 offen offset:1024 lds
    s_waitcnt vmcnt(10) lgkmcnt(0)
    s_barrier
    v_mfma_f32_16x16x32_bf16 v[0:3], v[144:147], v[128:131], v[0:3]
    ds_read_b128 v[176:179], v225 offset:0
    ds_read_b64_tr_b16 v[192:193], v234 offset:49152
    v_mfma_f32_16x16x32_bf16 v[4:7], v[148:151], v[128:131], v[4:7]
    ds_read_b64_tr_b16 v[194:195], v234 offset:50688
    ds_read_b64_tr_b16 v[196:197], v235 offset:49152
    v_mfma_f32_16x16x32_bf16 v[8:11], v[152:155], v[128:131], v[8:11]
    ds_read_b64_tr_b16 v[198:199], v235 offset:50688
    ds_read_b128 v[180:183], v225 offset:1024
    v_mfma_f32_16x16x32_bf16 v[12:15], v[156:159], v[128:131], v[12:15]
    ds_read_b64_tr_b16 v[200:201], v236 offset:49152
    v_mfma_f32_16x16x32_bf16 v[16:19], v[160:163], v[128:131], v[16:19]
    ds_read_b64_tr_b16 v[202:203], v236 offset:50688
    ds_read_b64_tr_b16 v[204:205], v237 offset:49152
    v_mfma_f32_16x16x32_bf16 v[20:23], v[164:167], v[128:131], v[20:23]
    ds_read_b64_tr_b16 v[206:207], v237 offset:50688
    ds_read_b64_tr_b16 v[208:209], v238 offset:49152
    v_mfma_f32_16x16x32_bf16 v[32:35], v[144:147], v[132:135], v[32:35]
    ds_read_b64_tr_b16 v[210:211], v238 offset:50688
    ds_read_b64_tr_b16 v[212:213], v239 offset:49152
    v_mfma_f32_16x16x32_bf16 v[36:39], v[148:151], v[132:135], v[36:39]
    ds_read_b64_tr_b16 v[214:215], v239 offset:50688
    v_mfma_f32_16x16x32_bf16 v[40:43], v[152:155], v[132:135], v[40:43]
    ds_read_b128 v[184:187], v225 offset:4096
    ds_read_b128 v[188:191], v225 offset:5120
    v_mfma_f32_16x16x32_bf16 v[44:47], v[156:159], v[132:135], v[44:47]
    s_add_u32 s30, s41, s43
    s_sub_u32 s37, s30, 7
    v_mfma_f32_16x16x32_bf16 v[48:51], v[160:163], v[132:135], v[48:51]
    s_cmp_ge_u32 s30, 7
    s_cselect_b32 s30, s37, s30
    v_mfma_f32_16x16x32_bf16 v[52:55], v[164:167], v[132:135], v[52:55]
    s_add_u32 s41, s41, 1
    v_mfma_f32_16x16x32_bf16 v[64:67], v[144:147], v[136:139], v[64:67]
    s_mul_i32 s30, s30, s45
    s_lshl_b32 s30, s30, 1
    v_mfma_f32_16x16x32_bf16 v[68:71], v[148:151], v[136:139], v[68:71]
    s_add_u32 m0, s33, 32768
    s_nop 0
    v_mfma_f32_16x16x32_bf16 v[72:75], v[152:155], v[136:139], v[72:75]
    buffer_load_dwordx4 v250, s[16:19], s30 offen offset:0 lds
    buffer_load_dwordx4 v251, s[16:19], s30 offen offset:1024 lds
    v_mfma_f32_16x16x32_bf16 v[76:79], v[156:159], v[136:139], v[76:79]
    s_add_u32 s30, s30, s45
    v_mfma_f32_16x16x32_bf16 v[80:83], v[160:163], v[136:139], v[80:83]
    s_add_u32 s35, s27, s32
    s_add_u32 m0, s35, 0x800
    v_mfma_f32_16x16x32_bf16 v[84:87], v[164:167], v[136:139], v[84:87]
    s_add_u32 s27, s27, 0x8000
    buffer_load_dwordx4 v246, s[12:15], s31 offen offset:0 lds
    v_mfma_f32_16x16x32_bf16 v[96:99], v[144:147], v[140:143], v[96:99]
    buffer_load_dwordx4 v247, s[12:15], s31 offen offset:1024 lds
    s_cmp_ge_u32 s27, 0x28000
    v_mfma_f32_16x16x32_bf16 v[100:103], v[148:151], v[140:143], v[100:103]
    s_cselect_b32 s27, 0x10000, s27
    v_mfma_f32_16x16x32_bf16 v[104:107], v[152:155], v[140:143], v[104:107]
    s_add_u32 s36, s28, 0x8000
    s_cmp_ge_u32 s36, 0x18000
    v_mfma_f32_16x16x32_bf16 v[108:111], v[156:159], v[140:143], v[108:111]
    s_cselect_b32 s36, 0, s36
    s_sub_u32 s29, s36, s28
    v_mfma_f32_16x16x32_bf16 v[112:115], v[160:163], v[140:143], v[112:115]
    s_mov_b32 s28, s36
    v_add_u32 v224, s29, v224
    v_mfma_f32_16x16x32_bf16 v[116:119], v[164:167], v[140:143], v[116:119]
    v_add_u32 v225, s29, v225
    s_waitcnt vmcnt(8) lgkmcnt(0)
    s_barrier
    v_mfma_f32_16x16x32_bf16 v[0:3], v[192:195], v[176:179], v[0:3]
    ds_read_b128 v[128:131], v224 offset:0
    ds_read_b64_tr_b16 v[144:145], v234 offset:0
    v_mfma_f32_16x16x32_bf16 v[4:7], v[196:199], v[176:179], v[4:7]
    ds_read_b64_tr_b16 v[146:147], v234 offset:1536
    v_mfma_f32_16x16x32_bf16 v[8:11], v[200:203], v[176:179], v[8:11]
    ds_read_b64_tr_b16 v[148:149], v235 offset:0
    v_mfma_f32_16x16x32_bf16 v[12:15], v[204:207], v[176:179], v[12:15]
    ds_read_b64_tr_b16 v[150:151], v235 offset:1536
    v_mfma_f32_16x16x32_bf16 v[16:19], v[208:211], v[176:179], v[16:19]
    ds_read_b128 v[132:135], v224 offset:1024
    ds_read_b64_tr_b16 v[152:153], v236 offset:0
    v_mfma_f32_16x16x32_bf16 v[20:23], v[212:215], v[176:179], v[20:23]
    ds_read_b64_tr_b16 v[154:155], v236 offset:1536
    v_mfma_f32_16x16x32_bf16 v[32:35], v[192:195], v[180:183], v[32:35]
    ds_read_b64_tr_b16 v[156:157], v237 offset:0
    v_mfma_f32_16x16x32_bf16 v[36:39], v[196:199], v[180:183], v[36:39]
    ds_read_b64_tr_b16 v[158:159], v237 offset:1536
    v_mfma_f32_16x16x32_bf16 v[40:43], v[200:203], v[180:183], v[40:43]
    ds_read_b64_tr_b16 v[160:161], v238 offset:0
    v_mfma_f32_16x16x32_bf16 v[44:47], v[204:207], v[180:183], v[44:47]
    ds_read_b64_tr_b16 v[162:163], v238 offset:1536
    ds_read_b64_tr_b16 v[164:165], v239 offset:0
    v_mfma_f32_16x16x32_bf16 v[48:51], v[208:211], v[180:183], v[48:51]
    ds_read_b64_tr_b16 v[166:167], v239 offset:1536
    v_mfma_f32_16x16x32_bf16 v[52:55], v[212:215], v[180:183], v[52:55]
    ds_read_b128 v[136:139], v224 offset:4096
    v_mfma_f32_16x16x32_bf16 v[64:67], v[192:195], v[184:187], v[64:67]
    ds_read_b128 v[140:143], v224 offset:5120
    v_mfma_f32_16x16x32_bf16 v[68:71], v[196:199], v[184:187], v[68:71]
    s_add_u32 m0, s33, 49152
    v_mfma_f32_16x16x32_bf16 v[72:75], v[200:203], v[184:187], v[72:75]
    s_nop 0
    buffer_load_dwordx4 v250, s[16:19], s30 offen offset:0 lds
    v_mfma_f32_16x16x32_bf16 v[76:79], v[204:207], v[184:187], v[76:79]
    buffer_load_dwordx4 v251, s[16:19], s30 offen offset:1024 lds
    v_mfma_f32_16x16x32_bf16 v[80:83], v[208:211], v[184:187], v[80:83]
    s_add_u32 s31, s40, s43
    v_mfma_f32_16x16x32_bf16 v[84:87], v[212:215], v[184:187], v[84:87]
    s_sub_u32 s37, s31, 7
    v_mfma_f32_16x16x32_bf16 v[96:99], v[192:195], v[188:191], v[96:99]
    s_cmp_ge_u32 s31, 7
    v_mfma_f32_16x16x32_bf16 v[100:103], v[196:199], v[188:191], v[100:103]
    s_cselect_b32 s31, s37, s31
    s_add_u32 s40, s40, 1
    v_mfma_f32_16x16x32_bf16 v[104:107], v[200:203], v[188:191], v[104:107]
    s_add_u32 m0, s27, s32
    v_mfma_f32_16x16x32_bf16 v[108:111], v[204:207], v[188:191], v[108:111]
    s_lshl_b32 s31, s31, 7
    v_mfma_f32_16x16x32_bf16 v[112:115], v[208:211], v[188:191], v[112:115]
    buffer_load_dwordx4 v244, s[12:15], s31 offen offset:0 lds
    v_mfma_f32_16x16x32_bf16 v[116:119], v[212:215], v[188:191], v[116:119]
    buffer_load_dwordx4 v245, s[12:15], s31 offen offset:1024 lds
    s_waitcnt vmcnt(10) lgkmcnt(0)
    s_barrier
    v_mfma_f32_16x16x32_bf16 v[0:3], v[144:147], v[128:131], v[0:3]
    ds_read_b128 v[176:179], v225 offset:0
    ds_read_b64_tr_b16 v[192:193], v234 offset:16384
    v_mfma_f32_16x16x32_bf16 v[4:7], v[148:151], v[128:131], v[4:7]
    ds_read_b64_tr_b16 v[194:195], v234 offset:17920
    ds_read_b64_tr_b16 v[196:197], v235 offset:16384
    v_mfma_f32_16x16x32_bf16 v[8:11], v[152:155], v[128:131], v[8:11]
    ds_read_b64_tr_b16 v[198:199], v235 offset:17920
    ds_read_b128 v[180:183], v225 offset:1024
    v_mfma_f32_16x16x32_bf16 v[12:15], v[156:159], v[128:131], v[12:15]
    ds_read_b64_tr_b16 v[200:201], v236 offset:16384
    v_mfma_f32_16x16x32_bf16 v[16:19], v[160:163], v[128:131], v[16:19]
    ds_read_b64_tr_b16 v[202:203], v236 offset:17920
    ds_read_b64_tr_b16 v[204:205], v237 offset:16384
    v_mfma_f32_16x16x32_bf16 v[20:23], v[164:167], v[128:131], v[20:23]
    ds_read_b64_tr_b16 v[206:207], v237 offset:17920
    ds_read_b64_tr_b16 v[208:209], v238 offset:16384
    v_mfma_f32_16x16x32_bf16 v[32:35], v[144:147], v[132:135], v[32:35]
    ds_read_b64_tr_b16 v[210:211], v238 offset:17920
    ds_read_b64_tr_b16 v[212:213], v239 offset:16384
    v_mfma_f32_16x16x32_bf16 v[36:39], v[148:151], v[132:135], v[36:39]
    ds_read_b64_tr_b16 v[214:215], v239 offset:17920
    v_mfma_f32_16x16x32_bf16 v[40:43], v[152:155], v[132:135], v[40:43]
    ds_read_b128 v[184:187], v225 offset:4096
    ds_read_b128 v[188:191], v225 offset:5120
    v_mfma_f32_16x16x32_bf16 v[44:47], v[156:159], v[132:135], v[44:47]
    s_add_u32 s30, s41, s43
    s_sub_u32 s37, s30, 7
    v_mfma_f32_16x16x32_bf16 v[48:51], v[160:163], v[132:135], v[48:51]
    s_cmp_ge_u32 s30, 7
    s_cselect_b32 s30, s37, s30
    v_mfma_f32_16x16x32_bf16 v[52:55], v[164:167], v[132:135], v[52:55]
    s_add_u32 s41, s41, 1
    v_mfma_f32_16x16x32_bf16 v[64:67], v[144:147], v[136:139], v[64:67]
    s_mul_i32 s30, s30, s45
    s_lshl_b32 s30, s30, 1
    v_mfma_f32_16x16x32_bf16 v[68:71], v[148:151], v[136:139], v[68:71]
    s_add_u32 m0, s33, 0
    s_nop 0
    v_mfma_f32_16x16x32_bf16 v[72:75], v[152:155], v[136:139], v[72:75]
    buffer_load_dwordx4 v250, s[16:19], s30 offen offset:0 lds
    buffer_load_dwordx4 v251, s[16:19], s30 offen offset:1024 lds
    v_mfma_f32_16x16x32_bf16 v[76:79], v[156:159], v[136:139], v[76:79]
    s_add_u32 s30, s30, s45
    v_mfma_f32_16x16x32_bf16 v[80:83], v[160:163], v[136:139], v[80:83]
    s_add_u32 s35, s27, s32
    s_add_u32 m0, s35, 0x800
    v_mfma_f32_16x16x32_bf16 v[84:87], v[164:167], v[136:139], v[84:87]
    s_add_u32 s27, s27, 0x8000
    buffer_load_dwordx4 v246, s[12:15], s31 offen offset:0 lds
    v_mfma_f32_16x16x32_bf16 v[96:99], v[144:147], v[140:143], v[96:99]
    buffer_load_dwordx4 v247, s[12:15], s31 offen offset:1024 lds
    s_cmp_ge_u32 s27, 0x28000
    v_mfma_f32_16x16x32_bf16 v[100:103], v[148:151], v[140:143], v[100:103]
    s_cselect_b32 s27, 0x10000, s27
    v_mfma_f32_16x16x32_bf16 v[104:107], v[152:155], v[140:143], v[104:107]
    s_add_u32 s36, s28, 0x8000
    s_cmp_ge_u32 s36, 0x18000
    v_mfma_f32_16x16x32_bf16 v[108:111], v[156:159], v[140:143], v[108:111]
    s_cselect_b32 s36, 0, s36
    s_sub_u32 s29, s36, s28
    v_mfma_f32_16x16x32_bf16 v[112:115], v[160:163], v[140:143], v[112:115]
    s_mov_b32 s28, s36
    v_add_u32 v224, s29, v224
    v_mfma_f32_16x16x32_bf16 v[116:119], v[164:167], v[140:143], v[116:119]
    v_add_u32 v225, s29, v225
    s_waitcnt vmcnt(8) lgkmcnt(0)
    s_barrier
    v_mfma_f32_16x16x32_bf16 v[0:3], v[192:195], v[176:179], v[0:3]
    ds_read_b128 v[128:131], v224 offset:0
    v_mfma_f32_16x16x32_bf16 v[4:7], v[196:199], v[176:179], v[4:7]
    ds_read_b64_tr_b16 v[144:145], v234 offset:32768
    v_mfma_f32_16x16x32_bf16 v[8:11], v[200:203], v[176:179], v[8:11]
    ds_read_b64_tr_b16 v[146:147], v234 offset:34304
    v_mfma_f32_16x16x32_bf16 v[12:15], v[204:207], v[176:179], v[12:15]
    ds_read_b64_tr_b16 v[148:149], v235 offset:32768
    v_mfma_f32_16x16x32_bf16 v[16:19], v[208:211], v[176:179], v[16:19]
    ds_read_b64_tr_b16 v[150:151], v235 offset:34304
    v_mfma_f32_16x16x32_bf16 v[20:23], v[212:215], v[176:179], v[20:23]
    v_mfma_f32_16x16x32_bf16 v[32:35], v[192:195], v[180:183], v[32:35]
    ds_read_b128 v[132:135], v224 offset:1024
    v_mfma_f32_16x16x32_bf16 v[36:39], v[196:199], v[180:183], v[36:39]
    ds_read_b64_tr_b16 v[152:153], v236 offset:32768
    v_mfma_f32_16x16x32_bf16 v[40:43], v[200:203], v[180:183], v[40:43]
    ds_read_b64_tr_b16 v[154:155], v236 offset:34304
    v_mfma_f32_16x16x32_bf16 v[44:47], v[204:207], v[180:183], v[44:47]
    ds_read_b64_tr_b16 v[156:157], v237 offset:32768
    v_mfma_f32_16x16x32_bf16 v[48:51], v[208:211], v[180:183], v[48:51]
    ds_read_b64_tr_b16 v[158:159], v237 offset:34304
    v_mfma_f32_16x16x32_bf16 v[52:55], v[212:215], v[180:183], v[52:55]
    v_mfma_f32_16x16x32_bf16 v[64:67], v[192:195], v[184:187], v[64:67]
    ds_read_b64_tr_b16 v[160:161], v238 offset:32768
    v_mfma_f32_16x16x32_bf16 v[68:71], v[196:199], v[184:187], v[68:71]
    ds_read_b64_tr_b16 v[162:163], v238 offset:34304
    v_mfma_f32_16x16x32_bf16 v[72:75], v[200:203], v[184:187], v[72:75]
    ds_read_b64_tr_b16 v[164:165], v239 offset:32768
    v_mfma_f32_16x16x32_bf16 v[76:79], v[204:207], v[184:187], v[76:79]
    ds_read_b64_tr_b16 v[166:167], v239 offset:34304
    v_mfma_f32_16x16x32_bf16 v[80:83], v[208:211], v[184:187], v[80:83]
    ds_read_b128 v[136:139], v224 offset:4096
    v_mfma_f32_16x16x32_bf16 v[84:87], v[212:215], v[184:187], v[84:87]
    v_mfma_f32_16x16x32_bf16 v[96:99], v[192:195], v[188:191], v[96:99]
    ds_read_b128 v[140:143], v224 offset:5120
    v_mfma_f32_16x16x32_bf16 v[100:103], v[196:199], v[188:191], v[100:103]
    s_add_u32 m0, s33, 16384
    v_mfma_f32_16x16x32_bf16 v[104:107], v[200:203], v[188:191], v[104:107]
    s_nop 0
    v_mfma_f32_16x16x32_bf16 v[108:111], v[204:207], v[188:191], v[108:111]
    buffer_load_dwordx4 v250, s[16:19], s30 offen offset:0 lds
    v_mfma_f32_16x16x32_bf16 v[112:115], v[208:211], v[188:191], v[112:115]
    buffer_load_dwordx4 v251, s[16:19], s30 offen offset:1024 lds
    v_mfma_f32_16x16x32_bf16 v[116:119], v[212:215], v[188:191], v[116:119]
    s_waitcnt vmcnt(8) lgkmcnt(0)
    s_barrier
    v_mfma_f32_16x16x32_bf16 v[0:3], v[144:147], v[128:131], v[0:3]
    ds_read_b128 v[176:179], v225 offset:0
    v_mfma_f32_16x16x32_bf16 v[4:7], v[148:151], v[128:131], v[4:7]
    ds_read_b64_tr_b16 v[192:193], v234 offset:49152
    v_mfma_f32_16x16x32_bf16 v[8:11], v[152:155], v[128:131], v[8:11]
    ds_read_b64_tr_b16 v[194:195], v234 offset:50688
    v_mfma_f32_16x16x32_bf16 v[12:15], v[156:159], v[128:131], v[12:15]
    ds_read_b64_tr_b16 v[196:197], v235 offset:49152
    v_mfma_f32_16x16x32_bf16 v[16:19], v[160:163], v[128:131], v[16:19]
    ds_read_b64_tr_b16 v[198:199], v235 offset:50688
    v_mfma_f32_16x16x32_bf16 v[20:23], v[164:167], v[128:131], v[20:23]
    ds_read_b128 v[180:183], v225 offset:1024
    v_mfma_f32_16x16x32_bf16 v[32:35], v[144:147], v[132:135], v[32:35]
    ds_read_b64_tr_b16 v[200:201], v236 offset:49152
    v_mfma_f32_16x16x32_bf16 v[36:39], v[148:151], v[132:135], v[36:39]
    ds_read_b64_tr_b16 v[202:203], v236 offset:50688
    v_mfma_f32_16x16x32_bf16 v[40:43], v[152:155], v[132:135], v[40:43]
    ds_read_b64_tr_b16 v[204:205], v237 offset:49152
    v_mfma_f32_16x16x32_bf16 v[44:47], v[156:159], v[132:135], v[44:47]
    ds_read_b64_tr_b16 v[206:207], v237 offset:50688
    v_mfma_f32_16x16x32_bf16 v[48:51], v[160:163], v[132:135], v[48:51]
    ds_read_b64_tr_b16 v[208:209], v238 offset:49152
    v_mfma_f32_16x16x32_bf16 v[52:55], v[164:167], v[132:135], v[52:55]
    ds_read_b64_tr_b16 v[210:211], v238 offset:50688
    v_mfma_f32_16x16x32_bf16 v[64:67], v[144:147], v[136:139], v[64:67]
    ds_read_b64_tr_b16 v[212:213], v239 offset:49152
    v_mfma_f32_16x16x32_bf16 v[68:71], v[148:151], v[136:139], v[68:71]
    ds_read_b64_tr_b16 v[214:215], v239 offset:50688
    v_mfma_f32_16x16x32_bf16 v[72:75], v[152:155], v[136:139], v[72:75]
    ds_read_b128 v[184:187], v225 offset:4096
    v_mfma_f32_16x16x32_bf16 v[76:79], v[156:159], v[136:139], v[76:79]
    ds_read_b128 v[188:191], v225 offset:5120
    v_mfma_f32_16x16x32_bf16 v[80:83], v[160:163], v[136:139], v[80:83]
    s_add_u32 s36, s28, 0x8000
    v_mfma_f32_16x16x32_bf16 v[84:87], v[164:167], v[136:139], v[84:87]
    s_cmp_ge_u32 s36, 0x18000
    v_mfma_f32_16x16x32_bf16 v[96:99], v[144:147], v[140:143], v[96:99]
    s_cselect_b32 s36, 0, s36
    v_mfma_f32_16x16x32_bf16 v[100:103], v[148:151], v[140:143], v[100:103]
    s_sub_u32 s29, s36, s28
    v_mfma_f32_16x16x32_bf16 v[104:107], v[152:155], v[140:143], v[104:107]
    s_mov_b32 s28, s36
    v_mfma_f32_16x16x32_bf16 v[108:111], v[156:159], v[140:143], v[108:111]
    v_add_u32 v224, s29, v224
    v_mfma_f32_16x16x32_bf16 v[112:115], v[160:163], v[140:143], v[112:115]
    v_add_u32 v225, s29, v225
    v_mfma_f32_16x16x32_bf16 v[116:119], v[164:167], v[140:143], v[116:119]
    s_waitcnt vmcnt(2) lgkmcnt(0)
    s_barrier
    v_mfma_f32_16x16x32_bf16 v[0:3], v[192:195], v[176:179], v[0:3]
    ds_read_b128 v[128:131], v224 offset:0
    v_mfma_f32_16x16x32_bf16 v[4:7], v[196:199], v[176:179], v[4:7]
    ds_read_b64_tr_b16 v[144:145], v234 offset:0
    v_mfma_f32_16x16x32_bf16 v[8:11], v[200:203], v[176:179], v[8:11]
    v_mfma_f32_16x16x32_bf16 v[12:15], v[204:207], v[176:179], v[12:15]
    ds_read_b64_tr_b16 v[146:147], v234 offset:1536
    v_mfma_f32_16x16x32_bf16 v[16:19], v[208:211], v[176:179], v[16:19]
    ds_read_b64_tr_b16 v[148:149], v235 offset:0
    v_mfma_f32_16x16x32_bf16 v[20:23], v[212:215], v[176:179], v[20:23]
    v_mfma_f32_16x16x32_bf16 v[32:35], v[192:195], v[180:183], v[32:35]
    ds_read_b64_tr_b16 v[150:151], v235 offset:1536
    v_mfma_f32_16x16x32_bf16 v[36:39], v[196:199], v[180:183], v[36:39]
    ds_read_b128 v[132:135], v224 offset:1024
    v_mfma_f32_16x16x32_bf16 v[40:43], v[200:203], v[180:183], v[40:43]
    v_mfma_f32_16x16x32_bf16 v[44:47], v[204:207], v[180:183], v[44:47]
    ds_read_b64_tr_b16 v[152:153], v236 offset:0
    v_mfma_f32_16x16x32_bf16 v[48:51], v[208:211], v[180:183], v[48:51]
    ds_read_b64_tr_b16 v[154:155], v236 offset:1536
    v_mfma_f32_16x16x32_bf16 v[52:55], v[212:215], v[180:183], v[52:55]
    v_mfma_f32_16x16x32_bf16 v[64:67], v[192:195], v[184:187], v[64:67]
    ds_read_b64_tr_b16 v[156:157], v237 offset:0
    v_mfma_f32_16x16x32_bf16 v[68:71], v[196:199], v[184:187], v[68:71]
    ds_read_b64_tr_b16 v[158:159], v237 offset:1536
    v_mfma_f32_16x16x32_bf16 v[72:75], v[200:203], v[184:187], v[72:75]
    v_mfma_f32_16x16x32_bf16 v[76:79], v[204:207], v[184:187], v[76:79]
    ds_read_b64_tr_b16 v[160:161], v238 offset:0
    v_mfma_f32_16x16x32_bf16 v[80:83], v[208:211], v[184:187], v[80:83]
    ds_read_b64_tr_b16 v[162:163], v238 offset:1536
    v_mfma_f32_16x16x32_bf16 v[84:87], v[212:215], v[184:187], v[84:87]
    v_mfma_f32_16x16x32_bf16 v[96:99], v[192:195], v[188:191], v[96:99]
    ds_read_b64_tr_b16 v[164:165], v239 offset:0
    v_mfma_f32_16x16x32_bf16 v[100:103], v[196:199], v[188:191], v[100:103]
    ds_read_b64_tr_b16 v[166:167], v239 offset:1536
    v_mfma_f32_16x16x32_bf16 v[104:107], v[200:203], v[188:191], v[104:107]
    v_mfma_f32_16x16x32_bf16 v[108:111], v[204:207], v[188:191], v[108:111]
    ds_read_b128 v[136:139], v224 offset:4096
    v_mfma_f32_16x16x32_bf16 v[112:115], v[208:211], v[188:191], v[112:115]
    ds_read_b128 v[140:143], v224 offset:5120
    v_mfma_f32_16x16x32_bf16 v[116:119], v[212:215], v[188:191], v[116:119]
    s_waitcnt vmcnt(0) lgkmcnt(0)
    s_barrier
    v_mfma_f32_16x16x32_bf16 v[0:3], v[144:147], v[128:131], v[0:3]
    ds_read_b128 v[176:179], v225 offset:0
    v_mfma_f32_16x16x32_bf16 v[4:7], v[148:151], v[128:131], v[4:7]
    ds_read_b64_tr_b16 v[192:193], v234 offset:16384
    v_mfma_f32_16x16x32_bf16 v[8:11], v[152:155], v[128:131], v[8:11]
    ds_read_b64_tr_b16 v[194:195], v234 offset:17920
    v_mfma_f32_16x16x32_bf16 v[12:15], v[156:159], v[128:131], v[12:15]
    ds_read_b64_tr_b16 v[196:197], v235 offset:16384
    v_mfma_f32_16x16x32_bf16 v[16:19], v[160:163], v[128:131], v[16:19]
    ds_read_b64_tr_b16 v[198:199], v235 offset:17920
    v_mfma_f32_16x16x32_bf16 v[20:23], v[164:167], v[128:131], v[20:23]
    ds_read_b128 v[180:183], v225 offset:1024
    v_mfma_f32_16x16x32_bf16 v[32:35], v[144:147], v[132:135], v[32:35]
    ds_read_b64_tr_b16 v[200:201], v236 offset:16384
    v_mfma_f32_16x16x32_bf16 v[36:39], v[148:151], v[132:135], v[36:39]
    ds_read_b64_tr_b16 v[202:203], v236 offset:17920
    v_mfma_f32_16x16x32_bf16 v[40:43], v[152:155], v[132:135], v[40:43]
    ds_read_b64_tr_b16 v[204:205], v237 offset:16384
    v_mfma_f32_16x16x32_bf16 v[44:47], v[156:159], v[132:135], v[44:47]
    ds_read_b64_tr_b16 v[206:207], v237 offset:17920
    v_mfma_f32_16x16x32_bf16 v[48:51], v[160:163], v[132:135], v[48:51]
    ds_read_b64_tr_b16 v[208:209], v238 offset:16384
    v_mfma_f32_16x16x32_bf16 v[52:55], v[164:167], v[132:135], v[52:55]
    ds_read_b64_tr_b16 v[210:211], v238 offset:17920
    v_mfma_f32_16x16x32_bf16 v[64:67], v[144:147], v[136:139], v[64:67]
    ds_read_b64_tr_b16 v[212:213], v239 offset:16384
    v_mfma_f32_16x16x32_bf16 v[68:71], v[148:151], v[136:139], v[68:71]
    ds_read_b64_tr_b16 v[214:215], v239 offset:17920
    v_mfma_f32_16x16x32_bf16 v[72:75], v[152:155], v[136:139], v[72:75]
    ds_read_b128 v[184:187], v225 offset:4096
    v_mfma_f32_16x16x32_bf16 v[76:79], v[156:159], v[136:139], v[76:79]
    ds_read_b128 v[188:191], v225 offset:5120
    v_mfma_f32_16x16x32_bf16 v[80:83], v[160:163], v[136:139], v[80:83]
    s_add_u32 s36, s28, 0x8000
    v_mfma_f32_16x16x32_bf16 v[84:87], v[164:167], v[136:139], v[84:87]
    s_cmp_ge_u32 s36, 0x18000
    v_mfma_f32_16x16x32_bf16 v[96:99], v[144:147], v[140:143], v[96:99]
    s_cselect_b32 s36, 0, s36
    v_mfma_f32_16x16x32_bf16 v[100:103], v[148:151], v[140:143], v[100:103]
    s_sub_u32 s29, s36, s28
    v_mfma_f32_16x16x32_bf16 v[104:107], v[152:155], v[140:143], v[104:107]
    s_mov_b32 s28, s36
    v_mfma_f32_16x16x32_bf16 v[108:111], v[156:159], v[140:143], v[108:111]
    v_add_u32 v224, s29, v224
    v_mfma_f32_16x16x32_bf16 v[112:115], v[160:163], v[140:143], v[112:115]
    v_add_u32 v225, s29, v225
    v_mfma_f32_16x16x32_bf16 v[116:119], v[164:167], v[140:143], v[116:119]
    s_waitcnt lgkmcnt(0)
    v_mfma_f32_16x16x32_bf16 v[0:3], v[192:195], v[176:179], v[0:3]
    v_mfma_f32_16x16x32_bf16 v[4:7], v[196:199], v[176:179], v[4:7]
    v_mfma_f32_16x16x32_bf16 v[8:11], v[200:203], v[176:179], v[8:11]
    v_mfma_f32_16x16x32_bf16 v[12:15], v[204:207], v[176:179], v[12:15]
    v_mfma_f32_16x16x32_bf16 v[16:19], v[208:211], v[176:179], v[16:19]
    v_mfma_f32_16x16x32_bf16 v[20:23], v[212:215], v[176:179], v[20:23]
    v_mfma_f32_16x16x32_bf16 v[32:35], v[192:195], v[180:183], v[32:35]
    v_mfma_f32_16x16x32_bf16 v[36:39], v[196:199], v[180:183], v[36:39]
    v_mfma_f32_16x16x32_bf16 v[40:43], v[200:203], v[180:183], v[40:43]
    v_mfma_f32_16x16x32_bf16 v[44:47], v[204:207], v[180:183], v[44:47]
    v_mfma_f32_16x16x32_bf16 v[48:51], v[208:211], v[180:183], v[48:51]
    v_mfma_f32_16x16x32_bf16 v[52:55], v[212:215], v[180:183], v[52:55]
    v_mfma_f32_16x16x32_bf16 v[64:67], v[192:195], v[184:187], v[64:67]
    v_mfma_f32_16x16x32_bf16 v[68:71], v[196:199], v[184:187], v[68:71]
    v_mfma_f32_16x16x32_bf16 v[72:75], v[200:203], v[184:187], v[72:75]
    v_mfma_f32_16x16x32_bf16 v[76:79], v[204:207], v[184:187], v[76:79]
    v_mfma_f32_16x16x32_bf16 v[80:83], v[208:211], v[184:187], v[80:83]
    v_mfma_f32_16x16x32_bf16 v[84:87], v[212:215], v[184:187], v[84:87]
    v_mfma_f32_16x16x32_bf16 v[96:99], v[192:195], v[188:191], v[96:99]
    v_mfma_f32_16x16x32_bf16 v[100:103], v[196:199], v[188:191], v[100:103]
    v_mfma_f32_16x16x32_bf16 v[104:107], v[200:203], v[188:191], v[104:107]
    v_mfma_f32_16x16x32_bf16 v[108:111], v[204:207], v[188:191], v[108:111]
    v_mfma_f32_16x16x32_bf16 v[112:115], v[208:211], v[188:191], v[112:115]
    v_mfma_f32_16x16x32_bf16 v[116:119], v[212:215], v[188:191], v[116:119]
    s_nop 7
    s_lshl_b32 s38, s51, 3
    s_lshl_b32 s36, s25, 1
    s_add_u32 s38, s38, s36
    s_mul_i32 s35, s26, 3
    s_add_u32 s35, s35, s68
    s_add_u32 s35, s35, 0
    s_cmp_lg_u32 s71, 0
    s_cbranch_scc1 K1_E_1
    s_lshr_b32 s36, s35, 3
    s_lshl_b32 s36, s36, 20
    s_and_b32 s37, s35, 7
    s_lshl_b32 s37, s37, 11
    s_add_u32 s39, s36, s37
    s_lshl_b32 s36, s38, 14
    s_add_u32 s39, s39, s36
    s_add_u32 s39, s39, 0x2000000
    s_cmp_ge_u32 s35, 128
    s_cselect_b32 s39, 0x7ff00000, s39
    s_cmp_lg_u32 s94, 0
    s_cselect_b32 s39, 0x7ff00000, s39
    v_cvt_pk_bf16_f32 v128, v0, v1
    v_cvt_pk_bf16_f32 v129, v2, v3
    v_cvt_pk_bf16_f32 v130, v4, v5
    v_cvt_pk_bf16_f32 v131, v6, v7
    buffer_store_dwordx4 v[128:131], v252, s[20:23], s39 offen offset:0 sc1
    v_cvt_pk_bf16_f32 v132, v32, v33
    v_cvt_pk_bf16_f32 v133, v34, v35
    v_cvt_pk_bf16_f32 v134, v36, v37
    v_cvt_pk_bf16_f32 v135, v38, v39
    buffer_store_dwordx4 v[132:135], v252, s[20:23], s39 offen offset:128 sc1
    s_add_u32 s39, s39, 16384
    v_cvt_pk_bf16_f32 v136, v64, v65
    v_cvt_pk_bf16_f32 v137, v66, v67
    v_cvt_pk_bf16_f32 v138, v68, v69
    v_cvt_pk_bf16_f32 v139, v70, v71
    buffer_store_dwordx4 v[136:139], v252, s[20:23], s39 offen offset:0 sc1
    v_cvt_pk_bf16_f32 v140, v96, v97
    v_cvt_pk_bf16_f32 v141, v98, v99
    v_cvt_pk_bf16_f32 v142, v100, v101
    v_cvt_pk_bf16_f32 v143, v102, v103
    buffer_store_dwordx4 v[140:143], v252, s[20:23], s39 offen offset:128 sc1
    s_add_u32 s39, s39, 16384
    s_branch K1_E_4
K1_E_1:
    s_and_b32 s36, s35, 15
    s_lshl_b32 s36, s36, 6
    s_add_u32 s36, s36, s38
    s_lshr_b32 s37, s35, 4
    s_cmp_eq_u32 s37, 1
    s_cbranch_scc1 K1_E_2
    s_cmp_eq_u32 s37, 2
    s_cbranch_scc1 K1_E_3
    s_lshl_b32 s39, s36, 11
    s_add_u32 s39, s39, 0x3000000
    v_mul_f32 v0, s95, v0
    v_mul_f32 v4, s95, v4
    v_mul_f32 v1, s95, v1
    v_mul_f32 v5, s95, v5
    v_mul_f32 v2, s95, v2
    v_mul_f32 v6, s95, v6
    v_mul_f32 v3, s95, v3
    v_mul_f32 v7, s95, v7
    s_mov_b32 exec_lo, 0
    s_mov_b32 exec_hi, 0xffff0000
    v_mov_b32 v4, 0
    v_mov_b32 v5, 0
    v_mov_b32 v6, 0
    v_mov_b32 v7, 0
    s_mov_b64 exec, -1
    v_cvt_pk_bf16_f32 v128, v0, v1
    v_cvt_pk_bf16_f32 v129, v2, v3
    v_cvt_pk_bf16_f32 v130, v4, v5
    v_cvt_pk_bf16_f32 v131, v6, v7
    buffer_store_dwordx4 v[128:131], v252, s[20:23], s39 offen offset:0 sc1
    v_mul_f32 v32, s95, v32
    v_mul_f32 v36, s95, v36
    v_mul_f32 v33, s95, v33
    v_mul_f32 v37, s95, v37
    v_mul_f32 v34, s95, v34
    v_mul_f32 v38, s95, v38
    v_mul_f32 v35, s95, v35
    v_mul_f32 v39, s95, v39
    s_mov_b32 exec_lo, 0
    s_mov_b32 exec_hi, 0xffff0000
    v_mov_b32 v36, 0
    v_mov_b32 v37, 0
    v_mov_b32 v38, 0
    v_mov_b32 v39, 0
    s_mov_b64 exec, -1
    v_cvt_pk_bf16_f32 v132, v32, v33
    v_cvt_pk_bf16_f32 v133, v34, v35
    v_cvt_pk_bf16_f32 v134, v36, v37
    v_cvt_pk_bf16_f32 v135, v38, v39
    buffer_store_dwordx4 v[132:135], v252, s[20:23], s39 offen offset:128 sc1
    v_mul_f32 v64, s95, v64
    v_mul_f32 v68, s95, v68
    v_mul_f32 v65, s95, v65
    v_mul_f32 v69, s95, v69
    v_mul_f32 v66, s95, v66
    v_mul_f32 v70, s95, v70
    v_mul_f32 v67, s95, v67
    v_mul_f32 v71, s95, v71
    s_mov_b32 exec_lo, 0
    s_mov_b32 exec_hi, 0xffff0000
    v_mov_b32 v68, 0
    v_mov_b32 v69, 0
    v_mov_b32 v70, 0
    v_mov_b32 v71, 0
    s_mov_b64 exec, -1
    v_cvt_pk_bf16_f32 v136, v64, v65
    v_cvt_pk_bf16_f32 v137, v66, v67
    v_cvt_pk_bf16_f32 v138, v68, v69
    v_cvt_pk_bf16_f32 v139, v70, v71
    buffer_store_dwordx4 v[136:139], v252, s[20:23], s39 offen offset:2048 sc1
    v_mul_f32 v96, s95, v96
    v_mul_f32 v100, s95, v100
    v_mul_f32 v97, s95, v97
    v_mul_f32 v101, s95, v101
    v_mul_f32 v98, s95, v98
    v_mul_f32 v102, s95, v102
    v_mul_f32 v99, s95, v99
    v_mul_f32 v103, s95, v103
    s_mov_b32 exec_lo, 0
    s_mov_b32 exec_hi, 0xffff0000
    v_mov_b32 v100, 0
    v_mov_b32 v101, 0
    v_mov_b32 v102, 0
    v_mov_b32 v103, 0
    s_mov_b64 exec, -1
    v_cvt_pk_bf16_f32 v140, v96, v97
    v_cvt_pk_bf16_f32 v141, v98, v99
    v_cvt_pk_bf16_f32 v142, v100, v101
    v_cvt_pk_bf16_f32 v143, v102, v103
    buffer_store_dwordx4 v[140:143], v252, s[20:23], s39 offen offset:2176 sc1
    s_branch K1_E_4
K1_E_2:
    s_lshl_b32 s39, s36, 12
    s_add_u32 s39, s39, 0x3200000
    s_mov_b32 exec_lo, 0
    s_mov_b32 exec_hi, 0xffff0000
    v_mov_b32 v4, 0
    v_mov_b32 v5, 0
    v_mov_b32 v6, 0
    v_mov_b32 v7, 0
    s_mov_b64 exec, -1
    v_cvt_pk_bf16_f32 v128, v0, v1
    v_cvt_pk_bf16_f32 v129, v2, v3
    v_cvt_pk_bf16_f32 v130, v4, v5
    v_cvt_pk_bf16_f32 v131, v6, v7
    buffer_store_dwordx4 v[128:131], v252, s[20:23], s39 offen offset:0 sc1
    s_mov_b32 exec_lo, 0
    s_mov_b32 exec_hi, 0xffff0000
    v_mov_b32 v36, 0
    v_mov_b32 v37, 0
    v_mov_b32 v38, 0
    v_mov_b32 v39, 0
    s_mov_b64 exec, -1
    v_cvt_pk_bf16_f32 v132, v32, v33
    v_cvt_pk_bf16_f32 v133, v34, v35
    v_cvt_pk_bf16_f32 v134, v36, v37
    v_cvt_pk_bf16_f32 v135, v38, v39
    buffer_store_dwordx4 v[132:135], v252, s[20:23], s39 offen offset:128 sc1
    s_add_u32 s39, s39, 4096
    s_mov_b32 exec_lo, 0
    s_mov_b32 exec_hi, 0xffff0000
    v_mov_b32 v68, 0
    v_mov_b32 v69, 0
    v_mov_b32 v70, 0
    v_mov_b32 v71, 0
    s_mov_b64 exec, -1
    v_cvt_pk_bf16_f32 v136, v64, v65
    v_cvt_pk_bf16_f32 v137, v66, v67
    v_cvt_pk_bf16_f32 v138, v68, v69
    v_cvt_pk_bf16_f32 v139, v70, v71
    buffer_store_dwordx4 v[136:139], v252, s[20:23], s39 offen offset:0 sc1
    s_mov_b32 exec_lo, 0
    s_mov_b32 exec_hi, 0xffff0000
    v_mov_b32 v100, 0
    v_mov_b32 v101, 0
    v_mov_b32 v102, 0
    v_mov_b32 v103, 0
    s_mov_b64 exec, -1
    v_cvt_pk_bf16_f32 v140, v96, v97
    v_cvt_pk_bf16_f32 v141, v98, v99
    v_cvt_pk_bf16_f32 v142, v100, v101
    v_cvt_pk_bf16_f32 v143, v102, v103
    buffer_store_dwordx4 v[140:143], v252, s[20:23], s39 offen offset:128 sc1
    s_add_u32 s39, s39, 4096
    s_branch K1_E_4
K1_E_3:
    s_lshl_b32 s39, s36, 12
    s_add_u32 s39, s39, 0x3200800
    v_bfe_u32 v254, v253, 3, 1
    v_and_b32 v255, 7, v253
    v_lshl_add_u32 v254, v254, 4, v255
    v_lshrrev_b32 v255, 4, v253
    v_lshlrev_b32 v255, 4, v255
    v_lshl_add_u32 v254, v254, 6, v255
    s_mov_b32 exec_lo, 0
    s_mov_b32 exec_hi, 0xffff0000
    v_mov_b32 v4, 1.0
    v_mov_b32 v5, 0
    v_mov_b32 v6, 0
    v_mov_b32 v7, 0
    s_mov_b64 exec, -1
    v_cvt_pk_bf16_f32 v128, v0, v1
    v_cvt_pk_bf16_f32 v129, v2, v3
    v_cvt_pk_bf16_f32 v130, v4, v5
    v_cvt_pk_bf16_f32 v131, v6, v7
    buffer_store_dwordx4 v[128:131], v254, s[20:23], s39 offen offset:0 sc1
    s_mov_b32 exec_lo, 0
    s_mov_b32 exec_hi, 0xffff0000
    v_mov_b32 v36, 1.0
    v_mov_b32 v37, 0
    v_mov_b32 v38, 0
    v_mov_b32 v39, 0
    s_mov_b64 exec, -1
    v_cvt_pk_bf16_f32 v132, v32, v33
    v_cvt_pk_bf16_f32 v133, v34, v35
    v_cvt_pk_bf16_f32 v134, v36, v37
    v_cvt_pk_bf16_f32 v135, v38, v39
    buffer_store_dwordx4 v[132:135], v254, s[20:23], s39 offen offset:512 sc1
    s_add_u32 s39, s39, 4096
    s_mov_b32 exec_lo, 0
    s_mov_b32 exec_hi, 0xffff0000
    v_mov_b32 v68, 1.0
    v_mov_b32 v69, 0
    v_mov_b32 v70, 0
    v_mov_b32 v71, 0
    s_mov_b64 exec, -1
    v_cvt_pk_bf16_f32 v136, v64, v65
    v_cvt_pk_bf16_f32 v137, v66, v67
    v_cvt_pk_bf16_f32 v138, v68, v69
    v_cvt_pk_bf16_f32 v139, v70, v71
    buffer_store_dwordx4 v[136:139], v254, s[20:23], s39 offen offset:0 sc1
    s_mov_b32 exec_lo, 0
    s_mov_b32 exec_hi, 0xffff0000
    v_mov_b32 v100, 1.0
    v_mov_b32 v101, 0
    v_mov_b32 v102, 0
    v_mov_b32 v103, 0
    s_mov_b64 exec, -1
    v_cvt_pk_bf16_f32 v140, v96, v97
    v_cvt_pk_bf16_f32 v141, v98, v99
    v_cvt_pk_bf16_f32 v142, v100, v101
    v_cvt_pk_bf16_f32 v143, v102, v103
    buffer_store_dwordx4 v[140:143], v254, s[20:23], s39 offen offset:512 sc1
    s_add_u32 s39, s39, 4096
K1_E_4:
    s_mul_i32 s35, s26, 3
    s_add_u32 s35, s35, s68
    s_add_u32 s35, s35, 1
    s_cmp_lg_u32 s71, 0
    s_cbranch_scc1 K1_E_5
    s_lshr_b32 s36, s35, 3
    s_lshl_b32 s36, s36, 20
    s_and_b32 s37, s35, 7
    s_lshl_b32 s37, s37, 11
    s_add_u32 s39, s36, s37
    s_lshl_b32 s36, s38, 14
    s_add_u32 s39, s39, s36
    s_add_u32 s39, s39, 0x2000000
    s_cmp_ge_u32 s35, 128
    s_cselect_b32 s39, 0x7ff00000, s39
    s_cmp_lg_u32 s94, 0
    s_cselect_b32 s39, 0x7ff00000, s39
    v_cvt_pk_bf16_f32 v144, v8, v9
    v_cvt_pk_bf16_f32 v145, v10, v11
    v_cvt_pk_bf16_f32 v146, v12, v13
    v_cvt_pk_bf16_f32 v147, v14, v15
    buffer_store_dwordx4 v[144:147], v252, s[20:23], s39 offen offset:0 sc1
    v_cvt_pk_bf16_f32 v148, v40, v41
    v_cvt_pk_bf16_f32 v149, v42, v43
    v_cvt_pk_bf16_f32 v150, v44, v45
    v_cvt_pk_bf16_f32 v151, v46, v47
    buffer_store_dwordx4 v[148:151], v252, s[20:23], s39 offen offset:128 sc1
    s_add_u32 s39, s39, 16384
    v_cvt_pk_bf16_f32 v152, v72, v73
    v_cvt_pk_bf16_f32 v153, v74, v75
    v_cvt_pk_bf16_f32 v154, v76, v77
    v_cvt_pk_bf16_f32 v155, v78, v79
    buffer_store_dwordx4 v[152:155], v252, s[20:23], s39 offen offset:0 sc1
    v_cvt_pk_bf16_f32 v156, v104, v105
    v_cvt_pk_bf16_f32 v157, v106, v107
    v_cvt_pk_bf16_f32 v158, v108, v109
    v_cvt_pk_bf16_f32 v159, v110, v111
    buffer_store_dwordx4 v[156:159], v252, s[20:23], s39 offen offset:128 sc1
    s_add_u32 s39, s39, 16384
    s_branch K1_E_8
K1_E_5:
    s_and_b32 s36, s35, 15
    s_lshl_b32 s36, s36, 6
    s_add_u32 s36, s36, s38
    s_lshr_b32 s37, s35, 4
    s_cmp_eq_u32 s37, 1
    s_cbranch_scc1 K1_E_6
    s_cmp_eq_u32 s37, 2
    s_cbranch_scc1 K1_E_7
    s_lshl_b32 s39, s36, 11
    s_add_u32 s39, s39, 0x3000000
    v_mul_f32 v8, s95, v8
    v_mul_f32 v12, s95, v12
    v_mul_f32 v9, s95, v9
    v_mul_f32 v13, s95, v13
    v_mul_f32 v10, s95, v10
    v_mul_f32 v14, s95, v14
    v_mul_f32 v11, s95, v11
    v_mul_f32 v15, s95, v15
    s_mov_b32 exec_lo, 0
    s_mov_b32 exec_hi, 0xffff0000
    v_mov_b32 v12, 0
    v_mov_b32 v13, 0
    v_mov_b32 v14, 0
    v_mov_b32 v15, 0
    s_mov_b64 exec, -1
    v_cvt_pk_bf16_f32 v144, v8, v9
    v_cvt_pk_bf16_f32 v145, v10, v11
    v_cvt_pk_bf16_f32 v146, v12, v13
    v_cvt_pk_bf16_f32 v147, v14, v15
    buffer_store_dwordx4 v[144:147], v252, s[20:23], s39 offen offset:0 sc1
    v_mul_f32 v40, s95, v40
    v_mul_f32 v44, s95, v44
    v_mul_f32 v41, s95, v41
    v_mul_f32 v45, s95, v45
    v_mul_f32 v42, s95, v42
    v_mul_f32 v46, s95, v46
    v_mul_f32 v43, s95, v43
    v_mul_f32 v47, s95, v47
    s_mov_b32 exec_lo, 0
    s_mov_b32 exec_hi, 0xffff0000
    v_mov_b32 v44, 0
    v_mov_b32 v45, 0
    v_mov_b32 v46, 0
    v_mov_b32 v47, 0
    s_mov_b64 exec, -1
    v_cvt_pk_bf16_f32 v148, v40, v41
    v_cvt_pk_bf16_f32 v149, v42, v43
    v_cvt_pk_bf16_f32 v150, v44, v45
    v_cvt_pk_bf16_f32 v151, v46, v47
    buffer_store_dwordx4 v[148:151], v252, s[20:23], s39 offen offset:128 sc1
    v_mul_f32 v72, s95, v72
    v_mul_f32 v76, s95, v76
    v_mul_f32 v73, s95, v73
    v_mul_f32 v77, s95, v77
    v_mul_f32 v74, s95, v74
    v_mul_f32 v78, s95, v78
    v_mul_f32 v75, s95, v75
    v_mul_f32 v79, s95, v79
    s_mov_b32 exec_lo, 0
    s_mov_b32 exec_hi, 0xffff0000
    v_mov_b32 v76, 0
    v_mov_b32 v77, 0
    v_mov_b32 v78, 0
    v_mov_b32 v79, 0
    s_mov_b64 exec, -1
    v_cvt_pk_bf16_f32 v152, v72, v73
    v_cvt_pk_bf16_f32 v153, v74, v75
    v_cvt_pk_bf16_f32 v154, v76, v77
    v_cvt_pk_bf16_f32 v155, v78, v79
    buffer_store_dwordx4 v[152:155], v252, s[20:23], s39 offen offset:2048 sc1
    v_mul_f32 v104, s95, v104
    v_mul_f32 v108, s95, v108
    v_mul_f32 v105, s95, v105
    v_mul_f32 v109, s95, v109
    v_mul_f32 v106, s95, v106
    v_mul_f32 v110, s95, v110
    v_mul_f32 v107, s95, v107
    v_mul_f32 v111, s95, v111
    s_mov_b32 exec_lo, 0
    s_mov_b32 exec_hi, 0xffff0000
    v_mov_b32 v108, 0
    v_mov_b32 v109, 0
    v_mov_b32 v110, 0
    v_mov_b32 v111, 0
    s_mov_b64 exec, -1
    v_cvt_pk_bf16_f32 v156, v104, v105
    v_cvt_pk_bf16_f32 v157, v106, v107
    v_cvt_pk_bf16_f32 v158, v108, v109
    v_cvt_pk_bf16_f32 v159, v110, v111
    buffer_store_dwordx4 v[156:159], v252, s[20:23], s39 offen offset:2176 sc1
    s_branch K1_E_8
K1_E_6:
    s_lshl_b32 s39, s36, 12
    s_add_u32 s39, s39, 0x3200000
    s_mov_b32 exec_lo, 0
    s_mov_b32 exec_hi, 0xffff0000
    v_mov_b32 v12, 0
    v_mov_b32 v13, 0
    v_mov_b32 v14, 0
    v_mov_b32 v15, 0
    s_mov_b64 exec, -1
    v_cvt_pk_bf16_f32 v144, v8, v9
    v_cvt_pk_bf16_f32 v145, v10, v11
    v_cvt_pk_bf16_f32 v146, v12, v13
    v_cvt_pk_bf16_f32 v147, v14, v15
    buffer_store_dwordx4 v[144:147], v252, s[20:23], s39 offen offset:0 sc1
    s_mov_b32 exec_lo, 0
    s_mov_b32 exec_hi, 0xffff0000
    v_mov_b32 v44, 0
    v_mov_b32 v45, 0
    v_mov_b32 v46, 0
    v_mov_b32 v47, 0
    s_mov_b64 exec, -1
    v_cvt_pk_bf16_f32 v148, v40, v41
    v_cvt_pk_bf16_f32 v149, v42, v43
    v_cvt_pk_bf16_f32 v150, v44, v45
    v_cvt_pk_bf16_f32 v151, v46, v47
    buffer_store_dwordx4 v[148:151], v252, s[20:23], s39 offen offset:128 sc1
    s_add_u32 s39, s39, 4096
    s_mov_b32 exec_lo, 0
    s_mov_b32 exec_hi, 0xffff0000
    v_mov_b32 v76, 0
    v_mov_b32 v77, 0
    v_mov_b32 v78, 0
    v_mov_b32 v79, 0
    s_mov_b64 exec, -1
    v_cvt_pk_bf16_f32 v152, v72, v73
    v_cvt_pk_bf16_f32 v153, v74, v75
    v_cvt_pk_bf16_f32 v154, v76, v77
    v_cvt_pk_bf16_f32 v155, v78, v79
    buffer_store_dwordx4 v[152:155], v252, s[20:23], s39 offen offset:0 sc1
    s_mov_b32 exec_lo, 0
    s_mov_b32 exec_hi, 0xffff0000
    v_mov_b32 v108, 0
    v_mov_b32 v109, 0
    v_mov_b32 v110, 0
    v_mov_b32 v111, 0
    s_mov_b64 exec, -1
    v_cvt_pk_bf16_f32 v156, v104, v105
    v_cvt_pk_bf16_f32 v157, v106, v107
    v_cvt_pk_bf16_f32 v158, v108, v109
    v_cvt_pk_bf16_f32 v159, v110, v111
    buffer_store_dwordx4 v[156:159], v252, s[20:23], s39 offen offset:128 sc1
    s_add_u32 s39, s39, 4096
    s_branch K1_E_8
K1_E_7:
    s_lshl_b32 s39, s36, 12
    s_add_u32 s39, s39, 0x3200800
    v_bfe_u32 v254, v253, 3, 1
    v_and_b32 v255, 7, v253
    v_lshl_add_u32 v254, v254, 4, v255
    v_lshrrev_b32 v255, 4, v253
    v_lshlrev_b32 v255, 4, v255
    v_lshl_add_u32 v254, v254, 6, v255
    s_mov_b32 exec_lo, 0
    s_mov_b32 exec_hi, 0xffff0000
    v_mov_b32 v12, 1.0
    v_mov_b32 v13, 0
    v_mov_b32 v14, 0
    v_mov_b32 v15, 0
    s_mov_b64 exec, -1
    v_cvt_pk_bf16_f32 v144, v8, v9
    v_cvt_pk_bf16_f32 v145, v10, v11
    v_cvt_pk_bf16_f32 v146, v12, v13
    v_cvt_pk_bf16_f32 v147, v14, v15
    buffer_store_dwordx4 v[144:147], v254, s[20:23], s39 offen offset:0 sc1
    s_mov_b32 exec_lo, 0
    s_mov_b32 exec_hi, 0xffff0000
    v_mov_b32 v44, 1.0
    v_mov_b32 v45, 0
    v_mov_b32 v46, 0
    v_mov_b32 v47, 0
    s_mov_b64 exec, -1
    v_cvt_pk_bf16_f32 v148, v40, v41
    v_cvt_pk_bf16_f32 v149, v42, v43
    v_cvt_pk_bf16_f32 v150, v44, v45
    v_cvt_pk_bf16_f32 v151, v46, v47
    buffer_store_dwordx4 v[148:151], v254, s[20:23], s39 offen offset:512 sc1
    s_add_u32 s39, s39, 4096
    s_mov_b32 exec_lo, 0
    s_mov_b32 exec_hi, 0xffff0000
    v_mov_b32 v76, 1.0
    v_mov_b32 v77, 0
    v_mov_b32 v78, 0
    v_mov_b32 v79, 0
    s_mov_b64 exec, -1
    v_cvt_pk_bf16_f32 v152, v72, v73
    v_cvt_pk_bf16_f32 v153, v74, v75
    v_cvt_pk_bf16_f32 v154, v76, v77
    v_cvt_pk_bf16_f32 v155, v78, v79
    buffer_store_dwordx4 v[152:155], v254, s[20:23], s39 offen offset:0 sc1
    s_mov_b32 exec_lo, 0
    s_mov_b32 exec_hi, 0xffff0000
    v_mov_b32 v108, 1.0
    v_mov_b32 v109, 0
    v_mov_b32 v110, 0
    v_mov_b32 v111, 0
    s_mov_b64 exec, -1
    v_cvt_pk_bf16_f32 v156, v104, v105
    v_cvt_pk_bf16_f32 v157, v106, v107
    v_cvt_pk_bf16_f32 v158, v108, v109
    v_cvt_pk_bf16_f32 v159, v110, v111
    buffer_store_dwordx4 v[156:159], v254, s[20:23], s39 offen offset:512 sc1
    s_add_u32 s39, s39, 4096
K1_E_8:
    s_mul_i32 s35, s26, 3
    s_add_u32 s35, s35, s68
    s_add_u32 s35, s35, 2
    s_cmp_lg_u32 s71, 0
    s_cbranch_scc1 K1_E_9
    s_lshr_b32 s36, s35, 3
    s_lshl_b32 s36, s36, 20
    s_and_b32 s37, s35, 7
    s_lshl_b32 s37, s37, 11
    s_add_u32 s39, s36, s37
    s_lshl_b32 s36, s38, 14
    s_add_u32 s39, s39, s36
    s_add_u32 s39, s39, 0x2000000
    s_cmp_ge_u32 s35, 128
    s_cselect_b32 s39, 0x7ff00000, s39
    s_cmp_lg_u32 s94, 0
    s_cselect_b32 s39, 0x7ff00000, s39
    v_cvt_pk_bf16_f32 v160, v16, v17
    v_cvt_pk_bf16_f32 v161, v18, v19
    v_cvt_pk_bf16_f32 v162, v20, v21
    v_cvt_pk_bf16_f32 v163, v22, v23
    buffer_store_dwordx4 v[160:163], v252, s[20:23], s39 offen offset:0 sc1
    v_cvt_pk_bf16_f32 v164, v48, v49
    v_cvt_pk_bf16_f32 v165, v50, v51
    v_cvt_pk_bf16_f32 v166, v52, v53
    v_cvt_pk_bf16_f32 v167, v54, v55
    buffer_store_dwordx4 v[164:167], v252, s[20:23], s39 offen offset:128 sc1
    s_add_u32 s39, s39, 16384
    v_cvt_pk_bf16_f32 v168, v80, v81
    v_cvt_pk_bf16_f32 v169, v82, v83
    v_cvt_pk_bf16_f32 v170, v84, v85
    v_cvt_pk_bf16_f32 v171, v86, v87
    buffer_store_dwordx4 v[168:171], v252, s[20:23], s39 offen offset:0 sc1
    v_cvt_pk_bf16_f32 v172, v112, v113
    v_cvt_pk_bf16_f32 v173, v114, v115
    v_cvt_pk_bf16_f32 v174, v116, v117
    v_cvt_pk_bf16_f32 v175, v118, v119
    buffer_store_dwordx4 v[172:175], v252, s[20:23], s39 offen offset:128 sc1
    s_add_u32 s39, s39, 16384
    s_branch K1_E_12
K1_E_9:
    s_and_b32 s36, s35, 15
    s_lshl_b32 s36, s36, 6
    s_add_u32 s36, s36, s38
    s_lshr_b32 s37, s35, 4
    s_cmp_eq_u32 s37, 1
    s_cbranch_scc1 K1_E_10
    s_cmp_eq_u32 s37, 2
    s_cbranch_scc1 K1_E_11
    s_lshl_b32 s39, s36, 11
    s_add_u32 s39, s39, 0x3000000
    v_mul_f32 v16, s95, v16
    v_mul_f32 v20, s95, v20
    v_mul_f32 v17, s95, v17
    v_mul_f32 v21, s95, v21
    v_mul_f32 v18, s95, v18
    v_mul_f32 v22, s95, v22
    v_mul_f32 v19, s95, v19
    v_mul_f32 v23, s95, v23
    s_mov_b32 exec_lo, 0
    s_mov_b32 exec_hi, 0xffff0000
    v_mov_b32 v20, 0
    v_mov_b32 v21, 0
    v_mov_b32 v22, 0
    v_mov_b32 v23, 0
    s_mov_b64 exec, -1
    v_cvt_pk_bf16_f32 v160, v16, v17
    v_cvt_pk_bf16_f32 v161, v18, v19
    v_cvt_pk_bf16_f32 v162, v20, v21
    v_cvt_pk_bf16_f32 v163, v22, v23
    buffer_store_dwordx4 v[160:163], v252, s[20:23], s39 offen offset:0 sc1
    v_mul_f32 v48, s95, v48
    v_mul_f32 v52, s95, v52
    v_mul_f32 v49, s95, v49
    v_mul_f32 v53, s95, v53
    v_mul_f32 v50, s95, v50
    v_mul_f32 v54, s95, v54
    v_mul_f32 v51, s95, v51
    v_mul_f32 v55, s95, v55
    s_mov_b32 exec_lo, 0
    s_mov_b32 exec_hi, 0xffff0000
    v_mov_b32 v52, 0
    v_mov_b32 v53, 0
    v_mov_b32 v54, 0
    v_mov_b32 v55, 0
    s_mov_b64 exec, -1
    v_cvt_pk_bf16_f32 v164, v48, v49
    v_cvt_pk_bf16_f32 v165, v50, v51
    v_cvt_pk_bf16_f32 v166, v52, v53
    v_cvt_pk_bf16_f32 v167, v54, v55
    buffer_store_dwordx4 v[164:167], v252, s[20:23], s39 offen offset:128 sc1
    v_mul_f32 v80, s95, v80
    v_mul_f32 v84, s95, v84
    v_mul_f32 v81, s95, v81
    v_mul_f32 v85, s95, v85
    v_mul_f32 v82, s95, v82
    v_mul_f32 v86, s95, v86
    v_mul_f32 v83, s95, v83
    v_mul_f32 v87, s95, v87
    s_mov_b32 exec_lo, 0
    s_mov_b32 exec_hi, 0xffff0000
    v_mov_b32 v84, 0
    v_mov_b32 v85, 0
    v_mov_b32 v86, 0
    v_mov_b32 v87, 0
    s_mov_b64 exec, -1
    v_cvt_pk_bf16_f32 v168, v80, v81
    v_cvt_pk_bf16_f32 v169, v82, v83
    v_cvt_pk_bf16_f32 v170, v84, v85
    v_cvt_pk_bf16_f32 v171, v86, v87
    buffer_store_dwordx4 v[168:171], v252, s[20:23], s39 offen offset:2048 sc1
    v_mul_f32 v112, s95, v112
    v_mul_f32 v116, s95, v116
    v_mul_f32 v113, s95, v113
    v_mul_f32 v117, s95, v117
    v_mul_f32 v114, s95, v114
    v_mul_f32 v118, s95, v118
    v_mul_f32 v115, s95, v115
    v_mul_f32 v119, s95, v119
    s_mov_b32 exec_lo, 0
    s_mov_b32 exec_hi, 0xffff0000
    v_mov_b32 v116, 0
    v_mov_b32 v117, 0
    v_mov_b32 v118, 0
    v_mov_b32 v119, 0
    s_mov_b64 exec, -1
    v_cvt_pk_bf16_f32 v172, v112, v113
    v_cvt_pk_bf16_f32 v173, v114, v115
    v_cvt_pk_bf16_f32 v174, v116, v117
    v_cvt_pk_bf16_f32 v175, v118, v119
    buffer_store_dwordx4 v[172:175], v252, s[20:23], s39 offen offset:2176 sc1
    s_branch K1_E_12
K1_E_10:
    s_lshl_b32 s39, s36, 12
    s_add_u32 s39, s39, 0x3200000
    s_mov_b32 exec_lo, 0
    s_mov_b32 exec_hi, 0xffff0000
    v_mov_b32 v20, 0
    v_mov_b32 v21, 0
    v_mov_b32 v22, 0
    v_mov_b32 v23, 0
    s_mov_b64 exec, -1
    v_cvt_pk_bf16_f32 v160, v16, v17
    v_cvt_pk_bf16_f32 v161, v18, v19
    v_cvt_pk_bf16_f32 v162, v20, v21
    v_cvt_pk_bf16_f32 v163, v22, v23
    buffer_store_dwordx4 v[160:163], v252, s[20:23], s39 offen offset:0 sc1
    s_mov_b32 exec_lo, 0
    s_mov_b32 exec_hi, 0xffff0000
    v_mov_b32 v52, 0
    v_mov_b32 v53, 0
    v_mov_b32 v54, 0
    v_mov_b32 v55, 0
    s_mov_b64 exec, -1
    v_cvt_pk_bf16_f32 v164, v48, v49
    v_cvt_pk_bf16_f32 v165, v50, v51
    v_cvt_pk_bf16_f32 v166, v52, v53
    v_cvt_pk_bf16_f32 v167, v54, v55
    buffer_store_dwordx4 v[164:167], v252, s[20:23], s39 offen offset:128 sc1
    s_add_u32 s39, s39, 4096
    s_mov_b32 exec_lo, 0
    s_mov_b32 exec_hi, 0xffff0000
    v_mov_b32 v84, 0
    v_mov_b32 v85, 0
    v_mov_b32 v86, 0
    v_mov_b32 v87, 0
    s_mov_b64 exec, -1
    v_cvt_pk_bf16_f32 v168, v80, v81
    v_cvt_pk_bf16_f32 v169, v82, v83
    v_cvt_pk_bf16_f32 v170, v84, v85
    v_cvt_pk_bf16_f32 v171, v86, v87
    buffer_store_dwordx4 v[168:171], v252, s[20:23], s39 offen offset:0 sc1
    s_mov_b32 exec_lo, 0
    s_mov_b32 exec_hi, 0xffff0000
    v_mov_b32 v116, 0
    v_mov_b32 v117, 0
    v_mov_b32 v118, 0
    v_mov_b32 v119, 0
    s_mov_b64 exec, -1
    v_cvt_pk_bf16_f32 v172, v112, v113
    v_cvt_pk_bf16_f32 v173, v114, v115
    v_cvt_pk_bf16_f32 v174, v116, v117
    v_cvt_pk_bf16_f32 v175, v118, v119
    buffer_store_dwordx4 v[172:175], v252, s[20:23], s39 offen offset:128 sc1
    s_add_u32 s39, s39, 4096
    s_branch K1_E_12
K1_E_11:
    s_lshl_b32 s39, s36, 12
    s_add_u32 s39, s39, 0x3200800
    v_bfe_u32 v254, v253, 3, 1
    v_and_b32 v255, 7, v253
    v_lshl_add_u32 v254, v254, 4, v255
    v_lshrrev_b32 v255, 4, v253
    v_lshlrev_b32 v255, 4, v255
    v_lshl_add_u32 v254, v254, 6, v255
    s_mov_b32 exec_lo, 0
    s_mov_b32 exec_hi, 0xffff0000
    v_mov_b32 v20, 1.0
    v_mov_b32 v21, 0
    v_mov_b32 v22, 0
    v_mov_b32 v23, 0
    s_mov_b64 exec, -1
    v_cvt_pk_bf16_f32 v160, v16, v17
    v_cvt_pk_bf16_f32 v161, v18, v19
    v_cvt_pk_bf16_f32 v162, v20, v21
    v_cvt_pk_bf16_f32 v163, v22, v23
    buffer_store_dwordx4 v[160:163], v254, s[20:23], s39 offen offset:0 sc1
    s_mov_b32 exec_lo, 0
    s_mov_b32 exec_hi, 0xffff0000
    v_mov_b32 v52, 1.0
    v_mov_b32 v53, 0
    v_mov_b32 v54, 0
    v_mov_b32 v55, 0
    s_mov_b64 exec, -1
    v_cvt_pk_bf16_f32 v164, v48, v49
    v_cvt_pk_bf16_f32 v165, v50, v51
    v_cvt_pk_bf16_f32 v166, v52, v53
    v_cvt_pk_bf16_f32 v167, v54, v55
    buffer_store_dwordx4 v[164:167], v254, s[20:23], s39 offen offset:512 sc1
    s_add_u32 s39, s39, 4096
    s_mov_b32 exec_lo, 0
    s_mov_b32 exec_hi, 0xffff0000
    v_mov_b32 v84, 1.0
    v_mov_b32 v85, 0
    v_mov_b32 v86, 0
    v_mov_b32 v87, 0
    s_mov_b64 exec, -1
    v_cvt_pk_bf16_f32 v168, v80, v81
    v_cvt_pk_bf16_f32 v169, v82, v83
    v_cvt_pk_bf16_f32 v170, v84, v85
    v_cvt_pk_bf16_f32 v171, v86, v87
    buffer_store_dwordx4 v[168:171], v254, s[20:23], s39 offen offset:0 sc1
    s_mov_b32 exec_lo, 0
    s_mov_b32 exec_hi, 0xffff0000
    v_mov_b32 v116, 1.0
    v_mov_b32 v117, 0
    v_mov_b32 v118, 0
    v_mov_b32 v119, 0
    s_mov_b64 exec, -1
    v_cvt_pk_bf16_f32 v172, v112, v113
    v_cvt_pk_bf16_f32 v173, v114, v115
    v_cvt_pk_bf16_f32 v174, v116, v117
    v_cvt_pk_bf16_f32 v175, v118, v119
    buffer_store_dwordx4 v[172:175], v254, s[20:23], s39 offen offset:512 sc1
    s_add_u32 s39, s39, 4096
K1_E_12:
    s_branch K1_FIN
K1_12V:
    s_mov_b32 s40, 0
    s_add_u32 s31, s40, s42
    s_and_b32 s31, s31, 3
    s_andn2_b32 s37, s40, 3
    s_or_b32 s31, s31, s37
    s_add_u32 s40, s40, 1
    s_add_u32 m0, s27, s32
    s_lshl_b32 s31, s31, 7
    buffer_load_dwordx4 v240, s[4:7], s31 offen offset:0 lds
    buffer_load_dwordx4 v241, s[4:7], s31 offen offset:1024 lds
    s_add_u32 s35, s27, s32
    s_add_u32 m0, s35, 0x800
    s_add_u32 s27, s27, 0x8000
    buffer_load_dwordx4 v242, s[4:7], s31 offen offset:0 lds
    buffer_load_dwordx4 v243, s[4:7], s31 offen offset:1024 lds
    s_cmp_ge_u32 s27, 0x28000
    s_cselect_b32 s27, 0x10000, s27
    s_mov_b32 s41, 0
    s_add_u32 s30, s41, s42
    s_and_b32 s30, s30, 3
    s_andn2_b32 s37, s41, 3
    s_or_b32 s30, s30, s37
    s_add_u32 s41, s41, 1
    s_mul_i32 s30, s30, s44
    s_lshl_b32 s30, s30, 1
    s_add_u32 m0, s33, 0
    s_nop 0
    buffer_load_dwordx4 v248, s[8:11], s30 offen offset:0 lds
    buffer_load_dwordx4 v249, s[8:11], s30 offen offset:1024 lds
    s_add_u32 s30, s30, s44
    s_add_u32 m0, s33, 16384
    s_nop 0
    buffer_load_dwordx4 v248, s[8:11], s30 offen offset:0 lds
    buffer_load_dwordx4 v249, s[8:11], s30 offen offset:1024 lds
    s_add_u32 s31, s40, s42
    s_and_b32 s31, s31, 3
    s_andn2_b32 s37, s40, 3
    s_or_b32 s31, s31, s37
    s_add_u32 s40, s40, 1
    s_add_u32 m0, s27, s32
    s_lshl_b32 s31, s31, 7
    buffer_load_dwordx4 v240, s[4:7], s31 offen offset:0 lds
    buffer_load_dwordx4 v241, s[4:7], s31 offen offset:1024 lds
    s_add_u32 s35, s27, s32
    s_add_u32 m0, s35, 0x800
    s_add_u32 s27, s27, 0x8000
    buffer_load_dwordx4 v242, s[4:7], s31 offen offset:0 lds
    buffer_load_dwordx4 v243, s[4:7], s31 offen offset:1024 lds
    s_cmp_ge_u32 s27, 0x28000
    s_cselect_b32 s27, 0x10000, s27
    s_add_u32 s30, s41, s42
    s_and_b32 s30, s30, 3
    s_andn2_b32 s37, s41, 3
    s_or_b32 s30, s30, s37
    s_add_u32 s41, s41, 1
    s_mul_i32 s30, s30, s44
    s_lshl_b32 s30, s30, 1
    s_add_u32 m0, s33, 32768
    s_nop 0
    buffer_load_dwordx4 v248, s[8:11], s30 offen offset:0 lds
    buffer_load_dwordx4 v249, s[8:11], s30 offen offset:1024 lds
    s_add_u32 s30, s30, s44
    v_lshrrev_b32 v132, 4, v253
    v_bfe_u32 v128, v253, 3, 1
    v_and_b32 v129, 7, v253
    v_lshl_add_u32 v133, v128, 4, v129
    v_bfe_u32 v131, v253, 1, 2
    v_lshl_add_u32 v131, v128, 2, v131
    v_xor_b32 v131, v131, v132
    v_lshlrev_b32 v131, 4, v131
    s_lshl_b32 s35, s25, 6
    v_add_u32 v130, s35, v133
    v_lshl_add_u32 v130, v130, 7, v131
    v_add_u32 v224, 0x10000, v130
    v_xor_b32 v225, 64, v224
    v_bfe_u32 v128, v253, 2, 2
    v_lshl_add_u32 v134, v132, 3, v128
    v_bfe_u32 v130, v253, 1, 1
    v_bfe_u32 v131, v253, 4, 1
    v_lshl_add_u32 v130, v130, 1, v131
    v_lshlrev_b32 v130, 4, v130
    v_and_b32 v129, 1, v253
    v_lshl_add_u32 v135, v129, 3, v130
    v_lshl_add_u32 v129, v134, 9, v135
    s_lshl_b32 s35, s26, 2
    s_add_u32 s36, s35, 0
    v_xor_b32 v130, s36, v128
    v_lshl_add_u32 v226, v130, 6, v129
    v_xor_b32 v227, 16, v226
    s_add_u32 s36, s35, 1
    v_xor_b32 v130, s36, v128
    v_lshl_add_u32 v228, v130, 6, v129
    v_xor_b32 v229, 16, v228
    s_add_u32 s36, s35, 2
    v_xor_b32 v130, s36, v128
    v_lshl_add_u32 v230, v130, 6, v129
    v_xor_b32 v231, 16, v230
    s_add_u32 s36, s35, 3
    v_xor_b32 v130, s36, v128
    v_lshl_add_u32 v232, v130, 6, v129
    v_xor_b32 v233, 16, v232
    v_mul_u32_u24 v129, 384, v134
    v_add_u32 v129, v129, v135
    v_bfe_u32 v128, v253, 3, 1
    s_mul_i32 s35, s26, 3
    s_add_u32 s36, s35, 0
    v_xor_b32 v130, s36, v128
    v_lshl_add_u32 v234, v130, 6, v129
    v_xor_b32 v235, 16, v234
    s_add_u32 s36, s35, 1
    v_xor_b32 v130, s36, v128
    v_lshl_add_u32 v236, v130, 6, v129
    v_xor_b32 v237, 16, v236
    s_add_u32 s36, s35, 2
    v_xor_b32 v130, s36, v128
    v_lshl_add_u32 v238, v130, 6, v129
    v_xor_b32 v239, 16, v238
    v_lshrrev_b32 v130, 5, v253
    v_lshl_add_u32 v129, v131, 5, v133
    v_lshlrev_b32 v129, 4, v129
    v_lshl_add_u32 v252, v130, 10, v129
    s_waitcnt vmcnt(8) lgkmcnt(0)
    s_barrier
    ds_read_b128 v[128:131], v224 offset:0
    ds_read_b64_tr_b16 v[144:145], v226 offset:0
    ds_read_b64_tr_b16 v[146:147], v226 offset:2048
    ds_read_b64_tr_b16 v[148:149], v227 offset:0
    ds_read_b64_tr_b16 v[150:151], v227 offset:2048
    ds_read_b128 v[132:135], v224 offset:1024
    ds_read_b64_tr_b16 v[152:153], v228 offset:0
    ds_read_b64_tr_b16 v[154:155], v228 offset:2048
    ds_read_b64_tr_b16 v[156:157], v229 offset:0
    ds_read_b64_tr_b16 v[158:159], v229 offset:2048
    ds_read_b64_tr_b16 v[160:161], v230 offset:0
    ds_read_b64_tr_b16 v[162:163], v230 offset:2048
    ds_read_b64_tr_b16 v[164:165], v231 offset:0
    ds_read_b64_tr_b16 v[166:167], v231 offset:2048
    ds_read_b64_tr_b16 v[168:169], v232 offset:0
    ds_read_b64_tr_b16 v[170:171], v232 offset:2048
    ds_read_b64_tr_b16 v[172:173], v233 offset:0
    ds_read_b64_tr_b16 v[174:175], v233 offset:2048
    ds_read_b128 v[136:139], v224 offset:4096
    ds_read_b128 v[140:143], v224 offset:5120
    s_add_u32 m0, s33, 49152
    s_nop 0
    buffer_load_dwordx4 v248, s[8:11], s30 offen offset:0 lds
    buffer_load_dwordx4 v249, s[8:11], s30 offen offset:1024 lds
    s_add_u32 s31, s40, s42
    s_and_b32 s31, s31, 3
    s_andn2_b32 s37, s40, 3
    s_or_b32 s31, s31, s37
    s_add_u32 s40, s40, 1
    s_add_u32 m0, s27, s32
    s_lshl_b32 s31, s31, 7
    buffer_load_dwordx4 v240, s[4:7], s31 offen offset:0 lds
    buffer_load_dwordx4 v241, s[4:7], s31 offen offset:1024 lds
    s_waitcnt vmcnt(10) lgkmcnt(0)
    s_barrier
    v_mfma_f32_16x16x32_bf16 v[0:3], v[128:131], v[144:147], 0
    ds_read_b128 v[176:179], v225 offset:0
    ds_read_b64_tr_b16 v[192:193], v226 offset:16384
    v_mfma_f32_16x16x32_bf16 v[4:7], v[128:131], v[148:151], 0
    ds_read_b64_tr_b16 v[194:195], v226 offset:18432
    v_mfma_f32_16x16x32_bf16 v[8:11], v[128:131], v[152:155], 0
    ds_read_b64_tr_b16 v[196:197], v227 offset:16384
    ds_read_b64_tr_b16 v[198:199], v227 offset:18432
    v_mfma_f32_16x16x32_bf16 v[12:15], v[128:131], v[156:159], 0
    ds_read_b128 v[180:183], v225 offset:1024
    v_mfma_f32_16x16x32_bf16 v[16:19], v[128:131], v[160:163], 0
    ds_read_b64_tr_b16 v[200:201], v228 offset:16384
    ds_read_b64_tr_b16 v[202:203], v228 offset:18432
    v_mfma_f32_16x16x32_bf16 v[20:23], v[128:131], v[164:167], 0
    ds_read_b64_tr_b16 v[204:205], v229 offset:16384
    v_mfma_f32_16x16x32_bf16 v[24:27], v[128:131], v[168:171], 0
    ds_read_b64_tr_b16 v[206:207], v229 offset:18432
    ds_read_b64_tr_b16 v[208:209], v230 offset:16384
    v_mfma_f32_16x16x32_bf16 v[28:31], v[128:131], v[172:175], 0
    ds_read_b64_tr_b16 v[210:211], v230 offset:18432
    v_mfma_f32_16x16x32_bf16 v[32:35], v[132:135], v[144:147], 0
    ds_read_b64_tr_b16 v[212:213], v231 offset:16384
    v_mfma_f32_16x16x32_bf16 v[36:39], v[132:135], v[148:151], 0
    ds_read_b64_tr_b16 v[214:215], v231 offset:18432
    ds_read_b64_tr_b16 v[216:217], v232 offset:16384
    v_mfma_f32_16x16x32_bf16 v[40:43], v[132:135], v[152:155], 0
    ds_read_b64_tr_b16 v[218:219], v232 offset:18432
    v_mfma_f32_16x16x32_bf16 v[44:47], v[132:135], v[156:159], 0
    ds_read_b64_tr_b16 v[220:221], v233 offset:16384
    ds_read_b64_tr_b16 v[222:223], v233 offset:18432
    v_mfma_f32_16x16x32_bf16 v[48:51], v[132:135], v[160:163], 0
    ds_read_b128 v[184:187], v225 offset:4096
    v_mfma_f32_16x16x32_bf16 v[52:55], v[132:135], v[164:167], 0
    ds_read_b128 v[188:191], v225 offset:5120
    s_add_u32 s30, s41, s42
    v_mfma_f32_16x16x32_bf16 v[56:59], v[132:135], v[168:171], 0
    s_and_b32 s30, s30, 3
    v_mfma_f32_16x16x32_bf16 v[60:63], v[132:135], v[172:175], 0
    s_andn2_b32 s37, s41, 3
    v_mfma_f32_16x16x32_bf16 v[64:67], v[136:139], v[144:147], 0
    s_or_b32 s30, s30, s37
    s_add_u32 s41, s41, 1
    v_mfma_f32_16x16x32_bf16 v[68:71], v[136:139], v[148:151], 0
    s_mul_i32 s30, s30, s44
    v_mfma_f32_16x16x32_bf16 v[72:75], v[136:139], v[152:155], 0
    s_lshl_b32 s30, s30, 1
    s_add_u32 m0, s33, 0
    v_mfma_f32_16x16x32_bf16 v[76:79], v[136:139], v[156:159], 0
    s_nop 0
    v_mfma_f32_16x16x32_bf16 v[80:83], v[136:139], v[160:163], 0
    buffer_load_dwordx4 v248, s[8:11], s30 offen offset:0 lds
    buffer_load_dwordx4 v249, s[8:11], s30 offen offset:1024 lds
    v_mfma_f32_16x16x32_bf16 v[84:87], v[136:139], v[164:167], 0
    s_add_u32 s30, s30, s44
    v_mfma_f32_16x16x32_bf16 v[88:91], v[136:139], v[168:171], 0
    s_add_u32 s35, s27, s32
    s_add_u32 m0, s35, 0x800
    v_mfma_f32_16x16x32_bf16 v[92:95], v[136:139], v[172:175], 0
    s_add_u32 s27, s27, 0x8000
    v_mfma_f32_16x16x32_bf16 v[96:99], v[140:143], v[144:147], 0
    buffer_load_dwordx4 v242, s[4:7], s31 offen offset:0 lds
    v_mfma_f32_16x16x32_bf16 v[100:103], v[140:143], v[148:151], 0
    buffer_load_dwordx4 v243, s[4:7], s31 offen offset:1024 lds
    s_cmp_ge_u32 s27, 0x28000
    v_mfma_f32_16x16x32_bf16 v[104:107], v[140:143], v[152:155], 0
    s_cselect_b32 s27, 0x10000, s27
    v_mfma_f32_16x16x32_bf16 v[108:111], v[140:143], v[156:159], 0
    s_add_u32 s36, s28, 0x8000
    s_cmp_ge_u32 s36, 0x18000
    v_mfma_f32_16x16x32_bf16 v[112:115], v[140:143], v[160:163], 0
    s_cselect_b32 s36, 0, s36
    v_mfma_f32_16x16x32_bf16 v[116:119], v[140:143], v[164:167], 0
    s_sub_u32 s29, s36, s28
    s_mov_b32 s28, s36
    v_mfma_f32_16x16x32_bf16 v[120:123], v[140:143], v[168:171], 0
    v_add_u32 v224, s29, v224
    v_mfma_f32_16x16x32_bf16 v[124:127], v[140:143], v[172:175], 0
    v_add_u32 v225, s29, v225
    s_waitcnt vmcnt(8) lgkmcnt(0)
    s_barrier
    v_mfma_f32_16x16x32_bf16 v[0:3], v[176:179], v[192:195], v[0:3]
    ds_read_b128 v[128:131], v224 offset:0
    ds_read_b64_tr_b16 v[144:145], v226 offset:32768
    v_mfma_f32_16x16x32_bf16 v[4:7], v[176:179], v[196:199], v[4:7]
    ds_read_b64_tr_b16 v[146:147], v226 offset:34816
    v_mfma_f32_16x16x32_bf16 v[8:11], v[176:179], v[200:203], v[8:11]
    ds_read_b64_tr_b16 v[148:149], v227 offset:32768
    v_mfma_f32_16x16x32_bf16 v[12:15], v[176:179], v[204:207], v[12:15]
    ds_read_b64_tr_b16 v[150:151], v227 offset:34816
    v_mfma_f32_16x16x32_bf16 v[16:19], v[176:179], v[208:211], v[16:19]
    ds_read_b128 v[132:135], v224 offset:1024
    v_mfma_f32_16x16x32_bf16 v[20:23], v[176:179], v[212:215], v[20:23]
    ds_read_b64_tr_b16 v[152:153], v228 offset:32768
    v_mfma_f32_16x16x32_bf16 v[24:27], v[176:179], v[216:219], v[24:27]
    ds_read_b64_tr_b16 v[154:155], v228 offset:34816
    v_mfma_f32_16x16x32_bf16 v[28:31], v[176:179], v[220:223], v[28:31]
    ds_read_b64_tr_b16 v[156:157], v229 offset:32768
    v_mfma_f32_16x16x32_bf16 v[32:35], v[180:183], v[192:195], v[32:35]
    ds_read_b64_tr_b16 v[158:159], v229 offset:34816
    v_mfma_f32_16x16x32_bf16 v[36:39], v[180:183], v[196:199], v[36:39]
    ds_read_b64_tr_b16 v[160:161], v230 offset:32768
    v_mfma_f32_16x16x32_bf16 v[40:43], v[180:183], v[200:203], v[40:43]
    ds_read_b64_tr_b16 v[162:163], v230 offset:34816
    v_mfma_f32_16x16x32_bf16 v[44:47], v[180:183], v[204:207], v[44:47]
    ds_read_b64_tr_b16 v[164:165], v231 offset:32768
    v_mfma_f32_16x16x32_bf16 v[48:51], v[180:183], v[208:211], v[48:51]
    ds_read_b64_tr_b16 v[166:167], v231 offset:34816
    v_mfma_f32_16x16x32_bf16 v[52:55], v[180:183], v[212:215], v[52:55]
    ds_read_b64_tr_b16 v[168:169], v232 offset:32768
    v_mfma_f32_16x16x32_bf16 v[56:59], v[180:183], v[216:219], v[56:59]
    ds_read_b64_tr_b16 v[170:171], v232 offset:34816
    v_mfma_f32_16x16x32_bf16 v[60:63], v[180:183], v[220:223], v[60:63]
    ds_read_b64_tr_b16 v[172:173], v233 offset:32768
    v_mfma_f32_16x16x32_bf16 v[64:67], v[184:187], v[192:195], v[64:67]
    ds_read_b64_tr_b16 v[174:175], v233 offset:34816
    v_mfma_f32_16x16x32_bf16 v[68:71], v[184:187], v[196:199], v[68:71]
    ds_read_b128 v[136:139], v224 offset:4096
    v_mfma_f32_16x16x32_bf16 v[72:75], v[184:187], v[200:203], v[72:75]
    ds_read_b128 v[140:143], v224 offset:5120
    v_mfma_f32_16x16x32_bf16 v[76:79], v[184:187], v[204:207], v[76:79]
    s_add_u32 m0, s33, 16384
    v_mfma_f32_16x16x32_bf16 v[80:83], v[184:187], v[208:211], v[80:83]
    s_nop 0
    v_mfma_f32_16x16x32_bf16 v[84:87], v[184:187], v[212:215], v[84:87]
    buffer_load_dwordx4 v248, s[8:11], s30 offen offset:0 lds
    v_mfma_f32_16x16x32_bf16 v[88:91], v[184:187], v[216:219], v[88:91]
    buffer_load_dwordx4 v249, s[8:11], s30 offen offset:1024 lds
    v_mfma_f32_16x16x32_bf16 v[92:95], v[184:187], v[220:223], v[92:95]
    s_add_u32 s31, s40, s42
    v_mfma_f32_16x16x32_bf16 v[96:99], v[188:191], v[192:195], v[96:99]
    s_and_b32 s31, s31, 3
    v_mfma_f32_16x16x32_bf16 v[100:103], v[188:191], v[196:199], v[100:103]
    s_andn2_b32 s37, s40, 3
    v_mfma_f32_16x16x32_bf16 v[104:107], v[188:191], v[200:203], v[104:107]
    s_or_b32 s31, s31, s37
    v_mfma_f32_16x16x32_bf16 v[108:111], v[188:191], v[204:207], v[108:111]
    s_add_u32 s40, s40, 1
    v_mfma_f32_16x16x32_bf16 v[112:115], v[188:191], v[208:211], v[112:115]
    s_add_u32 m0, s27, s32
    v_mfma_f32_16x16x32_bf16 v[116:119], v[188:191], v[212:215], v[116:119]
    s_lshl_b32 s31, s31, 7
    v_mfma_f32_16x16x32_bf16 v[120:123], v[188:191], v[216:219], v[120:123]
    buffer_load_dwordx4 v240, s[4:7], s31 offen offset:0 lds
    v_mfma_f32_16x16x32_bf16 v[124:127], v[188:191], v[220:223], v[124:127]
    buffer_load_dwordx4 v241, s[4:7], s31 offen offset:1024 lds
    s_waitcnt vmcnt(10) lgkmcnt(0)
    s_barrier
    v_mfma_f32_16x16x32_bf16 v[0:3], v[128:131], v[144:147], v[0:3]
    ds_read_b128 v[176:179], v225 offset:0
    ds_read_b64_tr_b16 v[192:193], v226 offset:49152
    v_mfma_f32_16x16x32_bf16 v[4:7], v[128:131], v[148:151], v[4:7]
    ds_read_b64_tr_b16 v[194:195], v226 offset:51200
    v_mfma_f32_16x16x32_bf16 v[8:11], v[128:131], v[152:155], v[8:11]
    ds_read_b64_tr_b16 v[196:197], v227 offset:49152
    ds_read_b64_tr_b16 v[198:199], v227 offset:51200
    v_mfma_f32_16x16x32_bf16 v[12:15], v[128:131], v[156:159], v[12:15]
    ds_read_b128 v[180:183], v225 offset:1024
    v_mfma_f32_16x16x32_bf16 v[16:19], v[128:131], v[160:163], v[16:19]
    ds_read_b64_tr_b16 v[200:201], v228 offset:49152
    ds_read_b64_tr_b16 v[202:203], v228 offset:51200
    v_mfma_f32_16x16x32_bf16 v[20:23], v[128:131], v[164:167], v[20:23]
    ds_read_b64_tr_b16 v[204:205], v229 offset:49152
    v_mfma_f32_16x16x32_bf16 v[24:27], v[128:131], v[168:171], v[24:27]
    ds_read_b64_tr_b16 v[206:207], v229 offset:51200
    ds_read_b64_tr_b16 v[208:209], v230 offset:49152
    v_mfma_f32_16x16x32_bf16 v[28:31], v[128:131], v[172:175], v[28:31]
    ds_read_b64_tr_b16 v[210:211], v230 offset:51200
    v_mfma_f32_16x16x32_bf16 v[32:35], v[132:135], v[144:147], v[32:35]
    ds_read_b64_tr_b16 v[212:213], v231 offset:49152
    v_mfma_f32_16x16x32_bf16 v[36:39], v[132:135], v[148:151], v[36:39]
    ds_read_b64_tr_b16 v[214:215], v231 offset:51200
    ds_read_b64_tr_b16 v[216:217], v232 offset:49152
    v_mfma_f32_16x16x32_bf16 v[40:43], v[132:135], v[152:155], v[40:43]
    ds_read_b64_tr_b16 v[218:219], v232 offset:51200
    v_mfma_f32_16x16x32_bf16 v[44:47], v[132:135], v[156:159], v[44:47]
    ds_read_b64_tr_b16 v[220:221], v233 offset:49152
    ds_read_b64_tr_b16 v[222:223], v233 offset:51200
    v_mfma_f32_16x16x32_bf16 v[48:51], v[132:135], v[160:163], v[48:51]
    ds_read_b128 v[184:187], v225 offset:4096
    v_mfma_f32_16x16x32_bf16 v[52:55], v[132:135], v[164:167], v[52:55]
    ds_read_b128 v[188:191], v225 offset:5120
    s_add_u32 s30, s41, s42
    v_mfma_f32_16x16x32_bf16 v[56:59], v[132:135], v[168:171], v[56:59]
    s_and_b32 s30, s30, 3
    v_mfma_f32_16x16x32_bf16 v[60:63], v[132:135], v[172:175], v[60:63]
    s_andn2_b32 s37, s41, 3
    v_mfma_f32_16x16x32_bf16 v[64:67], v[136:139], v[144:147], v[64:67]
    s_or_b32 s30, s30, s37
    s_add_u32 s41, s41, 1
    v_mfma_f32_16x16x32_bf16 v[68:71], v[136:139], v[148:151], v[68:71]
    s_mul_i32 s30, s30, s44
    v_mfma_f32_16x16x32_bf16 v[72:75], v[136:139], v[152:155], v[72:75]
    s_lshl_b32 s30, s30, 1
    s_add_u32 m0, s33, 32768
    v_mfma_f32_16x16x32_bf16 v[76:79], v[136:139], v[156:159], v[76:79]
    s_nop 0
    v_mfma_f32_16x16x32_bf16 v[80:83], v[136:139], v[160:163], v[80:83]
    buffer_load_dwordx4 v248, s[8:11], s30 offen offset:0 lds
    buffer_load_dwordx4 v249, s[8:11], s30 offen offset:1024 lds
    v_mfma_f32_16x16x32_bf16 v[84:87], v[136:139], v[164:167], v[84:87]
    s_add_u32 s30, s30, s44
    v_mfma_f32_16x16x32_bf16 v[88:91], v[136:139], v[168:171], v[88:91]
    s_add_u32 s35, s27, s32
    s_add_u32 m0, s35, 0x800
    v_mfma_f32_16x16x32_bf16 v[92:95], v[136:139], v[172:175], v[92:95]
    s_add_u32 s27, s27, 0x8000
    v_mfma_f32_16x16x32_bf16 v[96:99], v[140:143], v[144:147], v[96:99]
    buffer_load_dwordx4 v242, s[4:7], s31 offen offset:0 lds
    v_mfma_f32_16x16x32_bf16 v[100:103], v[140:143], v[148:151], v[100:103]
    buffer_load_dwordx4 v243, s[4:7], s31 offen offset:1024 lds
    s_cmp_ge_u32 s27, 0x28000
    v_mfma_f32_16x16x32_bf16 v[104:107], v[140:143], v[152:155], v[104:107]
    s_cselect_b32 s27, 0x10000, s27
    v_mfma_f32_16x16x32_bf16 v[108:111], v[140:143], v[156:159], v[108:111]
    s_add_u32 s36, s28, 0x8000
    s_cmp_ge_u32 s36, 0x18000
    v_mfma_f32_16x16x32_bf16 v[112:115], v[140:143], v[160:163], v[112:115]
    s_cselect_b32 s36, 0, s36
    v_mfma_f32_16x16x32_bf16 v[116:119], v[140:143], v[164:167], v[116:119]
    s_sub_u32 s29, s36, s28
    s_mov_b32 s28, s36
    v_mfma_f32_16x16x32_bf16 v[120:123], v[140:143], v[168:171], v[120:123]
    v_add_u32 v224, s29, v224
    v_mfma_f32_16x16x32_bf16 v[124:127], v[140:143], v[172:175], v[124:127]
    v_add_u32 v225, s29, v225
    s_mov_b32 s34, 6
K1_LOOP_12v:
    s_waitcnt vmcnt(8) lgkmcnt(0)
    s_barrier
    v_mfma_f32_16x16x32_bf16 v[0:3], v[176:179], v[192:195], v[0:3]
    ds_read_b128 v[128:131], v224 offset:0
    ds_read_b64_tr_b16 v[144:145], v226 offset:0
    v_mfma_f32_16x16x32_bf16 v[4:7], v[176:179], v[196:199], v[4:7]
    ds_read_b64_tr_b16 v[146:147], v226 offset:2048
    v_mfma_f32_16x16x32_bf16 v[8:11], v[176:179], v[200:203], v[8:11]
    ds_read_b64_tr_b16 v[148:149], v227 offset:0
    v_mfma_f32_16x16x32_bf16 v[12:15], v[176:179], v[204:207], v[12:15]
    ds_read_b64_tr_b16 v[150:151], v227 offset:2048
    v_mfma_f32_16x16x32_bf16 v[16:19], v[176:179], v[208:211], v[16:19]
    ds_read_b128 v[132:135], v224 offset:1024
    v_mfma_f32_16x16x32_bf16 v[20:23], v[176:179], v[212:215], v[20:23]
    ds_read_b64_tr_b16 v[152:153], v228 offset:0
    v_mfma_f32_16x16x32_bf16 v[24:27], v[176:179], v[216:219], v[24:27]
    ds_read_b64_tr_b16 v[154:155], v228 offset:2048
    v_mfma_f32_16x16x32_bf16 v[28:31], v[176:179], v[220:223], v[28:31]
    ds_read_b64_tr_b16 v[156:157], v229 offset:0
    v_mfma_f32_16x16x32_bf16 v[32:35], v[180:183], v[192:195], v[32:35]
    ds_read_b64_tr_b16 v[158:159], v229 offset:2048
    v_mfma_f32_16x16x32_bf16 v[36:39], v[180:183], v[196:199], v[36:39]
    ds_read_b64_tr_b16 v[160:161], v230 offset:0
    v_mfma_f32_16x16x32_bf16 v[40:43], v[180:183], v[200:203], v[40:43]
    ds_read_b64_tr_b16 v[162:163], v230 offset:2048
    v_mfma_f32_16x16x32_bf16 v[44:47], v[180:183], v[204:207], v[44:47]
    ds_read_b64_tr_b16 v[164:165], v231 offset:0
    v_mfma_f32_16x16x32_bf16 v[48:51], v[180:183], v[208:211], v[48:51]
    ds_read_b64_tr_b16 v[166:167], v231 offset:2048
    v_mfma_f32_16x16x32_bf16 v[52:55], v[180:183], v[212:215], v[52:55]
    ds_read_b64_tr_b16 v[168:169], v232 offset:0
    v_mfma_f32_16x16x32_bf16 v[56:59], v[180:183], v[216:219], v[56:59]
    ds_read_b64_tr_b16 v[170:171], v232 offset:2048
    v_mfma_f32_16x16x32_bf16 v[60:63], v[180:183], v[220:223], v[60:63]
    ds_read_b64_tr_b16 v[172:173], v233 offset:0
    v_mfma_f32_16x16x32_bf16 v[64:67], v[184:187], v[192:195], v[64:67]
    ds_read_b64_tr_b16 v[174:175], v233 offset:2048
    v_mfma_f32_16x16x32_bf16 v[68:71], v[184:187], v[196:199], v[68:71]
    ds_read_b128 v[136:139], v224 offset:4096
    v_mfma_f32_16x16x32_bf16 v[72:75], v[184:187], v[200:203], v[72:75]
    ds_read_b128 v[140:143], v224 offset:5120
    v_mfma_f32_16x16x32_bf16 v[76:79], v[184:187], v[204:207], v[76:79]
    s_add_u32 m0, s33, 49152
    v_mfma_f32_16x16x32_bf16 v[80:83], v[184:187], v[208:211], v[80:83]
    s_nop 0
    v_mfma_f32_16x16x32_bf16 v[84:87], v[184:187], v[212:215], v[84:87]
    buffer_load_dwordx4 v248, s[8:11], s30 offen offset:0 lds
    v_mfma_f32_16x16x32_bf16 v[88:91], v[184:187], v[216:219], v[88:91]
    buffer_load_dwordx4 v249, s[8:11], s30 offen offset:1024 lds
    v_mfma_f32_16x16x32_bf16 v[92:95], v[184:187], v[220:223], v[92:95]
    s_add_u32 s31, s40, s42
    v_mfma_f32_16x16x32_bf16 v[96:99], v[188:191], v[192:195], v[96:99]
    s_and_b32 s31, s31, 3
    v_mfma_f32_16x16x32_bf16 v[100:103], v[188:191], v[196:199], v[100:103]
    s_andn2_b32 s37, s40, 3
    v_mfma_f32_16x16x32_bf16 v[104:107], v[188:191], v[200:203], v[104:107]
    s_or_b32 s31, s31, s37
    v_mfma_f32_16x16x32_bf16 v[108:111], v[188:191], v[204:207], v[108:111]
    s_add_u32 s40, s40, 1
    v_mfma_f32_16x16x32_bf16 v[112:115], v[188:191], v[208:211], v[112:115]
    s_add_u32 m0, s27, s32
    v_mfma_f32_16x16x32_bf16 v[116:119], v[188:191], v[212:215], v[116:119]
    s_lshl_b32 s31, s31, 7
    v_mfma_f32_16x16x32_bf16 v[120:123], v[188:191], v[216:219], v[120:123]
    buffer_load_dwordx4 v240, s[4:7], s31 offen offset:0 lds
    v_mfma_f32_16x16x32_bf16 v[124:127], v[188:191], v[220:223], v[124:127]
    buffer_load_dwordx4 v241, s[4:7], s31 offen offset:1024 lds
    s_waitcnt vmcnt(10) lgkmcnt(0)
    s_barrier
    v_mfma_f32_16x16x32_bf16 v[0:3], v[128:131], v[144:147], v[0:3]
    ds_read_b128 v[176:179], v225 offset:0
    ds_read_b64_tr_b16 v[192:193], v226 offset:16384
    v_mfma_f32_16x16x32_bf16 v[4:7], v[128:131], v[148:151], v[4:7]
    ds_read_b64_tr_b16 v[194:195], v226 offset:18432
    v_mfma_f32_16x16x32_bf16 v[8:11], v[128:131], v[152:155], v[8:11]
    ds_read_b64_tr_b16 v[196:197], v227 offset:16384
    ds_read_b64_tr_b16 v[198:199], v227 offset:18432
    v_mfma_f32_16x16x32_bf16 v[12:15], v[128:131], v[156:159], v[12:15]
    ds_read_b128 v[180:183], v225 offset:1024
    v_mfma_f32_16x16x32_bf16 v[16:19], v[128:131], v[160:163], v[16:19]
    ds_read_b64_tr_b16 v[200:201], v228 offset:16384
    ds_read_b64_tr_b16 v[202:203], v228 offset:18432
    v_mfma_f32_16x16x32_bf16 v[20:23], v[128:131], v[164:167], v[20:23]
    ds_read_b64_tr_b16 v[204:205], v229 offset:16384
    v_mfma_f32_16x16x32_bf16 v[24:27], v[128:131], v[168:171], v[24:27]
    ds_read_b64_tr_b16 v[206:207], v229 offset:18432
    ds_read_b64_tr_b16 v[208:209], v230 offset:16384
    v_mfma_f32_16x16x32_bf16 v[28:31], v[128:131], v[172:175], v[28:31]
    ds_read_b64_tr_b16 v[210:211], v230 offset:18432
    v_mfma_f32_16x16x32_bf16 v[32:35], v[132:135], v[144:147], v[32:35]
    ds_read_b64_tr_b16 v[212:213], v231 offset:16384
    v_mfma_f32_16x16x32_bf16 v[36:39], v[132:135], v[148:151], v[36:39]
    ds_read_b64_tr_b16 v[214:215], v231 offset:18432
    ds_read_b64_tr_b16 v[216:217], v232 offset:16384
    v_mfma_f32_16x16x32_bf16 v[40:43], v[132:135], v[152:155], v[40:43]
    ds_read_b64_tr_b16 v[218:219], v232 offset:18432
    v_mfma_f32_16x16x32_bf16 v[44:47], v[132:135], v[156:159], v[44:47]
    ds_read_b64_tr_b16 v[220:221], v233 offset:16384
    ds_read_b64_tr_b16 v[222:223], v233 offset:18432
    v_mfma_f32_16x16x32_bf16 v[48:51], v[132:135], v[160:163], v[48:51]
    ds_read_b128 v[184:187], v225 offset:4096
    v_mfma_f32_16x16x32_bf16 v[52:55], v[132:135], v[164:167], v[52:55]
    ds_read_b128 v[188:191], v225 offset:5120
    s_add_u32 s30, s41, s42
    v_mfma_f32_16x16x32_bf16 v[56:59], v[132:135], v[168:171], v[56:59]
    s_and_b32 s30, s30, 3
    v_mfma_f32_16x16x32_bf16 v[60:63], v[132:135], v[172:175], v[60:63]
    s_andn2_b32 s37, s41, 3
    v_mfma_f32_16x16x32_bf16 v[64:67], v[136:139], v[144:147], v[64:67]
    s_or_b32 s30, s30, s37
    s_add_u32 s41, s41, 1
    v_mfma_f32_16x16x32_bf16 v[68:71], v[136:139], v[148:151], v[68:71]
    s_mul_i32 s30, s30, s44
    v_mfma_f32_16x16x32_bf16 v[72:75], v[136:139], v[152:155], v[72:75]
    s_lshl_b32 s30, s30, 1
    s_add_u32 m0, s33, 0
    v_mfma_f32_16x16x32_bf16 v[76:79], v[136:139], v[156:159], v[76:79]
    s_nop 0
    v_mfma_f32_16x16x32_bf16 v[80:83], v[136:139], v[160:163], v[80:83]
    buffer_load_dwordx4 v248, s[8:11], s30 offen offset:0 lds
    buffer_load_dwordx4 v249, s[8:11], s30 offen offset:1024 lds
    v_mfma_f32_16x16x32_bf16 v[84:87], v[136:139], v[164:167], v[84:87]
    s_add_u32 s30, s30, s44
    v_mfma_f32_16x16x32_bf16 v[88:91], v[136:139], v[168:171], v[88:91]
    s_add_u32 s35, s27, s32
    s_add_u32 m0, s35, 0x800
    v_mfma_f32_16x16x32_bf16 v[92:95], v[136:139], v[172:175], v[92:95]
    s_add_u32 s27, s27, 0x8000
    v_mfma_f32_16x16x32_bf16 v[96:99], v[140:143], v[144:147], v[96:99]
    buffer_load_dwordx4 v242, s[4:7], s31 offen offset:0 lds
    v_mfma_f32_16x16x32_bf16 v[100:103], v[140:143], v[148:151], v[100:103]
    buffer_load_dwordx4 v243, s[4:7], s31 offen offset:1024 lds
    s_cmp_ge_u32 s27, 0x28000
    v_mfma_f32_16x16x32_bf16 v[104:107], v[140:143], v[152:155], v[104:107]
    s_cselect_b32 s27, 0x10000, s27
    v_mfma_f32_16x16x32_bf16 v[108:111], v[140:143], v[156:159], v[108:111]
    s_add_u32 s36, s28, 0x8000
    s_cmp_ge_u32 s36, 0x18000
    v_mfma_f32_16x16x32_bf16 v[112:115], v[140:143], v[160:163], v[112:115]
    s_cselect_b32 s36, 0, s36
    v_mfma_f32_16x16x32_bf16 v[116:119], v[140:143], v[164:167], v[116:119]
    s_sub_u32 s29, s36, s28
    s_mov_b32 s28, s36
    v_mfma_f32_16x16x32_bf16 v[120:123], v[140:143], v[168:171], v[120:123]
    v_add_u32 v224, s29, v224
    v_mfma_f32_16x16x32_bf16 v[124:127], v[140:143], v[172:175], v[124:127]
    v_add_u32 v225, s29, v225
    s_waitcnt vmcnt(8) lgkmcnt(0)
    s_barrier
    v_mfma_f32_16x16x32_bf16 v[0:3], v[176:179], v[192:195], v[0:3]
    ds_read_b128 v[128:131], v224 offset:0
    ds_read_b64_tr_b16 v[144:145], v226 offset:32768
    v_mfma_f32_16x16x32_bf16 v[4:7], v[176:179], v[196:199], v[4:7]
    ds_read_b64_tr_b16 v[146:147], v226 offset:34816
    v_mfma_f32_16x16x32_bf16 v[8:11], v[176:179], v[200:203], v[8:11]
    ds_read_b64_tr_b16 v[148:149], v227 offset:32768
    v_mfma_f32_16x16x32_bf16 v[12:15], v[176:179], v[204:207], v[12:15]
    ds_read_b64_tr_b16 v[150:151], v227 offset:34816
    v_mfma_f32_16x16x32_bf16 v[16:19], v[176:179], v[208:211], v[16:19]
    ds_read_b128 v[132:135], v224 offset:1024
    v_mfma_f32_16x16x32_bf16 v[20:23], v[176:179], v[212:215], v[20:23]
    ds_read_b64_tr_b16 v[152:153], v228 offset:32768
    v_mfma_f32_16x16x32_bf16 v[24:27], v[176:179], v[216:219], v[24:27]
    ds_read_b64_tr_b16 v[154:155], v228 offset:34816
    v_mfma_f32_16x16x32_bf16 v[28:31], v[176:179], v[220:223], v[28:31]
    ds_read_b64_tr_b16 v[156:157], v229 offset:32768
    v_mfma_f32_16x16x32_bf16 v[32:35], v[180:183], v[192:195], v[32:35]
    ds_read_b64_tr_b16 v[158:159], v229 offset:34816
    v_mfma_f32_16x16x32_bf16 v[36:39], v[180:183], v[196:199], v[36:39]
    ds_read_b64_tr_b16 v[160:161], v230 offset:32768
    v_mfma_f32_16x16x32_bf16 v[40:43], v[180:183], v[200:203], v[40:43]
    ds_read_b64_tr_b16 v[162:163], v230 offset:34816
    v_mfma_f32_16x16x32_bf16 v[44:47], v[180:183], v[204:207], v[44:47]
    ds_read_b64_tr_b16 v[164:165], v231 offset:32768
    v_mfma_f32_16x16x32_bf16 v[48:51], v[180:183], v[208:211], v[48:51]
    ds_read_b64_tr_b16 v[166:167], v231 offset:34816
    v_mfma_f32_16x16x32_bf16 v[52:55], v[180:183], v[212:215], v[52:55]
    ds_read_b64_tr_b16 v[168:169], v232 offset:32768
    v_mfma_f32_16x16x32_bf16 v[56:59], v[180:183], v[216:219], v[56:59]
    ds_read_b64_tr_b16 v[170:171], v232 offset:34816
    v_mfma_f32_16x16x32_bf16 v[60:63], v[180:183], v[220:223], v[60:63]
    ds_read_b64_tr_b16 v[172:173], v233 offset:32768
    v_mfma_f32_16x16x32_bf16 v[64:67], v[184:187], v[192:195], v[64:67]
    ds_read_b64_tr_b16 v[174:175], v233 offset:34816
    v_mfma_f32_16x16x32_bf16 v[68:71], v[184:187], v[196:199], v[68:71]
    ds_read_b128 v[136:139], v224 offset:4096
    v_mfma_f32_16x16x32_bf16 v[72:75], v[184:187], v[200:203], v[72:75]
    ds_read_b128 v[140:143], v224 offset:5120
    v_mfma_f32_16x16x32_bf16 v[76:79], v[184:187], v[204:207], v[76:79]
    s_add_u32 m0, s33, 16384
    v_mfma_f32_16x16x32_bf16 v[80:83], v[184:187], v[208:211], v[80:83]
    s_nop 0
    v_mfma_f32_16x16x32_bf16 v[84:87], v[184:187], v[212:215], v[84:87]
    buffer_load_dwordx4 v248, s[8:11], s30 offen offset:0 lds
    v_mfma_f32_16x16x32_bf16 v[88:91], v[184:187], v[216:219], v[88:91]
    buffer_load_dwordx4 v249, s[8:11], s30 offen offset:1024 lds
    v_mfma_f32_16x16x32_bf16 v[92:95], v[184:187], v[220:223], v[92:95]
    s_add_u32 s31, s40, s42
    v_mfma_f32_16x16x32_bf16 v[96:99], v[188:191], v[192:195], v[96:99]
    s_and_b32 s31, s31, 3
    v_mfma_f32_16x16x32_bf16 v[100:103], v[188:191], v[196:199], v[100:103]
    s_andn2_b32 s37, s40, 3
    v_mfma_f32_16x16x32_bf16 v[104:107], v[188:191], v[200:203], v[104:107]
    s_or_b32 s31, s31, s37
    v_mfma_f32_16x16x32_bf16 v[108:111], v[188:191], v[204:207], v[108:111]
    s_add_u32 s40, s40, 1
    v_mfma_f32_16x16x32_bf16 v[112:115], v[188:191], v[208:211], v[112:115]
    s_add_u32 m0, s27, s32
    v_mfma_f32_16x16x32_bf16 v[116:119], v[188:191], v[212:215], v[116:119]
    s_lshl_b32 s31, s31, 7
    v_mfma_f32_16x16x32_bf16 v[120:123], v[188:191], v[216:219], v[120:123]
    buffer_load_dwordx4 v240, s[4:7], s31 offen offset:0 lds
    v_mfma_f32_16x16x32_bf16 v[124:127], v[188:191], v[220:223], v[124:127]
    buffer_load_dwordx4 v241, s[4:7], s31 offen offset:1024 lds
    s_waitcnt vmcnt(10) lgkmcnt(0)
    s_barrier
    v_mfma_f32_16x16x32_bf16 v[0:3], v[128:131], v[144:147], v[0:3]
    ds_read_b128 v[176:179], v225 offset:0
    ds_read_b64_tr_b16 v[192:193], v226 offset:49152
    v_mfma_f32_16x16x32_bf16 v[4:7], v[128:131], v[148:151], v[4:7]
    ds_read_b64_tr_b16 v[194:195], v226 offset:51200
    v_mfma_f32_16x16x32_bf16 v[8:11], v[128:131], v[152:155], v[8:11]
    ds_read_b64_tr_b16 v[196:197], v227 offset:49152
    ds_read_b64_tr_b16 v[198:199], v227 offset:51200
    v_mfma_f32_16x16x32_bf16 v[12:15], v[128:131], v[156:159], v[12:15]
    ds_read_b128 v[180:183], v225 offset:1024
    v_mfma_f32_16x16x32_bf16 v[16:19], v[128:131], v[160:163], v[16:19]
    ds_read_b64_tr_b16 v[200:201], v228 offset:49152
    ds_read_b64_tr_b16 v[202:203], v228 offset:51200
    v_mfma_f32_16x16x32_bf16 v[20:23], v[128:131], v[164:167], v[20:23]
    ds_read_b64_tr_b16 v[204:205], v229 offset:49152
    v_mfma_f32_16x16x32_bf16 v[24:27], v[128:131], v[168:171], v[24:27]
    ds_read_b64_tr_b16 v[206:207], v229 offset:51200
    ds_read_b64_tr_b16 v[208:209], v230 offset:49152
    v_mfma_f32_16x16x32_bf16 v[28:31], v[128:131], v[172:175], v[28:31]
    ds_read_b64_tr_b16 v[210:211], v230 offset:51200
    v_mfma_f32_16x16x32_bf16 v[32:35], v[132:135], v[144:147], v[32:35]
    ds_read_b64_tr_b16 v[212:213], v231 offset:49152
    v_mfma_f32_16x16x32_bf16 v[36:39], v[132:135], v[148:151], v[36:39]
    ds_read_b64_tr_b16 v[214:215], v231 offset:51200
    ds_read_b64_tr_b16 v[216:217], v232 offset:49152
    v_mfma_f32_16x16x32_bf16 v[40:43], v[132:135], v[152:155], v[40:43]
    ds_read_b64_tr_b16 v[218:219], v232 offset:51200
    v_mfma_f32_16x16x32_bf16 v[44:47], v[132:135], v[156:159], v[44:47]
    ds_read_b64_tr_b16 v[220:221], v233 offset:49152
    ds_read_b64_tr_b16 v[222:223], v233 offset:51200
    v_mfma_f32_16x16x32_bf16 v[48:51], v[132:135], v[160:163], v[48:51]
    ds_read_b128 v[184:187], v225 offset:4096
    v_mfma_f32_16x16x32_bf16 v[52:55], v[132:135], v[164:167], v[52:55]
    ds_read_b128 v[188:191], v225 offset:5120
    s_add_u32 s30, s41, s42
    v_mfma_f32_16x16x32_bf16 v[56:59], v[132:135], v[168:171], v[56:59]
    s_and_b32 s30, s30, 3
    v_mfma_f32_16x16x32_bf16 v[60:63], v[132:135], v[172:175], v[60:63]
    s_andn2_b32 s37, s41, 3
    v_mfma_f32_16x16x32_bf16 v[64:67], v[136:139], v[144:147], v[64:67]
    s_or_b32 s30, s30, s37
    s_add_u32 s41, s41, 1
    v_mfma_f32_16x16x32_bf16 v[68:71], v[136:139], v[148:151], v[68:71]
    s_mul_i32 s30, s30, s44
    v_mfma_f32_16x16x32_bf16 v[72:75], v[136:139], v[152:155], v[72:75]
    s_lshl_b32 s30, s30, 1
    s_add_u32 m0, s33, 32768
    v_mfma_f32_16x16x32_bf16 v[76:79], v[136:139], v[156:159], v[76:79]
    s_nop 0
    v_mfma_f32_16x16x32_bf16 v[80:83], v[136:139], v[160:163], v[80:83]
    buffer_load_dwordx4 v248, s[8:11], s30 offen offset:0 lds
    buffer_load_dwordx4 v249, s[8:11], s30 offen offset:1024 lds
    v_mfma_f32_16x16x32_bf16 v[84:87], v[136:139], v[164:167], v[84:87]
    s_add_u32 s30, s30, s44
    v_mfma_f32_16x16x32_bf16 v[88:91], v[136:139], v[168:171], v[88:91]
    s_add_u32 s35, s27, s32
    s_add_u32 m0, s35, 0x800
    v_mfma_f32_16x16x32_bf16 v[92:95], v[136:139], v[172:175], v[92:95]
    s_add_u32 s27, s27, 0x8000
    v_mfma_f32_16x16x32_bf16 v[96:99], v[140:143], v[144:147], v[96:99]
    buffer_load_dwordx4 v242, s[4:7], s31 offen offset:0 lds
    v_mfma_f32_16x16x32_bf16 v[100:103], v[140:143], v[148:151], v[100:103]
    buffer_load_dwordx4 v243, s[4:7], s31 offen offset:1024 lds
    s_cmp_ge_u32 s27, 0x28000
    v_mfma_f32_16x16x32_bf16 v[104:107], v[140:143], v[152:155], v[104:107]
    s_cselect_b32 s27, 0x10000, s27
    v_mfma_f32_16x16x32_bf16 v[108:111], v[140:143], v[156:159], v[108:111]
    s_add_u32 s36, s28, 0x8000
    s_cmp_ge_u32 s36, 0x18000
    v_mfma_f32_16x16x32_bf16 v[112:115], v[140:143], v[160:163], v[112:115]
    s_cselect_b32 s36, 0, s36
    v_mfma_f32_16x16x32_bf16 v[116:119], v[140:143], v[164:167], v[116:119]
    s_sub_u32 s29, s36, s28
    s_mov_b32 s28, s36
    v_mfma_f32_16x16x32_bf16 v[120:123], v[140:143], v[168:171], v[120:123]
    v_add_u32 v224, s29, v224
    v_mfma_f32_16x16x32_bf16 v[124:127], v[140:143], v[172:175], v[124:127]
    v_add_u32 v225, s29, v225
    s_sub_u32 s34, s34, 1
    s_cmp_lg_u32 s34, 0
    s_cbranch_scc1 K1_LOOP_12v
    s_waitcnt vmcnt(8) lgkmcnt(0)
    s_barrier
    v_mfma_f32_16x16x32_bf16 v[0:3], v[176:179], v[192:195], v[0:3]
    ds_read_b128 v[128:131], v224 offset:0
    ds_read_b64_tr_b16 v[144:145], v226 offset:0
    v_mfma_f32_16x16x32_bf16 v[4:7], v[176:179], v[196:199], v[4:7]
    ds_read_b64_tr_b16 v[146:147], v226 offset:2048
    v_mfma_f32_16x16x32_bf16 v[8:11], v[176:179], v[200:203], v[8:11]
    ds_read_b64_tr_b16 v[148:149], v227 offset:0
    v_mfma_f32_16x16x32_bf16 v[12:15], v[176:179], v[204:207], v[12:15]
    ds_read_b64_tr_b16 v[150:151], v227 offset:2048
    v_mfma_f32_16x16x32_bf16 v[16:19], v[176:179], v[208:211], v[16:19]
    ds_read_b128 v[132:135], v224 offset:1024
    v_mfma_f32_16x16x32_bf16 v[20:23], v[176:179], v[212:215], v[20:23]
    ds_read_b64_tr_b16 v[152:153], v228 offset:0
    v_mfma_f32_16x16x32_bf16 v[24:27], v[176:179], v[216:219], v[24:27]
    ds_read_b64_tr_b16 v[154:155], v228 offset:2048
    v_mfma_f32_16x16x32_bf16 v[28:31], v[176:179], v[220:223], v[28:31]
    ds_read_b64_tr_b16 v[156:157], v229 offset:0
    v_mfma_f32_16x16x32_bf16 v[32:35], v[180:183], v[192:195], v[32:35]
    ds_read_b64_tr_b16 v[158:159], v229 offset:2048
    v_mfma_f32_16x16x32_bf16 v[36:39], v[180:183], v[196:199], v[36:39]
    ds_read_b64_tr_b16 v[160:161], v230 offset:0
    v_mfma_f32_16x16x32_bf16 v[40:43], v[180:183], v[200:203], v[40:43]
    ds_read_b64_tr_b16 v[162:163], v230 offset:2048
    v_mfma_f32_16x16x32_bf16 v[44:47], v[180:183], v[204:207], v[44:47]
    ds_read_b64_tr_b16 v[164:165], v231 offset:0
    v_mfma_f32_16x16x32_bf16 v[48:51], v[180:183], v[208:211], v[48:51]
    ds_read_b64_tr_b16 v[166:167], v231 offset:2048
    v_mfma_f32_16x16x32_bf16 v[52:55], v[180:183], v[212:215], v[52:55]
    ds_read_b64_tr_b16 v[168:169], v232 offset:0
    v_mfma_f32_16x16x32_bf16 v[56:59], v[180:183], v[216:219], v[56:59]
    ds_read_b64_tr_b16 v[170:171], v232 offset:2048
    v_mfma_f32_16x16x32_bf16 v[60:63], v[180:183], v[220:223], v[60:63]
    ds_read_b64_tr_b16 v[172:173], v233 offset:0
    v_mfma_f32_16x16x32_bf16 v[64:67], v[184:187], v[192:195], v[64:67]
    ds_read_b64_tr_b16 v[174:175], v233 offset:2048
    ds_read_b128 v[136:139], v224 offset:4096
    v_mfma_f32_16x16x32_bf16 v[68:71], v[184:187], v[196:199], v[68:71]
    ds_read_b128 v[140:143], v224 offset:5120
    v_mfma_f32_16x16x32_bf16 v[72:75], v[184:187], v[200:203], v[72:75]
    s_add_u32 m0, s33, 49152
    v_mfma_f32_16x16x32_bf16 v[76:79], v[184:187], v[204:207], v[76:79]
    s_nop 0
    v_mfma_f32_16x16x32_bf16 v[80:83], v[184:187], v[208:211], v[80:83]
    buffer_load_dwordx4 v248, s[8:11], s30 offen offset:0 lds
    v_mfma_f32_16x16x32_bf16 v[84:87], v[184:187], v[212:215], v[84:87]
    buffer_load_dwordx4 v249, s[8:11], s30 offen offset:1024 lds
    v_mfma_f32_16x16x32_bf16 v[88:91], v[184:187], v[216:219], v[88:91]
    s_mov_b32 s40, 0
    v_mfma_f32_16x16x32_bf16 v[92:95], v[184:187], v[220:223], v[92:95]
    s_add_u32 s31, s40, s43
    v_mfma_f32_16x16x32_bf16 v[96:99], v[188:191], v[192:195], v[96:99]
    s_sub_u32 s37, s31, 7
    v_mfma_f32_16x16x32_bf16 v[100:103], v[188:191], v[196:199], v[100:103]
    s_cmp_ge_u32 s31, 7
    v_mfma_f32_16x16x32_bf16 v[104:107], v[188:191], v[200:203], v[104:107]
    s_cselect_b32 s31, s37, s31
    v_mfma_f32_16x16x32_bf16 v[108:111], v[188:191], v[204:207], v[108:111]
    s_add_u32 s40, s40, 1
    v_mfma_f32_16x16x32_bf16 v[112:115], v[188:191], v[208:211], v[112:115]
    s_add_u32 m0, s27, s32
    v_mfma_f32_16x16x32_bf16 v[116:119], v[188:191], v[212:215], v[116:119]
    s_lshl_b32 s31, s31, 7
    v_mfma_f32_16x16x32_bf16 v[120:123], v[188:191], v[216:219], v[120:123]
    buffer_load_dwordx4 v244, s[12:15], s31 offen offset:0 lds
    v_mfma_f32_16x16x32_bf16 v[124:127], v[188:191], v[220:223], v[124:127]
    buffer_load_dwordx4 v245, s[12:15], s31 offen offset:1024 lds
    s_waitcnt vmcnt(10) lgkmcnt(0)
    s_barrier
    v_mfma_f32_16x16x32_bf16 v[0:3], v[128:131], v[144:147], v[0:3]
    ds_read_b128 v[176:179], v225 offset:0
    ds_read_b64_tr_b16 v[192:193], v226 offset:16384
    v_mfma_f32_16x16x32_bf16 v[4:7], v[128:131], v[148:151], v[4:7]
    ds_read_b64_tr_b16 v[194:195], v226 offset:18432
    v_mfma_f32_16x16x32_bf16 v[8:11], v[128:131], v[152:155], v[8:11]
    ds_read_b64_tr_b16 v[196:197], v227 offset:16384
    ds_read_b64_tr_b16 v[198:199], v227 offset:18432
    v_mfma_f32_16x16x32_bf16 v[12:15], v[128:131], v[156:159], v[12:15]
    ds_read_b128 v[180:183], v225 offset:1024
    v_mfma_f32_16x16x32_bf16 v[16:19], v[128:131], v[160:163], v[16:19]
    ds_read_b64_tr_b16 v[200:201], v228 offset:16384
    ds_read_b64_tr_b16 v[202:203], v228 offset:18432
    v_mfma_f32_16x16x32_bf16 v[20:23], v[128:131], v[164:167], v[20:23]
    ds_read_b64_tr_b16 v[204:205], v229 offset:16384
    v_mfma_f32_16x16x32_bf16 v[24:27], v[128:131], v[168:171], v[24:27]
    ds_read_b64_tr_b16 v[206:207], v229 offset:18432
    ds_read_b64_tr_b16 v[208:209], v230 offset:16384
    v_mfma_f32_16x16x32_bf16 v[28:31], v[128:131], v[172:175], v[28:31]
    ds_read_b64_tr_b16 v[210:211], v230 offset:18432
    v_mfma_f32_16x16x32_bf16 v[32:35], v[132:135], v[144:147], v[32:35]
    ds_read_b64_tr_b16 v[212:213], v231 offset:16384
    ds_read_b64_tr_b16 v[214:215], v231 offset:18432
    v_mfma_f32_16x16x32_bf16 v[36:39], v[132:135], v[148:151], v[36:39]
    ds_read_b64_tr_b16 v[216:217], v232 offset:16384
    v_mfma_f32_16x16x32_bf16 v[40:43], v[132:135], v[152:155], v[40:43]
    ds_read_b64_tr_b16 v[218:219], v232 offset:18432
    ds_read_b64_tr_b16 v[220:221], v233 offset:16384
    v_mfma_f32_16x16x32_bf16 v[44:47], v[132:135], v[156:159], v[44:47]
    ds_read_b64_tr_b16 v[222:223], v233 offset:18432
    v_mfma_f32_16x16x32_bf16 v[48:51], v[132:135], v[160:163], v[48:51]
    ds_read_b128 v[184:187], v225 offset:4096
    ds_read_b128 v[188:191], v225 offset:5120
    v_mfma_f32_16x16x32_bf16 v[52:55], v[132:135], v[164:167], v[52:55]
    s_mov_b32 s41, 0
    v_mfma_f32_16x16x32_bf16 v[56:59], v[132:135], v[168:171], v[56:59]
    s_add_u32 s30, s41, s43
    s_sub_u32 s37, s30, 7
    v_mfma_f32_16x16x32_bf16 v[60:63], v[132:135], v[172:175], v[60:63]
    s_cmp_ge_u32 s30, 7
    v_mfma_f32_16x16x32_bf16 v[64:67], v[136:139], v[144:147], v[64:67]
    s_cselect_b32 s30, s37, s30
    v_mfma_f32_16x16x32_bf16 v[68:71], v[136:139], v[148:151], v[68:71]
    s_add_u32 s41, s41, 1
    s_mul_i32 s30, s30, s45
    v_mfma_f32_16x16x32_bf16 v[72:75], v[136:139], v[152:155], v[72:75]
    s_lshl_b32 s30, s30, 1
    v_mfma_f32_16x16x32_bf16 v[76:79], v[136:139], v[156:159], v[76:79]
    s_add_u32 m0, s33, 0
    s_nop 0
    v_mfma_f32_16x16x32_bf16 v[80:83], v[136:139], v[160:163], v[80:83]
    buffer_load_dwordx4 v250, s[16:19], s30 offen offset:0 lds
    v_mfma_f32_16x16x32_bf16 v[84:87], v[136:139], v[164:167], v[84:87]
    buffer_load_dwordx4 v251, s[16:19], s30 offen offset:1024 lds
    s_add_u32 s30, s30, s45
    v_mfma_f32_16x16x32_bf16 v[88:91], v[136:139], v[168:171], v[88:91]
    s_add_u32 s35, s27, s32
    v_mfma_f32_16x16x32_bf16 v[92:95], v[136:139], v[172:175], v[92:95]
    s_add_u32 m0, s35, 0x800
    s_add_u32 s27, s27, 0x8000
    v_mfma_f32_16x16x32_bf16 v[96:99], v[140:143], v[144:147], v[96:99]
    buffer_load_dwordx4 v246, s[12:15], s31 offen offset:0 lds
    v_mfma_f32_16x16x32_bf16 v[100:103], v[140:143], v[148:151], v[100:103]
    buffer_load_dwordx4 v247, s[12:15], s31 offen offset:1024 lds
    s_cmp_ge_u32 s27, 0x28000
    v_mfma_f32_16x16x32_bf16 v[104:107], v[140:143], v[152:155], v[104:107]
    s_cselect_b32 s27, 0x10000, s27
    v_mfma_f32_16x16x32_bf16 v[108:111], v[140:143], v[156:159], v[108:111]
    s_add_u32 s36, s28, 0x8000
    s_cmp_ge_u32 s36, 0x18000
    v_mfma_f32_16x16x32_bf16 v[112:115], v[140:143], v[160:163], v[112:115]
    s_cselect_b32 s36, 0, s36
    v_mfma_f32_16x16x32_bf16 v[116:119], v[140:143], v[164:167], v[116:119]
    s_sub_u32 s29, s36, s28
    s_mov_b32 s28, s36
    v_mfma_f32_16x16x32_bf16 v[120:123], v[140:143], v[168:171], v[120:123]
    v_add_u32 v224, s29, v224
    v_mfma_f32_16x16x32_bf16 v[124:127], v[140:143], v[172:175], v[124:127]
    v_add_u32 v225, s29, v225
    s_waitcnt vmcnt(8) lgkmcnt(0)
    s_barrier
    v_mfma_f32_16x16x32_bf16 v[0:3], v[176:179], v[192:195], v[0:3]
    ds_read_b128 v[128:131], v224 offset:0
    ds_read_b64_tr_b16 v[144:145], v226 offset:32768
    v_mfma_f32_16x16x32_bf16 v[4:7], v[176:179], v[196:199], v[4:7]
    ds_read_b64_tr_b16 v[146:147], v226 offset:34816
    v_mfma_f32_16x16x32_bf16 v[8:11], v[176:179], v[200:203], v[8:11]
    ds_read_b64_tr_b16 v[148:149], v227 offset:32768
    v_mfma_f32_16x16x32_bf16 v[12:15], v[176:179], v[204:207], v[12:15]
    ds_read_b64_tr_b16 v[150:151], v227 offset:34816
    v_mfma_f32_16x16x32_bf16 v[16:19], v[176:179], v[208:211], v[16:19]
    ds_read_b128 v[132:135], v224 offset:1024
    v_mfma_f32_16x16x32_bf16 v[20:23], v[176:179], v[212:215], v[20:23]
    ds_read_b64_tr_b16 v[152:153], v228 offset:32768
    v_mfma_f32_16x16x32_bf16 v[24:27], v[176:179], v[216:219], v[24:27]
    ds_read_b64_tr_b16 v[154:155], v228 offset:34816
    v_mfma_f32_16x16x32_bf16 v[28:31], v[176:179], v[220:223], v[28:31]
    ds_read_b64_tr_b16 v[156:157], v229 offset:32768
    v_mfma_f32_16x16x32_bf16 v[32:35], v[180:183], v[192:195], v[32:35]
    ds_read_b64_tr_b16 v[158:159], v229 offset:34816
    v_mfma_f32_16x16x32_bf16 v[36:39], v[180:183], v[196:199], v[36:39]
    ds_read_b64_tr_b16 v[160:161], v230 offset:32768
    v_mfma_f32_16x16x32_bf16 v[40:43], v[180:183], v[200:203], v[40:43]
    ds_read_b64_tr_b16 v[162:163], v230 offset:34816
    v_mfma_f32_16x16x32_bf16 v[44:47], v[180:183], v[204:207], v[44:47]
    ds_read_b64_tr_b16 v[164:165], v231 offset:32768
    v_mfma_f32_16x16x32_bf16 v[48:51], v[180:183], v[208:211], v[48:51]
    ds_read_b64_tr_b16 v[166:167], v231 offset:34816
    v_mfma_f32_16x16x32_bf16 v[52:55], v[180:183], v[212:215], v[52:55]
    ds_read_b64_tr_b16 v[168:169], v232 offset:32768
    v_mfma_f32_16x16x32_bf16 v[56:59], v[180:183], v[216:219], v[56:59]
    ds_read_b64_tr_b16 v[170:171], v232 offset:34816
    v_mfma_f32_16x16x32_bf16 v[60:63], v[180:183], v[220:223], v[60:63]
    ds_read_b64_tr_b16 v[172:173], v233 offset:32768
    v_mfma_f32_16x16x32_bf16 v[64:67], v[184:187], v[192:195], v[64:67]
    ds_read_b64_tr_b16 v[174:175], v233 offset:34816
    v_mfma_f32_16x16x32_bf16 v[68:71], v[184:187], v[196:199], v[68:71]
    ds_read_b128 v[136:139], v224 offset:4096
    v_mfma_f32_16x16x32_bf16 v[72:75], v[184:187], v[200:203], v[72:75]
    ds_read_b128 v[140:143], v224 offset:5120
    v_mfma_f32_16x16x32_bf16 v[76:79], v[184:187], v[204:207], v[76:79]
    s_add_u32 m0, s33, 16384
    v_mfma_f32_16x16x32_bf16 v[80:83], v[184:187], v[208:211], v[80:83]
    s_nop 0
    v_mfma_f32_16x16x32_bf16 v[84:87], v[184:187], v[212:215], v[84:87]
    buffer_load_dwordx4 v250, s[16:19], s30 offen offset:0 lds
    v_mfma_f32_16x16x32_bf16 v[88:91], v[184:187], v[216:219], v[88:91]
    buffer_load_dwordx4 v251, s[16:19], s30 offen offset:1024 lds
    v_mfma_f32_16x16x32_bf16 v[92:95], v[184:187], v[220:223], v[92:95]
    s_add_u32 s31, s40, s43
    v_mfma_f32_16x16x32_bf16 v[96:99], v[188:191], v[192:195], v[96:99]
    s_sub_u32 s37, s31, 7
    v_mfma_f32_16x16x32_bf16 v[100:103], v[188:191], v[196:199], v[100:103]
    s_cmp_ge_u32 s31, 7
    v_mfma_f32_16x16x32_bf16 v[104:107], v[188:191], v[200:203], v[104:107]
    s_cselect_b32 s31, s37, s31
    v_mfma_f32_16x16x32_bf16 v[108:111], v[188:191], v[204:207], v[108:111]
    s_add_u32 s40, s40, 1
    v_mfma_f32_16x16x32_bf16 v[112:115], v[188:191], v[208:211], v[112:115]
    s_add_u32 m0, s27, s32
    v_mfma_f32_16x16x32_bf16 v[116:119], v[188:191], v[212:215], v[116:119]
    s_lshl_b32 s31, s31, 7
    v_mfma_f32_16x16x32_bf16 v[120:123], v[188:191], v[216:219], v[120:123]
    buffer_load_dwordx4 v244, s[12:15], s31 offen offset:0 lds
    v_mfma_f32_16x16x32_bf16 v[124:127], v[188:191], v[220:223], v[124:127]
    buffer_load_dwordx4 v245, s[12:15], s31 offen offset:1024 lds
    s_waitcnt vmcnt(10) lgkmcnt(0)
    s_barrier
    v_mfma_f32_16x16x32_bf16 v[0:3], v[128:131], v[144:147], v[0:3]
    ds_read_b128 v[176:179], v225 offset:0
    ds_read_b64_tr_b16 v[192:193], v226 offset:49152
    v_mfma_f32_16x16x32_bf16 v[4:7], v[128:131], v[148:151], v[4:7]
    ds_read_b64_tr_b16 v[194:195], v226 offset:51200
    v_mfma_f32_16x16x32_bf16 v[8:11], v[128:131], v[152:155], v[8:11]
    ds_read_b64_tr_b16 v[196:197], v227 offset:49152
    ds_read_b64_tr_b16 v[198:199], v227 offset:51200
    v_mfma_f32_16x16x32_bf16 v[12:15], v[128:131], v[156:159], v[12:15]
    ds_read_b128 v[180:183], v225 offset:1024
    v_mfma_f32_16x16x32_bf16 v[16:19], v[128:131], v[160:163], v[16:19]
    ds_read_b64_tr_b16 v[200:201], v228 offset:49152
    ds_read_b64_tr_b16 v[202:203], v228 offset:51200
    v_mfma_f32_16x16x32_bf16 v[20:23], v[128:131], v[164:167], v[20:23]
    ds_read_b64_tr_b16 v[204:205], v229 offset:49152
    v_mfma_f32_16x16x32_bf16 v[24:27], v[128:131], v[168:171], v[24:27]
    ds_read_b64_tr_b16 v[206:207], v229 offset:51200
    ds_read_b64_tr_b16 v[208:209], v230 offset:49152
    v_mfma_f32_16x16x32_bf16 v[28:31], v[128:131], v[172:175], v[28:31]
    ds_read_b64_tr_b16 v[210:211], v230 offset:51200
    v_mfma_f32_16x16x32_bf16 v[32:35], v[132:135], v[144:147], v[32:35]
    ds_read_b64_tr_b16 v[212:213], v231 offset:49152
    v_mfma_f32_16x16x32_bf16 v[36:39], v[132:135], v[148:151], v[36:39]
    ds_read_b64_tr_b16 v[214:215], v231 offset:51200
    ds_read_b64_tr_b16 v[216:217], v232 offset:49152
    v_mfma_f32_16x16x32_bf16 v[40:43], v[132:135], v[152:155], v[40:43]
    ds_read_b64_tr_b16 v[218:219], v232 offset:51200
    v_mfma_f32_16x16x32_bf16 v[44:47], v[132:135], v[156:159], v[44:47]
    ds_read_b64_tr_b16 v[220:221], v233 offset:49152
    ds_read_b64_tr_b16 v[222:223], v233 offset:51200
    v_mfma_f32_16x16x32_bf16 v[48:51], v[132:135], v[160:163], v[48:51]
    ds_read_b128 v[184:187], v225 offset:4096
    v_mfma_f32_16x16x32_bf16 v[52:55], v[132:135], v[164:167], v[52:55]
    ds_read_b128 v[188:191], v225 offset:5120
    s_add_u32 s30, s41, s43
    v_mfma_f32_16x16x32_bf16 v[56:59], v[132:135], v[168:171], v[56:59]
    s_sub_u32 s37, s30, 7
    v_mfma_f32_16x16x32_bf16 v[60:63], v[132:135], v[172:175], v[60:63]
    s_cmp_ge_u32 s30, 7
    v_mfma_f32_16x16x32_bf16 v[64:67], v[136:139], v[144:147], v[64:67]
    s_cselect_b32 s30, s37, s30
    s_add_u32 s41, s41, 1
    v_mfma_f32_16x16x32_bf16 v[68:71], v[136:139], v[148:151], v[68:71]
    s_mul_i32 s30, s30, s45
    v_mfma_f32_16x16x32_bf16 v[72:75], v[136:139], v[152:155], v[72:75]
    s_lshl_b32 s30, s30, 1
    s_add_u32 m0, s33, 32768
    v_mfma_f32_16x16x32_bf16 v[76:79], v[136:139], v[156:159], v[76:79]
    s_nop 0
    v_mfma_f32_16x16x32_bf16 v[80:83], v[136:139], v[160:163], v[80:83]
    buffer_load_dwordx4 v250, s[16:19], s30 offen offset:0 lds
    buffer_load_dwordx4 v251, s[16:19], s30 offen offset:1024 lds
    v_mfma_f32_16x16x32_bf16 v[84:87], v[136:139], v[164:167], v[84:87]
    s_add_u32 s30, s30, s45
    v_mfma_f32_16x16x32_bf16 v[88:91], v[136:139], v[168:171], v[88:91]
    s_add_u32 s35, s27, s32
    s_add_u32 m0, s35, 0x800
    v_mfma_f32_16x16x32_bf16 v[92:95], v[136:139], v[172:175], v[92:95]
    s_add_u32 s27, s27, 0x8000
    v_mfma_f32_16x16x32_bf16 v[96:99], v[140:143], v[144:147], v[96:99]
    buffer_load_dwordx4 v246, s[12:15], s31 offen offset:0 lds
    v_mfma_f32_16x16x32_bf16 v[100:103], v[140:143], v[148:151], v[100:103]
    buffer_load_dwordx4 v247, s[12:15], s31 offen offset:1024 lds
    s_cmp_ge_u32 s27, 0x28000
    v_mfma_f32_16x16x32_bf16 v[104:107], v[140:143], v[152:155], v[104:107]
    s_cselect_b32 s27, 0x10000, s27
    v_mfma_f32_16x16x32_bf16 v[108:111], v[140:143], v[156:159], v[108:111]
    s_add_u32 s36, s28, 0x8000
    s_cmp_ge_u32 s36, 0x18000
    v_mfma_f32_16x16x32_bf16 v[112:115], v[140:143], v[160:163], v[112:115]
    s_cselect_b32 s36, 0, s36
    v_mfma_f32_16x16x32_bf16 v[116:119], v[140:143], v[164:167], v[116:119]
    s_sub_u32 s29, s36, s28
    s_mov_b32 s28, s36
    v_mfma_f32_16x16x32_bf16 v[120:123], v[140:143], v[168:171], v[120:123]
    v_add_u32 v224, s29, v224
    v_mfma_f32_16x16x32_bf16 v[124:127], v[140:143], v[172:175], v[124:127]
    v_add_u32 v225, s29, v225
    s_waitcnt vmcnt(8) lgkmcnt(0)
    s_barrier
    v_mfma_f32_16x16x32_bf16 v[0:3], v[176:179], v[192:195], v[0:3]
    ds_read_b128 v[128:131], v224 offset:0
    v_mfma_f32_16x16x32_bf16 v[4:7], v[176:179], v[196:199], v[4:7]
    ds_read_b64_tr_b16 v[144:145], v234 offset:0
    v_mfma_f32_16x16x32_bf16 v[8:11], v[176:179], v[200:203], v[8:11]
    ds_read_b64_tr_b16 v[146:147], v234 offset:1536
    v_mfma_f32_16x16x32_bf16 v[12:15], v[176:179], v[204:207], v[12:15]
    ds_read_b64_tr_b16 v[148:149], v235 offset:0
    v_mfma_f32_16x16x32_bf16 v[16:19], v[176:179], v[208:211], v[16:19]
    ds_read_b64_tr_b16 v[150:151], v235 offset:1536
    v_mfma_f32_16x16x32_bf16 v[20:23], v[176:179], v[212:215], v[20:23]
    ds_read_b128 v[132:135], v224 offset:1024
    v_mfma_f32_16x16x32_bf16 v[24:27], v[176:179], v[216:219], v[24:27]
    ds_read_b64_tr_b16 v[152:153], v236 offset:0
    v_mfma_f32_16x16x32_bf16 v[28:31], v[176:179], v[220:223], v[28:31]
    ds_read_b64_tr_b16 v[154:155], v236 offset:1536
    v_mfma_f32_16x16x32_bf16 v[32:35], v[180:183], v[192:195], v[32:35]
    ds_read_b64_tr_b16 v[156:157], v237 offset:0
    v_mfma_f32_16x16x32_bf16 v[36:39], v[180:183], v[196:199], v[36:39]
    ds_read_b64_tr_b16 v[158:159], v237 offset:1536
    v_mfma_f32_16x16x32_bf16 v[40:43], v[180:183], v[200:203], v[40:43]
    v_mfma_f32_16x16x32_bf16 v[44:47], v[180:183], v[204:207], v[44:47]
    ds_read_b64_tr_b16 v[160:161], v238 offset:0
    v_mfma_f32_16x16x32_bf16 v[48:51], v[180:183], v[208:211], v[48:51]
    ds_read_b64_tr_b16 v[162:163], v238 offset:1536
    v_mfma_f32_16x16x32_bf16 v[52:55], v[180:183], v[212:215], v[52:55]
    ds_read_b64_tr_b16 v[164:165], v239 offset:0
    v_mfma_f32_16x16x32_bf16 v[56:59], v[180:183], v[216:219], v[56:59]
    ds_read_b64_tr_b16 v[166:167], v239 offset:1536
    v_mfma_f32_16x16x32_bf16 v[60:63], v[180:183], v[220:223], v[60:63]
    ds_read_b128 v[136:139], v224 offset:4096
    v_mfma_f32_16x16x32_bf16 v[64:67], v[184:187], v[192:195], v[64:67]
    ds_read_b128 v[140:143], v224 offset:5120
    v_mfma_f32_16x16x32_bf16 v[68:71], v[184:187], v[196:199], v[68:71]
    s_add_u32 m0, s33, 49152
    v_mfma_f32_16x16x32_bf16 v[72:75], v[184:187], v[200:203], v[72:75]
    s_nop 0
    v_mfma_f32_16x16x32_bf16 v[76:79], v[184:187], v[204:207], v[76:79]
    buffer_load_dwordx4 v250, s[16:19], s30 offen offset:0 lds
    v_mfma_f32_16x16x32_bf16 v[80:83], v[184:187], v[208:211], v[80:83]
    buffer_load_dwordx4 v251, s[16:19], s30 offen offset:1024 lds
    v_mfma_f32_16x16x32_bf16 v[84:87], v[184:187], v[212:215], v[84:87]
    v_mfma_f32_16x16x32_bf16 v[88:91], v[184:187], v[216:219], v[88:91]
    s_add_u32 s31, s40, s43
    v_mfma_f32_16x16x32_bf16 v[92:95], v[184:187], v[220:223], v[92:95]
    s_sub_u32 s37, s31, 7
    v_mfma_f32_16x16x32_bf16 v[96:99], v[188:191], v[192:195], v[96:99]
    s_cmp_ge_u32 s31, 7
    v_mfma_f32_16x16x32_bf16 v[100:103], v[188:191], v[196:199], v[100:103]
    s_cselect_b32 s31, s37, s31
    v_mfma_f32_16x16x32_bf16 v[104:107], v[188:191], v[200:203], v[104:107]
    s_add_u32 s40, s40, 1
    v_mfma_f32_16x16x32_bf16 v[108:111], v[188:191], v[204:207], v[108:111]
    s_add_u32 m0, s27, s32
    v_mfma_f32_16x16x32_bf16 v[112:115], v[188:191], v[208:211], v[112:115]
    s_lshl_b32 s31, s31, 7
    v_mfma_f32_16x16x32_bf16 v[116:119], v[188:191], v[212:215], v[116:119]
    buffer_load_dwordx4 v244, s[12:15], s31 offen offset:0 lds
    v_mfma_f32_16x16x32_bf16 v[120:123], v[188:191], v[216:219], v[120:123]
    buffer_load_dwordx4 v245, s[12:15], s31 offen offset:1024 lds
    v_mfma_f32_16x16x32_bf16 v[124:127], v[188:191], v[220:223], v[124:127]
    s_nop 7
    s_lshl_b32 s35, s48, 6
    s_lshl_b32 s36, s50, 3
    s_add_u32 s35, s35, s36
    s_lshl_b32 s36, s25, 1
    s_add_u32 s35, s35, s36
    s_lshl_b32 s35, s35, 5
    s_lshl_b32 s36, s49, 4
    s_add_u32 s35, s35, s36
    s_lshl_b32 s36, s26, 3
    s_add_u32 s35, s35, s36
    s_lshl_b32 s39, s35, 10
    v_cvt_pk_bf16_f32 v176, v0, v1
    v_cvt_pk_bf16_f32 v177, v2, v3
    v_cvt_pk_bf16_f32 v178, v32, v33
    v_cvt_pk_bf16_f32 v179, v34, v35
    buffer_store_dwordx4 v[176:179], v252, s[20:23], s39 offen offset:0 sc1
    v_cvt_pk_bf16_f32 v180, v4, v5
    v_cvt_pk_bf16_f32 v181, v6, v7
    v_cvt_pk_bf16_f32 v182, v36, v37
    v_cvt_pk_bf16_f32 v183, v38, v39
    buffer_store_dwordx4 v[180:183], v252, s[20:23], s39 offen offset:128 sc1
    v_cvt_pk_bf16_f32 v184, v8, v9
    v_cvt_pk_bf16_f32 v185, v10, v11
    v_cvt_pk_bf16_f32 v186, v40, v41
    v_cvt_pk_bf16_f32 v187, v42, v43
    buffer_store_dwordx4 v[184:187], v252, s[20:23], s39 offen offset:2048 sc1
    v_cvt_pk_bf16_f32 v188, v12, v13
    v_cvt_pk_bf16_f32 v189, v14, v15
    v_cvt_pk_bf16_f32 v190, v44, v45
    v_cvt_pk_bf16_f32 v191, v46, v47
    buffer_store_dwordx4 v[188:191], v252, s[20:23], s39 offen offset:2176 sc1
    s_add_u32 s39, s39, 4096
    v_cvt_pk_bf16_f32 v192, v16, v17
    v_cvt_pk_bf16_f32 v193, v18, v19
    v_cvt_pk_bf16_f32 v194, v48, v49
    v_cvt_pk_bf16_f32 v195, v50, v51
    buffer_store_dwordx4 v[192:195], v252, s[20:23], s39 offen offset:0 sc1
    v_cvt_pk_bf16_f32 v196, v20, v21
    v_cvt_pk_bf16_f32 v197, v22, v23
    v_cvt_pk_bf16_f32 v198, v52, v53
    v_cvt_pk_bf16_f32 v199, v54, v55
    buffer_store_dwordx4 v[196:199], v252, s[20:23], s39 offen offset:128 sc1
    v_cvt_pk_bf16_f32 v200, v24, v25
    v_cvt_pk_bf16_f32 v201, v26, v27
    v_cvt_pk_bf16_f32 v202, v56, v57
    v_cvt_pk_bf16_f32 v203, v58, v59
    buffer_store_dwordx4 v[200:203], v252, s[20:23], s39 offen offset:2048 sc1
    v_cvt_pk_bf16_f32 v204, v28, v29
    v_cvt_pk_bf16_f32 v205, v30, v31
    v_cvt_pk_bf16_f32 v206, v60, v61
    v_cvt_pk_bf16_f32 v207, v62, v63
    buffer_store_dwordx4 v[204:207], v252, s[20:23], s39 offen offset:2176 sc1
    s_add_u32 s39, s39, 28672
    v_cvt_pk_bf16_f32 v208, v64, v65
    v_cvt_pk_bf16_f32 v209, v66, v67
    v_cvt_pk_bf16_f32 v210, v96, v97
    v_cvt_pk_bf16_f32 v211, v98, v99
    buffer_store_dwordx4 v[208:211], v252, s[20:23], s39 offen offset:0 sc1
    v_cvt_pk_bf16_f32 v212, v68, v69
    v_cvt_pk_bf16_f32 v213, v70, v71
    v_cvt_pk_bf16_f32 v214, v100, v101
    v_cvt_pk_bf16_f32 v215, v102, v103
    buffer_store_dwordx4 v[212:215], v252, s[20:23], s39 offen offset:128 sc1
    v_cvt_pk_bf16_f32 v216, v72, v73
    v_cvt_pk_bf16_f32 v217, v74, v75
    v_cvt_pk_bf16_f32 v218, v104, v105
    v_cvt_pk_bf16_f32 v219, v106, v107
    buffer_store_dwordx4 v[216:219], v252, s[20:23], s39 offen offset:2048 sc1
    v_cvt_pk_bf16_f32 v220, v76, v77
    v_cvt_pk_bf16_f32 v221, v78, v79
    v_cvt_pk_bf16_f32 v222, v108, v109
    v_cvt_pk_bf16_f32 v223, v110, v111
    buffer_store_dwordx4 v[220:223], v252, s[20:23], s39 offen offset:2176 sc1
    s_add_u32 s39, s39, 4096
    v_cvt_pk_bf16_f32 v176, v80, v81
    v_cvt_pk_bf16_f32 v177, v82, v83
    v_cvt_pk_bf16_f32 v178, v112, v113
    v_cvt_pk_bf16_f32 v179, v114, v115
    buffer_store_dwordx4 v[176:179], v252, s[20:23], s39 offen offset:0 sc1
    v_cvt_pk_bf16_f32 v180, v84, v85
    v_cvt_pk_bf16_f32 v181, v86, v87
    v_cvt_pk_bf16_f32 v182, v116, v117
    v_cvt_pk_bf16_f32 v183, v118, v119
    buffer_store_dwordx4 v[180:183], v252, s[20:23], s39 offen offset:128 sc1
    v_cvt_pk_bf16_f32 v184, v88, v89
    v_cvt_pk_bf16_f32 v185, v90, v91
    v_cvt_pk_bf16_f32 v186, v120, v121
    v_cvt_pk_bf16_f32 v187, v122, v123
    buffer_store_dwordx4 v[184:187], v252, s[20:23], s39 offen offset:2048 sc1
    v_cvt_pk_bf16_f32 v188, v92, v93
    v_cvt_pk_bf16_f32 v189, v94, v95
    v_cvt_pk_bf16_f32 v190, v124, v125
    v_cvt_pk_bf16_f32 v191, v126, v127
    buffer_store_dwordx4 v[188:191], v252, s[20:23], s39 offen offset:2176 sc1
    s_add_u32 s39, s39, 28672
    s_cmp_lg_u32 s94, 0
    s_cbranch_scc1 K1_GATE
    s_waitcnt vmcnt(26) lgkmcnt(0)
    s_barrier
    v_mfma_f32_16x16x32_bf16 v[0:3], v[144:147], v[128:131], 0
    ds_read_b128 v[176:179], v225 offset:0
    ds_read_b64_tr_b16 v[192:193], v234 offset:16384
    v_mfma_f32_16x16x32_bf16 v[4:7], v[148:151], v[128:131], 0
    ds_read_b64_tr_b16 v[194:195], v234 offset:17920
    ds_read_b64_tr_b16 v[196:197], v235 offset:16384
    v_mfma_f32_16x16x32_bf16 v[8:11], v[152:155], v[128:131], 0
    ds_read_b64_tr_b16 v[198:199], v235 offset:17920
    ds_read_b128 v[180:183], v225 offset:1024
    v_mfma_f32_16x16x32_bf16 v[12:15], v[156:159], v[128:131], 0
    ds_read_b64_tr_b16 v[200:201], v236 offset:16384
    v_mfma_f32_16x16x32_bf16 v[16:19], v[160:163], v[128:131], 0
    ds_read_b64_tr_b16 v[202:203], v236 offset:17920
    ds_read_b64_tr_b16 v[204:205], v237 offset:16384
    v_mfma_f32_16x16x32_bf16 v[20:23], v[164:167], v[128:131], 0
    ds_read_b64_tr_b16 v[206:207], v237 offset:17920
    ds_read_b64_tr_b16 v[208:209], v238 offset:16384
    v_mfma_f32_16x16x32_bf16 v[32:35], v[144:147], v[132:135], 0
    ds_read_b64_tr_b16 v[210:211], v238 offset:17920
    ds_read_b64_tr_b16 v[212:213], v239 offset:16384
    v_mfma_f32_16x16x32_bf16 v[36:39], v[148:151], v[132:135], 0
    ds_read_b64_tr_b16 v[214:215], v239 offset:17920
    v_mfma_f32_16x16x32_bf16 v[40:43], v[152:155], v[132:135], 0
    ds_read_b128 v[184:187], v225 offset:4096
    ds_read_b128 v[188:191], v225 offset:5120
    v_mfma_f32_16x16x32_bf16 v[44:47], v[156:159], v[132:135], 0
    s_add_u32 s30, s41, s43
    s_sub_u32 s37, s30, 7
    v_mfma_f32_16x16x32_bf16 v[48:51], v[160:163], v[132:135], 0
    s_cmp_ge_u32 s30, 7
    s_cselect_b32 s30, s37, s30
    v_mfma_f32_16x16x32_bf16 v[52:55], v[164:167], v[132:135], 0
    s_add_u32 s41, s41, 1
    v_mfma_f32_16x16x32_bf16 v[64:67], v[144:147], v[136:139], 0
    s_mul_i32 s30, s30, s45
    s_lshl_b32 s30, s30, 1
    v_mfma_f32_16x16x32_bf16 v[68:71], v[148:151], v[136:139], 0
    s_add_u32 m0, s33, 0
    s_nop 0
    v_mfma_f32_16x16x32_bf16 v[72:75], v[152:155], v[136:139], 0
    buffer_load_dwordx4 v250, s[16:19], s30 offen offset:0 lds
    buffer_load_dwordx4 v251, s[16:19], s30 offen offset:1024 lds
    v_mfma_f32_16x16x32_bf16 v[76:79], v[156:159], v[136:139], 0
    s_add_u32 s30, s30, s45
    v_mfma_f32_16x16x32_bf16 v[80:83], v[160:163], v[136:139], 0
    s_add_u32 s35, s27, s32
    s_add_u32 m0, s35, 0x800
    v_mfma_f32_16x16x32_bf16 v[84:87], v[164:167], v[136:139], 0
    s_add_u32 s27, s27, 0x8000
    buffer_load_dwordx4 v246, s[12:15], s31 offen offset:0 lds
    v_mfma_f32_16x16x32_bf16 v[96:99], v[144:147], v[140:143], 0
    buffer_load_dwordx4 v247, s[12:15], s31 offen offset:1024 lds
    s_cmp_ge_u32 s27, 0x28000
    v_mfma_f32_16x16x32_bf16 v[100:103], v[148:151], v[140:143], 0
    s_cselect_b32 s27, 0x10000, s27
    v_mfma_f32_16x16x32_bf16 v[104:107], v[152:155], v[140:143], 0
    s_add_u32 s36, s28, 0x8000
    s_cmp_ge_u32 s36, 0x18000
    v_mfma_f32_16x16x32_bf16 v[108:111], v[156:159], v[140:143], 0
    s_cselect_b32 s36, 0, s36
    s_sub_u32 s29, s36, s28
    v_mfma_f32_16x16x32_bf16 v[112:115], v[160:163], v[140:143], 0
    s_mov_b32 s28, s36
    v_add_u32 v224, s29, v224
    v_mfma_f32_16x16x32_bf16 v[116:119], v[164:167], v[140:143], 0
    v_add_u32 v225, s29, v225
    s_waitcnt vmcnt(24) lgkmcnt(0)
    s_barrier
    v_mfma_f32_16x16x32_bf16 v[0:3], v[192:195], v[176:179], v[0:3]
    ds_read_b128 v[128:131], v224 offset:0
    ds_read_b64_tr_b16 v[144:145], v234 offset:32768
    v_mfma_f32_16x16x32_bf16 v[4:7], v[196:199], v[176:179], v[4:7]
    ds_read_b64_tr_b16 v[146:147], v234 offset:34304
    v_mfma_f32_16x16x32_bf16 v[8:11], v[200:203], v[176:179], v[8:11]
    ds_read_b64_tr_b16 v[148:149], v235 offset:32768
    v_mfma_f32_16x16x32_bf16 v[12:15], v[204:207], v[176:179], v[12:15]
    ds_read_b64_tr_b16 v[150:151], v235 offset:34304
    v_mfma_f32_16x16x32_bf16 v[16:19], v[208:211], v[176:179], v[16:19]
    ds_read_b128 v[132:135], v224 offset:1024
    ds_read_b64_tr_b16 v[152:153], v236 offset:32768
    v_mfma_f32_16x16x32_bf16 v[20:23], v[212:215], v[176:179], v[20:23]
    ds_read_b64_tr_b16 v[154:155], v236 offset:34304
    v_mfma_f32_16x16x32_bf16 v[32:35], v[192:195], v[180:183], v[32:35]
    ds_read_b64_tr_b16 v[156:157], v237 offset:32768
    v_mfma_f32_16x16x32_bf16 v[36:39], v[196:199], v[180:183], v[36:39]
    ds_read_b64_tr_b16 v[158:159], v237 offset:34304
    v_mfma_f32_16x16x32_bf16 v[40:43], v[200:203], v[180:183], v[40:43]
    ds_read_b64_tr_b16 v[160:161], v238 offset:32768
    v_mfma_f32_16x16x32_bf16 v[44:47], v[204:207], v[180:183], v[44:47]
    ds_read_b64_tr_b16 v[162:163], v238 offset:34304
    ds_read_b64_tr_b16 v[164:165], v239 offset:32768
    v_mfma_f32_16x16x32_bf16 v[48:51], v[208:211], v[180:183], v[48:51]
    ds_read_b64_tr_b16 v[166:167], v239 offset:34304
    v_mfma_f32_16x16x32_bf16 v[52:55], v[212:215], v[180:183], v[52:55]
    ds_read_b128 v[136:139], v224 offset:4096
    v_mfma_f32_16x16x32_bf16 v[64:67], v[192:195], v[184:187], v[64:67]
    ds_read_b128 v[140:143], v224 offset:5120
    v_mfma_f32_16x16x32_bf16 v[68:71], v[196:199], v[184:187], v[68:71]
    s_add_u32 m0, s33, 16384
    v_mfma_f32_16x16x32_bf16 v[72:75], v[200:203], v[184:187], v[72:75]
    s_nop 0
    buffer_load_dwordx4 v250, s[16:19], s30 offen offset:0 lds
    v_mfma_f32_16x16x32_bf16 v[76:79], v[204:207], v[184:187], v[76:79]
    buffer_load_dwordx4 v251, s[16:19], s30 offen offset:1024 lds
    v_mfma_f32_16x16x32_bf16 v[80:83], v[208:211], v[184:187], v[80:83]
    s_add_u32 s31, s40, s43
    v_mfma_f32_16x16x32_bf16 v[84:87], v[212:215], v[184:187], v[84:87]
    s_sub_u32 s37, s31, 7
    v_mfma_f32_16x16x32_bf16 v[96:99], v[192:195], v[188:191], v[96:99]
    s_cmp_ge_u32 s31, 7
    v_mfma_f32_16x16x32_bf16 v[100:103], v[196:199], v[188:191], v[100:103]
    s_cselect_b32 s31, s37, s31
    s_add_u32 s40, s40, 1
    v_mfma_f32_16x16x32_bf16 v[104:107], v[200:203], v[188:191], v[104:107]
    s_add_u32 m0, s27, s32
    v_mfma_f32_16x16x32_bf16 v[108:111], v[204:207], v[188:191], v[108:111]
    s_lshl_b32 s31, s31, 7
    v_mfma_f32_16x16x32_bf16 v[112:115], v[208:211], v[188:191], v[112:115]
    buffer_load_dwordx4 v244, s[12:15], s31 offen offset:0 lds
    v_mfma_f32_16x16x32_bf16 v[116:119], v[212:215], v[188:191], v[116:119]
    buffer_load_dwordx4 v245, s[12:15], s31 offen offset:1024 lds
    s_waitcnt vmcnt(26) lgkmcnt(0)
    s_barrier
    v_mfma_f32_16x16x32_bf16 v[0:3], v[144:147], v[128:131], v[0:3]
    ds_read_b128 v[176:179], v225 offset:0
    ds_read_b64_tr_b16 v[192:193], v234 offset:49152
    v_mfma_f32_16x16x32_bf16 v[4:7], v[148:151], v[128:131], v[4:7]
    ds_read_b64_tr_b16 v[194:195], v234 offset:50688
    ds_read_b64_tr_b16 v[196:197], v235 offset:49152
    v_mfma_f32_16x16x32_bf16 v[8:11], v[152:155], v[128:131], v[8:11]
    ds_read_b64_tr_b16 v[198:199], v235 offset:50688
    ds_read_b128 v[180:183], v225 offset:1024
    v_mfma_f32_16x16x32_bf16 v[12:15], v[156:159], v[128:131], v[12:15]
    ds_read_b64_tr_b16 v[200:201], v236 offset:49152
    v_mfma_f32_16x16x32_bf16 v[16:19], v[160:163], v[128:131], v[16:19]
    ds_read_b64_tr_b16 v[202:203], v236 offset:50688
    ds_read_b64_tr_b16 v[204:205], v237 offset:49152
    v_mfma_f32_16x16x32_bf16 v[20:23], v[164:167], v[128:131], v[20:23]
    ds_read_b64_tr_b16 v[206:207], v237 offset:50688
    ds_read_b64_tr_b16 v[208:209], v238 offset:49152
    v_mfma_f32_16x16x32_bf16 v[32:35], v[144:147], v[132:135], v[32:35]
    ds_read_b64_tr_b16 v[210:211], v238 offset:50688
    ds_read_b64_tr_b16 v[212:213], v239 offset:49152
    v_mfma_f32_16x16x32_bf16 v[36:39], v[148:151], v[132:135], v[36:39]
    ds_read_b64_tr_b16 v[214:215], v239 offset:50688
    v_mfma_f32_16x16x32_bf16 v[40:43], v[152:155], v[132:135], v[40:43]
    ds_read_b128 v[184:187], v225 offset:4096
    ds_read_b128 v[188:191], v225 offset:5120
    v_mfma_f32_16x16x32_bf16 v[44:47], v[156:159], v[132:135], v[44:47]
    s_add_u32 s30, s41, s43
    s_sub_u32 s37, s30, 7
    v_mfma_f32_16x16x32_bf16 v[48:51], v[160:163], v[132:135], v[48:51]
    s_cmp_ge_u32 s30, 7
    s_cselect_b32 s30, s37, s30
    v_mfma_f32_16x16x32_bf16 v[52:55], v[164:167], v[132:135], v[52:55]
    s_add_u32 s41, s41, 1
    v_mfma_f32_16x16x32_bf16 v[64:67], v[144:147], v[136:139], v[64:67]
    s_mul_i32 s30, s30, s45
    s_lshl_b32 s30, s30, 1
    v_mfma_f32_16x16x32_bf16 v[68:71], v[148:151], v[136:139], v[68:71]
    s_add_u32 m0, s33, 32768
    s_nop 0
    v_mfma_f32_16x16x32_bf16 v[72:75], v[152:155], v[136:139], v[72:75]
    buffer_load_dwordx4 v250, s[16:19], s30 offen offset:0 lds
    buffer_load_dwordx4 v251, s[16:19], s30 offen offset:1024 lds
    v_mfma_f32_16x16x32_bf16 v[76:79], v[156:159], v[136:139], v[76:79]
    s_add_u32 s30, s30, s45
    v_mfma_f32_16x16x32_bf16 v[80:83], v[160:163], v[136:139], v[80:83]
    s_add_u32 s35, s27, s32
    s_add_u32 m0, s35, 0x800
    v_mfma_f32_16x16x32_bf16 v[84:87], v[164:167], v[136:139], v[84:87]
    s_add_u32 s27, s27, 0x8000
    buffer_load_dwordx4 v246, s[12:15], s31 offen offset:0 lds
    v_mfma_f32_16x16x32_bf16 v[96:99], v[144:147], v[140:143], v[96:99]
    buffer_load_dwordx4 v247, s[12:15], s31 offen offset:1024 lds
    s_cmp_ge_u32 s27, 0x28000
    v_mfma_f32_16x16x32_bf16 v[100:103], v[148:151], v[140:143], v[100:103]
    s_cselect_b32 s27, 0x10000, s27
    v_mfma_f32_16x16x32_bf16 v[104:107], v[152:155], v[140:143], v[104:107]
    s_add_u32 s36, s28, 0x8000
    s_cmp_ge_u32 s36, 0x18000
    v_mfma_f32_16x16x32_bf16 v[108:111], v[156:159], v[140:143], v[108:111]
    s_cselect_b32 s36, 0, s36
    s_sub_u32 s29, s36, s28
    v_mfma_f32_16x16x32_bf16 v[112:115], v[160:163], v[140:143], v[112:115]
    s_mov_b32 s28, s36
    v_add_u32 v224, s29, v224
    v_mfma_f32_16x16x32_bf16 v[116:119], v[164:167], v[140:143], v[116:119]
    v_add_u32 v225, s29, v225
    s_waitcnt vmcnt(8) lgkmcnt(0)
    s_barrier
    v_mfma_f32_16x16x32_bf16 v[0:3], v[192:195], v[176:179], v[0:3]
    ds_read_b128 v[128:131], v224 offset:0
    ds_read_b64_tr_b16 v[144:145], v234 offset:0
    v_mfma_f32_16x16x32_bf16 v[4:7], v[196:199], v[176:179], v[4:7]
    ds_read_b64_tr_b16 v[146:147], v234 offset:1536
    v_mfma_f32_16x16x32_bf16 v[8:11], v[200:203], v[176:179], v[8:11]
    ds_read_b64_tr_b16 v[148:149], v235 offset:0
    v_mfma_f32_16x16x32_bf16 v[12:15], v[204:207], v[176:179], v[12:15]
    ds_read_b64_tr_b16 v[150:151], v235 offset:1536
    v_mfma_f32_16x16x32_bf16 v[16:19], v[208:211], v[176:179], v[16:19]
    ds_read_b128 v[132:135], v224 offset:1024
    ds_read_b64_tr_b16 v[152:153], v236 offset:0
    v_mfma_f32_16x16x32_bf16 v[20:23], v[212:215], v[176:179], v[20:23]
    ds_read_b64_tr_b16 v[154:155], v236 offset:1536
    v_mfma_f32_16x16x32_bf16 v[32:35], v[192:195], v[180:183], v[32:35]
    ds_read_b64_tr_b16 v[156:157], v237 offset:0
    v_mfma_f32_16x16x32_bf16 v[36:39], v[196:199], v[180:183], v[36:39]
    ds_read_b64_tr_b16 v[158:159], v237 offset:1536
    v_mfma_f32_16x16x32_bf16 v[40:43], v[200:203], v[180:183], v[40:43]
    ds_read_b64_tr_b16 v[160:161], v238 offset:0
    v_mfma_f32_16x16x32_bf16 v[44:47], v[204:207], v[180:183], v[44:47]
    ds_read_b64_tr_b16 v[162:163], v238 offset:1536
    ds_read_b64_tr_b16 v[164:165], v239 offset:0
    v_mfma_f32_16x16x32_bf16 v[48:51], v[208:211], v[180:183], v[48:51]
    ds_read_b64_tr_b16 v[166:167], v239 offset:1536
    v_mfma_f32_16x16x32_bf16 v[52:55], v[212:215], v[180:183], v[52:55]
    ds_read_b128 v[136:139], v224 offset:4096
    v_mfma_f32_16x16x32_bf16 v[64:67], v[192:195], v[184:187], v[64:67]
    ds_read_b128 v[140:143], v224 offset:5120
    v_mfma_f32_16x16x32_bf16 v[68:71], v[196:199], v[184:187], v[68:71]
    s_add_u32 m0, s33, 49152
    v_mfma_f32_16x16x32_bf16 v[72:75], v[200:203], v[184:187], v[72:75]
    s_nop 0
    buffer_load_dwordx4 v250, s[16:19], s30 offen offset:0 lds
    v_mfma_f32_16x16x32_bf16 v[76:79], v[204:207], v[184:187], v[76:79]
    buffer_load_dwordx4 v251, s[16:19], s30 offen offset:1024 lds
    v_mfma_f32_16x16x32_bf16 v[80:83], v[208:211], v[184:187], v[80:83]
    s_add_u32 s31, s40, s43
    v_mfma_f32_16x16x32_bf16 v[84:87], v[212:215], v[184:187], v[84:87]
    s_sub_u32 s37, s31, 7
    v_mfma_f32_16x16x32_bf16 v[96:99], v[192:195], v[188:191], v[96:99]
    s_cmp_ge_u32 s31, 7
    v_mfma_f32_16x16x32_bf16 v[100:103], v[196:199], v[188:191], v[100:103]
    s_cselect_b32 s31, s37, s31
    s_add_u32 s40, s40, 1
    v_mfma_f32_16x16x32_bf16 v[104:107], v[200:203], v[188:191], v[104:107]
    s_add_u32 m0, s27, s32
    v_mfma_f32_16x16x32_bf16 v[108:111], v[204:207], v[188:191], v[108:111]
    s_lshl_b32 s31, s31, 7
    v_mfma_f32_16x16x32_bf16 v[112:115], v[208:211], v[188:191], v[112:115]
    buffer_load_dwordx4 v244, s[12:15], s31 offen offset:0 lds
    v_mfma_f32_16x16x32_bf16 v[116:119], v[212:215], v[188:191], v[116:119]
    buffer_load_dwordx4 v245, s[12:15], s31 offen offset:1024 lds
    s_waitcnt vmcnt(10) lgkmcnt(0)
    s_barrier
    v_mfma_f32_16x16x32_bf16 v[0:3], v[144:147], v[128:131], v[0:3]
    ds_read_b128 v[176:179], v225 offset:0
    ds_read_b64_tr_b16 v[192:193], v234 offset:16384
    v_mfma_f32_16x16x32_bf16 v[4:7], v[148:151], v[128:131], v[4:7]
    ds_read_b64_tr_b16 v[194:195], v234 offset:17920
    ds_read_b64_tr_b16 v[196:197], v235 offset:16384
    v_mfma_f32_16x16x32_bf16 v[8:11], v[152:155], v[128:131], v[8:11]
    ds_read_b64_tr_b16 v[198:199], v235 offset:17920
    ds_read_b128 v[180:183], v225 offset:1024
    v_mfma_f32_16x16x32_bf16 v[12:15], v[156:159], v[128:131], v[12:15]
    ds_read_b64_tr_b16 v[200:201], v236 offset:16384
    v_mfma_f32_16x16x32_bf16 v[16:19], v[160:163], v[128:131], v[16:19]
    ds_read_b64_tr_b16 v[202:203], v236 offset:17920
    ds_read_b64_tr_b16 v[204:205], v237 offset:16384
    v_mfma_f32_16x16x32_bf16 v[20:23], v[164:167], v[128:131], v[20:23]
    ds_read_b64_tr_b16 v[206:207], v237 offset:17920
    ds_read_b64_tr_b16 v[208:209], v238 offset:16384
    v_mfma_f32_16x16x32_bf16 v[32:35], v[144:147], v[132:135], v[32:35]
    ds_read_b64_tr_b16 v[210:211], v238 offset:17920
    ds_read_b64_tr_b16 v[212:213], v239 offset:16384
    v_mfma_f32_16x16x32_bf16 v[36:39], v[148:151], v[132:135], v[36:39]
    ds_read_b64_tr_b16 v[214:215], v239 offset:17920
    v_mfma_f32_16x16x32_bf16 v[40:43], v[152:155], v[132:135], v[40:43]
    ds_read_b128 v[184:187], v225 offset:4096
    ds_read_b128 v[188:191], v225 offset:5120
    v_mfma_f32_16x16x32_bf16 v[44:47], v[156:159], v[132:135], v[44:47]
    s_add_u32 s30, s41, s43
    s_sub_u32 s37, s30, 7
    v_mfma_f32_16x16x32_bf16 v[48:51], v[160:163], v[132:135], v[48:51]
    s_cmp_ge_u32 s30, 7
    s_cselect_b32 s30, s37, s30
    v_mfma_f32_16x16x32_bf16 v[52:55], v[164:167], v[132:135], v[52:55]
    s_add_u32 s41, s41, 1
    v_mfma_f32_16x16x32_bf16 v[64:67], v[144:147], v[136:139], v[64:67]
    s_mul_i32 s30, s30, s45
    s_lshl_b32 s30, s30, 1
    v_mfma_f32_16x16x32_bf16 v[68:71], v[148:151], v[136:139], v[68:71]
    s_add_u32 m0, s33, 0
    s_nop 0
    v_mfma_f32_16x16x32_bf16 v[72:75], v[152:155], v[136:139], v[72:75]
    buffer_load_dwordx4 v250, s[16:19], s30 offen offset:0 lds
    buffer_load_dwordx4 v251, s[16:19], s30 offen offset:1024 lds
    v_mfma_f32_16x16x32_bf16 v[76:79], v[156:159], v[136:139], v[76:79]
    s_add_u32 s30, s30, s45
    v_mfma_f32_16x16x32_bf16 v[80:83], v[160:163], v[136:139], v[80:83]
    s_add_u32 s35, s27, s32
    s_add_u32 m0, s35, 0x800
    v_mfma_f32_16x16x32_bf16 v[84:87], v[164:167], v[136:139], v[84:87]
    s_add_u32 s27, s27, 0x8000
    buffer_load_dwordx4 v246, s[12:15], s31 offen offset:0 lds
    v_mfma_f32_16x16x32_bf16 v[96:99], v[144:147], v[140:143], v[96:99]
    buffer_load_dwordx4 v247, s[12:15], s31 offen offset:1024 lds
    s_cmp_ge_u32 s27, 0x28000
    v_mfma_f32_16x16x32_bf16 v[100:103], v[148:151], v[140:143], v[100:103]
    s_cselect_b32 s27, 0x10000, s27
    v_mfma_f32_16x16x32_bf16 v[104:107], v[152:155], v[140:143], v[104:107]
    s_add_u32 s36, s28, 0x8000
    s_cmp_ge_u32 s36, 0x18000
    v_mfma_f32_16x16x32_bf16 v[108:111], v[156:159], v[140:143], v[108:111]
    s_cselect_b32 s36, 0, s36
    s_sub_u32 s29, s36, s28
    v_mfma_f32_16x16x32_bf16 v[112:115], v[160:163], v[140:143], v[112:115]
    s_mov_b32 s28, s36
    v_add_u32 v224, s29, v224
    v_mfma_f32_16x16x32_bf16 v[116:119], v[164:167], v[140:143], v[116:119]
    v_add_u32 v225, s29, v225
    s_waitcnt vmcnt(8) lgkmcnt(0)
    s_barrier
    v_mfma_f32_16x16x32_bf16 v[0:3], v[192:195], v[176:179], v[0:3]
    ds_read_b128 v[128:131], v224 offset:0
    ds_read_b64_tr_b16 v[144:145], v234 offset:32768
    v_mfma_f32_16x16x32_bf16 v[4:7], v[196:199], v[176:179], v[4:7]
    ds_read_b64_tr_b16 v[146:147], v234 offset:34304
    v_mfma_f32_16x16x32_bf16 v[8:11], v[200:203], v[176:179], v[8:11]
    ds_read_b64_tr_b16 v[148:149], v235 offset:32768
    v_mfma_f32_16x16x32_bf16 v[12:15], v[204:207], v[176:179], v[12:15]
    ds_read_b64_tr_b16 v[150:151], v235 offset:34304
    v_mfma_f32_16x16x32_bf16 v[16:19], v[208:211], v[176:179], v[16:19]
    ds_read_b128 v[132:135], v224 offset:1024
    ds_read_b64_tr_b16 v[152:153], v236 offset:32768
    v_mfma_f32_16x16x32_bf16 v[20:23], v[212:215], v[176:179], v[20:23]
    ds_read_b64_tr_b16 v[154:155], v236 offset:34304
    v_mfma_f32_16x16x32_bf16 v[32:35], v[192:195], v[180:183], v[32:35]
    ds_read_b64_tr_b16 v[156:157], v237 offset:32768
    v_mfma_f32_16x16x32_bf16 v[36:39], v[196:199], v[180:183], v[36:39]
    ds_read_b64_tr_b16 v[158:159], v237 offset:34304
    v_mfma_f32_16x16x32_bf16 v[40:43], v[200:203], v[180:183], v[40:43]
    ds_read_b64_tr_b16 v[160:161], v238 offset:32768
    v_mfma_f32_16x16x32_bf16 v[44:47], v[204:207], v[180:183], v[44:47]
    ds_read_b64_tr_b16 v[162:163], v238 offset:34304
    ds_read_b64_tr_b16 v[164:165], v239 offset:32768
    v_mfma_f32_16x16x32_bf16 v[48:51], v[208:211], v[180:183], v[48:51]
    ds_read_b64_tr_b16 v[166:167], v239 offset:34304
    v_mfma_f32_16x16x32_bf16 v[52:55], v[212:215], v[180:183], v[52:55]
    ds_read_b128 v[136:139], v224 offset:4096
    v_mfma_f32_16x16x32_bf16 v[64:67], v[192:195], v[184:187], v[64:67]
    ds_read_b128 v[140:143], v224 offset:5120
    v_mfma_f32_16x16x32_bf16 v[68:71], v[196:199], v[184:187], v[68:71]
    s_add_u32 m0, s33, 16384
    v_mfma_f32_16x16x32_bf16 v[72:75], v[200:203], v[184:187], v[72:75]
    s_nop 0
    buffer_load_dwordx4 v250, s[16:19], s30 offen offset:0 lds
    v_mfma_f32_16x16x32_bf16 v[76:79], v[204:207], v[184:187], v[76:79]
    buffer_load_dwordx4 v251, s[16:19], s30 offen offset:1024 lds
    v_mfma_f32_16x16x32_bf16 v[80:83], v[208:211], v[184:187], v[80:83]
    s_add_u32 s31, s40, s43
    v_mfma_f32_16x16x32_bf16 v[84:87], v[212:215], v[184:187], v[84:87]
    s_sub_u32 s37, s31, 7
    v_mfma_f32_16x16x32_bf16 v[96:99], v[192:195], v[188:191], v[96:99]
    s_cmp_ge_u32 s31, 7
    v_mfma_f32_16x16x32_bf16 v[100:103], v[196:199], v[188:191], v[100:103]
    s_cselect_b32 s31, s37, s31
    s_add_u32 s40, s40, 1
    v_mfma_f32_16x16x32_bf16 v[104:107], v[200:203], v[188:191], v[104:107]
    s_add_u32 m0, s27, s32
    v_mfma_f32_16x16x32_bf16 v[108:111], v[204:207], v[188:191], v[108:111]
    s_lshl_b32 s31, s31, 7
    v_mfma_f32_16x16x32_bf16 v[112:115], v[208:211], v[188:191], v[112:115]
    buffer_load_dwordx4 v244, s[12:15], s31 offen offset:0 lds
    v_mfma_f32_16x16x32_bf16 v[116:119], v[212:215], v[188:191], v[116:119]
    buffer_load_dwordx4 v245, s[12:15], s31 offen offset:1024 lds
    s_waitcnt vmcnt(10) lgkmcnt(0)
    s_barrier
    v_mfma_f32_16x16x32_bf16 v[0:3], v[144:147], v[128:131], v[0:3]
    ds_read_b128 v[176:179], v225 offset:0
    ds_read_b64_tr_b16 v[192:193], v234 offset:49152
    v_mfma_f32_16x16x32_bf16 v[4:7], v[148:151], v[128:131], v[4:7]
    ds_read_b64_tr_b16 v[194:195], v234 offset:50688
    ds_read_b64_tr_b16 v[196:197], v235 offset:49152
    v_mfma_f32_16x16x32_bf16 v[8:11], v[152:155], v[128:131], v[8:11]
    ds_read_b64_tr_b16 v[198:199], v235 offset:50688
    ds_read_b128 v[180:183], v225 offset:1024
    v_mfma_f32_16x16x32_bf16 v[12:15], v[156:159], v[128:131], v[12:15]
    ds_read_b64_tr_b16 v[200:201], v236 offset:49152
    v_mfma_f32_16x16x32_bf16 v[16:19], v[160:163], v[128:131], v[16:19]
    ds_read_b64_tr_b16 v[202:203], v236 offset:50688
    ds_read_b64_tr_b16 v[204:205], v237 offset:49152
    v_mfma_f32_16x16x32_bf16 v[20:23], v[164:167], v[128:131], v[20:23]
    ds_read_b64_tr_b16 v[206:207], v237 offset:50688
    ds_read_b64_tr_b16 v[208:209], v238 offset:49152
    v_mfma_f32_16x16x32_bf16 v[32:35], v[144:147], v[132:135], v[32:35]
    ds_read_b64_tr_b16 v[210:211], v238 offset:50688
    ds_read_b64_tr_b16 v[212:213], v239 offset:49152
    v_mfma_f32_16x16x32_bf16 v[36:39], v[148:151], v[132:135], v[36:39]
    ds_read_b64_tr_b16 v[214:215], v239 offset:50688
    v_mfma_f32_16x16x32_bf16 v[40:43], v[152:155], v[132:135], v[40:43]
    ds_read_b128 v[184:187], v225 offset:4096
    ds_read_b128 v[188:191], v225 offset:5120
    v_mfma_f32_16x16x32_bf16 v[44:47], v[156:159], v[132:135], v[44:47]
    s_add_u32 s30, s41, s43
    s_sub_u32 s37, s30, 7
    v_mfma_f32_16x16x32_bf16 v[48:51], v[160:163], v[132:135], v[48:51]
    s_cmp_ge_u32 s30, 7
    s_cselect_b32 s30, s37, s30
    v_mfma_f32_16x16x32_bf16 v[52:55], v[164:167], v[132:135], v[52:55]
    s_add_u32 s41, s41, 1
    v_mfma_f32_16x16x32_bf16 v[64:67], v[144:147], v[136:139], v[64:67]
    s_mul_i32 s30, s30, s45
    s_lshl_b32 s30, s30, 1
    v_mfma_f32_16x16x32_bf16 v[68:71], v[148:151], v[136:139], v[68:71]
    s_add_u32 m0, s33, 32768
    s_nop 0
    v_mfma_f32_16x16x32_bf16 v[72:75], v[152:155], v[136:139], v[72:75]
    buffer_load_dwordx4 v250, s[16:19], s30 offen offset:0 lds
    buffer_load_dwordx4 v251, s[16:19], s30 offen offset:1024 lds
    v_mfma_f32_16x16x32_bf16 v[76:79], v[156:159], v[136:139], v[76:79]
    s_add_u32 s30, s30, s45
    v_mfma_f32_16x16x32_bf16 v[80:83], v[160:163], v[136:139], v[80:83]
    s_add_u32 s35, s27, s32
    s_add_u32 m0, s35, 0x800
    v_mfma_f32_16x16x32_bf16 v[84:87], v[164:167], v[136:139], v[84:87]
    s_add_u32 s27, s27, 0x8000
    buffer_load_dwordx4 v246, s[12:15], s31 offen offset:0 lds
    v_mfma_f32_16x16x32_bf16 v[96:99], v[144:147], v[140:143], v[96:99]
    buffer_load_dwordx4 v247, s[12:15], s31 offen offset:1024 lds
    s_cmp_ge_u32 s27, 0x28000
    v_mfma_f32_16x16x32_bf16 v[100:103], v[148:151], v[140:143], v[100:103]
    s_cselect_b32 s27, 0x10000, s27
    v_mfma_f32_16x16x32_bf16 v[104:107], v[152:155], v[140:143], v[104:107]
    s_add_u32 s36, s28, 0x8000
    s_cmp_ge_u32 s36, 0x18000
    v_mfma_f32_16x16x32_bf16 v[108:111], v[156:159], v[140:143], v[108:111]
    s_cselect_b32 s36, 0, s36
    s_sub_u32 s29, s36, s28
    v_mfma_f32_16x16x32_bf16 v[112:115], v[160:163], v[140:143], v[112:115]
    s_mov_b32 s28, s36
    v_add_u32 v224, s29, v224
    v_mfma_f32_16x16x32_bf16 v[116:119], v[164:167], v[140:143], v[116:119]
    v_add_u32 v225, s29, v225
    s_waitcnt vmcnt(8) lgkmcnt(0)
    s_barrier
    v_mfma_f32_16x16x32_bf16 v[0:3], v[192:195], v[176:179], v[0:3]
    ds_read_b128 v[128:131], v224 offset:0
    ds_read_b64_tr_b16 v[144:145], v234 offset:0
    v_mfma_f32_16x16x32_bf16 v[4:7], v[196:199], v[176:179], v[4:7]
    ds_read_b64_tr_b16 v[146:147], v234 offset:1536
    v_mfma_f32_16x16x32_bf16 v[8:11], v[200:203], v[176:179], v[8:11]
    ds_read_b64_tr_b16 v[148:149], v235 offset:0
    v_mfma_f32_16x16x32_bf16 v[12:15], v[204:207], v[176:179], v[12:15]
    ds_read_b64_tr_b16 v[150:151], v235 offset:1536
    v_mfma_f32_16x16x32_bf16 v[16:19], v[208:211], v[176:179], v[16:19]
    ds_read_b128 v[132:135], v224 offset:1024
    ds_read_b64_tr_b16 v[152:153], v236 offset:0
    v_mfma_f32_16x16x32_bf16 v[20:23], v[212:215], v[176:179], v[20:23]
    ds_read_b64_tr_b16 v[154:155], v236 offset:1536
    v_mfma_f32_16x16x32_bf16 v[32:35], v[192:195], v[180:183], v[32:35]
    ds_read_b64_tr_b16 v[156:157], v237 offset:0
    v_mfma_f32_16x16x32_bf16 v[36:39], v[196:199], v[180:183], v[36:39]
    ds_read_b64_tr_b16 v[158:159], v237 offset:1536
    v_mfma_f32_16x16x32_bf16 v[40:43], v[200:203], v[180:183], v[40:43]
    ds_read_b64_tr_b16 v[160:161], v238 offset:0
    v_mfma_f32_16x16x32_bf16 v[44:47], v[204:207], v[180:183], v[44:47]
    ds_read_b64_tr_b16 v[162:163], v238 offset:1536
    ds_read_b64_tr_b16 v[164:165], v239 offset:0
    v_mfma_f32_16x16x32_bf16 v[48:51], v[208:211], v[180:183], v[48:51]
    ds_read_b64_tr_b16 v[166:167], v239 offset:1536
    v_mfma_f32_16x16x32_bf16 v[52:55], v[212:215], v[180:183], v[52:55]
    ds_read_b128 v[136:139], v224 offset:4096
    v_mfma_f32_16x16x32_bf16 v[64:67], v[192:195], v[184:187], v[64:67]
    ds_read_b128 v[140:143], v224 offset:5120
    v_mfma_f32_16x16x32_bf16 v[68:71], v[196:199], v[184:187], v[68:71]
    s_add_u32 m0, s33, 49152
    v_mfma_f32_16x16x32_bf16 v[72:75], v[200:203], v[184:187], v[72:75]
    s_nop 0
    buffer_load_dwordx4 v250, s[16:19], s30 offen offset:0 lds
    v_mfma_f32_16x16x32_bf16 v[76:79], v[204:207], v[184:187], v[76:79]
    buffer_load_dwordx4 v251, s[16:19], s30 offen offset:1024 lds
    v_mfma_f32_16x16x32_bf16 v[80:83], v[208:211], v[184:187], v[80:83]
    s_add_u32 s31, s40, s43
    v_mfma_f32_16x16x32_bf16 v[84:87], v[212:215], v[184:187], v[84:87]
    s_sub_u32 s37, s31, 7
    v_mfma_f32_16x16x32_bf16 v[96:99], v[192:195], v[188:191], v[96:99]
    s_cmp_ge_u32 s31, 7
    v_mfma_f32_16x16x32_bf16 v[100:103], v[196:199], v[188:191], v[100:103]
    s_cselect_b32 s31, s37, s31
    s_add_u32 s40, s40, 1
    v_mfma_f32_16x16x32_bf16 v[104:107], v[200:203], v[188:191], v[104:107]
    s_add_u32 m0, s27, s32
    v_mfma_f32_16x16x32_bf16 v[108:111], v[204:207], v[188:191], v[108:111]
    s_lshl_b32 s31, s31, 7
    v_mfma_f32_16x16x32_bf16 v[112:115], v[208:211], v[188:191], v[112:115]
    buffer_load_dwordx4 v244, s[12:15], s31 offen offset:0 lds
    v_mfma_f32_16x16x32_bf16 v[116:119], v[212:215], v[188:191], v[116:119]
    buffer_load_dwordx4 v245, s[12:15], s31 offen offset:1024 lds
    s_waitcnt vmcnt(10) lgkmcnt(0)
    s_barrier
    v_mfma_f32_16x16x32_bf16 v[0:3], v[144:147], v[128:131], v[0:3]
    ds_read_b128 v[176:179], v225 offset:0
    ds_read_b64_tr_b16 v[192:193], v234 offset:16384
    v_mfma_f32_16x16x32_bf16 v[4:7], v[148:151], v[128:131], v[4:7]
    ds_read_b64_tr_b16 v[194:195], v234 offset:17920
    ds_read_b64_tr_b16 v[196:197], v235 offset:16384
    v_mfma_f32_16x16x32_bf16 v[8:11], v[152:155], v[128:131], v[8:11]
    ds_read_b64_tr_b16 v[198:199], v235 offset:17920
    ds_read_b128 v[180:183], v225 offset:1024
    v_mfma_f32_16x16x32_bf16 v[12:15], v[156:159], v[128:131], v[12:15]
    ds_read_b64_tr_b16 v[200:201], v236 offset:16384
    v_mfma_f32_16x16x32_bf16 v[16:19], v[160:163], v[128:131], v[16:19]
    ds_read_b64_tr_b16 v[202:203], v236 offset:17920
    ds_read_b64_tr_b16 v[204:205], v237 offset:16384
    v_mfma_f32_16x16x32_bf16 v[20:23], v[164:167], v[128:131], v[20:23]
    ds_read_b64_tr_b16 v[206:207], v237 offset:17920
    ds_read_b64_tr_b16 v[208:209], v238 offset:16384
    v_mfma_f32_16x16x32_bf16 v[32:35], v[144:147], v[132:135], v[32:35]
    ds_read_b64_tr_b16 v[210:211], v238 offset:17920
    ds_read_b64_tr_b16 v[212:213], v239 offset:16384
    v_mfma_f32_16x16x32_bf16 v[36:39], v[148:151], v[132:135], v[36:39]
    ds_read_b64_tr_b16 v[214:215], v239 offset:17920
    v_mfma_f32_16x16x32_bf16 v[40:43], v[152:155], v[132:135], v[40:43]
    ds_read_b128 v[184:187], v225 offset:4096
    ds_read_b128 v[188:191], v225 offset:5120
    v_mfma_f32_16x16x32_bf16 v[44:47], v[156:159], v[132:135], v[44:47]
    s_add_u32 s30, s41, s43
    s_sub_u32 s37, s30, 7
    v_mfma_f32_16x16x32_bf16 v[48:51], v[160:163], v[132:135], v[48:51]
    s_cmp_ge_u32 s30, 7
    s_cselect_b32 s30, s37, s30
    v_mfma_f32_16x16x32_bf16 v[52:55], v[164:167], v[132:135], v[52:55]
    s_add_u32 s41, s41, 1
    v_mfma_f32_16x16x32_bf16 v[64:67], v[144:147], v[136:139], v[64:67]
    s_mul_i32 s30, s30, s45
    s_lshl_b32 s30, s30, 1
    v_mfma_f32_16x16x32_bf16 v[68:71], v[148:151], v[136:139], v[68:71]
    s_add_u32 m0, s33, 0
    s_nop 0
    v_mfma_f32_16x16x32_bf16 v[72:75], v[152:155], v[136:139], v[72:75]
    buffer_load_dwordx4 v250, s[16:19], s30 offen offset:0 lds
    buffer_load_dwordx4 v251, s[16:19], s30 offen offset:1024 lds
    v_mfma_f32_16x16x32_bf16 v[76:79], v[156:159], v[136:139], v[76:79]
    s_add_u32 s30, s30, s45
    v_mfma_f32_16x16x32_bf16 v[80:83], v[160:163], v[136:139], v[80:83]
    s_add_u32 s35, s27, s32
    s_add_u32 m0, s35, 0x800
    v_mfma_f32_16x16x32_bf16 v[84:87], v[164:167], v[136:139], v[84:87]
    s_add_u32 s27, s27, 0x8000
    buffer_load_dwordx4 v246, s[12:15], s31 offen offset:0 lds
    v_mfma_f32_16x16x32_bf16 v[96:99], v[144:147], v[140:143], v[96:99]
    buffer_load_dwordx4 v247, s[12:15], s31 offen offset:1024 lds
    s_cmp_ge_u32 s27, 0x28000
    v_mfma_f32_16x16x32_bf16 v[100:103], v[148:151], v[140:143], v[100:103]
    s_cselect_b32 s27, 0x10000, s27
    v_mfma_f32_16x16x32_bf16 v[104:107], v[152:155], v[140:143], v[104:107]
    s_add_u32 s36, s28, 0x8000
    s_cmp_ge_u32 s36, 0x18000
    v_mfma_f32_16x16x32_bf16 v[108:111], v[156:159], v[140:143], v[108:111]
    s_cselect_b32 s36, 0, s36
    s_sub_u32 s29, s36, s28
    v_mfma_f32_16x16x32_bf16 v[112:115], v[160:163], v[140:143], v[112:115]
    s_mov_b32 s28, s36
    v_add_u32 v224, s29, v224
    v_mfma_f32_16x16x32_bf16 v[116:119], v[164:167], v[140:143], v[116:119]
    v_add_u32 v225, s29, v225
    s_waitcnt vmcnt(8) lgkmcnt(0)
    s_barrier
    v_mfma_f32_16x16x32_bf16 v[0:3], v[192:195], v[176:179], v[0:3]
    ds_read_b128 v[128:131], v224 offset:0
    v_mfma_f32_16x16x32_bf16 v[4:7], v[196:199], v[176:179], v[4:7]
    ds_read_b64_tr_b16 v[144:145], v234 offset:32768
    v_mfma_f32_16x16x32_bf16 v[8:11], v[200:203], v[176:179], v[8:11]
    ds_read_b64_tr_b16 v[146:147], v234 offset:34304
    v_mfma_f32_16x16x32_bf16 v[12:15], v[204:207], v[176:179], v[12:15]
    ds_read_b64_tr_b16 v[148:149], v235 offset:32768
    v_mfma_f32_16x16x32_bf16 v[16:19], v[208:211], v[176:179], v[16:19]
    ds_read_b64_tr_b16 v[150:151], v235 offset:34304
    v_mfma_f32_16x16x32_bf16 v[20:23], v[212:215], v[176:179], v[20:23]
    v_mfma_f32_16x16x32_bf16 v[32:35], v[192:195], v[180:183], v[32:35]
    ds_read_b128 v[132:135], v224 offset:1024
    v_mfma_f32_16x16x32_bf16 v[36:39], v[196:199], v[180:183], v[36:39]
    ds_read_b64_tr_b16 v[152:153], v236 offset:32768
    v_mfma_f32_16x16x32_bf16 v[40:43], v[200:203], v[180:183], v[40:43]
    ds_read_b64_tr_b16 v[154:155], v236 offset:34304
    v_mfma_f32_16x16x32_bf16 v[44:47], v[204:207], v[180:183], v[44:47]
    ds_read_b64_tr_b16 v[156:157], v237 offset:32768
    v_mfma_f32_16x16x32_bf16 v[48:51], v[208:211], v[180:183], v[48:51]
    ds_read_b64_tr_b16 v[158:159], v237 offset:34304
    v_mfma_f32_16x16x32_bf16 v[52:55], v[212:215], v[180:183], v[52:55]
    v_mfma_f32_16x16x32_bf16 v[64:67], v[192:195], v[184:187], v[64:67]
    ds_read_b64_tr_b16 v[160:161], v238 offset:32768
    v_mfma_f32_16x16x32_bf16 v[68:71], v[196:199], v[184:187], v[68:71]
    ds_read_b64_tr_b16 v[162:163], v238 offset:34304
    v_mfma_f32_16x16x32_bf16 v[72:75], v[200:203], v[184:187], v[72:75]
    ds_read_b64_tr_b16 v[164:165], v239 offset:32768
    v_mfma_f32_16x16x32_bf16 v[76:79], v[204:207], v[184:187], v[76:79]
    ds_read_b64_tr_b16 v[166:167], v239 offset:34304
    v_mfma_f32_16x16x32_bf16 v[80:83], v[208:211], v[184:187], v[80:83]
    ds_read_b128 v[136:139], v224 offset:4096
    v_mfma_f32_16x16x32_bf16 v[84:87], v[212:215], v[184:187], v[84:87]
    v_mfma_f32_16x16x32_bf16 v[96:99], v[192:195], v[188:191], v[96:99]
    ds_read_b128 v[140:143], v224 offset:5120
    v_mfma_f32_16x16x32_bf16 v[100:103], v[196:199], v[188:191], v[100:103]
    s_add_u32 m0, s33, 16384
    v_mfma_f32_16x16x32_bf16 v[104:107], v[200:203], v[188:191], v[104:107]
    s_nop 0
    v_mfma_f32_16x16x32_bf16 v[108:111], v[204:207], v[188:191], v[108:111]
    buffer_load_dwordx4 v250, s[16:19], s30 offen offset:0 lds
    v_mfma_f32_16x16x32_bf16 v[112:115], v[208:211], v[188:191], v[112:115]
    buffer_load_dwordx4 v251, s[16:19], s30 offen offset:1024 lds
    v_mfma_f32_16x16x32_bf16 v[116:119], v[212:215], v[188:191], v[116:119]
    s_waitcnt vmcnt(8) lgkmcnt(0)
    s_barrier
    v_mfma_f32_16x16x32_bf16 v[0:3], v[144:147], v[128:131], v[0:3]
    ds_read_b128 v[176:179], v225 offset:0
    v_mfma_f32_16x16x32_bf16 v[4:7], v[148:151], v[128:131], v[4:7]
    ds_read_b64_tr_b16 v[192:193], v234 offset:49152
    v_mfma_f32_16x16x32_bf16 v[8:11], v[152:155], v[128:131], v[8:11]
    ds_read_b64_tr_b16 v[194:195], v234 offset:50688
    v_mfma_f32_16x16x32_bf16 v[12:15], v[156:159], v[128:131], v[12:15]
    ds_read_b64_tr_b16 v[196:197], v235 offset:49152
    v_mfma_f32_16x16x32_bf16 v[16:19], v[160:163], v[128:131], v[16:19]
    ds_read_b64_tr_b16 v[198:199], v235 offset:50688
    v_mfma_f32_16x16x32_bf16 v[20:23], v[164:167], v[128:131], v[20:23]
    ds_read_b128 v[180:183], v225 offset:1024
    v_mfma_f32_16x16x32_bf16 v[32:35], v[144:147], v[132:135], v[32:35]
    ds_read_b64_tr_b16 v[200:201], v236 offset:49152
    v_mfma_f32_16x16x32_bf16 v[36:39], v[148:151], v[132:135], v[36:39]
    ds_read_b64_tr_b16 v[202:203], v236 offset:50688
    v_mfma_f32_16x16x32_bf16 v[40:43], v[152:155], v[132:135], v[40:43]
    ds_read_b64_tr_b16 v[204:205], v237 offset:49152
    v_mfma_f32_16x16x32_bf16 v[44:47], v[156:159], v[132:135], v[44:47]
    ds_read_b64_tr_b16 v[206:207], v237 offset:50688
    v_mfma_f32_16x16x32_bf16 v[48:51], v[160:163], v[132:135], v[48:51]
    ds_read_b64_tr_b16 v[208:209], v238 offset:49152
    v_mfma_f32_16x16x32_bf16 v[52:55], v[164:167], v[132:135], v[52:55]
    ds_read_b64_tr_b16 v[210:211], v238 offset:50688
    v_mfma_f32_16x16x32_bf16 v[64:67], v[144:147], v[136:139], v[64:67]
    ds_read_b64_tr_b16 v[212:213], v239 offset:49152
    v_mfma_f32_16x16x32_bf16 v[68:71], v[148:151], v[136:139], v[68:71]
    ds_read_b64_tr_b16 v[214:215], v239 offset:50688
    v_mfma_f32_16x16x32_bf16 v[72:75], v[152:155], v[136:139], v[72:75]
    ds_read_b128 v[184:187], v225 offset:4096
    v_mfma_f32_16x16x32_bf16 v[76:79], v[156:159], v[136:139], v[76:79]
    ds_read_b128 v[188:191], v225 offset:5120
    v_mfma_f32_16x16x32_bf16 v[80:83], v[160:163], v[136:139], v[80:83]
    s_add_u32 s36, s28, 0x8000
    v_mfma_f32_16x16x32_bf16 v[84:87], v[164:167], v[136:139], v[84:87]
    s_cmp_ge_u32 s36, 0x18000
    v_mfma_f32_16x16x32_bf16 v[96:99], v[144:147], v[140:143], v[96:99]
    s_cselect_b32 s36, 0, s36
    v_mfma_f32_16x16x32_bf16 v[100:103], v[148:151], v[140:143], v[100:103]
    s_sub_u32 s29, s36, s28
    v_mfma_f32_16x16x32_bf16 v[104:107], v[152:155], v[140:143], v[104:107]
    s_mov_b32 s28, s36
    v_mfma_f32_16x16x32_bf16 v[108:111], v[156:159], v[140:143], v[108:111]
    v_add_u32 v224, s29, v224
    v_mfma_f32_16x16x32_bf16 v[112:115], v[160:163], v[140:143], v[112:115]
    v_add_u32 v225, s29, v225
    v_mfma_f32_16x16x32_bf16 v[116:119], v[164:167], v[140:143], v[116:119]
    s_waitcnt vmcnt(2) lgkmcnt(0)
    s_barrier
    v_mfma_f32_16x16x32_bf16 v[0:3], v[192:195], v[176:179], v[0:3]
    ds_read_b128 v[128:131], v224 offset:0
    v_mfma_f32_16x16x32_bf16 v[4:7], v[196:199], v[176:179], v[4:7]
    ds_read_b64_tr_b16 v[144:145], v234 offset:0
    v_mfma_f32_16x16x32_bf16 v[8:11], v[200:203], v[176:179], v[8:11]
    v_mfma_f32_16x16x32_bf16 v[12:15], v[204:207], v[176:179], v[12:15]
    ds_read_b64_tr_b16 v[146:147], v234 offset:1536
    v_mfma_f32_16x16x32_bf16 v[16:19], v[208:211], v[176:179], v[16:19]
    ds_read_b64_tr_b16 v[148:149], v235 offset:0
    v_mfma_f32_16x16x32_bf16 v[20:23], v[212:215], v[176:179], v[20:23]
    v_mfma_f32_16x16x32_bf16 v[32:35], v[192:195], v[180:183], v[32:35]
    ds_read_b64_tr_b16 v[150:151], v235 offset:1536
    v_mfma_f32_16x16x32_bf16 v[36:39], v[196:199], v[180:183], v[36:39]
    ds_read_b128 v[132:135], v224 offset:1024
    v_mfma_f32_16x16x32_bf16 v[40:43], v[200:203], v[180:183], v[40:43]
    v_mfma_f32_16x16x32_bf16 v[44:47], v[204:207], v[180:183], v[44:47]
    ds_read_b64_tr_b16 v[152:153], v236 offset:0
    v_mfma_f32_16x16x32_bf16 v[48:51], v[208:211], v[180:183], v[48:51]
    ds_read_b64_tr_b16 v[154:155], v236 offset:1536
    v_mfma_f32_16x16x32_bf16 v[52:55], v[212:215], v[180:183], v[52:55]
    v_mfma_f32_16x16x32_bf16 v[64:67], v[192:195], v[184:187], v[64:67]
    ds_read_b64_tr_b16 v[156:157], v237 offset:0
    v_mfma_f32_16x16x32_bf16 v[68:71], v[196:199], v[184:187], v[68:71]
    ds_read_b64_tr_b16 v[158:159], v237 offset:1536
    v_mfma_f32_16x16x32_bf16 v[72:75], v[200:203], v[184:187], v[72:75]
    v_mfma_f32_16x16x32_bf16 v[76:79], v[204:207], v[184:187], v[76:79]
    ds_read_b64_tr_b16 v[160:161], v238 offset:0
    v_mfma_f32_16x16x32_bf16 v[80:83], v[208:211], v[184:187], v[80:83]
    ds_read_b64_tr_b16 v[162:163], v238 offset:1536
    v_mfma_f32_16x16x32_bf16 v[84:87], v[212:215], v[184:187], v[84:87]
    v_mfma_f32_16x16x32_bf16 v[96:99], v[192:195], v[188:191], v[96:99]
    ds_read_b64_tr_b16 v[164:165], v239 offset:0
    v_mfma_f32_16x16x32_bf16 v[100:103], v[196:199], v[188:191], v[100:103]
    ds_read_b64_tr_b16 v[166:167], v239 offset:1536
    v_mfma_f32_16x16x32_bf16 v[104:107], v[200:203], v[188:191], v[104:107]
    v_mfma_f32_16x16x32_bf16 v[108:111], v[204:207], v[188:191], v[108:111]
    ds_read_b128 v[136:139], v224 offset:4096
    v_mfma_f32_16x16x32_bf16 v[112:115], v[208:211], v[188:191], v[112:115]
    ds_read_b128 v[140:143], v224 offset:5120
    v_mfma_f32_16x16x32_bf16 v[116:119], v[212:215], v[188:191], v[116:119]
    s_waitcnt vmcnt(0) lgkmcnt(0)
    s_barrier
    v_mfma_f32_16x16x32_bf16 v[0:3], v[144:147], v[128:131], v[0:3]
    ds_read_b128 v[176:179], v225 offset:0
    v_mfma_f32_16x16x32_bf16 v[4:7], v[148:151], v[128:131], v[4:7]
    ds_read_b64_tr_b16 v[192:193], v234 offset:16384
    v_mfma_f32_16x16x32_bf16 v[8:11], v[152:155], v[128:131], v[8:11]
    ds_read_b64_tr_b16 v[194:195], v234 offset:17920
    v_mfma_f32_16x16x32_bf16 v[12:15], v[156:159], v[128:131], v[12:15]
    ds_read_b64_tr_b16 v[196:197], v235 offset:16384
    v_mfma_f32_16x16x32_bf16 v[16:19], v[160:163], v[128:131], v[16:19]
    ds_read_b64_tr_b16 v[198:199], v235 offset:17920
    v_mfma_f32_16x16x32_bf16 v[20:23], v[164:167], v[128:131], v[20:23]
    ds_read_b128 v[180:183], v225 offset:1024
    v_mfma_f32_16x16x32_bf16 v[32:35], v[144:147], v[132:135], v[32:35]
    ds_read_b64_tr_b16 v[200:201], v236 offset:16384
    v_mfma_f32_16x16x32_bf16 v[36:39], v[148:151], v[132:135], v[36:39]
    ds_read_b64_tr_b16 v[202:203], v236 offset:17920
    v_mfma_f32_16x16x32_bf16 v[40:43], v[152:155], v[132:135], v[40:43]
    ds_read_b64_tr_b16 v[204:205], v237 offset:16384
    v_mfma_f32_16x16x32_bf16 v[44:47], v[156:159], v[132:135], v[44:47]
    ds_read_b64_tr_b16 v[206:207], v237 offset:17920
    v_mfma_f32_16x16x32_bf16 v[48:51], v[160:163], v[132:135], v[48:51]
    ds_read_b64_tr_b16 v[208:209], v238 offset:16384
    v_mfma_f32_16x16x32_bf16 v[52:55], v[164:167], v[132:135], v[52:55]
    ds_read_b64_tr_b16 v[210:211], v238 offset:17920
    v_mfma_f32_16x16x32_bf16 v[64:67], v[144:147], v[136:139], v[64:67]
    ds_read_b64_tr_b16 v[212:213], v239 offset:16384
    v_mfma_f32_16x16x32_bf16 v[68:71], v[148:151], v[136:139], v[68:71]
    ds_read_b64_tr_b16 v[214:215], v239 offset:17920
    v_mfma_f32_16x16x32_bf16 v[72:75], v[152:155], v[136:139], v[72:75]
    ds_read_b128 v[184:187], v225 offset:4096
    v_mfma_f32_16x16x32_bf16 v[76:79], v[156:159], v[136:139], v[76:79]
    ds_read_b128 v[188:191], v225 offset:5120
    v_mfma_f32_16x16x32_bf16 v[80:83], v[160:163], v[136:139], v[80:83]
    s_add_u32 s36, s28, 0x8000
    v_mfma_f32_16x16x32_bf16 v[84:87], v[164:167], v[136:139], v[84:87]
    s_cmp_ge_u32 s36, 0x18000
    v_mfma_f32_16x16x32_bf16 v[96:99], v[144:147], v[140:143], v[96:99]
    s_cselect_b32 s36, 0, s36
    v_mfma_f32_16x16x32_bf16 v[100:103], v[148:151], v[140:143], v[100:103]
    s_sub_u32 s29, s36, s28
    v_mfma_f32_16x16x32_bf16 v[104:107], v[152:155], v[140:143], v[104:107]
    s_mov_b32 s28, s36
    v_mfma_f32_16x16x32_bf16 v[108:111], v[156:159], v[140:143], v[108:111]
    v_add_u32 v224, s29, v224
    v_mfma_f32_16x16x32_bf16 v[112:115], v[160:163], v[140:143], v[112:115]
    v_add_u32 v225, s29, v225
    v_mfma_f32_16x16x32_bf16 v[116:119], v[164:167], v[140:143], v[116:119]
    s_waitcnt lgkmcnt(0)
    v_mfma_f32_16x16x32_bf16 v[0:3], v[192:195], v[176:179], v[0:3]
    v_mfma_f32_16x16x32_bf16 v[4:7], v[196:199], v[176:179], v[4:7]
    v_mfma_f32_16x16x32_bf16 v[8:11], v[200:203], v[176:179], v[8:11]
    v_mfma_f32_16x16x32_bf16 v[12:15], v[204:207], v[176:179], v[12:15]
    v_mfma_f32_16x16x32_bf16 v[16:19], v[208:211], v[176:179], v[16:19]
    v_mfma_f32_16x16x32_bf16 v[20:23], v[212:215], v[176:179], v[20:23]
    v_mfma_f32_16x16x32_bf16 v[32:35], v[192:195], v[180:183], v[32:35]
    v_mfma_f32_16x16x32_bf16 v[36:39], v[196:199], v[180:183], v[36:39]
    v_mfma_f32_16x16x32_bf16 v[40:43], v[200:203], v[180:183], v[40:43]
    v_mfma_f32_16x16x32_bf16 v[44:47], v[204:207], v[180:183], v[44:47]
    v_mfma_f32_16x16x32_bf16 v[48:51], v[208:211], v[180:183], v[48:51]
    v_mfma_f32_16x16x32_bf16 v[52:55], v[212:215], v[180:183], v[52:55]
    v_mfma_f32_16x16x32_bf16 v[64:67], v[192:195], v[184:187], v[64:67]
    v_mfma_f32_16x16x32_bf16 v[68:71], v[196:199], v[184:187], v[68:71]
    v_mfma_f32_16x16x32_bf16 v[72:75], v[200:203], v[184:187], v[72:75]
    v_mfma_f32_16x16x32_bf16 v[76:79], v[204:207], v[184:187], v[76:79]
    v_mfma_f32_16x16x32_bf16 v[80:83], v[208:211], v[184:187], v[80:83]
    v_mfma_f32_16x16x32_bf16 v[84:87], v[212:215], v[184:187], v[84:87]
    v_mfma_f32_16x16x32_bf16 v[96:99], v[192:195], v[188:191], v[96:99]
    v_mfma_f32_16x16x32_bf16 v[100:103], v[196:199], v[188:191], v[100:103]
    v_mfma_f32_16x16x32_bf16 v[104:107], v[200:203], v[188:191], v[104:107]
    v_mfma_f32_16x16x32_bf16 v[108:111], v[204:207], v[188:191], v[108:111]
    v_mfma_f32_16x16x32_bf16 v[112:115], v[208:211], v[188:191], v[112:115]
    v_mfma_f32_16x16x32_bf16 v[116:119], v[212:215], v[188:191], v[116:119]
    s_nop 7
    s_lshl_b32 s38, s51, 3
    s_lshl_b32 s36, s25, 1
    s_add_u32 s38, s38, s36
    s_mul_i32 s35, s26, 3
    s_add_u32 s35, s35, s68
    s_add_u32 s35, s35, 0
    s_cmp_lg_u32 s71, 0
    s_cbranch_scc1 K1_E_13
    s_lshr_b32 s36, s35, 3
    s_lshl_b32 s36, s36, 20
    s_and_b32 s37, s35, 7
    s_lshl_b32 s37, s37, 11
    s_add_u32 s39, s36, s37
    s_lshl_b32 s36, s38, 14
    s_add_u32 s39, s39, s36
    s_add_u32 s39, s39, 0x2000000
    s_cmp_ge_u32 s35, 128
    s_cselect_b32 s39, 0x7ff00000, s39
    s_cmp_lg_u32 s94, 0
    s_cselect_b32 s39, 0x7ff00000, s39
    v_cvt_pk_bf16_f32 v128, v0, v1
    v_cvt_pk_bf16_f32 v129, v2, v3
    v_cvt_pk_bf16_f32 v130, v4, v5
    v_cvt_pk_bf16_f32 v131, v6, v7
    buffer_store_dwordx4 v[128:131], v252, s[20:23], s39 offen offset:0 sc1
    v_cvt_pk_bf16_f32 v132, v32, v33
    v_cvt_pk_bf16_f32 v133, v34, v35
    v_cvt_pk_bf16_f32 v134, v36, v37
    v_cvt_pk_bf16_f32 v135, v38, v39
    buffer_store_dwordx4 v[132:135], v252, s[20:23], s39 offen offset:128 sc1
    s_add_u32 s39, s39, 16384
    v_cvt_pk_bf16_f32 v136, v64, v65
    v_cvt_pk_bf16_f32 v137, v66, v67
    v_cvt_pk_bf16_f32 v138, v68, v69
    v_cvt_pk_bf16_f32 v139, v70, v71
    buffer_store_dwordx4 v[136:139], v252, s[20:23], s39 offen offset:0 sc1
    v_cvt_pk_bf16_f32 v140, v96, v97
    v_cvt_pk_bf16_f32 v141, v98, v99
    v_cvt_pk_bf16_f32 v142, v100, v101
    v_cvt_pk_bf16_f32 v143, v102, v103
    buffer_store_dwordx4 v[140:143], v252, s[20:23], s39 offen offset:128 sc1
    s_add_u32 s39, s39, 16384
    s_branch K1_E_16
K1_E_13:
    s_and_b32 s36, s35, 15
    s_lshl_b32 s36, s36, 6
    s_add_u32 s36, s36, s38
    s_lshr_b32 s37, s35, 4
    s_cmp_eq_u32 s37, 1
    s_cbranch_scc1 K1_E_14
    s_cmp_eq_u32 s37, 2
    s_cbranch_scc1 K1_E_15
    s_lshl_b32 s39, s36, 11
    s_add_u32 s39, s39, 0x3000000
    v_mul_f32 v0, s95, v0
    v_mul_f32 v4, s95, v4
    v_mul_f32 v1, s95, v1
    v_mul_f32 v5, s95, v5
    v_mul_f32 v2, s95, v2
    v_mul_f32 v6, s95, v6
    v_mul_f32 v3, s95, v3
    v_mul_f32 v7, s95, v7
    s_mov_b32 exec_lo, 0
    s_mov_b32 exec_hi, 0xffff0000
    v_mov_b32 v4, 0
    v_mov_b32 v5, 0
    v_mov_b32 v6, 0
    v_mov_b32 v7, 0
    s_mov_b64 exec, -1
    v_cvt_pk_bf16_f32 v128, v0, v1
    v_cvt_pk_bf16_f32 v129, v2, v3
    v_cvt_pk_bf16_f32 v130, v4, v5
    v_cvt_pk_bf16_f32 v131, v6, v7
    buffer_store_dwordx4 v[128:131], v252, s[20:23], s39 offen offset:0 sc1
    v_mul_f32 v32, s95, v32
    v_mul_f32 v36, s95, v36
    v_mul_f32 v33, s95, v33
    v_mul_f32 v37, s95, v37
    v_mul_f32 v34, s95, v34
    v_mul_f32 v38, s95, v38
    v_mul_f32 v35, s95, v35
    v_mul_f32 v39, s95, v39
    s_mov_b32 exec_lo, 0
    s_mov_b32 exec_hi, 0xffff0000
    v_mov_b32 v36, 0
    v_mov_b32 v37, 0
    v_mov_b32 v38, 0
    v_mov_b32 v39, 0
    s_mov_b64 exec, -1
    v_cvt_pk_bf16_f32 v132, v32, v33
    v_cvt_pk_bf16_f32 v133, v34, v35
    v_cvt_pk_bf16_f32 v134, v36, v37
    v_cvt_pk_bf16_f32 v135, v38, v39
    buffer_store_dwordx4 v[132:135], v252, s[20:23], s39 offen offset:128 sc1
    v_mul_f32 v64, s95, v64
    v_mul_f32 v68, s95, v68
    v_mul_f32 v65, s95, v65
    v_mul_f32 v69, s95, v69
    v_mul_f32 v66, s95, v66
    v_mul_f32 v70, s95, v70
    v_mul_f32 v67, s95, v67
    v_mul_f32 v71, s95, v71
    s_mov_b32 exec_lo, 0
    s_mov_b32 exec_hi, 0xffff0000
    v_mov_b32 v68, 0
    v_mov_b32 v69, 0
    v_mov_b32 v70, 0
    v_mov_b32 v71, 0
    s_mov_b64 exec, -1
    v_cvt_pk_bf16_f32 v136, v64, v65
    v_cvt_pk_bf16_f32 v137, v66, v67
    v_cvt_pk_bf16_f32 v138, v68, v69
    v_cvt_pk_bf16_f32 v139, v70, v71
    buffer_store_dwordx4 v[136:139], v252, s[20:23], s39 offen offset:2048 sc1
    v_mul_f32 v96, s95, v96
    v_mul_f32 v100, s95, v100
    v_mul_f32 v97, s95, v97
    v_mul_f32 v101, s95, v101
    v_mul_f32 v98, s95, v98
    v_mul_f32 v102, s95, v102
    v_mul_f32 v99, s95, v99
    v_mul_f32 v103, s95, v103
    s_mov_b32 exec_lo, 0
    s_mov_b32 exec_hi, 0xffff0000
    v_mov_b32 v100, 0
    v_mov_b32 v101, 0
    v_mov_b32 v102, 0
    v_mov_b32 v103, 0
    s_mov_b64 exec, -1
    v_cvt_pk_bf16_f32 v140, v96, v97
    v_cvt_pk_bf16_f32 v141, v98, v99
    v_cvt_pk_bf16_f32 v142, v100, v101
    v_cvt_pk_bf16_f32 v143, v102, v103
    buffer_store_dwordx4 v[140:143], v252, s[20:23], s39 offen offset:2176 sc1
    s_branch K1_E_16
K1_E_14:
    s_lshl_b32 s39, s36, 12
    s_add_u32 s39, s39, 0x3200000
    s_mov_b32 exec_lo, 0
    s_mov_b32 exec_hi, 0xffff0000
    v_mov_b32 v4, 0
    v_mov_b32 v5, 0
    v_mov_b32 v6, 0
    v_mov_b32 v7, 0
    s_mov_b64 exec, -1
    v_cvt_pk_bf16_f32 v128, v0, v1
    v_cvt_pk_bf16_f32 v129, v2, v3
    v_cvt_pk_bf16_f32 v130, v4, v5
    v_cvt_pk_bf16_f32 v131, v6, v7
    buffer_store_dwordx4 v[128:131], v252, s[20:23], s39 offen offset:0 sc1
    s_mov_b32 exec_lo, 0
    s_mov_b32 exec_hi, 0xffff0000
    v_mov_b32 v36, 0
    v_mov_b32 v37, 0
    v_mov_b32 v38, 0
    v_mov_b32 v39, 0
    s_mov_b64 exec, -1
    v_cvt_pk_bf16_f32 v132, v32, v33
    v_cvt_pk_bf16_f32 v133, v34, v35
    v_cvt_pk_bf16_f32 v134, v36, v37
    v_cvt_pk_bf16_f32 v135, v38, v39
    buffer_store_dwordx4 v[132:135], v252, s[20:23], s39 offen offset:128 sc1
    s_add_u32 s39, s39, 4096
    s_mov_b32 exec_lo, 0
    s_mov_b32 exec_hi, 0xffff0000
    v_mov_b32 v68, 0
    v_mov_b32 v69, 0
    v_mov_b32 v70, 0
    v_mov_b32 v71, 0
    s_mov_b64 exec, -1
    v_cvt_pk_bf16_f32 v136, v64, v65
    v_cvt_pk_bf16_f32 v137, v66, v67
    v_cvt_pk_bf16_f32 v138, v68, v69
    v_cvt_pk_bf16_f32 v139, v70, v71
    buffer_store_dwordx4 v[136:139], v252, s[20:23], s39 offen offset:0 sc1
    s_mov_b32 exec_lo, 0
    s_mov_b32 exec_hi, 0xffff0000
    v_mov_b32 v100, 0
    v_mov_b32 v101, 0
    v_mov_b32 v102, 0
    v_mov_b32 v103, 0
    s_mov_b64 exec, -1
    v_cvt_pk_bf16_f32 v140, v96, v97
    v_cvt_pk_bf16_f32 v141, v98, v99
    v_cvt_pk_bf16_f32 v142, v100, v101
    v_cvt_pk_bf16_f32 v143, v102, v103
    buffer_store_dwordx4 v[140:143], v252, s[20:23], s39 offen offset:128 sc1
    s_add_u32 s39, s39, 4096
    s_branch K1_E_16
K1_E_15:
    s_lshl_b32 s39, s36, 12
    s_add_u32 s39, s39, 0x3200800
    v_bfe_u32 v254, v253, 3, 1
    v_and_b32 v255, 7, v253
    v_lshl_add_u32 v254, v254, 4, v255
    v_lshrrev_b32 v255, 4, v253
    v_lshlrev_b32 v255, 4, v255
    v_lshl_add_u32 v254, v254, 6, v255
    s_mov_b32 exec_lo, 0
    s_mov_b32 exec_hi, 0xffff0000
    v_mov_b32 v4, 1.0
    v_mov_b32 v5, 0
    v_mov_b32 v6, 0
    v_mov_b32 v7, 0
    s_mov_b64 exec, -1
    v_cvt_pk_bf16_f32 v128, v0, v1
    v_cvt_pk_bf16_f32 v129, v2, v3
    v_cvt_pk_bf16_f32 v130, v4, v5
    v_cvt_pk_bf16_f32 v131, v6, v7
    buffer_store_dwordx4 v[128:131], v254, s[20:23], s39 offen offset:0 sc1
    s_mov_b32 exec_lo, 0
    s_mov_b32 exec_hi, 0xffff0000
    v_mov_b32 v36, 1.0
    v_mov_b32 v37, 0
    v_mov_b32 v38, 0
    v_mov_b32 v39, 0
    s_mov_b64 exec, -1
    v_cvt_pk_bf16_f32 v132, v32, v33
    v_cvt_pk_bf16_f32 v133, v34, v35
    v_cvt_pk_bf16_f32 v134, v36, v37
    v_cvt_pk_bf16_f32 v135, v38, v39
    buffer_store_dwordx4 v[132:135], v254, s[20:23], s39 offen offset:512 sc1
    s_add_u32 s39, s39, 4096
    s_mov_b32 exec_lo, 0
    s_mov_b32 exec_hi, 0xffff0000
    v_mov_b32 v68, 1.0
    v_mov_b32 v69, 0
    v_mov_b32 v70, 0
    v_mov_b32 v71, 0
    s_mov_b64 exec, -1
    v_cvt_pk_bf16_f32 v136, v64, v65
    v_cvt_pk_bf16_f32 v137, v66, v67
    v_cvt_pk_bf16_f32 v138, v68, v69
    v_cvt_pk_bf16_f32 v139, v70, v71
    buffer_store_dwordx4 v[136:139], v254, s[20:23], s39 offen offset:0 sc1
    s_mov_b32 exec_lo, 0
    s_mov_b32 exec_hi, 0xffff0000
    v_mov_b32 v100, 1.0
    v_mov_b32 v101, 0
    v_mov_b32 v102, 0
    v_mov_b32 v103, 0
    s_mov_b64 exec, -1
    v_cvt_pk_bf16_f32 v140, v96, v97
    v_cvt_pk_bf16_f32 v141, v98, v99
    v_cvt_pk_bf16_f32 v142, v100, v101
    v_cvt_pk_bf16_f32 v143, v102, v103
    buffer_store_dwordx4 v[140:143], v254, s[20:23], s39 offen offset:512 sc1
    s_add_u32 s39, s39, 4096
K1_E_16:
    s_mul_i32 s35, s26, 3
    s_add_u32 s35, s35, s68
    s_add_u32 s35, s35, 1
    s_cmp_lg_u32 s71, 0
    s_cbranch_scc1 K1_E_17
    s_lshr_b32 s36, s35, 3
    s_lshl_b32 s36, s36, 20
    s_and_b32 s37, s35, 7
    s_lshl_b32 s37, s37, 11
    s_add_u32 s39, s36, s37
    s_lshl_b32 s36, s38, 14
    s_add_u32 s39, s39, s36
    s_add_u32 s39, s39, 0x2000000
    s_cmp_ge_u32 s35, 128
    s_cselect_b32 s39, 0x7ff00000, s39
    s_cmp_lg_u32 s94, 0
    s_cselect_b32 s39, 0x7ff00000, s39
    v_cvt_pk_bf16_f32 v144, v8, v9
    v_cvt_pk_bf16_f32 v145, v10, v11
    v_cvt_pk_bf16_f32 v146, v12, v13
    v_cvt_pk_bf16_f32 v147, v14, v15
    buffer_store_dwordx4 v[144:147], v252, s[20:23], s39 offen offset:0 sc1
    v_cvt_pk_bf16_f32 v148, v40, v41
    v_cvt_pk_bf16_f32 v149, v42, v43
    v_cvt_pk_bf16_f32 v150, v44, v45
    v_cvt_pk_bf16_f32 v151, v46, v47
    buffer_store_dwordx4 v[148:151], v252, s[20:23], s39 offen offset:128 sc1
    s_add_u32 s39, s39, 16384
    v_cvt_pk_bf16_f32 v152, v72, v73
    v_cvt_pk_bf16_f32 v153, v74, v75
    v_cvt_pk_bf16_f32 v154, v76, v77
    v_cvt_pk_bf16_f32 v155, v78, v79
    buffer_store_dwordx4 v[152:155], v252, s[20:23], s39 offen offset:0 sc1
    v_cvt_pk_bf16_f32 v156, v104, v105
    v_cvt_pk_bf16_f32 v157, v106, v107
    v_cvt_pk_bf16_f32 v158, v108, v109
    v_cvt_pk_bf16_f32 v159, v110, v111
    buffer_store_dwordx4 v[156:159], v252, s[20:23], s39 offen offset:128 sc1
    s_add_u32 s39, s39, 16384
    s_branch K1_E_20
K1_E_17:
    s_and_b32 s36, s35, 15
    s_lshl_b32 s36, s36, 6
    s_add_u32 s36, s36, s38
    s_lshr_b32 s37, s35, 4
    s_cmp_eq_u32 s37, 1
    s_cbranch_scc1 K1_E_18
    s_cmp_eq_u32 s37, 2
    s_cbranch_scc1 K1_E_19
    s_lshl_b32 s39, s36, 11
    s_add_u32 s39, s39, 0x3000000
    v_mul_f32 v8, s95, v8
    v_mul_f32 v12, s95, v12
    v_mul_f32 v9, s95, v9
    v_mul_f32 v13, s95, v13
    v_mul_f32 v10, s95, v10
    v_mul_f32 v14, s95, v14
    v_mul_f32 v11, s95, v11
    v_mul_f32 v15, s95, v15
    s_mov_b32 exec_lo, 0
    s_mov_b32 exec_hi, 0xffff0000
    v_mov_b32 v12, 0
    v_mov_b32 v13, 0
    v_mov_b32 v14, 0
    v_mov_b32 v15, 0
    s_mov_b64 exec, -1
    v_cvt_pk_bf16_f32 v144, v8, v9
    v_cvt_pk_bf16_f32 v145, v10, v11
    v_cvt_pk_bf16_f32 v146, v12, v13
    v_cvt_pk_bf16_f32 v147, v14, v15
    buffer_store_dwordx4 v[144:147], v252, s[20:23], s39 offen offset:0 sc1
    v_mul_f32 v40, s95, v40
    v_mul_f32 v44, s95, v44
    v_mul_f32 v41, s95, v41
    v_mul_f32 v45, s95, v45
    v_mul_f32 v42, s95, v42
    v_mul_f32 v46, s95, v46
    v_mul_f32 v43, s95, v43
    v_mul_f32 v47, s95, v47
    s_mov_b32 exec_lo, 0
    s_mov_b32 exec_hi, 0xffff0000
    v_mov_b32 v44, 0
    v_mov_b32 v45, 0
    v_mov_b32 v46, 0
    v_mov_b32 v47, 0
    s_mov_b64 exec, -1
    v_cvt_pk_bf16_f32 v148, v40, v41
    v_cvt_pk_bf16_f32 v149, v42, v43
    v_cvt_pk_bf16_f32 v150, v44, v45
    v_cvt_pk_bf16_f32 v151, v46, v47
    buffer_store_dwordx4 v[148:151], v252, s[20:23], s39 offen offset:128 sc1
    v_mul_f32 v72, s95, v72
    v_mul_f32 v76, s95, v76
    v_mul_f32 v73, s95, v73
    v_mul_f32 v77, s95, v77
    v_mul_f32 v74, s95, v74
    v_mul_f32 v78, s95, v78
    v_mul_f32 v75, s95, v75
    v_mul_f32 v79, s95, v79
    s_mov_b32 exec_lo, 0
    s_mov_b32 exec_hi, 0xffff0000
    v_mov_b32 v76, 0
    v_mov_b32 v77, 0
    v_mov_b32 v78, 0
    v_mov_b32 v79, 0
    s_mov_b64 exec, -1
    v_cvt_pk_bf16_f32 v152, v72, v73
    v_cvt_pk_bf16_f32 v153, v74, v75
    v_cvt_pk_bf16_f32 v154, v76, v77
    v_cvt_pk_bf16_f32 v155, v78, v79
    buffer_store_dwordx4 v[152:155], v252, s[20:23], s39 offen offset:2048 sc1
    v_mul_f32 v104, s95, v104
    v_mul_f32 v108, s95, v108
    v_mul_f32 v105, s95, v105
    v_mul_f32 v109, s95, v109
    v_mul_f32 v106, s95, v106
    v_mul_f32 v110, s95, v110
    v_mul_f32 v107, s95, v107
    v_mul_f32 v111, s95, v111
    s_mov_b32 exec_lo, 0
    s_mov_b32 exec_hi, 0xffff0000
    v_mov_b32 v108, 0
    v_mov_b32 v109, 0
    v_mov_b32 v110, 0
    v_mov_b32 v111, 0
    s_mov_b64 exec, -1
    v_cvt_pk_bf16_f32 v156, v104, v105
    v_cvt_pk_bf16_f32 v157, v106, v107
    v_cvt_pk_bf16_f32 v158, v108, v109
    v_cvt_pk_bf16_f32 v159, v110, v111
    buffer_store_dwordx4 v[156:159], v252, s[20:23], s39 offen offset:2176 sc1
    s_branch K1_E_20
K1_E_18:
    s_lshl_b32 s39, s36, 12
    s_add_u32 s39, s39, 0x3200000
    s_mov_b32 exec_lo, 0
    s_mov_b32 exec_hi, 0xffff0000
    v_mov_b32 v12, 0
    v_mov_b32 v13, 0
    v_mov_b32 v14, 0
    v_mov_b32 v15, 0
    s_mov_b64 exec, -1
    v_cvt_pk_bf16_f32 v144, v8, v9
    v_cvt_pk_bf16_f32 v145, v10, v11
    v_cvt_pk_bf16_f32 v146, v12, v13
    v_cvt_pk_bf16_f32 v147, v14, v15
    buffer_store_dwordx4 v[144:147], v252, s[20:23], s39 offen offset:0 sc1
    s_mov_b32 exec_lo, 0
    s_mov_b32 exec_hi, 0xffff0000
    v_mov_b32 v44, 0
    v_mov_b32 v45, 0
    v_mov_b32 v46, 0
    v_mov_b32 v47, 0
    s_mov_b64 exec, -1
    v_cvt_pk_bf16_f32 v148, v40, v41
    v_cvt_pk_bf16_f32 v149, v42, v43
    v_cvt_pk_bf16_f32 v150, v44, v45
    v_cvt_pk_bf16_f32 v151, v46, v47
    buffer_store_dwordx4 v[148:151], v252, s[20:23], s39 offen offset:128 sc1
    s_add_u32 s39, s39, 4096
    s_mov_b32 exec_lo, 0
    s_mov_b32 exec_hi, 0xffff0000
    v_mov_b32 v76, 0
    v_mov_b32 v77, 0
    v_mov_b32 v78, 0
    v_mov_b32 v79, 0
    s_mov_b64 exec, -1
    v_cvt_pk_bf16_f32 v152, v72, v73
    v_cvt_pk_bf16_f32 v153, v74, v75
    v_cvt_pk_bf16_f32 v154, v76, v77
    v_cvt_pk_bf16_f32 v155, v78, v79
    buffer_store_dwordx4 v[152:155], v252, s[20:23], s39 offen offset:0 sc1
    s_mov_b32 exec_lo, 0
    s_mov_b32 exec_hi, 0xffff0000
    v_mov_b32 v108, 0
    v_mov_b32 v109, 0
    v_mov_b32 v110, 0
    v_mov_b32 v111, 0
    s_mov_b64 exec, -1
    v_cvt_pk_bf16_f32 v156, v104, v105
    v_cvt_pk_bf16_f32 v157, v106, v107
    v_cvt_pk_bf16_f32 v158, v108, v109
    v_cvt_pk_bf16_f32 v159, v110, v111
    buffer_store_dwordx4 v[156:159], v252, s[20:23], s39 offen offset:128 sc1
    s_add_u32 s39, s39, 4096
    s_branch K1_E_20
K1_E_19:
    s_lshl_b32 s39, s36, 12
    s_add_u32 s39, s39, 0x3200800
    v_bfe_u32 v254, v253, 3, 1
    v_and_b32 v255, 7, v253
    v_lshl_add_u32 v254, v254, 4, v255
    v_lshrrev_b32 v255, 4, v253
    v_lshlrev_b32 v255, 4, v255
    v_lshl_add_u32 v254, v254, 6, v255
    s_mov_b32 exec_lo, 0
    s_mov_b32 exec_hi, 0xffff0000
    v_mov_b32 v12, 1.0
    v_mov_b32 v13, 0
    v_mov_b32 v14, 0
    v_mov_b32 v15, 0
    s_mov_b64 exec, -1
    v_cvt_pk_bf16_f32 v144, v8, v9
    v_cvt_pk_bf16_f32 v145, v10, v11
    v_cvt_pk_bf16_f32 v146, v12, v13
    v_cvt_pk_bf16_f32 v147, v14, v15
    buffer_store_dwordx4 v[144:147], v254, s[20:23], s39 offen offset:0 sc1
    s_mov_b32 exec_lo, 0
    s_mov_b32 exec_hi, 0xffff0000
    v_mov_b32 v44, 1.0
    v_mov_b32 v45, 0
    v_mov_b32 v46, 0
    v_mov_b32 v47, 0
    s_mov_b64 exec, -1
    v_cvt_pk_bf16_f32 v148, v40, v41
    v_cvt_pk_bf16_f32 v149, v42, v43
    v_cvt_pk_bf16_f32 v150, v44, v45
    v_cvt_pk_bf16_f32 v151, v46, v47
    buffer_store_dwordx4 v[148:151], v254, s[20:23], s39 offen offset:512 sc1
    s_add_u32 s39, s39, 4096
    s_mov_b32 exec_lo, 0
    s_mov_b32 exec_hi, 0xffff0000
    v_mov_b32 v76, 1.0
    v_mov_b32 v77, 0
    v_mov_b32 v78, 0
    v_mov_b32 v79, 0
    s_mov_b64 exec, -1
    v_cvt_pk_bf16_f32 v152, v72, v73
    v_cvt_pk_bf16_f32 v153, v74, v75
    v_cvt_pk_bf16_f32 v154, v76, v77
    v_cvt_pk_bf16_f32 v155, v78, v79
    buffer_store_dwordx4 v[152:155], v254, s[20:23], s39 offen offset:0 sc1
    s_mov_b32 exec_lo, 0
    s_mov_b32 exec_hi, 0xffff0000
    v_mov_b32 v108, 1.0
    v_mov_b32 v109, 0
    v_mov_b32 v110, 0
    v_mov_b32 v111, 0
    s_mov_b64 exec, -1
    v_cvt_pk_bf16_f32 v156, v104, v105
    v_cvt_pk_bf16_f32 v157, v106, v107
    v_cvt_pk_bf16_f32 v158, v108, v109
    v_cvt_pk_bf16_f32 v159, v110, v111
    buffer_store_dwordx4 v[156:159], v254, s[20:23], s39 offen offset:512 sc1
    s_add_u32 s39, s39, 4096
K1_E_20:
    s_mul_i32 s35, s26, 3
    s_add_u32 s35, s35, s68
    s_add_u32 s35, s35, 2
    s_cmp_lg_u32 s71, 0
    s_cbranch_scc1 K1_E_21
    s_lshr_b32 s36, s35, 3
    s_lshl_b32 s36, s36, 20
    s_and_b32 s37, s35, 7
    s_lshl_b32 s37, s37, 11
    s_add_u32 s39, s36, s37
    s_lshl_b32 s36, s38, 14
    s_add_u32 s39, s39, s36
    s_add_u32 s39, s39, 0x2000000
    s_cmp_ge_u32 s35, 128
    s_cselect_b32 s39, 0x7ff00000, s39
    s_cmp_lg_u32 s94, 0
    s_cselect_b32 s39, 0x7ff00000, s39
    v_cvt_pk_bf16_f32 v160, v16, v17
    v_cvt_pk_bf16_f32 v161, v18, v19
    v_cvt_pk_bf16_f32 v162, v20, v21
    v_cvt_pk_bf16_f32 v163, v22, v23
    buffer_store_dwordx4 v[160:163], v252, s[20:23], s39 offen offset:0 sc1
    v_cvt_pk_bf16_f32 v164, v48, v49
    v_cvt_pk_bf16_f32 v165, v50, v51
    v_cvt_pk_bf16_f32 v166, v52, v53
    v_cvt_pk_bf16_f32 v167, v54, v55
    buffer_store_dwordx4 v[164:167], v252, s[20:23], s39 offen offset:128 sc1
    s_add_u32 s39, s39, 16384
    v_cvt_pk_bf16_f32 v168, v80, v81
    v_cvt_pk_bf16_f32 v169, v82, v83
    v_cvt_pk_bf16_f32 v170, v84, v85
    v_cvt_pk_bf16_f32 v171, v86, v87
    buffer_store_dwordx4 v[168:171], v252, s[20:23], s39 offen offset:0 sc1
    v_cvt_pk_bf16_f32 v172, v112, v113
    v_cvt_pk_bf16_f32 v173, v114, v115
    v_cvt_pk_bf16_f32 v174, v116, v117
    v_cvt_pk_bf16_f32 v175, v118, v119
    buffer_store_dwordx4 v[172:175], v252, s[20:23], s39 offen offset:128 sc1
    s_add_u32 s39, s39, 16384
    s_branch K1_E_24
K1_E_21:
    s_and_b32 s36, s35, 15
    s_lshl_b32 s36, s36, 6
    s_add_u32 s36, s36, s38
    s_lshr_b32 s37, s35, 4
    s_cmp_eq_u32 s37, 1
    s_cbranch_scc1 K1_E_22
    s_cmp_eq_u32 s37, 2
    s_cbranch_scc1 K1_E_23
    s_lshl_b32 s39, s36, 11
    s_add_u32 s39, s39, 0x3000000
    v_mul_f32 v16, s95, v16
    v_mul_f32 v20, s95, v20
    v_mul_f32 v17, s95, v17
    v_mul_f32 v21, s95, v21
    v_mul_f32 v18, s95, v18
    v_mul_f32 v22, s95, v22
    v_mul_f32 v19, s95, v19
    v_mul_f32 v23, s95, v23
    s_mov_b32 exec_lo, 0
    s_mov_b32 exec_hi, 0xffff0000
    v_mov_b32 v20, 0
    v_mov_b32 v21, 0
    v_mov_b32 v22, 0
    v_mov_b32 v23, 0
    s_mov_b64 exec, -1
    v_cvt_pk_bf16_f32 v160, v16, v17
    v_cvt_pk_bf16_f32 v161, v18, v19
    v_cvt_pk_bf16_f32 v162, v20, v21
    v_cvt_pk_bf16_f32 v163, v22, v23
    buffer_store_dwordx4 v[160:163], v252, s[20:23], s39 offen offset:0 sc1
    v_mul_f32 v48, s95, v48
    v_mul_f32 v52, s95, v52
    v_mul_f32 v49, s95, v49
    v_mul_f32 v53, s95, v53
    v_mul_f32 v50, s95, v50
    v_mul_f32 v54, s95, v54
    v_mul_f32 v51, s95, v51
    v_mul_f32 v55, s95, v55
    s_mov_b32 exec_lo, 0
    s_mov_b32 exec_hi, 0xffff0000
    v_mov_b32 v52, 0
    v_mov_b32 v53, 0
    v_mov_b32 v54, 0
    v_mov_b32 v55, 0
    s_mov_b64 exec, -1
    v_cvt_pk_bf16_f32 v164, v48, v49
    v_cvt_pk_bf16_f32 v165, v50, v51
    v_cvt_pk_bf16_f32 v166, v52, v53
    v_cvt_pk_bf16_f32 v167, v54, v55
    buffer_store_dwordx4 v[164:167], v252, s[20:23], s39 offen offset:128 sc1
    v_mul_f32 v80, s95, v80
    v_mul_f32 v84, s95, v84
    v_mul_f32 v81, s95, v81
    v_mul_f32 v85, s95, v85
    v_mul_f32 v82, s95, v82
    v_mul_f32 v86, s95, v86
    v_mul_f32 v83, s95, v83
    v_mul_f32 v87, s95, v87
    s_mov_b32 exec_lo, 0
    s_mov_b32 exec_hi, 0xffff0000
    v_mov_b32 v84, 0
    v_mov_b32 v85, 0
    v_mov_b32 v86, 0
    v_mov_b32 v87, 0
    s_mov_b64 exec, -1
    v_cvt_pk_bf16_f32 v168, v80, v81
    v_cvt_pk_bf16_f32 v169, v82, v83
    v_cvt_pk_bf16_f32 v170, v84, v85
    v_cvt_pk_bf16_f32 v171, v86, v87
    buffer_store_dwordx4 v[168:171], v252, s[20:23], s39 offen offset:2048 sc1
    v_mul_f32 v112, s95, v112
    v_mul_f32 v116, s95, v116
    v_mul_f32 v113, s95, v113
    v_mul_f32 v117, s95, v117
    v_mul_f32 v114, s95, v114
    v_mul_f32 v118, s95, v118
    v_mul_f32 v115, s95, v115
    v_mul_f32 v119, s95, v119
    s_mov_b32 exec_lo, 0
    s_mov_b32 exec_hi, 0xffff0000
    v_mov_b32 v116, 0
    v_mov_b32 v117, 0
    v_mov_b32 v118, 0
    v_mov_b32 v119, 0
    s_mov_b64 exec, -1
    v_cvt_pk_bf16_f32 v172, v112, v113
    v_cvt_pk_bf16_f32 v173, v114, v115
    v_cvt_pk_bf16_f32 v174, v116, v117
    v_cvt_pk_bf16_f32 v175, v118, v119
    buffer_store_dwordx4 v[172:175], v252, s[20:23], s39 offen offset:2176 sc1
    s_branch K1_E_24
K1_E_22:
    s_lshl_b32 s39, s36, 12
    s_add_u32 s39, s39, 0x3200000
    s_mov_b32 exec_lo, 0
    s_mov_b32 exec_hi, 0xffff0000
    v_mov_b32 v20, 0
    v_mov_b32 v21, 0
    v_mov_b32 v22, 0
    v_mov_b32 v23, 0
    s_mov_b64 exec, -1
    v_cvt_pk_bf16_f32 v160, v16, v17
    v_cvt_pk_bf16_f32 v161, v18, v19
    v_cvt_pk_bf16_f32 v162, v20, v21
    v_cvt_pk_bf16_f32 v163, v22, v23
    buffer_store_dwordx4 v[160:163], v252, s[20:23], s39 offen offset:0 sc1
    s_mov_b32 exec_lo, 0
    s_mov_b32 exec_hi, 0xffff0000
    v_mov_b32 v52, 0
    v_mov_b32 v53, 0
    v_mov_b32 v54, 0
    v_mov_b32 v55, 0
    s_mov_b64 exec, -1
    v_cvt_pk_bf16_f32 v164, v48, v49
    v_cvt_pk_bf16_f32 v165, v50, v51
    v_cvt_pk_bf16_f32 v166, v52, v53
    v_cvt_pk_bf16_f32 v167, v54, v55
    buffer_store_dwordx4 v[164:167], v252, s[20:23], s39 offen offset:128 sc1
    s_add_u32 s39, s39, 4096
    s_mov_b32 exec_lo, 0
    s_mov_b32 exec_hi, 0xffff0000
    v_mov_b32 v84, 0
    v_mov_b32 v85, 0
    v_mov_b32 v86, 0
    v_mov_b32 v87, 0
    s_mov_b64 exec, -1
    v_cvt_pk_bf16_f32 v168, v80, v81
    v_cvt_pk_bf16_f32 v169, v82, v83
    v_cvt_pk_bf16_f32 v170, v84, v85
    v_cvt_pk_bf16_f32 v171, v86, v87
    buffer_store_dwordx4 v[168:171], v252, s[20:23], s39 offen offset:0 sc1
    s_mov_b32 exec_lo, 0
    s_mov_b32 exec_hi, 0xffff0000
    v_mov_b32 v116, 0
    v_mov_b32 v117, 0
    v_mov_b32 v118, 0
    v_mov_b32 v119, 0
    s_mov_b64 exec, -1
    v_cvt_pk_bf16_f32 v172, v112, v113
    v_cvt_pk_bf16_f32 v173, v114, v115
    v_cvt_pk_bf16_f32 v174, v116, v117
    v_cvt_pk_bf16_f32 v175, v118, v119
    buffer_store_dwordx4 v[172:175], v252, s[20:23], s39 offen offset:128 sc1
    s_add_u32 s39, s39, 4096
    s_branch K1_E_24
K1_E_23:
    s_lshl_b32 s39, s36, 12
    s_add_u32 s39, s39, 0x3200800
    v_bfe_u32 v254, v253, 3, 1
    v_and_b32 v255, 7, v253
    v_lshl_add_u32 v254, v254, 4, v255
    v_lshrrev_b32 v255, 4, v253
    v_lshlrev_b32 v255, 4, v255
    v_lshl_add_u32 v254, v254, 6, v255
    s_mov_b32 exec_lo, 0
    s_mov_b32 exec_hi, 0xffff0000
    v_mov_b32 v20, 1.0
    v_mov_b32 v21, 0
    v_mov_b32 v22, 0
    v_mov_b32 v23, 0
    s_mov_b64 exec, -1
    v_cvt_pk_bf16_f32 v160, v16, v17
    v_cvt_pk_bf16_f32 v161, v18, v19
    v_cvt_pk_bf16_f32 v162, v20, v21
    v_cvt_pk_bf16_f32 v163, v22, v23
    buffer_store_dwordx4 v[160:163], v254, s[20:23], s39 offen offset:0 sc1
    s_mov_b32 exec_lo, 0
    s_mov_b32 exec_hi, 0xffff0000
    v_mov_b32 v52, 1.0
    v_mov_b32 v53, 0
    v_mov_b32 v54, 0
    v_mov_b32 v55, 0
    s_mov_b64 exec, -1
    v_cvt_pk_bf16_f32 v164, v48, v49
    v_cvt_pk_bf16_f32 v165, v50, v51
    v_cvt_pk_bf16_f32 v166, v52, v53
    v_cvt_pk_bf16_f32 v167, v54, v55
    buffer_store_dwordx4 v[164:167], v254, s[20:23], s39 offen offset:512 sc1
    s_add_u32 s39, s39, 4096
    s_mov_b32 exec_lo, 0
    s_mov_b32 exec_hi, 0xffff0000
    v_mov_b32 v84, 1.0
    v_mov_b32 v85, 0
    v_mov_b32 v86, 0
    v_mov_b32 v87, 0
    s_mov_b64 exec, -1
    v_cvt_pk_bf16_f32 v168, v80, v81
    v_cvt_pk_bf16_f32 v169, v82, v83
    v_cvt_pk_bf16_f32 v170, v84, v85
    v_cvt_pk_bf16_f32 v171, v86, v87
    buffer_store_dwordx4 v[168:171], v254, s[20:23], s39 offen offset:0 sc1
    s_mov_b32 exec_lo, 0
    s_mov_b32 exec_hi, 0xffff0000
    v_mov_b32 v116, 1.0
    v_mov_b32 v117, 0
    v_mov_b32 v118, 0
    v_mov_b32 v119, 0
    s_mov_b64 exec, -1
    v_cvt_pk_bf16_f32 v172, v112, v113
    v_cvt_pk_bf16_f32 v173, v114, v115
    v_cvt_pk_bf16_f32 v174, v116, v117
    v_cvt_pk_bf16_f32 v175, v118, v119
    buffer_store_dwordx4 v[172:175], v254, s[20:23], s39 offen offset:512 sc1
    s_add_u32 s39, s39, 4096
K1_E_24:
    s_branch K1_FIN
K1_ORD21:
    s_cmp_lg_u32 s49, 0
    s_cbranch_scc1 K1_21V
    s_mov_b32 s40, 0
    s_add_u32 s31, s40, s43
    s_sub_u32 s37, s31, 7
    s_cmp_ge_u32 s31, 7
    s_cselect_b32 s31, s37, s31
    s_add_u32 s40, s40, 1
    s_add_u32 m0, s27, s32
    s_lshl_b32 s31, s31, 7
    buffer_load_dwordx4 v244, s[12:15], s31 offen offset:0 lds
    buffer_load_dwordx4 v245, s[12:15], s31 offen offset:1024 lds
    s_add_u32 s35, s27, s32
    s_add_u32 m0, s35, 0x800
    s_add_u32 s27, s27, 0x8000
    buffer_load_dwordx4 v246, s[12:15], s31 offen offset:0 lds
    buffer_load_dwordx4 v247, s[12:15], s31 offen offset:1024 lds
    s_cmp_ge_u32 s27, 0x28000
    s_cselect_b32 s27, 0x10000, s27
    s_mov_b32 s41, 0
    s_add_u32 s30, s41, s43
    s_sub_u32 s37, s30, 7
    s_cmp_ge_u32 s30, 7
    s_cselect_b32 s30, s37, s30
    s_add_u32 s41, s41, 1
    s_mul_i32 s30, s30, s45
    s_lshl_b32 s30, s30, 1
    s_add_u32 m0, s33, 0
    s_nop 0
    buffer_load_dwordx4 v250, s[16:19], s30 offen offset:0 lds
    buffer_load_dwordx4 v251, s[16:19], s30 offen offset:1024 lds
    s_add_u32 s30, s30, s45
    s_add_u32 m0, s33, 16384
    s_nop 0
    buffer_load_dwordx4 v250, s[16:19], s30 offen offset:0 lds
    buffer_load_dwordx4 v251, s[16:19], s30 offen offset:1024 lds
    s_add_u32 s31, s40, s43
    s_sub_u32 s37, s31, 7
    s_cmp_ge_u32 s31, 7
    s_cselect_b32 s31, s37, s31
    s_add_u32 s40, s40, 1
    s_add_u32 m0, s27, s32
    s_lshl_b32 s31, s31, 7
    buffer_load_dwordx4 v244, s[12:15], s31 offen offset:0 lds
    buffer_load_dwordx4 v245, s[12:15], s31 offen offset:1024 lds
    s_add_u32 s35, s27, s32
    s_add_u32 m0, s35, 0x800
    s_add_u32 s27, s27, 0x8000
    buffer_load_dwordx4 v246, s[12:15], s31 offen offset:0 lds
    buffer_load_dwordx4 v247, s[12:15], s31 offen offset:1024 lds
    s_cmp_ge_u32 s27, 0x28000
    s_cselect_b32 s27, 0x10000, s27
    s_add_u32 s30, s41, s43
    s_sub_u32 s37, s30, 7
    s_cmp_ge_u32 s30, 7
    s_cselect_b32 s30, s37, s30
    s_add_u32 s41, s41, 1
    s_mul_i32 s30, s30, s45
    s_lshl_b32 s30, s30, 1
    s_add_u32 m0, s33, 32768
    s_nop 0
    buffer_load_dwordx4 v250, s[16:19], s30 offen offset:0 lds
    buffer_load_dwordx4 v251, s[16:19], s30 offen offset:1024 lds
    s_add_u32 s30, s30, s45
    v_lshrrev_b32 v132, 4, v253
    v_bfe_u32 v128, v253, 3, 1
    v_and_b32 v129, 7, v253
    v_lshl_add_u32 v133, v128, 4, v129
    v_bfe_u32 v131, v253, 1, 2
    v_lshl_add_u32 v131, v128, 2, v131
    v_xor_b32 v131, v131, v132
    v_lshlrev_b32 v131, 4, v131
    s_lshl_b32 s35, s25, 6
    v_add_u32 v130, s35, v133
    v_lshl_add_u32 v130, v130, 7, v131
    v_add_u32 v224, 0x10000, v130
    v_xor_b32 v225, 64, v224
    v_bfe_u32 v128, v253, 2, 2
    v_lshl_add_u32 v134, v132, 3, v128
    v_bfe_u32 v130, v253, 1, 1
    v_bfe_u32 v131, v253, 4, 1
    v_lshl_add_u32 v130, v130, 1, v131
    v_lshlrev_b32 v130, 4, v130
    v_and_b32 v129, 1, v253
    v_lshl_add_u32 v135, v129, 3, v130
    v_lshl_add_u32 v129, v134, 9, v135
    s_lshl_b32 s35, s26, 2
    s_add_u32 s36, s35, 0
    v_xor_b32 v130, s36, v128
    v_lshl_add_u32 v226, v130, 6, v129
    v_xor_b32 v227, 16, v226
    s_add_u32 s36, s35, 1
    v_xor_b32 v130, s36, v128
    v_lshl_add_u32 v228, v130, 6, v129
    v_xor_b32 v229, 16, v228
    s_add_u32 s36, s35, 2
    v_xor_b32 v130, s36, v128
    v_lshl_add_u32 v230, v130, 6, v129
    v_xor_b32 v231, 16, v230
    s_add_u32 s36, s35, 3
    v_xor_b32 v130, s36, v128
    v_lshl_add_u32 v232, v130, 6, v129
    v_xor_b32 v233, 16, v232
    v_mul_u32_u24 v129, 384, v134
    v_add_u32 v129, v129, v135
    v_bfe_u32 v128, v253, 3, 1
    s_mul_i32 s35, s26, 3
    s_add_u32 s36, s35, 0
    v_xor_b32 v130, s36, v128
    v_lshl_add_u32 v234, v130, 6, v129
    v_xor_b32 v235, 16, v234
    s_add_u32 s36, s35, 1
    v_xor_b32 v130, s36, v128
    v_lshl_add_u32 v236, v130, 6, v129
    v_xor_b32 v237, 16, v236
    s_add_u32 s36, s35, 2
    v_xor_b32 v130, s36, v128
    v_lshl_add_u32 v238, v130, 6, v129
    v_xor_b32 v239, 16, v238
    v_lshrrev_b32 v130, 5, v253
    v_lshl_add_u32 v129, v131, 5, v133
    v_lshlrev_b32 v129, 4, v129
    v_lshl_add_u32 v252, v130, 10, v129
    s_waitcnt vmcnt(8) lgkmcnt(0)
    s_barrier
    ds_read_b128 v[128:131], v224 offset:0
    ds_read_b64_tr_b16 v[144:145], v234 offset:0
    ds_read_b64_tr_b16 v[146:147], v234 offset:1536
    ds_read_b64_tr_b16 v[148:149], v235 offset:0
    ds_read_b64_tr_b16 v[150:151], v235 offset:1536
    ds_read_b128 v[132:135], v224 offset:1024
    ds_read_b64_tr_b16 v[152:153], v236 offset:0
    ds_read_b64_tr_b16 v[154:155], v236 offset:1536
    ds_read_b64_tr_b16 v[156:157], v237 offset:0
    ds_read_b64_tr_b16 v[158:159], v237 offset:1536
    ds_read_b64_tr_b16 v[160:161], v238 offset:0
    ds_read_b64_tr_b16 v[162:163], v238 offset:1536
    ds_read_b64_tr_b16 v[164:165], v239 offset:0
    ds_read_b64_tr_b16 v[166:167], v239 offset:1536
    ds_read_b128 v[136:139], v224 offset:4096
    ds_read_b128 v[140:143], v224 offset:5120
    s_add_u32 m0, s33, 49152
    s_nop 0
    buffer_load_dwordx4 v250, s[16:19], s30 offen offset:0 lds
    buffer_load_dwordx4 v251, s[16:19], s30 offen offset:1024 lds
    s_add_u32 s31, s40, s43
    s_sub_u32 s37, s31, 7
    s_cmp_ge_u32 s31, 7
    s_cselect_b32 s31, s37, s31
    s_add_u32 s40, s40, 1
    s_add_u32 m0, s27, s32
    s_lshl_b32 s31, s31, 7
    buffer_load_dwordx4 v244, s[12:15], s31 offen offset:0 lds
    buffer_load_dwordx4 v245, s[12:15], s31 offen offset:1024 lds
    s_waitcnt vmcnt(10) lgkmcnt(0)
    s_barrier
    v_mfma_f32_16x16x32_bf16 v[0:3], v[144:147], v[128:131], 0
    ds_read_b128 v[176:179], v225 offset:0
    ds_read_b64_tr_b16 v[192:193], v234 offset:16384
    v_mfma_f32_16x16x32_bf16 v[4:7], v[148:151], v[128:131], 0
    ds_read_b64_tr_b16 v[194:195], v234 offset:17920
    ds_read_b64_tr_b16 v[196:197], v235 offset:16384
    v_mfma_f32_16x16x32_bf16 v[8:11], v[152:155], v[128:131], 0
    ds_read_b64_tr_b16 v[198:199], v235 offset:17920
    ds_read_b128 v[180:183], v225 offset:1024
    v_mfma_f32_16x16x32_bf16 v[12:15], v[156:159], v[128:131], 0
    ds_read_b64_tr_b16 v[200:201], v236 offset:16384
    v_mfma_f32_16x16x32_bf16 v[16:19], v[160:163], v[128:131], 0
    ds_read_b64_tr_b16 v[202:203], v236 offset:17920
    ds_read_b64_tr_b16 v[204:205], v237 offset:16384
    v_mfma_f32_16x16x32_bf16 v[20:23], v[164:167], v[128:131], 0
    ds_read_b64_tr_b16 v[206:207], v237 offset:17920
    ds_read_b64_tr_b16 v[208:209], v238 offset:16384
    v_mfma_f32_16x16x32_bf16 v[32:35], v[144:147], v[132:135], 0
    ds_read_b64_tr_b16 v[210:211], v238 offset:17920
    ds_read_b64_tr_b16 v[212:213], v239 offset:16384
    v_mfma_f32_16x16x32_bf16 v[36:39], v[148:151], v[132:135], 0
    ds_read_b64_tr_b16 v[214:215], v239 offset:17920
    v_mfma_f32_16x16x32_bf16 v[40:43], v[152:155], v[132:135], 0
    ds_read_b128 v[184:187], v225 offset:4096
    ds_read_b128 v[188:191], v225 offset:5120
    v_mfma_f32_16x16x32_bf16 v[44:47], v[156:159], v[132:135], 0
    s_add_u32 s30, s41, s43
    s_sub_u32 s37, s30, 7
    v_mfma_f32_16x16x32_bf16 v[48:51], v[160:163], v[132:135], 0
    s_cmp_ge_u32 s30, 7
    s_cselect_b32 s30, s37, s30
    v_mfma_f32_16x16x32_bf16 v[52:55], v[164:167], v[132:135], 0
    s_add_u32 s41, s41, 1
    v_mfma_f32_16x16x32_bf16 v[64:67], v[144:147], v[136:139], 0
    s_mul_i32 s30, s30, s45
    s_lshl_b32 s30, s30, 1
    v_mfma_f32_16x16x32_bf16 v[68:71], v[148:151], v[136:139], 0
    s_add_u32 m0, s33, 0
    s_nop 0
    v_mfma_f32_16x16x32_bf16 v[72:75], v[152:155], v[136:139], 0
    buffer_load_dwordx4 v250, s[16:19], s30 offen offset:0 lds
    buffer_load_dwordx4 v251, s[16:19], s30 offen offset:1024 lds
    v_mfma_f32_16x16x32_bf16 v[76:79], v[156:159], v[136:139], 0
    s_add_u32 s30, s30, s45
    v_mfma_f32_16x16x32_bf16 v[80:83], v[160:163], v[136:139], 0
    s_add_u32 s35, s27, s32
    s_add_u32 m0, s35, 0x800
    v_mfma_f32_16x16x32_bf16 v[84:87], v[164:167], v[136:139], 0
    s_add_u32 s27, s27, 0x8000
    buffer_load_dwordx4 v246, s[12:15], s31 offen offset:0 lds
    v_mfma_f32_16x16x32_bf16 v[96:99], v[144:147], v[140:143], 0
    buffer_load_dwordx4 v247, s[12:15], s31 offen offset:1024 lds
    s_cmp_ge_u32 s27, 0x28000
    v_mfma_f32_16x16x32_bf16 v[100:103], v[148:151], v[140:143], 0
    s_cselect_b32 s27, 0x10000, s27
    v_mfma_f32_16x16x32_bf16 v[104:107], v[152:155], v[140:143], 0
    s_add_u32 s36, s28, 0x8000
    s_cmp_ge_u32 s36, 0x18000
    v_mfma_f32_16x16x32_bf16 v[108:111], v[156:159], v[140:143], 0
    s_cselect_b32 s36, 0, s36
    s_sub_u32 s29, s36, s28
    v_mfma_f32_16x16x32_bf16 v[112:115], v[160:163], v[140:143], 0
    s_mov_b32 s28, s36
    v_add_u32 v224, s29, v224
    v_mfma_f32_16x16x32_bf16 v[116:119], v[164:167], v[140:143], 0
    v_add_u32 v225, s29, v225
    s_waitcnt vmcnt(8) lgkmcnt(0)
    s_barrier
    v_mfma_f32_16x16x32_bf16 v[0:3], v[192:195], v[176:179], v[0:3]
    ds_read_b128 v[128:131], v224 offset:0
    ds_read_b64_tr_b16 v[144:145], v234 offset:32768
    v_mfma_f32_16x16x32_bf16 v[4:7], v[196:199], v[176:179], v[4:7]
    ds_read_b64_tr_b16 v[146:147], v234 offset:34304
    v_mfma_f32_16x16x32_bf16 v[8:11], v[200:203], v[176:179], v[8:11]
    ds_read_b64_tr_b16 v[148:149], v235 offset:32768
    v_mfma_f32_16x16x32_bf16 v[12:15], v[204:207], v[176:179], v[12:15]
    ds_read_b64_tr_b16 v[150:151], v235 offset:34304
    v_mfma_f32_16x16x32_bf16 v[16:19], v[208:211], v[176:179], v[16:19]
    ds_read_b128 v[132:135], v224 offset:1024
    ds_read_b64_tr_b16 v[152:153], v236 offset:32768
    v_mfma_f32_16x16x32_bf16 v[20:23], v[212:215], v[176:179], v[20:23]
    ds_read_b64_tr_b16 v[154:155], v236 offset:34304
    v_mfma_f32_16x16x32_bf16 v[32:35], v[192:195], v[180:183], v[32:35]
    ds_read_b64_tr_b16 v[156:157], v237 offset:32768
    v_mfma_f32_16x16x32_bf16 v[36:39], v[196:199], v[180:183], v[36:39]
    ds_read_b64_tr_b16 v[158:159], v237 offset:34304
    v_mfma_f32_16x16x32_bf16 v[40:43], v[200:203], v[180:183], v[40:43]
    ds_read_b64_tr_b16 v[160:161], v238 offset:32768
    v_mfma_f32_16x16x32_bf16 v[44:47], v[204:207], v[180:183], v[44:47]
    ds_read_b64_tr_b16 v[162:163], v238 offset:34304
    ds_read_b64_tr_b16 v[164:165], v239 offset:32768
    v_mfma_f32_16x16x32_bf16 v[48:51], v[208:211], v[180:183], v[48:51]
    ds_read_b64_tr_b16 v[166:167], v239 offset:34304
    v_mfma_f32_16x16x32_bf16 v[52:55], v[212:215], v[180:183], v[52:55]
    ds_read_b128 v[136:139], v224 offset:4096
    v_mfma_f32_16x16x32_bf16 v[64:67], v[192:195], v[184:187], v[64:67]
    ds_read_b128 v[140:143], v224 offset:5120
    v_mfma_f32_16x16x32_bf16 v[68:71], v[196:199], v[184:187], v[68:71]
    s_add_u32 m0, s33, 16384
    v_mfma_f32_16x16x32_bf16 v[72:75], v[200:203], v[184:187], v[72:75]
    s_nop 0
    buffer_load_dwordx4 v250, s[16:19], s30 offen offset:0 lds
    v_mfma_f32_16x16x32_bf16 v[76:79], v[204:207], v[184:187], v[76:79]
    buffer_load_dwordx4 v251, s[16:19], s30 offen offset:1024 lds
    v_mfma_f32_16x16x32_bf16 v[80:83], v[208:211], v[184:187], v[80:83]
    s_add_u32 s31, s40, s43
    v_mfma_f32_16x16x32_bf16 v[84:87], v[212:215], v[184:187], v[84:87]
    s_sub_u32 s37, s31, 7
    v_mfma_f32_16x16x32_bf16 v[96:99], v[192:195], v[188:191], v[96:99]
    s_cmp_ge_u32 s31, 7
    v_mfma_f32_16x16x32_bf16 v[100:103], v[196:199], v[188:191], v[100:103]
    s_cselect_b32 s31, s37, s31
    s_add_u32 s40, s40, 1
    v_mfma_f32_16x16x32_bf16 v[104:107], v[200:203], v[188:191], v[104:107]
    s_add_u32 m0, s27, s32
    v_mfma_f32_16x16x32_bf16 v[108:111], v[204:207], v[188:191], v[108:111]
    s_lshl_b32 s31, s31, 7
    v_mfma_f32_16x16x32_bf16 v[112:115], v[208:211], v[188:191], v[112:115]
    buffer_load_dwordx4 v244, s[12:15], s31 offen offset:0 lds
    v_mfma_f32_16x16x32_bf16 v[116:119], v[212:215], v[188:191], v[116:119]
    buffer_load_dwordx4 v245, s[12:15], s31 offen offset:1024 lds
    s_waitcnt vmcnt(10) lgkmcnt(0)
    s_barrier
    v_mfma_f32_16x16x32_bf16 v[0:3], v[144:147], v[128:131], v[0:3]
    ds_read_b128 v[176:179], v225 offset:0
    ds_read_b64_tr_b16 v[192:193], v234 offset:49152
    v_mfma_f32_16x16x32_bf16 v[4:7], v[148:151], v[128:131], v[4:7]
    ds_read_b64_tr_b16 v[194:195], v234 offset:50688
    ds_read_b64_tr_b16 v[196:197], v235 offset:49152
    v_mfma_f32_16x16x32_bf16 v[8:11], v[152:155], v[128:131], v[8:11]
    ds_read_b64_tr_b16 v[198:199], v235 offset:50688
    ds_read_b128 v[180:183], v225 offset:1024
    v_mfma_f32_16x16x32_bf16 v[12:15], v[156:159], v[128:131], v[12:15]
    ds_read_b64_tr_b16 v[200:201], v236 offset:49152
    v_mfma_f32_16x16x32_bf16 v[16:19], v[160:163], v[128:131], v[16:19]
    ds_read_b64_tr_b16 v[202:203], v236 offset:50688
    ds_read_b64_tr_b16 v[204:205], v237 offset:49152
    v_mfma_f32_16x16x32_bf16 v[20:23], v[164:167], v[128:131], v[20:23]
    ds_read_b64_tr_b16 v[206:207], v237 offset:50688
    ds_read_b64_tr_b16 v[208:209], v238 offset:49152
    v_mfma_f32_16x16x32_bf16 v[32:35], v[144:147], v[132:135], v[32:35]
    ds_read_b64_tr_b16 v[210:211], v238 offset:50688
    ds_read_b64_tr_b16 v[212:213], v239 offset:49152
    v_mfma_f32_16x16x32_bf16 v[36:39], v[148:151], v[132:135], v[36:39]
    ds_read_b64_tr_b16 v[214:215], v239 offset:50688
    v_mfma_f32_16x16x32_bf16 v[40:43], v[152:155], v[132:135], v[40:43]
    ds_read_b128 v[184:187], v225 offset:4096
    ds_read_b128 v[188:191], v225 offset:5120
    v_mfma_f32_16x16x32_bf16 v[44:47], v[156:159], v[132:135], v[44:47]
    s_add_u32 s30, s41, s43
    s_sub_u32 s37, s30, 7
    v_mfma_f32_16x16x32_bf16 v[48:51], v[160:163], v[132:135], v[48:51]
    s_cmp_ge_u32 s30, 7
    s_cselect_b32 s30, s37, s30
    v_mfma_f32_16x16x32_bf16 v[52:55], v[164:167], v[132:135], v[52:55]
    s_add_u32 s41, s41, 1
    v_mfma_f32_16x16x32_bf16 v[64:67], v[144:147], v[136:139], v[64:67]
    s_mul_i32 s30, s30, s45
    s_lshl_b32 s30, s30, 1
    v_mfma_f32_16x16x32_bf16 v[68:71], v[148:151], v[136:139], v[68:71]
    s_add_u32 m0, s33, 32768
    s_nop 0
    v_mfma_f32_16x16x32_bf16 v[72:75], v[152:155], v[136:139], v[72:75]
    buffer_load_dwordx4 v250, s[16:19], s30 offen offset:0 lds
    buffer_load_dwordx4 v251, s[16:19], s30 offen offset:1024 lds
    v_mfma_f32_16x16x32_bf16 v[76:79], v[156:159], v[136:139], v[76:79]
    s_add_u32 s30, s30, s45
    v_mfma_f32_16x16x32_bf16 v[80:83], v[160:163], v[136:139], v[80:83]
    s_add_u32 s35, s27, s32
    s_add_u32 m0, s35, 0x800
    v_mfma_f32_16x16x32_bf16 v[84:87], v[164:167], v[136:139], v[84:87]
    s_add_u32 s27, s27, 0x8000
    buffer_load_dwordx4 v246, s[12:15], s31 offen offset:0 lds
    v_mfma_f32_16x16x32_bf16 v[96:99], v[144:147], v[140:143], v[96:99]
    buffer_load_dwordx4 v247, s[12:15], s31 offen offset:1024 lds
    s_cmp_ge_u32 s27, 0x28000
    v_mfma_f32_16x16x32_bf16 v[100:103], v[148:151], v[140:143], v[100:103]
    s_cselect_b32 s27, 0x10000, s27
    v_mfma_f32_16x16x32_bf16 v[104:107], v[152:155], v[140:143], v[104:107]
    s_add_u32 s36, s28, 0x8000
    s_cmp_ge_u32 s36, 0x18000
    v_mfma_f32_16x16x32_bf16 v[108:111], v[156:159], v[140:143], v[108:111]
    s_cselect_b32 s36, 0, s36
    s_sub_u32 s29, s36, s28
    v_mfma_f32_16x16x32_bf16 v[112:115], v[160:163], v[140:143], v[112:115]
    s_mov_b32 s28, s36
    v_add_u32 v224, s29, v224
    v_mfma_f32_16x16x32_bf16 v[116:119], v[164:167], v[140:143], v[116:119]
    v_add_u32 v225, s29, v225
    s_waitcnt vmcnt(8) lgkmcnt(0)
    s_barrier
    v_mfma_f32_16x16x32_bf16 v[0:3], v[192:195], v[176:179], v[0:3]
    ds_read_b128 v[128:131], v224 offset:0
    ds_read_b64_tr_b16 v[144:145], v234 offset:0
    v_mfma_f32_16x16x32_bf16 v[4:7], v[196:199], v[176:179], v[4:7]
    ds_read_b64_tr_b16 v[146:147], v234 offset:1536
    v_mfma_f32_16x16x32_bf16 v[8:11], v[200:203], v[176:179], v[8:11]
    ds_read_b64_tr_b16 v[148:149], v235 offset:0
    v_mfma_f32_16x16x32_bf16 v[12:15], v[204:207], v[176:179], v[12:15]
    ds_read_b64_tr_b16 v[150:151], v235 offset:1536
    v_mfma_f32_16x16x32_bf16 v[16:19], v[208:211], v[176:179], v[16:19]
    ds_read_b128 v[132:135], v224 offset:1024
    ds_read_b64_tr_b16 v[152:153], v236 offset:0
    v_mfma_f32_16x16x32_bf16 v[20:23], v[212:215], v[176:179], v[20:23]
    ds_read_b64_tr_b16 v[154:155], v236 offset:1536
    v_mfma_f32_16x16x32_bf16 v[32:35], v[192:195], v[180:183], v[32:35]
    ds_read_b64_tr_b16 v[156:157], v237 offset:0
    v_mfma_f32_16x16x32_bf16 v[36:39], v[196:199], v[180:183], v[36:39]
    ds_read_b64_tr_b16 v[158:159], v237 offset:1536
    v_mfma_f32_16x16x32_bf16 v[40:43], v[200:203], v[180:183], v[40:43]
    ds_read_b64_tr_b16 v[160:161], v238 offset:0
    v_mfma_f32_16x16x32_bf16 v[44:47], v[204:207], v[180:183], v[44:47]
    ds_read_b64_tr_b16 v[162:163], v238 offset:1536
    ds_read_b64_tr_b16 v[164:165], v239 offset:0
    v_mfma_f32_16x16x32_bf16 v[48:51], v[208:211], v[180:183], v[48:51]
    ds_read_b64_tr_b16 v[166:167], v239 offset:1536
    v_mfma_f32_16x16x32_bf16 v[52:55], v[212:215], v[180:183], v[52:55]
    ds_read_b128 v[136:139], v224 offset:4096
    v_mfma_f32_16x16x32_bf16 v[64:67], v[192:195], v[184:187], v[64:67]
    ds_read_b128 v[140:143], v224 offset:5120
    v_mfma_f32_16x16x32_bf16 v[68:71], v[196:199], v[184:187], v[68:71]
    s_add_u32 m0, s33, 49152
    v_mfma_f32_16x16x32_bf16 v[72:75], v[200:203], v[184:187], v[72:75]
    s_nop 0
    buffer_load_dwordx4 v250, s[16:19], s30 offen offset:0 lds
    v_mfma_f32_16x16x32_bf16 v[76:79], v[204:207], v[184:187], v[76:79]
    buffer_load_dwordx4 v251, s[16:19], s30 offen offset:1024 lds
    v_mfma_f32_16x16x32_bf16 v[80:83], v[208:211], v[184:187], v[80:83]
    s_add_u32 s31, s40, s43
    v_mfma_f32_16x16x32_bf16 v[84:87], v[212:215], v[184:187], v[84:87]
    s_sub_u32 s37, s31, 7
    v_mfma_f32_16x16x32_bf16 v[96:99], v[192:195], v[188:191], v[96:99]
    s_cmp_ge_u32 s31, 7
    v_mfma_f32_16x16x32_bf16 v[100:103], v[196:199], v[188:191], v[100:103]
    s_cselect_b32 s31, s37, s31
    s_add_u32 s40, s40, 1
    v_mfma_f32_16x16x32_bf16 v[104:107], v[200:203], v[188:191], v[104:107]
    s_add_u32 m0, s27, s32
    v_mfma_f32_16x16x32_bf16 v[108:111], v[204:207], v[188:191], v[108:111]
    s_lshl_b32 s31, s31, 7
    v_mfma_f32_16x16x32_bf16 v[112:115], v[208:211], v[188:191], v[112:115]
    buffer_load_dwordx4 v244, s[12:15], s31 offen offset:0 lds
    v_mfma_f32_16x16x32_bf16 v[116:119], v[212:215], v[188:191], v[116:119]
    buffer_load_dwordx4 v245, s[12:15], s31 offen offset:1024 lds
    s_waitcnt vmcnt(10) lgkmcnt(0)
    s_barrier
    v_mfma_f32_16x16x32_bf16 v[0:3], v[144:147], v[128:131], v[0:3]
    ds_read_b128 v[176:179], v225 offset:0
    ds_read_b64_tr_b16 v[192:193], v234 offset:16384
    v_mfma_f32_16x16x32_bf16 v[4:7], v[148:151], v[128:131], v[4:7]
    ds_read_b64_tr_b16 v[194:195], v234 offset:17920
    ds_read_b64_tr_b16 v[196:197], v235 offset:16384
    v_mfma_f32_16x16x32_bf16 v[8:11], v[152:155], v[128:131], v[8:11]
    ds_read_b64_tr_b16 v[198:199], v235 offset:17920
    ds_read_b128 v[180:183], v225 offset:1024
    v_mfma_f32_16x16x32_bf16 v[12:15], v[156:159], v[128:131], v[12:15]
    ds_read_b64_tr_b16 v[200:201], v236 offset:16384
    v_mfma_f32_16x16x32_bf16 v[16:19], v[160:163], v[128:131], v[16:19]
    ds_read_b64_tr_b16 v[202:203], v236 offset:17920
    ds_read_b64_tr_b16 v[204:205], v237 offset:16384
    v_mfma_f32_16x16x32_bf16 v[20:23], v[164:167], v[128:131], v[20:23]
    ds_read_b64_tr_b16 v[206:207], v237 offset:17920
    ds_read_b64_tr_b16 v[208:209], v238 offset:16384
    v_mfma_f32_16x16x32_bf16 v[32:35], v[144:147], v[132:135], v[32:35]
    ds_read_b64_tr_b16 v[210:211], v238 offset:17920
    ds_read_b64_tr_b16 v[212:213], v239 offset:16384
    v_mfma_f32_16x16x32_bf16 v[36:39], v[148:151], v[132:135], v[36:39]
    ds_read_b64_tr_b16 v[214:215], v239 offset:17920
    v_mfma_f32_16x16x32_bf16 v[40:43], v[152:155], v[132:135], v[40:43]
    ds_read_b128 v[184:187], v225 offset:4096
    ds_read_b128 v[188:191], v225 offset:5120
    v_mfma_f32_16x16x32_bf16 v[44:47], v[156:159], v[132:135], v[44:47]
    s_add_u32 s30, s41, s43
    s_sub_u32 s37, s30, 7
    v_mfma_f32_16x16x32_bf16 v[48:51], v[160:163], v[132:135], v[48:51]
    s_cmp_ge_u32 s30, 7
    s_cselect_b32 s30, s37, s30
    v_mfma_f32_16x16x32_bf16 v[52:55], v[164:167], v[132:135], v[52:55]
    s_add_u32 s41, s41, 1
    v_mfma_f32_16x16x32_bf16 v[64:67], v[144:147], v[136:139], v[64:67]
    s_mul_i32 s30, s30, s45
    s_lshl_b32 s30, s30, 1
    v_mfma_f32_16x16x32_bf16 v[68:71], v[148:151], v[136:139], v[68:71]
    s_add_u32 m0, s33, 0
    s_nop 0
    v_mfma_f32_16x16x32_bf16 v[72:75], v[152:155], v[136:139], v[72:75]
    buffer_load_dwordx4 v250, s[16:19], s30 offen offset:0 lds
    buffer_load_dwordx4 v251, s[16:19], s30 offen offset:1024 lds
    v_mfma_f32_16x16x32_bf16 v[76:79], v[156:159], v[136:139], v[76:79]
    s_add_u32 s30, s30, s45
    v_mfma_f32_16x16x32_bf16 v[80:83], v[160:163], v[136:139], v[80:83]
    s_add_u32 s35, s27, s32
    s_add_u32 m0, s35, 0x800
    v_mfma_f32_16x16x32_bf16 v[84:87], v[164:167], v[136:139], v[84:87]
    s_add_u32 s27, s27, 0x8000
    buffer_load_dwordx4 v246, s[12:15], s31 offen offset:0 lds
    v_mfma_f32_16x16x32_bf16 v[96:99], v[144:147], v[140:143], v[96:99]
    buffer_load_dwordx4 v247, s[12:15], s31 offen offset:1024 lds
    s_cmp_ge_u32 s27, 0x28000
    v_mfma_f32_16x16x32_bf16 v[100:103], v[148:151], v[140:143], v[100:103]
    s_cselect_b32 s27, 0x10000, s27
    v_mfma_f32_16x16x32_bf16 v[104:107], v[152:155], v[140:143], v[104:107]
    s_add_u32 s36, s28, 0x8000
    s_cmp_ge_u32 s36, 0x18000
    v_mfma_f32_16x16x32_bf16 v[108:111], v[156:159], v[140:143], v[108:111]
    s_cselect_b32 s36, 0, s36
    s_sub_u32 s29, s36, s28
    v_mfma_f32_16x16x32_bf16 v[112:115], v[160:163], v[140:143], v[112:115]
    s_mov_b32 s28, s36
    v_add_u32 v224, s29, v224
    v_mfma_f32_16x16x32_bf16 v[116:119], v[164:167], v[140:143], v[116:119]
    v_add_u32 v225, s29, v225
    s_waitcnt vmcnt(8) lgkmcnt(0)
    s_barrier
    v_mfma_f32_16x16x32_bf16 v[0:3], v[192:195], v[176:179], v[0:3]
    ds_read_b128 v[128:131], v224 offset:0
    ds_read_b64_tr_b16 v[144:145], v234 offset:32768
    v_mfma_f32_16x16x32_bf16 v[4:7], v[196:199], v[176:179], v[4:7]
    ds_read_b64_tr_b16 v[146:147], v234 offset:34304
    v_mfma_f32_16x16x32_bf16 v[8:11], v[200:203], v[176:179], v[8:11]
    ds_read_b64_tr_b16 v[148:149], v235 offset:32768
    v_mfma_f32_16x16x32_bf16 v[12:15], v[204:207], v[176:179], v[12:15]
    ds_read_b64_tr_b16 v[150:151], v235 offset:34304
    v_mfma_f32_16x16x32_bf16 v[16:19], v[208:211], v[176:179], v[16:19]
    ds_read_b128 v[132:135], v224 offset:1024
    ds_read_b64_tr_b16 v[152:153], v236 offset:32768
    v_mfma_f32_16x16x32_bf16 v[20:23], v[212:215], v[176:179], v[20:23]
    ds_read_b64_tr_b16 v[154:155], v236 offset:34304
    v_mfma_f32_16x16x32_bf16 v[32:35], v[192:195], v[180:183], v[32:35]
    ds_read_b64_tr_b16 v[156:157], v237 offset:32768
    v_mfma_f32_16x16x32_bf16 v[36:39], v[196:199], v[180:183], v[36:39]
    ds_read_b64_tr_b16 v[158:159], v237 offset:34304
    v_mfma_f32_16x16x32_bf16 v[40:43], v[200:203], v[180:183], v[40:43]
    ds_read_b64_tr_b16 v[160:161], v238 offset:32768
    v_mfma_f32_16x16x32_bf16 v[44:47], v[204:207], v[180:183], v[44:47]
    ds_read_b64_tr_b16 v[162:163], v238 offset:34304
    ds_read_b64_tr_b16 v[164:165], v239 offset:32768
    v_mfma_f32_16x16x32_bf16 v[48:51], v[208:211], v[180:183], v[48:51]
    ds_read_b64_tr_b16 v[166:167], v239 offset:34304
    v_mfma_f32_16x16x32_bf16 v[52:55], v[212:215], v[180:183], v[52:55]
    ds_read_b128 v[136:139], v224 offset:4096
    v_mfma_f32_16x16x32_bf16 v[64:67], v[192:195], v[184:187], v[64:67]
    ds_read_b128 v[140:143], v224 offset:5120
    v_mfma_f32_16x16x32_bf16 v[68:71], v[196:199], v[184:187], v[68:71]
    s_add_u32 m0, s33, 16384
    v_mfma_f32_16x16x32_bf16 v[72:75], v[200:203], v[184:187], v[72:75]
    s_nop 0
    buffer_load_dwordx4 v250, s[16:19], s30 offen offset:0 lds
    v_mfma_f32_16x16x32_bf16 v[76:79], v[204:207], v[184:187], v[76:79]
    buffer_load_dwordx4 v251, s[16:19], s30 offen offset:1024 lds
    v_mfma_f32_16x16x32_bf16 v[80:83], v[208:211], v[184:187], v[80:83]
    s_add_u32 s31, s40, s43
    v_mfma_f32_16x16x32_bf16 v[84:87], v[212:215], v[184:187], v[84:87]
    s_sub_u32 s37, s31, 7
    v_mfma_f32_16x16x32_bf16 v[96:99], v[192:195], v[188:191], v[96:99]
    s_cmp_ge_u32 s31, 7
    v_mfma_f32_16x16x32_bf16 v[100:103], v[196:199], v[188:191], v[100:103]
    s_cselect_b32 s31, s37, s31
    s_add_u32 s40, s40, 1
    v_mfma_f32_16x16x32_bf16 v[104:107], v[200:203], v[188:191], v[104:107]
    s_add_u32 m0, s27, s32
    v_mfma_f32_16x16x32_bf16 v[108:111], v[204:207], v[188:191], v[108:111]
    s_lshl_b32 s31, s31, 7
    v_mfma_f32_16x16x32_bf16 v[112:115], v[208:211], v[188:191], v[112:115]
    buffer_load_dwordx4 v244, s[12:15], s31 offen offset:0 lds
    v_mfma_f32_16x16x32_bf16 v[116:119], v[212:215], v[188:191], v[116:119]
    buffer_load_dwordx4 v245, s[12:15], s31 offen offset:1024 lds
    s_waitcnt vmcnt(10) lgkmcnt(0)
    s_barrier
    v_mfma_f32_16x16x32_bf16 v[0:3], v[144:147], v[128:131], v[0:3]
    ds_read_b128 v[176:179], v225 offset:0
    ds_read_b64_tr_b16 v[192:193], v234 offset:49152
    v_mfma_f32_16x16x32_bf16 v[4:7], v[148:151], v[128:131], v[4:7]
    ds_read_b64_tr_b16 v[194:195], v234 offset:50688
    ds_read_b64_tr_b16 v[196:197], v235 offset:49152
    v_mfma_f32_16x16x32_bf16 v[8:11], v[152:155], v[128:131], v[8:11]
    ds_read_b64_tr_b16 v[198:199], v235 offset:50688
    ds_read_b128 v[180:183], v225 offset:1024
    v_mfma_f32_16x16x32_bf16 v[12:15], v[156:159], v[128:131], v[12:15]
    ds_read_b64_tr_b16 v[200:201], v236 offset:49152
    v_mfma_f32_16x16x32_bf16 v[16:19], v[160:163], v[128:131], v[16:19]
    ds_read_b64_tr_b16 v[202:203], v236 offset:50688
    ds_read_b64_tr_b16 v[204:205], v237 offset:49152
    v_mfma_f32_16x16x32_bf16 v[20:23], v[164:167], v[128:131], v[20:23]
    ds_read_b64_tr_b16 v[206:207], v237 offset:50688
    ds_read_b64_tr_b16 v[208:209], v238 offset:49152
    v_mfma_f32_16x16x32_bf16 v[32:35], v[144:147], v[132:135], v[32:35]
    ds_read_b64_tr_b16 v[210:211], v238 offset:50688
    ds_read_b64_tr_b16 v[212:213], v239 offset:49152
    v_mfma_f32_16x16x32_bf16 v[36:39], v[148:151], v[132:135], v[36:39]
    ds_read_b64_tr_b16 v[214:215], v239 offset:50688
    v_mfma_f32_16x16x32_bf16 v[40:43], v[152:155], v[132:135], v[40:43]
    ds_read_b128 v[184:187], v225 offset:4096
    ds_read_b128 v[188:191], v225 offset:5120
    v_mfma_f32_16x16x32_bf16 v[44:47], v[156:159], v[132:135], v[44:47]
    s_add_u32 s30, s41, s43
    s_sub_u32 s37, s30, 7
    v_mfma_f32_16x16x32_bf16 v[48:51], v[160:163], v[132:135], v[48:51]
    s_cmp_ge_u32 s30, 7
    s_cselect_b32 s30, s37, s30
    v_mfma_f32_16x16x32_bf16 v[52:55], v[164:167], v[132:135], v[52:55]
    s_add_u32 s41, s41, 1
    v_mfma_f32_16x16x32_bf16 v[64:67], v[144:147], v[136:139], v[64:67]
    s_mul_i32 s30, s30, s45
    s_lshl_b32 s30, s30, 1
    v_mfma_f32_16x16x32_bf16 v[68:71], v[148:151], v[136:139], v[68:71]
    s_add_u32 m0, s33, 32768
    s_nop 0
    v_mfma_f32_16x16x32_bf16 v[72:75], v[152:155], v[136:139], v[72:75]
    buffer_load_dwordx4 v250, s[16:19], s30 offen offset:0 lds
    buffer_load_dwordx4 v251, s[16:19], s30 offen offset:1024 lds
    v_mfma_f32_16x16x32_bf16 v[76:79], v[156:159], v[136:139], v[76:79]
    s_add_u32 s30, s30, s45
    v_mfma_f32_16x16x32_bf16 v[80:83], v[160:163], v[136:139], v[80:83]
    s_add_u32 s35, s27, s32
    s_add_u32 m0, s35, 0x800
    v_mfma_f32_16x16x32_bf16 v[84:87], v[164:167], v[136:139], v[84:87]
    s_add_u32 s27, s27, 0x8000
    buffer_load_dwordx4 v246, s[12:15], s31 offen offset:0 lds
    v_mfma_f32_16x16x32_bf16 v[96:99], v[144:147], v[140:143], v[96:99]
    buffer_load_dwordx4 v247, s[12:15], s31 offen offset:1024 lds
    s_cmp_ge_u32 s27, 0x28000
    v_mfma_f32_16x16x32_bf16 v[100:103], v[148:151], v[140:143], v[100:103]
    s_cselect_b32 s27, 0x10000, s27
    v_mfma_f32_16x16x32_bf16 v[104:107], v[152:155], v[140:143], v[104:107]
    s_add_u32 s36, s28, 0x8000
    s_cmp_ge_u32 s36, 0x18000
    v_mfma_f32_16x16x32_bf16 v[108:111], v[156:159], v[140:143], v[108:111]
    s_cselect_b32 s36, 0, s36
    s_sub_u32 s29, s36, s28
    v_mfma_f32_16x16x32_bf16 v[112:115], v[160:163], v[140:143], v[112:115]
    s_mov_b32 s28, s36
    v_add_u32 v224, s29, v224
    v_mfma_f32_16x16x32_bf16 v[116:119], v[164:167], v[140:143], v[116:119]
    v_add_u32 v225, s29, v225
    s_waitcnt vmcnt(8) lgkmcnt(0)
    s_barrier
    v_mfma_f32_16x16x32_bf16 v[0:3], v[192:195], v[176:179], v[0:3]
    ds_read_b128 v[128:131], v224 offset:0
    ds_read_b64_tr_b16 v[144:145], v234 offset:0
    v_mfma_f32_16x16x32_bf16 v[4:7], v[196:199], v[176:179], v[4:7]
    ds_read_b64_tr_b16 v[146:147], v234 offset:1536
    v_mfma_f32_16x16x32_bf16 v[8:11], v[200:203], v[176:179], v[8:11]
    ds_read_b64_tr_b16 v[148:149], v235 offset:0
    v_mfma_f32_16x16x32_bf16 v[12:15], v[204:207], v[176:179], v[12:15]
    ds_read_b64_tr_b16 v[150:151], v235 offset:1536
    v_mfma_f32_16x16x32_bf16 v[16:19], v[208:211], v[176:179], v[16:19]
    ds_read_b128 v[132:135], v224 offset:1024
    ds_read_b64_tr_b16 v[152:153], v236 offset:0
    v_mfma_f32_16x16x32_bf16 v[20:23], v[212:215], v[176:179], v[20:23]
    ds_read_b64_tr_b16 v[154:155], v236 offset:1536
    v_mfma_f32_16x16x32_bf16 v[32:35], v[192:195], v[180:183], v[32:35]
    ds_read_b64_tr_b16 v[156:157], v237 offset:0
    v_mfma_f32_16x16x32_bf16 v[36:39], v[196:199], v[180:183], v[36:39]
    ds_read_b64_tr_b16 v[158:159], v237 offset:1536
    v_mfma_f32_16x16x32_bf16 v[40:43], v[200:203], v[180:183], v[40:43]
    ds_read_b64_tr_b16 v[160:161], v238 offset:0
    v_mfma_f32_16x16x32_bf16 v[44:47], v[204:207], v[180:183], v[44:47]
    ds_read_b64_tr_b16 v[162:163], v238 offset:1536
    ds_read_b64_tr_b16 v[164:165], v239 offset:0
    v_mfma_f32_16x16x32_bf16 v[48:51], v[208:211], v[180:183], v[48:51]
    ds_read_b64_tr_b16 v[166:167], v239 offset:1536
    v_mfma_f32_16x16x32_bf16 v[52:55], v[212:215], v[180:183], v[52:55]
    ds_read_b128 v[136:139], v224 offset:4096
    v_mfma_f32_16x16x32_bf16 v[64:67], v[192:195], v[184:187], v[64:67]
    ds_read_b128 v[140:143], v224 offset:5120
    v_mfma_f32_16x16x32_bf16 v[68:71], v[196:199], v[184:187], v[68:71]
    s_add_u32 m0, s33, 49152
    v_mfma_f32_16x16x32_bf16 v[72:75], v[200:203], v[184:187], v[72:75]
    s_nop 0
    buffer_load_dwordx4 v250, s[16:19], s30 offen offset:0 lds
    v_mfma_f32_16x16x32_bf16 v[76:79], v[204:207], v[184:187], v[76:79]
    buffer_load_dwordx4 v251, s[16:19], s30 offen offset:1024 lds
    v_mfma_f32_16x16x32_bf16 v[80:83], v[208:211], v[184:187], v[80:83]
    s_add_u32 s31, s40, s43
    v_mfma_f32_16x16x32_bf16 v[84:87], v[212:215], v[184:187], v[84:87]
    s_sub_u32 s37, s31, 7
    v_mfma_f32_16x16x32_bf16 v[96:99], v[192:195], v[188:191], v[96:99]
    s_cmp_ge_u32 s31, 7
    v_mfma_f32_16x16x32_bf16 v[100:103], v[196:199], v[188:191], v[100:103]
    s_cselect_b32 s31, s37, s31
    s_add_u32 s40, s40, 1
    v_mfma_f32_16x16x32_bf16 v[104:107], v[200:203], v[188:191], v[104:107]
    s_add_u32 m0, s27, s32
    v_mfma_f32_16x16x32_bf16 v[108:111], v[204:207], v[188:191], v[108:111]
    s_lshl_b32 s31, s31, 7
    v_mfma_f32_16x16x32_bf16 v[112:115], v[208:211], v[188:191], v[112:115]
    buffer_load_dwordx4 v244, s[12:15], s31 offen offset:0 lds
    v_mfma_f32_16x16x32_bf16 v[116:119], v[212:215], v[188:191], v[116:119]
    buffer_load_dwordx4 v245, s[12:15], s31 offen offset:1024 lds
    s_waitcnt vmcnt(10) lgkmcnt(0)
    s_barrier
    v_mfma_f32_16x16x32_bf16 v[0:3], v[144:147], v[128:131], v[0:3]
    ds_read_b128 v[176:179], v225 offset:0
    ds_read_b64_tr_b16 v[192:193], v234 offset:16384
    v_mfma_f32_16x16x32_bf16 v[4:7], v[148:151], v[128:131], v[4:7]
    ds_read_b64_tr_b16 v[194:195], v234 offset:17920
    ds_read_b64_tr_b16 v[196:197], v235 offset:16384
    v_mfma_f32_16x16x32_bf16 v[8:11], v[152:155], v[128:131], v[8:11]
    ds_read_b64_tr_b16 v[198:199], v235 offset:17920
    ds_read_b128 v[180:183], v225 offset:1024
    v_mfma_f32_16x16x32_bf16 v[12:15], v[156:159], v[128:131], v[12:15]
    ds_read_b64_tr_b16 v[200:201], v236 offset:16384
    v_mfma_f32_16x16x32_bf16 v[16:19], v[160:163], v[128:131], v[16:19]
    ds_read_b64_tr_b16 v[202:203], v236 offset:17920
    ds_read_b64_tr_b16 v[204:205], v237 offset:16384
    v_mfma_f32_16x16x32_bf16 v[20:23], v[164:167], v[128:131], v[20:23]
    ds_read_b64_tr_b16 v[206:207], v237 offset:17920
    ds_read_b64_tr_b16 v[208:209], v238 offset:16384
    v_mfma_f32_16x16x32_bf16 v[32:35], v[144:147], v[132:135], v[32:35]
    ds_read_b64_tr_b16 v[210:211], v238 offset:17920
    ds_read_b64_tr_b16 v[212:213], v239 offset:16384
    v_mfma_f32_16x16x32_bf16 v[36:39], v[148:151], v[132:135], v[36:39]
    ds_read_b64_tr_b16 v[214:215], v239 offset:17920
    v_mfma_f32_16x16x32_bf16 v[40:43], v[152:155], v[132:135], v[40:43]
    ds_read_b128 v[184:187], v225 offset:4096
    ds_read_b128 v[188:191], v225 offset:5120
    v_mfma_f32_16x16x32_bf16 v[44:47], v[156:159], v[132:135], v[44:47]
    s_add_u32 s30, s41, s43
    s_sub_u32 s37, s30, 7
    v_mfma_f32_16x16x32_bf16 v[48:51], v[160:163], v[132:135], v[48:51]
    s_cmp_ge_u32 s30, 7
    s_cselect_b32 s30, s37, s30
    v_mfma_f32_16x16x32_bf16 v[52:55], v[164:167], v[132:135], v[52:55]
    s_add_u32 s41, s41, 1
    v_mfma_f32_16x16x32_bf16 v[64:67], v[144:147], v[136:139], v[64:67]
    s_mul_i32 s30, s30, s45
    s_lshl_b32 s30, s30, 1
    v_mfma_f32_16x16x32_bf16 v[68:71], v[148:151], v[136:139], v[68:71]
    s_add_u32 m0, s33, 0
    s_nop 0
    v_mfma_f32_16x16x32_bf16 v[72:75], v[152:155], v[136:139], v[72:75]
    buffer_load_dwordx4 v250, s[16:19], s30 offen offset:0 lds
    buffer_load_dwordx4 v251, s[16:19], s30 offen offset:1024 lds
    v_mfma_f32_16x16x32_bf16 v[76:79], v[156:159], v[136:139], v[76:79]
    s_add_u32 s30, s30, s45
    v_mfma_f32_16x16x32_bf16 v[80:83], v[160:163], v[136:139], v[80:83]
    s_add_u32 s35, s27, s32
    s_add_u32 m0, s35, 0x800
    v_mfma_f32_16x16x32_bf16 v[84:87], v[164:167], v[136:139], v[84:87]
    s_add_u32 s27, s27, 0x8000
    buffer_load_dwordx4 v246, s[12:15], s31 offen offset:0 lds
    v_mfma_f32_16x16x32_bf16 v[96:99], v[144:147], v[140:143], v[96:99]
    buffer_load_dwordx4 v247, s[12:15], s31 offen offset:1024 lds
    s_cmp_ge_u32 s27, 0x28000
    v_mfma_f32_16x16x32_bf16 v[100:103], v[148:151], v[140:143], v[100:103]
    s_cselect_b32 s27, 0x10000, s27
    v_mfma_f32_16x16x32_bf16 v[104:107], v[152:155], v[140:143], v[104:107]
    s_add_u32 s36, s28, 0x8000
    s_cmp_ge_u32 s36, 0x18000
    v_mfma_f32_16x16x32_bf16 v[108:111], v[156:159], v[140:143], v[108:111]
    s_cselect_b32 s36, 0, s36
    s_sub_u32 s29, s36, s28
    v_mfma_f32_16x16x32_bf16 v[112:115], v[160:163], v[140:143], v[112:115]
    s_mov_b32 s28, s36
    v_add_u32 v224, s29, v224
    v_mfma_f32_16x16x32_bf16 v[116:119], v[164:167], v[140:143], v[116:119]
    v_add_u32 v225, s29, v225
    s_waitcnt vmcnt(8) lgkmcnt(0)
    s_barrier
    v_mfma_f32_16x16x32_bf16 v[0:3], v[192:195], v[176:179], v[0:3]
    ds_read_b128 v[128:131], v224 offset:0
    ds_read_b64_tr_b16 v[144:145], v234 offset:32768
    v_mfma_f32_16x16x32_bf16 v[4:7], v[196:199], v[176:179], v[4:7]
    ds_read_b64_tr_b16 v[146:147], v234 offset:34304
    v_mfma_f32_16x16x32_bf16 v[8:11], v[200:203], v[176:179], v[8:11]
    ds_read_b64_tr_b16 v[148:149], v235 offset:32768
    v_mfma_f32_16x16x32_bf16 v[12:15], v[204:207], v[176:179], v[12:15]
    ds_read_b64_tr_b16 v[150:151], v235 offset:34304
    v_mfma_f32_16x16x32_bf16 v[16:19], v[208:211], v[176:179], v[16:19]
    ds_read_b128 v[132:135], v224 offset:1024
    ds_read_b64_tr_b16 v[152:153], v236 offset:32768
    v_mfma_f32_16x16x32_bf16 v[20:23], v[212:215], v[176:179], v[20:23]
    ds_read_b64_tr_b16 v[154:155], v236 offset:34304
    v_mfma_f32_16x16x32_bf16 v[32:35], v[192:195], v[180:183], v[32:35]
    ds_read_b64_tr_b16 v[156:157], v237 offset:32768
    v_mfma_f32_16x16x32_bf16 v[36:39], v[196:199], v[180:183], v[36:39]
    ds_read_b64_tr_b16 v[158:159], v237 offset:34304
    v_mfma_f32_16x16x32_bf16 v[40:43], v[200:203], v[180:183], v[40:43]
    ds_read_b64_tr_b16 v[160:161], v238 offset:32768
    ds_read_b64_tr_b16 v[162:163], v238 offset:34304
    v_mfma_f32_16x16x32_bf16 v[44:47], v[204:207], v[180:183], v[44:47]
    ds_read_b64_tr_b16 v[164:165], v239 offset:32768
    v_mfma_f32_16x16x32_bf16 v[48:51], v[208:211], v[180:183], v[48:51]
    ds_read_b64_tr_b16 v[166:167], v239 offset:34304
    v_mfma_f32_16x16x32_bf16 v[52:55], v[212:215], v[180:183], v[52:55]
    ds_read_b128 v[136:139], v224 offset:4096
    v_mfma_f32_16x16x32_bf16 v[64:67], v[192:195], v[184:187], v[64:67]
    ds_read_b128 v[140:143], v224 offset:5120
    s_add_u32 m0, s33, 16384
    v_mfma_f32_16x16x32_bf16 v[68:71], v[196:199], v[184:187], v[68:71]
    s_nop 0
    v_mfma_f32_16x16x32_bf16 v[72:75], v[200:203], v[184:187], v[72:75]
    buffer_load_dwordx4 v250, s[16:19], s30 offen offset:0 lds
    v_mfma_f32_16x16x32_bf16 v[76:79], v[204:207], v[184:187], v[76:79]
    buffer_load_dwordx4 v251, s[16:19], s30 offen offset:1024 lds
    v_mfma_f32_16x16x32_bf16 v[80:83], v[208:211], v[184:187], v[80:83]
    s_mov_b32 s40, 0
    s_add_u32 s31, s40, s42
    v_mfma_f32_16x16x32_bf16 v[84:87], v[212:215], v[184:187], v[84:87]
    s_and_b32 s31, s31, 3
    v_mfma_f32_16x16x32_bf16 v[96:99], v[192:195], v[188:191], v[96:99]
    s_andn2_b32 s37, s40, 3
    v_mfma_f32_16x16x32_bf16 v[100:103], v[196:199], v[188:191], v[100:103]
    s_or_b32 s31, s31, s37
    v_mfma_f32_16x16x32_bf16 v[104:107], v[200:203], v[188:191], v[104:107]
    s_add_u32 s40, s40, 1
    s_add_u32 m0, s27, s32
    v_mfma_f32_16x16x32_bf16 v[108:111], v[204:207], v[188:191], v[108:111]
    s_lshl_b32 s31, s31, 7
    v_mfma_f32_16x16x32_bf16 v[112:115], v[208:211], v[188:191], v[112:115]
    buffer_load_dwordx4 v240, s[4:7], s31 offen offset:0 lds
    v_mfma_f32_16x16x32_bf16 v[116:119], v[212:215], v[188:191], v[116:119]
    buffer_load_dwordx4 v241, s[4:7], s31 offen offset:1024 lds
    s_waitcnt vmcnt(10) lgkmcnt(0)
    s_barrier
    v_mfma_f32_16x16x32_bf16 v[0:3], v[144:147], v[128:131], v[0:3]
    ds_read_b128 v[176:179], v225 offset:0
    ds_read_b64_tr_b16 v[192:193], v234 offset:49152
    v_mfma_f32_16x16x32_bf16 v[4:7], v[148:151], v[128:131], v[4:7]
    ds_read_b64_tr_b16 v[194:195], v234 offset:50688
    ds_read_b64_tr_b16 v[196:197], v235 offset:49152
    v_mfma_f32_16x16x32_bf16 v[8:11], v[152:155], v[128:131], v[8:11]
    ds_read_b64_tr_b16 v[198:199], v235 offset:50688
    ds_read_b128 v[180:183], v225 offset:1024
    v_mfma_f32_16x16x32_bf16 v[12:15], v[156:159], v[128:131], v[12:15]
    ds_read_b64_tr_b16 v[200:201], v236 offset:49152
    ds_read_b64_tr_b16 v[202:203], v236 offset:50688
    v_mfma_f32_16x16x32_bf16 v[16:19], v[160:163], v[128:131], v[16:19]
    ds_read_b64_tr_b16 v[204:205], v237 offset:49152
    v_mfma_f32_16x16x32_bf16 v[20:23], v[164:167], v[128:131], v[20:23]
    ds_read_b64_tr_b16 v[206:207], v237 offset:50688
    ds_read_b64_tr_b16 v[208:209], v238 offset:49152
    v_mfma_f32_16x16x32_bf16 v[32:35], v[144:147], v[132:135], v[32:35]
    ds_read_b64_tr_b16 v[210:211], v238 offset:50688
    ds_read_b64_tr_b16 v[212:213], v239 offset:49152
    v_mfma_f32_16x16x32_bf16 v[36:39], v[148:151], v[132:135], v[36:39]
    ds_read_b64_tr_b16 v[214:215], v239 offset:50688
    ds_read_b128 v[184:187], v225 offset:4096
    v_mfma_f32_16x16x32_bf16 v[40:43], v[152:155], v[132:135], v[40:43]
    ds_read_b128 v[188:191], v225 offset:5120
    s_mov_b32 s41, 0
    v_mfma_f32_16x16x32_bf16 v[44:47], v[156:159], v[132:135], v[44:47]
    s_add_u32 s30, s41, s42
    v_mfma_f32_16x16x32_bf16 v[48:51], v[160:163], v[132:135], v[48:51]
    s_and_b32 s30, s30, 3
    s_andn2_b32 s37, s41, 3
    v_mfma_f32_16x16x32_bf16 v[52:55], v[164:167], v[132:135], v[52:55]
    s_or_b32 s30, s30, s37
    s_add_u32 s41, s41, 1
    v_mfma_f32_16x16x32_bf16 v[64:67], v[144:147], v[136:139], v[64:67]
    s_mul_i32 s30, s30, s44
    s_lshl_b32 s30, s30, 1
    v_mfma_f32_16x16x32_bf16 v[68:71], v[148:151], v[136:139], v[68:71]
    s_add_u32 m0, s33, 32768
    s_nop 0
    v_mfma_f32_16x16x32_bf16 v[72:75], v[152:155], v[136:139], v[72:75]
    buffer_load_dwordx4 v248, s[8:11], s30 offen offset:0 lds
    v_mfma_f32_16x16x32_bf16 v[76:79], v[156:159], v[136:139], v[76:79]
    buffer_load_dwordx4 v249, s[8:11], s30 offen offset:1024 lds
    s_add_u32 s30, s30, s44
    v_mfma_f32_16x16x32_bf16 v[80:83], v[160:163], v[136:139], v[80:83]
    s_add_u32 s35, s27, s32
    s_add_u32 m0, s35, 0x800
    v_mfma_f32_16x16x32_bf16 v[84:87], v[164:167], v[136:139], v[84:87]
    s_add_u32 s27, s27, 0x8000
    buffer_load_dwordx4 v242, s[4:7], s31 offen offset:0 lds
    v_mfma_f32_16x16x32_bf16 v[96:99], v[144:147], v[140:143], v[96:99]
    buffer_load_dwordx4 v243, s[4:7], s31 offen offset:1024 lds
    s_cmp_ge_u32 s27, 0x28000
    v_mfma_f32_16x16x32_bf16 v[100:103], v[148:151], v[140:143], v[100:103]
    s_cselect_b32 s27, 0x10000, s27
    v_mfma_f32_16x16x32_bf16 v[104:107], v[152:155], v[140:143], v[104:107]
    s_add_u32 s36, s28, 0x8000
    s_cmp_ge_u32 s36, 0x18000
    v_mfma_f32_16x16x32_bf16 v[108:111], v[156:159], v[140:143], v[108:111]
    s_cselect_b32 s36, 0, s36
    s_sub_u32 s29, s36, s28
    v_mfma_f32_16x16x32_bf16 v[112:115], v[160:163], v[140:143], v[112:115]
    s_mov_b32 s28, s36
    v_add_u32 v224, s29, v224
    v_mfma_f32_16x16x32_bf16 v[116:119], v[164:167], v[140:143], v[116:119]
    v_add_u32 v225, s29, v225
    s_waitcnt vmcnt(8) lgkmcnt(0)
    s_barrier
    v_mfma_f32_16x16x32_bf16 v[0:3], v[192:195], v[176:179], v[0:3]
    ds_read_b128 v[128:131], v224 offset:0
    ds_read_b64_tr_b16 v[144:145], v234 offset:0
    v_mfma_f32_16x16x32_bf16 v[4:7], v[196:199], v[176:179], v[4:7]
    ds_read_b64_tr_b16 v[146:147], v234 offset:1536
    v_mfma_f32_16x16x32_bf16 v[8:11], v[200:203], v[176:179], v[8:11]
    ds_read_b64_tr_b16 v[148:149], v235 offset:0
    v_mfma_f32_16x16x32_bf16 v[12:15], v[204:207], v[176:179], v[12:15]
    ds_read_b64_tr_b16 v[150:151], v235 offset:1536
    v_mfma_f32_16x16x32_bf16 v[16:19], v[208:211], v[176:179], v[16:19]
    ds_read_b128 v[132:135], v224 offset:1024
    ds_read_b64_tr_b16 v[152:153], v236 offset:0
    v_mfma_f32_16x16x32_bf16 v[20:23], v[212:215], v[176:179], v[20:23]
    ds_read_b64_tr_b16 v[154:155], v236 offset:1536
    v_mfma_f32_16x16x32_bf16 v[32:35], v[192:195], v[180:183], v[32:35]
    ds_read_b64_tr_b16 v[156:157], v237 offset:0
    v_mfma_f32_16x16x32_bf16 v[36:39], v[196:199], v[180:183], v[36:39]
    ds_read_b64_tr_b16 v[158:159], v237 offset:1536
    v_mfma_f32_16x16x32_bf16 v[40:43], v[200:203], v[180:183], v[40:43]
    ds_read_b64_tr_b16 v[160:161], v238 offset:0
    v_mfma_f32_16x16x32_bf16 v[44:47], v[204:207], v[180:183], v[44:47]
    ds_read_b64_tr_b16 v[162:163], v238 offset:1536
    ds_read_b64_tr_b16 v[164:165], v239 offset:0
    v_mfma_f32_16x16x32_bf16 v[48:51], v[208:211], v[180:183], v[48:51]
    ds_read_b64_tr_b16 v[166:167], v239 offset:1536
    v_mfma_f32_16x16x32_bf16 v[52:55], v[212:215], v[180:183], v[52:55]
    ds_read_b128 v[136:139], v224 offset:4096
    v_mfma_f32_16x16x32_bf16 v[64:67], v[192:195], v[184:187], v[64:67]
    ds_read_b128 v[140:143], v224 offset:5120
    v_mfma_f32_16x16x32_bf16 v[68:71], v[196:199], v[184:187], v[68:71]
    s_add_u32 m0, s33, 49152
    v_mfma_f32_16x16x32_bf16 v[72:75], v[200:203], v[184:187], v[72:75]
    s_nop 0
    buffer_load_dwordx4 v248, s[8:11], s30 offen offset:0 lds
    v_mfma_f32_16x16x32_bf16 v[76:79], v[204:207], v[184:187], v[76:79]
    buffer_load_dwordx4 v249, s[8:11], s30 offen offset:1024 lds
    v_mfma_f32_16x16x32_bf16 v[80:83], v[208:211], v[184:187], v[80:83]
    s_add_u32 s31, s40, s42
    v_mfma_f32_16x16x32_bf16 v[84:87], v[212:215], v[184:187], v[84:87]
    s_and_b32 s31, s31, 3
    v_mfma_f32_16x16x32_bf16 v[96:99], v[192:195], v[188:191], v[96:99]
    s_andn2_b32 s37, s40, 3
    v_mfma_f32_16x16x32_bf16 v[100:103], v[196:199], v[188:191], v[100:103]
    s_or_b32 s31, s31, s37
    s_add_u32 s40, s40, 1
    v_mfma_f32_16x16x32_bf16 v[104:107], v[200:203], v[188:191], v[104:107]
    s_add_u32 m0, s27, s32
    v_mfma_f32_16x16x32_bf16 v[108:111], v[204:207], v[188:191], v[108:111]
    s_lshl_b32 s31, s31, 7
    v_mfma_f32_16x16x32_bf16 v[112:115], v[208:211], v[188:191], v[112:115]
    buffer_load_dwordx4 v240, s[4:7], s31 offen offset:0 lds
    v_mfma_f32_16x16x32_bf16 v[116:119], v[212:215], v[188:191], v[116:119]
    buffer_load_dwordx4 v241, s[4:7], s31 offen offset:1024 lds
    s_waitcnt vmcnt(10) lgkmcnt(0)
    s_barrier
    v_mfma_f32_16x16x32_bf16 v[0:3], v[144:147], v[128:131], v[0:3]
    ds_read_b128 v[176:179], v225 offset:0
    ds_read_b64_tr_b16 v[192:193], v234 offset:16384
    v_mfma_f32_16x16x32_bf16 v[4:7], v[148:151], v[128:131], v[4:7]
    ds_read_b64_tr_b16 v[194:195], v234 offset:17920
    ds_read_b64_tr_b16 v[196:197], v235 offset:16384
    v_mfma_f32_16x16x32_bf16 v[8:11], v[152:155], v[128:131], v[8:11]
    ds_read_b64_tr_b16 v[198:199], v235 offset:17920
    ds_read_b128 v[180:183], v225 offset:1024
    v_mfma_f32_16x16x32_bf16 v[12:15], v[156:159], v[128:131], v[12:15]
    ds_read_b64_tr_b16 v[200:201], v236 offset:16384
    v_mfma_f32_16x16x32_bf16 v[16:19], v[160:163], v[128:131], v[16:19]
    ds_read_b64_tr_b16 v[202:203], v236 offset:17920
    ds_read_b64_tr_b16 v[204:205], v237 offset:16384
    v_mfma_f32_16x16x32_bf16 v[20:23], v[164:167], v[128:131], v[20:23]
    ds_read_b64_tr_b16 v[206:207], v237 offset:17920
    ds_read_b64_tr_b16 v[208:209], v238 offset:16384
    v_mfma_f32_16x16x32_bf16 v[32:35], v[144:147], v[132:135], v[32:35]
    ds_read_b64_tr_b16 v[210:211], v238 offset:17920
    ds_read_b64_tr_b16 v[212:213], v239 offset:16384
    v_mfma_f32_16x16x32_bf16 v[36:39], v[148:151], v[132:135], v[36:39]
    ds_read_b64_tr_b16 v[214:215], v239 offset:17920
    v_mfma_f32_16x16x32_bf16 v[40:43], v[152:155], v[132:135], v[40:43]
    ds_read_b128 v[184:187], v225 offset:4096
    ds_read_b128 v[188:191], v225 offset:5120
    v_mfma_f32_16x16x32_bf16 v[44:47], v[156:159], v[132:135], v[44:47]
    s_add_u32 s30, s41, s42
    s_and_b32 s30, s30, 3
    v_mfma_f32_16x16x32_bf16 v[48:51], v[160:163], v[132:135], v[48:51]
    s_andn2_b32 s37, s41, 3
    s_or_b32 s30, s30, s37
    v_mfma_f32_16x16x32_bf16 v[52:55], v[164:167], v[132:135], v[52:55]
    s_add_u32 s41, s41, 1
    v_mfma_f32_16x16x32_bf16 v[64:67], v[144:147], v[136:139], v[64:67]
    s_mul_i32 s30, s30, s44
    s_lshl_b32 s30, s30, 1
    v_mfma_f32_16x16x32_bf16 v[68:71], v[148:151], v[136:139], v[68:71]
    s_add_u32 m0, s33, 0
    s_nop 0
    v_mfma_f32_16x16x32_bf16 v[72:75], v[152:155], v[136:139], v[72:75]
    buffer_load_dwordx4 v248, s[8:11], s30 offen offset:0 lds
    buffer_load_dwordx4 v249, s[8:11], s30 offen offset:1024 lds
    v_mfma_f32_16x16x32_bf16 v[76:79], v[156:159], v[136:139], v[76:79]
    s_add_u32 s30, s30, s44
    v_mfma_f32_16x16x32_bf16 v[80:83], v[160:163], v[136:139], v[80:83]
    s_add_u32 s35, s27, s32
    s_add_u32 m0, s35, 0x800
    v_mfma_f32_16x16x32_bf16 v[84:87], v[164:167], v[136:139], v[84:87]
    s_add_u32 s27, s27, 0x8000
    buffer_load_dwordx4 v242, s[4:7], s31 offen offset:0 lds
    v_mfma_f32_16x16x32_bf16 v[96:99], v[144:147], v[140:143], v[96:99]
    buffer_load_dwordx4 v243, s[4:7], s31 offen offset:1024 lds
    s_cmp_ge_u32 s27, 0x28000
    v_mfma_f32_16x16x32_bf16 v[100:103], v[148:151], v[140:143], v[100:103]
    s_cselect_b32 s27, 0x10000, s27
    v_mfma_f32_16x16x32_bf16 v[104:107], v[152:155], v[140:143], v[104:107]
    s_add_u32 s36, s28, 0x8000
    s_cmp_ge_u32 s36, 0x18000
    v_mfma_f32_16x16x32_bf16 v[108:111], v[156:159], v[140:143], v[108:111]
    s_cselect_b32 s36, 0, s36
    s_sub_u32 s29, s36, s28
    v_mfma_f32_16x16x32_bf16 v[112:115], v[160:163], v[140:143], v[112:115]
    s_mov_b32 s28, s36
    v_add_u32 v224, s29, v224
    v_mfma_f32_16x16x32_bf16 v[116:119], v[164:167], v[140:143], v[116:119]
    v_add_u32 v225, s29, v225
    s_waitcnt vmcnt(8) lgkmcnt(0)
    s_barrier
    v_mfma_f32_16x16x32_bf16 v[0:3], v[192:195], v[176:179], v[0:3]
    ds_read_b128 v[128:131], v224 offset:0
    ds_read_b64_tr_b16 v[144:145], v226 offset:32768
    v_mfma_f32_16x16x32_bf16 v[4:7], v[196:199], v[176:179], v[4:7]
    ds_read_b64_tr_b16 v[146:147], v226 offset:34816
    v_mfma_f32_16x16x32_bf16 v[8:11], v[200:203], v[176:179], v[8:11]
    ds_read_b64_tr_b16 v[148:149], v227 offset:32768
    ds_read_b64_tr_b16 v[150:151], v227 offset:34816
    v_mfma_f32_16x16x32_bf16 v[12:15], v[204:207], v[176:179], v[12:15]
    ds_read_b128 v[132:135], v224 offset:1024
    v_mfma_f32_16x16x32_bf16 v[16:19], v[208:211], v[176:179], v[16:19]
    ds_read_b64_tr_b16 v[152:153], v228 offset:32768
    v_mfma_f32_16x16x32_bf16 v[20:23], v[212:215], v[176:179], v[20:23]
    ds_read_b64_tr_b16 v[154:155], v228 offset:34816
    ds_read_b64_tr_b16 v[156:157], v229 offset:32768
    v_mfma_f32_16x16x32_bf16 v[32:35], v[192:195], v[180:183], v[32:35]
    ds_read_b64_tr_b16 v[158:159], v229 offset:34816
    v_mfma_f32_16x16x32_bf16 v[36:39], v[196:199], v[180:183], v[36:39]
    ds_read_b64_tr_b16 v[160:161], v230 offset:32768
    v_mfma_f32_16x16x32_bf16 v[40:43], v[200:203], v[180:183], v[40:43]
    ds_read_b64_tr_b16 v[162:163], v230 offset:34816
    ds_read_b64_tr_b16 v[164:165], v231 offset:32768
    v_mfma_f32_16x16x32_bf16 v[44:47], v[204:207], v[180:183], v[44:47]
    ds_read_b64_tr_b16 v[166:167], v231 offset:34816
    v_mfma_f32_16x16x32_bf16 v[48:51], v[208:211], v[180:183], v[48:51]
    ds_read_b64_tr_b16 v[168:169], v232 offset:32768
    ds_read_b64_tr_b16 v[170:171], v232 offset:34816
    v_mfma_f32_16x16x32_bf16 v[52:55], v[212:215], v[180:183], v[52:55]
    ds_read_b64_tr_b16 v[172:173], v233 offset:32768
    v_mfma_f32_16x16x32_bf16 v[64:67], v[192:195], v[184:187], v[64:67]
    ds_read_b64_tr_b16 v[174:175], v233 offset:34816
    v_mfma_f32_16x16x32_bf16 v[68:71], v[196:199], v[184:187], v[68:71]
    ds_read_b128 v[136:139], v224 offset:4096
    ds_read_b128 v[140:143], v224 offset:5120
    v_mfma_f32_16x16x32_bf16 v[72:75], v[200:203], v[184:187], v[72:75]
    s_add_u32 m0, s33, 16384
    v_mfma_f32_16x16x32_bf16 v[76:79], v[204:207], v[184:187], v[76:79]
    s_nop 0
    v_mfma_f32_16x16x32_bf16 v[80:83], v[208:211], v[184:187], v[80:83]
    buffer_load_dwordx4 v248, s[8:11], s30 offen offset:0 lds
    buffer_load_dwordx4 v249, s[8:11], s30 offen offset:1024 lds
    v_mfma_f32_16x16x32_bf16 v[84:87], v[212:215], v[184:187], v[84:87]
    s_add_u32 s31, s40, s42
    v_mfma_f32_16x16x32_bf16 v[96:99], v[192:195], v[188:191], v[96:99]
    s_and_b32 s31, s31, 3
    s_andn2_b32 s37, s40, 3
    v_mfma_f32_16x16x32_bf16 v[100:103], v[196:199], v[188:191], v[100:103]
    s_or_b32 s31, s31, s37
    v_mfma_f32_16x16x32_bf16 v[104:107], v[200:203], v[188:191], v[104:107]
    s_add_u32 s40, s40, 1
    v_mfma_f32_16x16x32_bf16 v[108:111], v[204:207], v[188:191], v[108:111]
    s_add_u32 m0, s27, s32
    s_lshl_b32 s31, s31, 7
    v_mfma_f32_16x16x32_bf16 v[112:115], v[208:211], v[188:191], v[112:115]
    buffer_load_dwordx4 v240, s[4:7], s31 offen offset:0 lds
    v_mfma_f32_16x16x32_bf16 v[116:119], v[212:215], v[188:191], v[116:119]
    buffer_load_dwordx4 v241, s[4:7], s31 offen offset:1024 lds
    s_nop 7
    s_lshl_b32 s38, s51, 3
    s_lshl_b32 s36, s25, 1
    s_add_u32 s38, s38, s36
    s_mul_i32 s35, s26, 3
    s_add_u32 s35, s35, s68
    s_add_u32 s35, s35, 0
    s_cmp_lg_u32 s71, 0
    s_cbranch_scc1 K1_E_25
    s_lshr_b32 s36, s35, 3
    s_lshl_b32 s36, s36, 20
    s_and_b32 s37, s35, 7
    s_lshl_b32 s37, s37, 11
    s_add_u32 s39, s36, s37
    s_lshl_b32 s36, s38, 14
    s_add_u32 s39, s39, s36
    s_add_u32 s39, s39, 0x2000000
    s_cmp_ge_u32 s35, 128
    s_cselect_b32 s39, 0x7ff00000, s39
    s_cmp_lg_u32 s94, 0
    s_cselect_b32 s39, 0x7ff00000, s39
    v_cvt_pk_bf16_f32 v176, v0, v1
    v_cvt_pk_bf16_f32 v177, v2, v3
    v_cvt_pk_bf16_f32 v178, v4, v5
    v_cvt_pk_bf16_f32 v179, v6, v7
    buffer_store_dwordx4 v[176:179], v252, s[20:23], s39 offen offset:0 sc1
    v_cvt_pk_bf16_f32 v180, v32, v33
    v_cvt_pk_bf16_f32 v181, v34, v35
    v_cvt_pk_bf16_f32 v182, v36, v37
    v_cvt_pk_bf16_f32 v183, v38, v39
    buffer_store_dwordx4 v[180:183], v252, s[20:23], s39 offen offset:128 sc1
    s_add_u32 s39, s39, 16384
    v_cvt_pk_bf16_f32 v184, v64, v65
    v_cvt_pk_bf16_f32 v185, v66, v67
    v_cvt_pk_bf16_f32 v186, v68, v69
    v_cvt_pk_bf16_f32 v187, v70, v71
    buffer_store_dwordx4 v[184:187], v252, s[20:23], s39 offen offset:0 sc1
    v_cvt_pk_bf16_f32 v188, v96, v97
    v_cvt_pk_bf16_f32 v189, v98, v99
    v_cvt_pk_bf16_f32 v190, v100, v101
    v_cvt_pk_bf16_f32 v191, v102, v103
    buffer_store_dwordx4 v[188:191], v252, s[20:23], s39 offen offset:128 sc1
    s_add_u32 s39, s39, 16384
    s_branch K1_E_28
K1_E_25:
    s_and_b32 s36, s35, 15
    s_lshl_b32 s36, s36, 6
    s_add_u32 s36, s36, s38
    s_lshr_b32 s37, s35, 4
    s_cmp_eq_u32 s37, 1
    s_cbranch_scc1 K1_E_26
    s_cmp_eq_u32 s37, 2
    s_cbranch_scc1 K1_E_27
    s_lshl_b32 s39, s36, 11
    s_add_u32 s39, s39, 0x3000000
    v_mul_f32 v0, s95, v0
    v_mul_f32 v4, s95, v4
    v_mul_f32 v1, s95, v1
    v_mul_f32 v5, s95, v5
    v_mul_f32 v2, s95, v2
    v_mul_f32 v6, s95, v6
    v_mul_f32 v3, s95, v3
    v_mul_f32 v7, s95, v7
    s_mov_b32 exec_lo, 0
    s_mov_b32 exec_hi, 0xffff0000
    v_mov_b32 v4, 0
    v_mov_b32 v5, 0
    v_mov_b32 v6, 0
    v_mov_b32 v7, 0
    s_mov_b64 exec, -1
    v_cvt_pk_bf16_f32 v176, v0, v1
    v_cvt_pk_bf16_f32 v177, v2, v3
    v_cvt_pk_bf16_f32 v178, v4, v5
    v_cvt_pk_bf16_f32 v179, v6, v7
    buffer_store_dwordx4 v[176:179], v252, s[20:23], s39 offen offset:0 sc1
    v_mul_f32 v32, s95, v32
    v_mul_f32 v36, s95, v36
    v_mul_f32 v33, s95, v33
    v_mul_f32 v37, s95, v37
    v_mul_f32 v34, s95, v34
    v_mul_f32 v38, s95, v38
    v_mul_f32 v35, s95, v35
    v_mul_f32 v39, s95, v39
    s_mov_b32 exec_lo, 0
    s_mov_b32 exec_hi, 0xffff0000
    v_mov_b32 v36, 0
    v_mov_b32 v37, 0
    v_mov_b32 v38, 0
    v_mov_b32 v39, 0
    s_mov_b64 exec, -1
    v_cvt_pk_bf16_f32 v180, v32, v33
    v_cvt_pk_bf16_f32 v181, v34, v35
    v_cvt_pk_bf16_f32 v182, v36, v37
    v_cvt_pk_bf16_f32 v183, v38, v39
    buffer_store_dwordx4 v[180:183], v252, s[20:23], s39 offen offset:128 sc1
    v_mul_f32 v64, s95, v64
    v_mul_f32 v68, s95, v68
    v_mul_f32 v65, s95, v65
    v_mul_f32 v69, s95, v69
    v_mul_f32 v66, s95, v66
    v_mul_f32 v70, s95, v70
    v_mul_f32 v67, s95, v67
    v_mul_f32 v71, s95, v71
    s_mov_b32 exec_lo, 0
    s_mov_b32 exec_hi, 0xffff0000
    v_mov_b32 v68, 0
    v_mov_b32 v69, 0
    v_mov_b32 v70, 0
    v_mov_b32 v71, 0
    s_mov_b64 exec, -1
    v_cvt_pk_bf16_f32 v184, v64, v65
    v_cvt_pk_bf16_f32 v185, v66, v67
    v_cvt_pk_bf16_f32 v186, v68, v69
    v_cvt_pk_bf16_f32 v187, v70, v71
    buffer_store_dwordx4 v[184:187], v252, s[20:23], s39 offen offset:2048 sc1
    v_mul_f32 v96, s95, v96
    v_mul_f32 v100, s95, v100
    v_mul_f32 v97, s95, v97
    v_mul_f32 v101, s95, v101
    v_mul_f32 v98, s95, v98
    v_mul_f32 v102, s95, v102
    v_mul_f32 v99, s95, v99
    v_mul_f32 v103, s95, v103
    s_mov_b32 exec_lo, 0
    s_mov_b32 exec_hi, 0xffff0000
    v_mov_b32 v100, 0
    v_mov_b32 v101, 0
    v_mov_b32 v102, 0
    v_mov_b32 v103, 0
    s_mov_b64 exec, -1
    v_cvt_pk_bf16_f32 v188, v96, v97
    v_cvt_pk_bf16_f32 v189, v98, v99
    v_cvt_pk_bf16_f32 v190, v100, v101
    v_cvt_pk_bf16_f32 v191, v102, v103
    buffer_store_dwordx4 v[188:191], v252, s[20:23], s39 offen offset:2176 sc1
    s_branch K1_E_28
K1_E_26:
    s_lshl_b32 s39, s36, 12
    s_add_u32 s39, s39, 0x3200000
    s_mov_b32 exec_lo, 0
    s_mov_b32 exec_hi, 0xffff0000
    v_mov_b32 v4, 0
    v_mov_b32 v5, 0
    v_mov_b32 v6, 0
    v_mov_b32 v7, 0
    s_mov_b64 exec, -1
    v_cvt_pk_bf16_f32 v176, v0, v1
    v_cvt_pk_bf16_f32 v177, v2, v3
    v_cvt_pk_bf16_f32 v178, v4, v5
    v_cvt_pk_bf16_f32 v179, v6, v7
    buffer_store_dwordx4 v[176:179], v252, s[20:23], s39 offen offset:0 sc1
    s_mov_b32 exec_lo, 0
    s_mov_b32 exec_hi, 0xffff0000
    v_mov_b32 v36, 0
    v_mov_b32 v37, 0
    v_mov_b32 v38, 0
    v_mov_b32 v39, 0
    s_mov_b64 exec, -1
    v_cvt_pk_bf16_f32 v180, v32, v33
    v_cvt_pk_bf16_f32 v181, v34, v35
    v_cvt_pk_bf16_f32 v182, v36, v37
    v_cvt_pk_bf16_f32 v183, v38, v39
    buffer_store_dwordx4 v[180:183], v252, s[20:23], s39 offen offset:128 sc1
    s_add_u32 s39, s39, 4096
    s_mov_b32 exec_lo, 0
    s_mov_b32 exec_hi, 0xffff0000
    v_mov_b32 v68, 0
    v_mov_b32 v69, 0
    v_mov_b32 v70, 0
    v_mov_b32 v71, 0
    s_mov_b64 exec, -1
    v_cvt_pk_bf16_f32 v184, v64, v65
    v_cvt_pk_bf16_f32 v185, v66, v67
    v_cvt_pk_bf16_f32 v186, v68, v69
    v_cvt_pk_bf16_f32 v187, v70, v71
    buffer_store_dwordx4 v[184:187], v252, s[20:23], s39 offen offset:0 sc1
    s_mov_b32 exec_lo, 0
    s_mov_b32 exec_hi, 0xffff0000
    v_mov_b32 v100, 0
    v_mov_b32 v101, 0
    v_mov_b32 v102, 0
    v_mov_b32 v103, 0
    s_mov_b64 exec, -1
    v_cvt_pk_bf16_f32 v188, v96, v97
    v_cvt_pk_bf16_f32 v189, v98, v99
    v_cvt_pk_bf16_f32 v190, v100, v101
    v_cvt_pk_bf16_f32 v191, v102, v103
    buffer_store_dwordx4 v[188:191], v252, s[20:23], s39 offen offset:128 sc1
    s_add_u32 s39, s39, 4096
    s_branch K1_E_28
K1_E_27:
    s_lshl_b32 s39, s36, 12
    s_add_u32 s39, s39, 0x3200800
    v_bfe_u32 v254, v253, 3, 1
    v_and_b32 v255, 7, v253
    v_lshl_add_u32 v254, v254, 4, v255
    v_lshrrev_b32 v255, 4, v253
    v_lshlrev_b32 v255, 4, v255
    v_lshl_add_u32 v254, v254, 6, v255
    s_mov_b32 exec_lo, 0
    s_mov_b32 exec_hi, 0xffff0000
    v_mov_b32 v4, 1.0
    v_mov_b32 v5, 0
    v_mov_b32 v6, 0
    v_mov_b32 v7, 0
    s_mov_b64 exec, -1
    v_cvt_pk_bf16_f32 v176, v0, v1
    v_cvt_pk_bf16_f32 v177, v2, v3
    v_cvt_pk_bf16_f32 v178, v4, v5
    v_cvt_pk_bf16_f32 v179, v6, v7
    buffer_store_dwordx4 v[176:179], v254, s[20:23], s39 offen offset:0 sc1
    s_mov_b32 exec_lo, 0
    s_mov_b32 exec_hi, 0xffff0000
    v_mov_b32 v36, 1.0
    v_mov_b32 v37, 0
    v_mov_b32 v38, 0
    v_mov_b32 v39, 0
    s_mov_b64 exec, -1
    v_cvt_pk_bf16_f32 v180, v32, v33
    v_cvt_pk_bf16_f32 v181, v34, v35
    v_cvt_pk_bf16_f32 v182, v36, v37
    v_cvt_pk_bf16_f32 v183, v38, v39
    buffer_store_dwordx4 v[180:183], v254, s[20:23], s39 offen offset:512 sc1
    s_add_u32 s39, s39, 4096
    s_mov_b32 exec_lo, 0
    s_mov_b32 exec_hi, 0xffff0000
    v_mov_b32 v68, 1.0
    v_mov_b32 v69, 0
    v_mov_b32 v70, 0
    v_mov_b32 v71, 0
    s_mov_b64 exec, -1
    v_cvt_pk_bf16_f32 v184, v64, v65
    v_cvt_pk_bf16_f32 v185, v66, v67
    v_cvt_pk_bf16_f32 v186, v68, v69
    v_cvt_pk_bf16_f32 v187, v70, v71
    buffer_store_dwordx4 v[184:187], v254, s[20:23], s39 offen offset:0 sc1
    s_mov_b32 exec_lo, 0
    s_mov_b32 exec_hi, 0xffff0000
    v_mov_b32 v100, 1.0
    v_mov_b32 v101, 0
    v_mov_b32 v102, 0
    v_mov_b32 v103, 0
    s_mov_b64 exec, -1
    v_cvt_pk_bf16_f32 v188, v96, v97
    v_cvt_pk_bf16_f32 v189, v98, v99
    v_cvt_pk_bf16_f32 v190, v100, v101
    v_cvt_pk_bf16_f32 v191, v102, v103
    buffer_store_dwordx4 v[188:191], v254, s[20:23], s39 offen offset:512 sc1
    s_add_u32 s39, s39, 4096
K1_E_28:
    s_mul_i32 s35, s26, 3
    s_add_u32 s35, s35, s68
    s_add_u32 s35, s35, 1
    s_cmp_lg_u32 s71, 0
    s_cbranch_scc1 K1_E_29
    s_lshr_b32 s36, s35, 3
    s_lshl_b32 s36, s36, 20
    s_and_b32 s37, s35, 7
    s_lshl_b32 s37, s37, 11
    s_add_u32 s39, s36, s37
    s_lshl_b32 s36, s38, 14
    s_add_u32 s39, s39, s36
    s_add_u32 s39, s39, 0x2000000
    s_cmp_ge_u32 s35, 128
    s_cselect_b32 s39, 0x7ff00000, s39
    s_cmp_lg_u32 s94, 0
    s_cselect_b32 s39, 0x7ff00000, s39
    v_cvt_pk_bf16_f32 v192, v8, v9
    v_cvt_pk_bf16_f32 v193, v10, v11
    v_cvt_pk_bf16_f32 v194, v12, v13
    v_cvt_pk_bf16_f32 v195, v14, v15
    buffer_store_dwordx4 v[192:195], v252, s[20:23], s39 offen offset:0 sc1
    v_cvt_pk_bf16_f32 v196, v40, v41
    v_cvt_pk_bf16_f32 v197, v42, v43
    v_cvt_pk_bf16_f32 v198, v44, v45
    v_cvt_pk_bf16_f32 v199, v46, v47
    buffer_store_dwordx4 v[196:199], v252, s[20:23], s39 offen offset:128 sc1
    s_add_u32 s39, s39, 16384
    v_cvt_pk_bf16_f32 v200, v72, v73
    v_cvt_pk_bf16_f32 v201, v74, v75
    v_cvt_pk_bf16_f32 v202, v76, v77
    v_cvt_pk_bf16_f32 v203, v78, v79
    buffer_store_dwordx4 v[200:203], v252, s[20:23], s39 offen offset:0 sc1
    v_cvt_pk_bf16_f32 v204, v104, v105
    v_cvt_pk_bf16_f32 v205, v106, v107
    v_cvt_pk_bf16_f32 v206, v108, v109
    v_cvt_pk_bf16_f32 v207, v110, v111
    buffer_store_dwordx4 v[204:207], v252, s[20:23], s39 offen offset:128 sc1
    s_add_u32 s39, s39, 16384
    s_branch K1_E_32
K1_E_29:
    s_and_b32 s36, s35, 15
    s_lshl_b32 s36, s36, 6
    s_add_u32 s36, s36, s38
    s_lshr_b32 s37, s35, 4
    s_cmp_eq_u32 s37, 1
    s_cbranch_scc1 K1_E_30
    s_cmp_eq_u32 s37, 2
    s_cbranch_scc1 K1_E_31
    s_lshl_b32 s39, s36, 11
    s_add_u32 s39, s39, 0x3000000
    v_mul_f32 v8, s95, v8
    v_mul_f32 v12, s95, v12
    v_mul_f32 v9, s95, v9
    v_mul_f32 v13, s95, v13
    v_mul_f32 v10, s95, v10
    v_mul_f32 v14, s95, v14
    v_mul_f32 v11, s95, v11
    v_mul_f32 v15, s95, v15
    s_mov_b32 exec_lo, 0
    s_mov_b32 exec_hi, 0xffff0000
    v_mov_b32 v12, 0
    v_mov_b32 v13, 0
    v_mov_b32 v14, 0
    v_mov_b32 v15, 0
    s_mov_b64 exec, -1
    v_cvt_pk_bf16_f32 v192, v8, v9
    v_cvt_pk_bf16_f32 v193, v10, v11
    v_cvt_pk_bf16_f32 v194, v12, v13
    v_cvt_pk_bf16_f32 v195, v14, v15
    buffer_store_dwordx4 v[192:195], v252, s[20:23], s39 offen offset:0 sc1
    v_mul_f32 v40, s95, v40
    v_mul_f32 v44, s95, v44
    v_mul_f32 v41, s95, v41
    v_mul_f32 v45, s95, v45
    v_mul_f32 v42, s95, v42
    v_mul_f32 v46, s95, v46
    v_mul_f32 v43, s95, v43
    v_mul_f32 v47, s95, v47
    s_mov_b32 exec_lo, 0
    s_mov_b32 exec_hi, 0xffff0000
    v_mov_b32 v44, 0
    v_mov_b32 v45, 0
    v_mov_b32 v46, 0
    v_mov_b32 v47, 0
    s_mov_b64 exec, -1
    v_cvt_pk_bf16_f32 v196, v40, v41
    v_cvt_pk_bf16_f32 v197, v42, v43
    v_cvt_pk_bf16_f32 v198, v44, v45
    v_cvt_pk_bf16_f32 v199, v46, v47
    buffer_store_dwordx4 v[196:199], v252, s[20:23], s39 offen offset:128 sc1
    v_mul_f32 v72, s95, v72
    v_mul_f32 v76, s95, v76
    v_mul_f32 v73, s95, v73
    v_mul_f32 v77, s95, v77
    v_mul_f32 v74, s95, v74
    v_mul_f32 v78, s95, v78
    v_mul_f32 v75, s95, v75
    v_mul_f32 v79, s95, v79
    s_mov_b32 exec_lo, 0
    s_mov_b32 exec_hi, 0xffff0000
    v_mov_b32 v76, 0
    v_mov_b32 v77, 0
    v_mov_b32 v78, 0
    v_mov_b32 v79, 0
    s_mov_b64 exec, -1
    v_cvt_pk_bf16_f32 v200, v72, v73
    v_cvt_pk_bf16_f32 v201, v74, v75
    v_cvt_pk_bf16_f32 v202, v76, v77
    v_cvt_pk_bf16_f32 v203, v78, v79
    buffer_store_dwordx4 v[200:203], v252, s[20:23], s39 offen offset:2048 sc1
    v_mul_f32 v104, s95, v104
    v_mul_f32 v108, s95, v108
    v_mul_f32 v105, s95, v105
    v_mul_f32 v109, s95, v109
    v_mul_f32 v106, s95, v106
    v_mul_f32 v110, s95, v110
    v_mul_f32 v107, s95, v107
    v_mul_f32 v111, s95, v111
    s_mov_b32 exec_lo, 0
    s_mov_b32 exec_hi, 0xffff0000
    v_mov_b32 v108, 0
    v_mov_b32 v109, 0
    v_mov_b32 v110, 0
    v_mov_b32 v111, 0
    s_mov_b64 exec, -1
    v_cvt_pk_bf16_f32 v204, v104, v105
    v_cvt_pk_bf16_f32 v205, v106, v107
    v_cvt_pk_bf16_f32 v206, v108, v109
    v_cvt_pk_bf16_f32 v207, v110, v111
    buffer_store_dwordx4 v[204:207], v252, s[20:23], s39 offen offset:2176 sc1
    s_branch K1_E_32
K1_E_30:
    s_lshl_b32 s39, s36, 12
    s_add_u32 s39, s39, 0x3200000
    s_mov_b32 exec_lo, 0
    s_mov_b32 exec_hi, 0xffff0000
    v_mov_b32 v12, 0
    v_mov_b32 v13, 0
    v_mov_b32 v14, 0
    v_mov_b32 v15, 0
    s_mov_b64 exec, -1
    v_cvt_pk_bf16_f32 v192, v8, v9
    v_cvt_pk_bf16_f32 v193, v10, v11
    v_cvt_pk_bf16_f32 v194, v12, v13
    v_cvt_pk_bf16_f32 v195, v14, v15
    buffer_store_dwordx4 v[192:195], v252, s[20:23], s39 offen offset:0 sc1
    s_mov_b32 exec_lo, 0
    s_mov_b32 exec_hi, 0xffff0000
    v_mov_b32 v44, 0
    v_mov_b32 v45, 0
    v_mov_b32 v46, 0
    v_mov_b32 v47, 0
    s_mov_b64 exec, -1
    v_cvt_pk_bf16_f32 v196, v40, v41
    v_cvt_pk_bf16_f32 v197, v42, v43
    v_cvt_pk_bf16_f32 v198, v44, v45
    v_cvt_pk_bf16_f32 v199, v46, v47
    buffer_store_dwordx4 v[196:199], v252, s[20:23], s39 offen offset:128 sc1
    s_add_u32 s39, s39, 4096
    s_mov_b32 exec_lo, 0
    s_mov_b32 exec_hi, 0xffff0000
    v_mov_b32 v76, 0
    v_mov_b32 v77, 0
    v_mov_b32 v78, 0
    v_mov_b32 v79, 0
    s_mov_b64 exec, -1
    v_cvt_pk_bf16_f32 v200, v72, v73
    v_cvt_pk_bf16_f32 v201, v74, v75
    v_cvt_pk_bf16_f32 v202, v76, v77
    v_cvt_pk_bf16_f32 v203, v78, v79
    buffer_store_dwordx4 v[200:203], v252, s[20:23], s39 offen offset:0 sc1
    s_mov_b32 exec_lo, 0
    s_mov_b32 exec_hi, 0xffff0000
    v_mov_b32 v108, 0
    v_mov_b32 v109, 0
    v_mov_b32 v110, 0
    v_mov_b32 v111, 0
    s_mov_b64 exec, -1
    v_cvt_pk_bf16_f32 v204, v104, v105
    v_cvt_pk_bf16_f32 v205, v106, v107
    v_cvt_pk_bf16_f32 v206, v108, v109
    v_cvt_pk_bf16_f32 v207, v110, v111
    buffer_store_dwordx4 v[204:207], v252, s[20:23], s39 offen offset:128 sc1
    s_add_u32 s39, s39, 4096
    s_branch K1_E_32
K1_E_31:
    s_lshl_b32 s39, s36, 12
    s_add_u32 s39, s39, 0x3200800
    v_bfe_u32 v254, v253, 3, 1
    v_and_b32 v255, 7, v253
    v_lshl_add_u32 v254, v254, 4, v255
    v_lshrrev_b32 v255, 4, v253
    v_lshlrev_b32 v255, 4, v255
    v_lshl_add_u32 v254, v254, 6, v255
    s_mov_b32 exec_lo, 0
    s_mov_b32 exec_hi, 0xffff0000
    v_mov_b32 v12, 1.0
    v_mov_b32 v13, 0
    v_mov_b32 v14, 0
    v_mov_b32 v15, 0
    s_mov_b64 exec, -1
    v_cvt_pk_bf16_f32 v192, v8, v9
    v_cvt_pk_bf16_f32 v193, v10, v11
    v_cvt_pk_bf16_f32 v194, v12, v13
    v_cvt_pk_bf16_f32 v195, v14, v15
    buffer_store_dwordx4 v[192:195], v254, s[20:23], s39 offen offset:0 sc1
    s_mov_b32 exec_lo, 0
    s_mov_b32 exec_hi, 0xffff0000
    v_mov_b32 v44, 1.0
    v_mov_b32 v45, 0
    v_mov_b32 v46, 0
    v_mov_b32 v47, 0
    s_mov_b64 exec, -1
    v_cvt_pk_bf16_f32 v196, v40, v41
    v_cvt_pk_bf16_f32 v197, v42, v43
    v_cvt_pk_bf16_f32 v198, v44, v45
    v_cvt_pk_bf16_f32 v199, v46, v47
    buffer_store_dwordx4 v[196:199], v254, s[20:23], s39 offen offset:512 sc1
    s_add_u32 s39, s39, 4096
    s_mov_b32 exec_lo, 0
    s_mov_b32 exec_hi, 0xffff0000
    v_mov_b32 v76, 1.0
    v_mov_b32 v77, 0
    v_mov_b32 v78, 0
    v_mov_b32 v79, 0
    s_mov_b64 exec, -1
    v_cvt_pk_bf16_f32 v200, v72, v73
    v_cvt_pk_bf16_f32 v201, v74, v75
    v_cvt_pk_bf16_f32 v202, v76, v77
    v_cvt_pk_bf16_f32 v203, v78, v79
    buffer_store_dwordx4 v[200:203], v254, s[20:23], s39 offen offset:0 sc1
    s_mov_b32 exec_lo, 0
    s_mov_b32 exec_hi, 0xffff0000
    v_mov_b32 v108, 1.0
    v_mov_b32 v109, 0
    v_mov_b32 v110, 0
    v_mov_b32 v111, 0
    s_mov_b64 exec, -1
    v_cvt_pk_bf16_f32 v204, v104, v105
    v_cvt_pk_bf16_f32 v205, v106, v107
    v_cvt_pk_bf16_f32 v206, v108, v109
    v_cvt_pk_bf16_f32 v207, v110, v111
    buffer_store_dwordx4 v[204:207], v254, s[20:23], s39 offen offset:512 sc1
    s_add_u32 s39, s39, 4096
K1_E_32:
    s_mul_i32 s35, s26, 3
    s_add_u32 s35, s35, s68
    s_add_u32 s35, s35, 2
    s_cmp_lg_u32 s71, 0
    s_cbranch_scc1 K1_E_33
    s_lshr_b32 s36, s35, 3
    s_lshl_b32 s36, s36, 20
    s_and_b32 s37, s35, 7
    s_lshl_b32 s37, s37, 11
    s_add_u32 s39, s36, s37
    s_lshl_b32 s36, s38, 14
    s_add_u32 s39, s39, s36
    s_add_u32 s39, s39, 0x2000000
    s_cmp_ge_u32 s35, 128
    s_cselect_b32 s39, 0x7ff00000, s39
    s_cmp_lg_u32 s94, 0
    s_cselect_b32 s39, 0x7ff00000, s39
    v_cvt_pk_bf16_f32 v208, v16, v17
    v_cvt_pk_bf16_f32 v209, v18, v19
    v_cvt_pk_bf16_f32 v210, v20, v21
    v_cvt_pk_bf16_f32 v211, v22, v23
    buffer_store_dwordx4 v[208:211], v252, s[20:23], s39 offen offset:0 sc1
    v_cvt_pk_bf16_f32 v212, v48, v49
    v_cvt_pk_bf16_f32 v213, v50, v51
    v_cvt_pk_bf16_f32 v214, v52, v53
    v_cvt_pk_bf16_f32 v215, v54, v55
    buffer_store_dwordx4 v[212:215], v252, s[20:23], s39 offen offset:128 sc1
    s_add_u32 s39, s39, 16384
    v_cvt_pk_bf16_f32 v216, v80, v81
    v_cvt_pk_bf16_f32 v217, v82, v83
    v_cvt_pk_bf16_f32 v218, v84, v85
    v_cvt_pk_bf16_f32 v219, v86, v87
    buffer_store_dwordx4 v[216:219], v252, s[20:23], s39 offen offset:0 sc1
    v_cvt_pk_bf16_f32 v220, v112, v113
    v_cvt_pk_bf16_f32 v221, v114, v115
    v_cvt_pk_bf16_f32 v222, v116, v117
    v_cvt_pk_bf16_f32 v223, v118, v119
    buffer_store_dwordx4 v[220:223], v252, s[20:23], s39 offen offset:128 sc1
    s_add_u32 s39, s39, 16384
    s_branch K1_E_36
K1_E_33:
    s_and_b32 s36, s35, 15
    s_lshl_b32 s36, s36, 6
    s_add_u32 s36, s36, s38
    s_lshr_b32 s37, s35, 4
    s_cmp_eq_u32 s37, 1
    s_cbranch_scc1 K1_E_34
    s_cmp_eq_u32 s37, 2
    s_cbranch_scc1 K1_E_35
    s_lshl_b32 s39, s36, 11
    s_add_u32 s39, s39, 0x3000000
    v_mul_f32 v16, s95, v16
    v_mul_f32 v20, s95, v20
    v_mul_f32 v17, s95, v17
    v_mul_f32 v21, s95, v21
    v_mul_f32 v18, s95, v18
    v_mul_f32 v22, s95, v22
    v_mul_f32 v19, s95, v19
    v_mul_f32 v23, s95, v23
    s_mov_b32 exec_lo, 0
    s_mov_b32 exec_hi, 0xffff0000
    v_mov_b32 v20, 0
    v_mov_b32 v21, 0
    v_mov_b32 v22, 0
    v_mov_b32 v23, 0
    s_mov_b64 exec, -1
    v_cvt_pk_bf16_f32 v208, v16, v17
    v_cvt_pk_bf16_f32 v209, v18, v19
    v_cvt_pk_bf16_f32 v210, v20, v21
    v_cvt_pk_bf16_f32 v211, v22, v23
    buffer_store_dwordx4 v[208:211], v252, s[20:23], s39 offen offset:0 sc1
    v_mul_f32 v48, s95, v48
    v_mul_f32 v52, s95, v52
    v_mul_f32 v49, s95, v49
    v_mul_f32 v53, s95, v53
    v_mul_f32 v50, s95, v50
    v_mul_f32 v54, s95, v54
    v_mul_f32 v51, s95, v51
    v_mul_f32 v55, s95, v55
    s_mov_b32 exec_lo, 0
    s_mov_b32 exec_hi, 0xffff0000
    v_mov_b32 v52, 0
    v_mov_b32 v53, 0
    v_mov_b32 v54, 0
    v_mov_b32 v55, 0
    s_mov_b64 exec, -1
    v_cvt_pk_bf16_f32 v212, v48, v49
    v_cvt_pk_bf16_f32 v213, v50, v51
    v_cvt_pk_bf16_f32 v214, v52, v53
    v_cvt_pk_bf16_f32 v215, v54, v55
    buffer_store_dwordx4 v[212:215], v252, s[20:23], s39 offen offset:128 sc1
    v_mul_f32 v80, s95, v80
    v_mul_f32 v84, s95, v84
    v_mul_f32 v81, s95, v81
    v_mul_f32 v85, s95, v85
    v_mul_f32 v82, s95, v82
    v_mul_f32 v86, s95, v86
    v_mul_f32 v83, s95, v83
    v_mul_f32 v87, s95, v87
    s_mov_b32 exec_lo, 0
    s_mov_b32 exec_hi, 0xffff0000
    v_mov_b32 v84, 0
    v_mov_b32 v85, 0
    v_mov_b32 v86, 0
    v_mov_b32 v87, 0
    s_mov_b64 exec, -1
    v_cvt_pk_bf16_f32 v216, v80, v81
    v_cvt_pk_bf16_f32 v217, v82, v83
    v_cvt_pk_bf16_f32 v218, v84, v85
    v_cvt_pk_bf16_f32 v219, v86, v87
    buffer_store_dwordx4 v[216:219], v252, s[20:23], s39 offen offset:2048 sc1
    v_mul_f32 v112, s95, v112
    v_mul_f32 v116, s95, v116
    v_mul_f32 v113, s95, v113
    v_mul_f32 v117, s95, v117
    v_mul_f32 v114, s95, v114
    v_mul_f32 v118, s95, v118
    v_mul_f32 v115, s95, v115
    v_mul_f32 v119, s95, v119
    s_mov_b32 exec_lo, 0
    s_mov_b32 exec_hi, 0xffff0000
    v_mov_b32 v116, 0
    v_mov_b32 v117, 0
    v_mov_b32 v118, 0
    v_mov_b32 v119, 0
    s_mov_b64 exec, -1
    v_cvt_pk_bf16_f32 v220, v112, v113
    v_cvt_pk_bf16_f32 v221, v114, v115
    v_cvt_pk_bf16_f32 v222, v116, v117
    v_cvt_pk_bf16_f32 v223, v118, v119
    buffer_store_dwordx4 v[220:223], v252, s[20:23], s39 offen offset:2176 sc1
    s_branch K1_E_36
K1_E_34:
    s_lshl_b32 s39, s36, 12
    s_add_u32 s39, s39, 0x3200000
    s_mov_b32 exec_lo, 0
    s_mov_b32 exec_hi, 0xffff0000
    v_mov_b32 v20, 0
    v_mov_b32 v21, 0
    v_mov_b32 v22, 0
    v_mov_b32 v23, 0
    s_mov_b64 exec, -1
    v_cvt_pk_bf16_f32 v208, v16, v17
    v_cvt_pk_bf16_f32 v209, v18, v19
    v_cvt_pk_bf16_f32 v210, v20, v21
    v_cvt_pk_bf16_f32 v211, v22, v23
    buffer_store_dwordx4 v[208:211], v252, s[20:23], s39 offen offset:0 sc1
    s_mov_b32 exec_lo, 0
    s_mov_b32 exec_hi, 0xffff0000
    v_mov_b32 v52, 0
    v_mov_b32 v53, 0
    v_mov_b32 v54, 0
    v_mov_b32 v55, 0
    s_mov_b64 exec, -1
    v_cvt_pk_bf16_f32 v212, v48, v49
    v_cvt_pk_bf16_f32 v213, v50, v51
    v_cvt_pk_bf16_f32 v214, v52, v53
    v_cvt_pk_bf16_f32 v215, v54, v55
    buffer_store_dwordx4 v[212:215], v252, s[20:23], s39 offen offset:128 sc1
    s_add_u32 s39, s39, 4096
    s_mov_b32 exec_lo, 0
    s_mov_b32 exec_hi, 0xffff0000
    v_mov_b32 v84, 0
    v_mov_b32 v85, 0
    v_mov_b32 v86, 0
    v_mov_b32 v87, 0
    s_mov_b64 exec, -1
    v_cvt_pk_bf16_f32 v216, v80, v81
    v_cvt_pk_bf16_f32 v217, v82, v83
    v_cvt_pk_bf16_f32 v218, v84, v85
    v_cvt_pk_bf16_f32 v219, v86, v87
    buffer_store_dwordx4 v[216:219], v252, s[20:23], s39 offen offset:0 sc1
    s_mov_b32 exec_lo, 0
    s_mov_b32 exec_hi, 0xffff0000
    v_mov_b32 v116, 0
    v_mov_b32 v117, 0
    v_mov_b32 v118, 0
    v_mov_b32 v119, 0
    s_mov_b64 exec, -1
    v_cvt_pk_bf16_f32 v220, v112, v113
    v_cvt_pk_bf16_f32 v221, v114, v115
    v_cvt_pk_bf16_f32 v222, v116, v117
    v_cvt_pk_bf16_f32 v223, v118, v119
    buffer_store_dwordx4 v[220:223], v252, s[20:23], s39 offen offset:128 sc1
    s_add_u32 s39, s39, 4096
    s_branch K1_E_36
K1_E_35:
    s_lshl_b32 s39, s36, 12
    s_add_u32 s39, s39, 0x3200800
    v_bfe_u32 v254, v253, 3, 1
    v_and_b32 v255, 7, v253
    v_lshl_add_u32 v254, v254, 4, v255
    v_lshrrev_b32 v255, 4, v253
    v_lshlrev_b32 v255, 4, v255
    v_lshl_add_u32 v254, v254, 6, v255
    s_mov_b32 exec_lo, 0
    s_mov_b32 exec_hi, 0xffff0000
    v_mov_b32 v20, 1.0
    v_mov_b32 v21, 0
    v_mov_b32 v22, 0
    v_mov_b32 v23, 0
    s_mov_b64 exec, -1
    v_cvt_pk_bf16_f32 v208, v16, v17
    v_cvt_pk_bf16_f32 v209, v18, v19
    v_cvt_pk_bf16_f32 v210, v20, v21
    v_cvt_pk_bf16_f32 v211, v22, v23
    buffer_store_dwordx4 v[208:211], v254, s[20:23], s39 offen offset:0 sc1
    s_mov_b32 exec_lo, 0
    s_mov_b32 exec_hi, 0xffff0000
    v_mov_b32 v52, 1.0
    v_mov_b32 v53, 0
    v_mov_b32 v54, 0
    v_mov_b32 v55, 0
    s_mov_b64 exec, -1
    v_cvt_pk_bf16_f32 v212, v48, v49
    v_cvt_pk_bf16_f32 v213, v50, v51
    v_cvt_pk_bf16_f32 v214, v52, v53
    v_cvt_pk_bf16_f32 v215, v54, v55
    buffer_store_dwordx4 v[212:215], v254, s[20:23], s39 offen offset:512 sc1
    s_add_u32 s39, s39, 4096
    s_mov_b32 exec_lo, 0
    s_mov_b32 exec_hi, 0xffff0000
    v_mov_b32 v84, 1.0
    v_mov_b32 v85, 0
    v_mov_b32 v86, 0
    v_mov_b32 v87, 0
    s_mov_b64 exec, -1
    v_cvt_pk_bf16_f32 v216, v80, v81
    v_cvt_pk_bf16_f32 v217, v82, v83
    v_cvt_pk_bf16_f32 v218, v84, v85
    v_cvt_pk_bf16_f32 v219, v86, v87
    buffer_store_dwordx4 v[216:219], v254, s[20:23], s39 offen offset:0 sc1
    s_mov_b32 exec_lo, 0
    s_mov_b32 exec_hi, 0xffff0000
    v_mov_b32 v116, 1.0
    v_mov_b32 v117, 0
    v_mov_b32 v118, 0
    v_mov_b32 v119, 0
    s_mov_b64 exec, -1
    v_cvt_pk_bf16_f32 v220, v112, v113
    v_cvt_pk_bf16_f32 v221, v114, v115
    v_cvt_pk_bf16_f32 v222, v116, v117
    v_cvt_pk_bf16_f32 v223, v118, v119
    buffer_store_dwordx4 v[220:223], v254, s[20:23], s39 offen offset:512 sc1
    s_add_u32 s39, s39, 4096
K1_E_36:
    s_waitcnt vmcnt(22) lgkmcnt(0)
    s_barrier
    v_mfma_f32_16x16x32_bf16 v[0:3], v[144:147], v[128:131], 0
    ds_read_b128 v[176:179], v225 offset:0
    ds_read_b64_tr_b16 v[192:193], v226 offset:49152
    v_mfma_f32_16x16x32_bf16 v[4:7], v[148:151], v[128:131], 0
    ds_read_b64_tr_b16 v[194:195], v226 offset:51200
    v_mfma_f32_16x16x32_bf16 v[8:11], v[152:155], v[128:131], 0
    ds_read_b64_tr_b16 v[196:197], v227 offset:49152
    ds_read_b64_tr_b16 v[198:199], v227 offset:51200
    v_mfma_f32_16x16x32_bf16 v[12:15], v[156:159], v[128:131], 0
    ds_read_b128 v[180:183], v225 offset:1024
    v_mfma_f32_16x16x32_bf16 v[16:19], v[160:163], v[128:131], 0
    ds_read_b64_tr_b16 v[200:201], v228 offset:49152
    ds_read_b64_tr_b16 v[202:203], v228 offset:51200
    v_mfma_f32_16x16x32_bf16 v[20:23], v[164:167], v[128:131], 0
    ds_read_b64_tr_b16 v[204:205], v229 offset:49152
    v_mfma_f32_16x16x32_bf16 v[24:27], v[168:171], v[128:131], 0
    ds_read_b64_tr_b16 v[206:207], v229 offset:51200
    ds_read_b64_tr_b16 v[208:209], v230 offset:49152
    v_mfma_f32_16x16x32_bf16 v[28:31], v[172:175], v[128:131], 0
    ds_read_b64_tr_b16 v[210:211], v230 offset:51200
    v_mfma_f32_16x16x32_bf16 v[32:35], v[144:147], v[132:135], 0
    ds_read_b64_tr_b16 v[212:213], v231 offset:49152
    v_mfma_f32_16x16x32_bf16 v[36:39], v[148:151], v[132:135], 0
    ds_read_b64_tr_b16 v[214:215], v231 offset:51200
    ds_read_b64_tr_b16 v[216:217], v232 offset:49152
    v_mfma_f32_16x16x32_bf16 v[40:43], v[152:155], v[132:135], 0
    ds_read_b64_tr_b16 v[218:219], v232 offset:51200
    v_mfma_f32_16x16x32_bf16 v[44:47], v[156:159], v[132:135], 0
    ds_read_b64_tr_b16 v[220:221], v233 offset:49152
    ds_read_b64_tr_b16 v[222:223], v233 offset:51200
    v_mfma_f32_16x16x32_bf16 v[48:51], v[160:163], v[132:135], 0
    ds_read_b128 v[184:187], v225 offset:4096
    v_mfma_f32_16x16x32_bf16 v[52:55], v[164:167], v[132:135], 0
    ds_read_b128 v[188:191], v225 offset:5120
    s_add_u32 s30, s41, s42
    v_mfma_f32_16x16x32_bf16 v[56:59], v[168:171], v[132:135], 0
    s_and_b32 s30, s30, 3
    v_mfma_f32_16x16x32_bf16 v[60:63], v[172:175], v[132:135], 0
    s_andn2_b32 s37, s41, 3
    v_mfma_f32_16x16x32_bf16 v[64:67], v[144:147], v[136:139], 0
    s_or_b32 s30, s30, s37
    s_add_u32 s41, s41, 1
    v_mfma_f32_16x16x32_bf16 v[68:71], v[148:151], v[136:139], 0
    s_mul_i32 s30, s30, s44
    v_mfma_f32_16x16x32_bf16 v[72:75], v[152:155], v[136:139], 0
    s_lshl_b32 s30, s30, 1
    s_add_u32 m0, s33, 32768
    v_mfma_f32_16x16x32_bf16 v[76:79], v[156:159], v[136:139], 0
    s_nop 0
    v_mfma_f32_16x16x32_bf16 v[80:83], v[160:163], v[136:139], 0
    buffer_load_dwordx4 v248, s[8:11], s30 offen offset:0 lds
    buffer_load_dwordx4 v249, s[8:11], s30 offen offset:1024 lds
    v_mfma_f32_16x16x32_bf16 v[84:87], v[164:167], v[136:139], 0
    s_add_u32 s30, s30, s44
    v_mfma_f32_16x16x32_bf16 v[88:91], v[168:171], v[136:139], 0
    s_add_u32 s35, s27, s32
    s_add_u32 m0, s35, 0x800
    v_mfma_f32_16x16x32_bf16 v[92:95], v[172:175], v[136:139], 0
    s_add_u32 s27, s27, 0x8000
    v_mfma_f32_16x16x32_bf16 v[96:99], v[144:147], v[140:143], 0
    buffer_load_dwordx4 v242, s[4:7], s31 offen offset:0 lds
    v_mfma_f32_16x16x32_bf16 v[100:103], v[148:151], v[140:143], 0
    buffer_load_dwordx4 v243, s[4:7], s31 offen offset:1024 lds
    s_cmp_ge_u32 s27, 0x28000
    v_mfma_f32_16x16x32_bf16 v[104:107], v[152:155], v[140:143], 0
    s_cselect_b32 s27, 0x10000, s27
    v_mfma_f32_16x16x32_bf16 v[108:111], v[156:159], v[140:143], 0
    s_add_u32 s36, s28, 0x8000
    s_cmp_ge_u32 s36, 0x18000
    v_mfma_f32_16x16x32_bf16 v[112:115], v[160:163], v[140:143], 0
    s_cselect_b32 s36, 0, s36
    v_mfma_f32_16x16x32_bf16 v[116:119], v[164:167], v[140:143], 0
    s_sub_u32 s29, s36, s28
    s_mov_b32 s28, s36
    v_mfma_f32_16x16x32_bf16 v[120:123], v[168:171], v[140:143], 0
    v_add_u32 v224, s29, v224
    v_mfma_f32_16x16x32_bf16 v[124:127], v[172:175], v[140:143], 0
    v_add_u32 v225, s29, v225
    s_waitcnt vmcnt(20) lgkmcnt(0)
    s_barrier
    v_mfma_f32_16x16x32_bf16 v[0:3], v[192:195], v[176:179], v[0:3]
    ds_read_b128 v[128:131], v224 offset:0
    ds_read_b64_tr_b16 v[144:145], v226 offset:0
    v_mfma_f32_16x16x32_bf16 v[4:7], v[196:199], v[176:179], v[4:7]
    ds_read_b64_tr_b16 v[146:147], v226 offset:2048
    v_mfma_f32_16x16x32_bf16 v[8:11], v[200:203], v[176:179], v[8:11]
    ds_read_b64_tr_b16 v[148:149], v227 offset:0
    v_mfma_f32_16x16x32_bf16 v[12:15], v[204:207], v[176:179], v[12:15]
    ds_read_b64_tr_b16 v[150:151], v227 offset:2048
    v_mfma_f32_16x16x32_bf16 v[16:19], v[208:211], v[176:179], v[16:19]
    ds_read_b128 v[132:135], v224 offset:1024
    v_mfma_f32_16x16x32_bf16 v[20:23], v[212:215], v[176:179], v[20:23]
    ds_read_b64_tr_b16 v[152:153], v228 offset:0
    v_mfma_f32_16x16x32_bf16 v[24:27], v[216:219], v[176:179], v[24:27]
    ds_read_b64_tr_b16 v[154:155], v228 offset:2048
    v_mfma_f32_16x16x32_bf16 v[28:31], v[220:223], v[176:179], v[28:31]
    ds_read_b64_tr_b16 v[156:157], v229 offset:0
    v_mfma_f32_16x16x32_bf16 v[32:35], v[192:195], v[180:183], v[32:35]
    ds_read_b64_tr_b16 v[158:159], v229 offset:2048
    v_mfma_f32_16x16x32_bf16 v[36:39], v[196:199], v[180:183], v[36:39]
    ds_read_b64_tr_b16 v[160:161], v230 offset:0
    v_mfma_f32_16x16x32_bf16 v[40:43], v[200:203], v[180:183], v[40:43]
    ds_read_b64_tr_b16 v[162:163], v230 offset:2048
    v_mfma_f32_16x16x32_bf16 v[44:47], v[204:207], v[180:183], v[44:47]
    ds_read_b64_tr_b16 v[164:165], v231 offset:0
    v_mfma_f32_16x16x32_bf16 v[48:51], v[208:211], v[180:183], v[48:51]
    ds_read_b64_tr_b16 v[166:167], v231 offset:2048
    v_mfma_f32_16x16x32_bf16 v[52:55], v[212:215], v[180:183], v[52:55]
    ds_read_b64_tr_b16 v[168:169], v232 offset:0
    v_mfma_f32_16x16x32_bf16 v[56:59], v[216:219], v[180:183], v[56:59]
    ds_read_b64_tr_b16 v[170:171], v232 offset:2048
    v_mfma_f32_16x16x32_bf16 v[60:63], v[220:223], v[180:183], v[60:63]
    ds_read_b64_tr_b16 v[172:173], v233 offset:0
    v_mfma_f32_16x16x32_bf16 v[64:67], v[192:195], v[184:187], v[64:67]
    ds_read_b64_tr_b16 v[174:175], v233 offset:2048
    v_mfma_f32_16x16x32_bf16 v[68:71], v[196:199], v[184:187], v[68:71]
    ds_read_b128 v[136:139], v224 offset:4096
    v_mfma_f32_16x16x32_bf16 v[72:75], v[200:203], v[184:187], v[72:75]
    ds_read_b128 v[140:143], v224 offset:5120
    v_mfma_f32_16x16x32_bf16 v[76:79], v[204:207], v[184:187], v[76:79]
    s_add_u32 m0, s33, 49152
    v_mfma_f32_16x16x32_bf16 v[80:83], v[208:211], v[184:187], v[80:83]
    s_nop 0
    v_mfma_f32_16x16x32_bf16 v[84:87], v[212:215], v[184:187], v[84:87]
    buffer_load_dwordx4 v248, s[8:11], s30 offen offset:0 lds
    v_mfma_f32_16x16x32_bf16 v[88:91], v[216:219], v[184:187], v[88:91]
    buffer_load_dwordx4 v249, s[8:11], s30 offen offset:1024 lds
    v_mfma_f32_16x16x32_bf16 v[92:95], v[220:223], v[184:187], v[92:95]
    s_add_u32 s31, s40, s42
    v_mfma_f32_16x16x32_bf16 v[96:99], v[192:195], v[188:191], v[96:99]
    s_and_b32 s31, s31, 3
    v_mfma_f32_16x16x32_bf16 v[100:103], v[196:199], v[188:191], v[100:103]
    s_andn2_b32 s37, s40, 3
    v_mfma_f32_16x16x32_bf16 v[104:107], v[200:203], v[188:191], v[104:107]
    s_or_b32 s31, s31, s37
    v_mfma_f32_16x16x32_bf16 v[108:111], v[204:207], v[188:191], v[108:111]
    s_add_u32 s40, s40, 1
    v_mfma_f32_16x16x32_bf16 v[112:115], v[208:211], v[188:191], v[112:115]
    s_add_u32 m0, s27, s32
    v_mfma_f32_16x16x32_bf16 v[116:119], v[212:215], v[188:191], v[116:119]
    s_lshl_b32 s31, s31, 7
    v_mfma_f32_16x16x32_bf16 v[120:123], v[216:219], v[188:191], v[120:123]
    buffer_load_dwordx4 v240, s[4:7], s31 offen offset:0 lds
    v_mfma_f32_16x16x32_bf16 v[124:127], v[220:223], v[188:191], v[124:127]
    buffer_load_dwordx4 v241, s[4:7], s31 offen offset:1024 lds
    s_waitcnt vmcnt(22) lgkmcnt(0)
    s_barrier
    v_mfma_f32_16x16x32_bf16 v[0:3], v[144:147], v[128:131], v[0:3]
    ds_read_b128 v[176:179], v225 offset:0
    ds_read_b64_tr_b16 v[192:193], v226 offset:16384
    v_mfma_f32_16x16x32_bf16 v[4:7], v[148:151], v[128:131], v[4:7]
    ds_read_b64_tr_b16 v[194:195], v226 offset:18432
    v_mfma_f32_16x16x32_bf16 v[8:11], v[152:155], v[128:131], v[8:11]
    ds_read_b64_tr_b16 v[196:197], v227 offset:16384
    ds_read_b64_tr_b16 v[198:199], v227 offset:18432
    v_mfma_f32_16x16x32_bf16 v[12:15], v[156:159], v[128:131], v[12:15]
    ds_read_b128 v[180:183], v225 offset:1024
    v_mfma_f32_16x16x32_bf16 v[16:19], v[160:163], v[128:131], v[16:19]
    ds_read_b64_tr_b16 v[200:201], v228 offset:16384
    ds_read_b64_tr_b16 v[202:203], v228 offset:18432
    v_mfma_f32_16x16x32_bf16 v[20:23], v[164:167], v[128:131], v[20:23]
    ds_read_b64_tr_b16 v[204:205], v229 offset:16384
    v_mfma_f32_16x16x32_bf16 v[24:27], v[168:171], v[128:131], v[24:27]
    ds_read_b64_tr_b16 v[206:207], v229 offset:18432
    ds_read_b64_tr_b16 v[208:209], v230 offset:16384
    v_mfma_f32_16x16x32_bf16 v[28:31], v[172:175], v[128:131], v[28:31]
    ds_read_b64_tr_b16 v[210:211], v230 offset:18432
    v_mfma_f32_16x16x32_bf16 v[32:35], v[144:147], v[132:135], v[32:35]
    ds_read_b64_tr_b16 v[212:213], v231 offset:16384
    v_mfma_f32_16x16x32_bf16 v[36:39], v[148:151], v[132:135], v[36:39]
    ds_read_b64_tr_b16 v[214:215], v231 offset:18432
    ds_read_b64_tr_b16 v[216:217], v232 offset:16384
    v_mfma_f32_16x16x32_bf16 v[40:43], v[152:155], v[132:135], v[40:43]
    ds_read_b64_tr_b16 v[218:219], v232 offset:18432
    v_mfma_f32_16x16x32_bf16 v[44:47], v[156:159], v[132:135], v[44:47]
    ds_read_b64_tr_b16 v[220:221], v233 offset:16384
    ds_read_b64_tr_b16 v[222:223], v233 offset:18432
    v_mfma_f32_16x16x32_bf16 v[48:51], v[160:163], v[132:135], v[48:51]
    ds_read_b128 v[184:187], v225 offset:4096
    v_mfma_f32_16x16x32_bf16 v[52:55], v[164:167], v[132:135], v[52:55]
    ds_read_b128 v[188:191], v225 offset:5120
    s_add_u32 s30, s41, s42
    v_mfma_f32_16x16x32_bf16 v[56:59], v[168:171], v[132:135], v[56:59]
    s_and_b32 s30, s30, 3
    v_mfma_f32_16x16x32_bf16 v[60:63], v[172:175], v[132:135], v[60:63]
    s_andn2_b32 s37, s41, 3
    v_mfma_f32_16x16x32_bf16 v[64:67], v[144:147], v[136:139], v[64:67]
    s_or_b32 s30, s30, s37
    s_add_u32 s41, s41, 1
    v_mfma_f32_16x16x32_bf16 v[68:71], v[148:151], v[136:139], v[68:71]
    s_mul_i32 s30, s30, s44
    v_mfma_f32_16x16x32_bf16 v[72:75], v[152:155], v[136:139], v[72:75]
    s_lshl_b32 s30, s30, 1
    s_add_u32 m0, s33, 0
    v_mfma_f32_16x16x32_bf16 v[76:79], v[156:159], v[136:139], v[76:79]
    s_nop 0
    v_mfma_f32_16x16x32_bf16 v[80:83], v[160:163], v[136:139], v[80:83]
    buffer_load_dwordx4 v248, s[8:11], s30 offen offset:0 lds
    buffer_load_dwordx4 v249, s[8:11], s30 offen offset:1024 lds
    v_mfma_f32_16x16x32_bf16 v[84:87], v[164:167], v[136:139], v[84:87]
    s_add_u32 s30, s30, s44
    v_mfma_f32_16x16x32_bf16 v[88:91], v[168:171], v[136:139], v[88:91]
    s_add_u32 s35, s27, s32
    s_add_u32 m0, s35, 0x800
    v_mfma_f32_16x16x32_bf16 v[92:95], v[172:175], v[136:139], v[92:95]
    s_add_u32 s27, s27, 0x8000
    v_mfma_f32_16x16x32_bf16 v[96:99], v[144:147], v[140:143], v[96:99]
    buffer_load_dwordx4 v242, s[4:7], s31 offen offset:0 lds
    v_mfma_f32_16x16x32_bf16 v[100:103], v[148:151], v[140:143], v[100:103]
    buffer_load_dwordx4 v243, s[4:7], s31 offen offset:1024 lds
    s_cmp_ge_u32 s27, 0x28000
    v_mfma_f32_16x16x32_bf16 v[104:107], v[152:155], v[140:143], v[104:107]
    s_cselect_b32 s27, 0x10000, s27
    v_mfma_f32_16x16x32_bf16 v[108:111], v[156:159], v[140:143], v[108:111]
    s_add_u32 s36, s28, 0x8000
    s_cmp_ge_u32 s36, 0x18000
    v_mfma_f32_16x16x32_bf16 v[112:115], v[160:163], v[140:143], v[112:115]
    s_cselect_b32 s36, 0, s36
    v_mfma_f32_16x16x32_bf16 v[116:119], v[164:167], v[140:143], v[116:119]
    s_sub_u32 s29, s36, s28
    s_mov_b32 s28, s36
    v_mfma_f32_16x16x32_bf16 v[120:123], v[168:171], v[140:143], v[120:123]
    v_add_u32 v224, s29, v224
    v_mfma_f32_16x16x32_bf16 v[124:127], v[172:175], v[140:143], v[124:127]
    v_add_u32 v225, s29, v225
    s_waitcnt vmcnt(8) lgkmcnt(0)
    s_barrier
    v_mfma_f32_16x16x32_bf16 v[0:3], v[192:195], v[176:179], v[0:3]
    ds_read_b128 v[128:131], v224 offset:0
    ds_read_b64_tr_b16 v[144:145], v226 offset:32768
    v_mfma_f32_16x16x32_bf16 v[4:7], v[196:199], v[176:179], v[4:7]
    ds_read_b64_tr_b16 v[146:147], v226 offset:34816
    v_mfma_f32_16x16x32_bf16 v[8:11], v[200:203], v[176:179], v[8:11]
    ds_read_b64_tr_b16 v[148:149], v227 offset:32768
    v_mfma_f32_16x16x32_bf16 v[12:15], v[204:207], v[176:179], v[12:15]
    ds_read_b64_tr_b16 v[150:151], v227 offset:34816
    v_mfma_f32_16x16x32_bf16 v[16:19], v[208:211], v[176:179], v[16:19]
    ds_read_b128 v[132:135], v224 offset:1024
    v_mfma_f32_16x16x32_bf16 v[20:23], v[212:215], v[176:179], v[20:23]
    ds_read_b64_tr_b16 v[152:153], v228 offset:32768
    v_mfma_f32_16x16x32_bf16 v[24:27], v[216:219], v[176:179], v[24:27]
    ds_read_b64_tr_b16 v[154:155], v228 offset:34816
    v_mfma_f32_16x16x32_bf16 v[28:31], v[220:223], v[176:179], v[28:31]
    ds_read_b64_tr_b16 v[156:157], v229 offset:32768
    v_mfma_f32_16x16x32_bf16 v[32:35], v[192:195], v[180:183], v[32:35]
    ds_read_b64_tr_b16 v[158:159], v229 offset:34816
    v_mfma_f32_16x16x32_bf16 v[36:39], v[196:199], v[180:183], v[36:39]
    ds_read_b64_tr_b16 v[160:161], v230 offset:32768
    v_mfma_f32_16x16x32_bf16 v[40:43], v[200:203], v[180:183], v[40:43]
    ds_read_b64_tr_b16 v[162:163], v230 offset:34816
    v_mfma_f32_16x16x32_bf16 v[44:47], v[204:207], v[180:183], v[44:47]
    ds_read_b64_tr_b16 v[164:165], v231 offset:32768
    v_mfma_f32_16x16x32_bf16 v[48:51], v[208:211], v[180:183], v[48:51]
    ds_read_b64_tr_b16 v[166:167], v231 offset:34816
    v_mfma_f32_16x16x32_bf16 v[52:55], v[212:215], v[180:183], v[52:55]
    ds_read_b64_tr_b16 v[168:169], v232 offset:32768
    v_mfma_f32_16x16x32_bf16 v[56:59], v[216:219], v[180:183], v[56:59]
    ds_read_b64_tr_b16 v[170:171], v232 offset:34816
    v_mfma_f32_16x16x32_bf16 v[60:63], v[220:223], v[180:183], v[60:63]
    ds_read_b64_tr_b16 v[172:173], v233 offset:32768
    v_mfma_f32_16x16x32_bf16 v[64:67], v[192:195], v[184:187], v[64:67]
    ds_read_b64_tr_b16 v[174:175], v233 offset:34816
    v_mfma_f32_16x16x32_bf16 v[68:71], v[196:199], v[184:187], v[68:71]
    ds_read_b128 v[136:139], v224 offset:4096
    v_mfma_f32_16x16x32_bf16 v[72:75], v[200:203], v[184:187], v[72:75]
    ds_read_b128 v[140:143], v224 offset:5120
    v_mfma_f32_16x16x32_bf16 v[76:79], v[204:207], v[184:187], v[76:79]
    s_add_u32 m0, s33, 16384
    v_mfma_f32_16x16x32_bf16 v[80:83], v[208:211], v[184:187], v[80:83]
    s_nop 0
    v_mfma_f32_16x16x32_bf16 v[84:87], v[212:215], v[184:187], v[84:87]
    buffer_load_dwordx4 v248, s[8:11], s30 offen offset:0 lds
    v_mfma_f32_16x16x32_bf16 v[88:91], v[216:219], v[184:187], v[88:91]
    buffer_load_dwordx4 v249, s[8:11], s30 offen offset:1024 lds
    v_mfma_f32_16x16x32_bf16 v[92:95], v[220:223], v[184:187], v[92:95]
    s_add_u32 s31, s40, s42
    v_mfma_f32_16x16x32_bf16 v[96:99], v[192:195], v[188:191], v[96:99]
    s_and_b32 s31, s31, 3
    v_mfma_f32_16x16x32_bf16 v[100:103], v[196:199], v[188:191], v[100:103]
    s_andn2_b32 s37, s40, 3
    v_mfma_f32_16x16x32_bf16 v[104:107], v[200:203], v[188:191], v[104:107]
    s_or_b32 s31, s31, s37
    v_mfma_f32_16x16x32_bf16 v[108:111], v[204:207], v[188:191], v[108:111]
    s_add_u32 s40, s40, 1
    v_mfma_f32_16x16x32_bf16 v[112:115], v[208:211], v[188:191], v[112:115]
    s_add_u32 m0, s27, s32
    v_mfma_f32_16x16x32_bf16 v[116:119], v[212:215], v[188:191], v[116:119]
    s_lshl_b32 s31, s31, 7
    v_mfma_f32_16x16x32_bf16 v[120:123], v[216:219], v[188:191], v[120:123]
    buffer_load_dwordx4 v240, s[4:7], s31 offen offset:0 lds
    v_mfma_f32_16x16x32_bf16 v[124:127], v[220:223], v[188:191], v[124:127]
    buffer_load_dwordx4 v241, s[4:7], s31 offen offset:1024 lds
    s_waitcnt vmcnt(10) lgkmcnt(0)
    s_barrier
    v_mfma_f32_16x16x32_bf16 v[0:3], v[144:147], v[128:131], v[0:3]
    ds_read_b128 v[176:179], v225 offset:0
    ds_read_b64_tr_b16 v[192:193], v226 offset:49152
    v_mfma_f32_16x16x32_bf16 v[4:7], v[148:151], v[128:131], v[4:7]
    ds_read_b64_tr_b16 v[194:195], v226 offset:51200
    v_mfma_f32_16x16x32_bf16 v[8:11], v[152:155], v[128:131], v[8:11]
    ds_read_b64_tr_b16 v[196:197], v227 offset:49152
    ds_read_b64_tr_b16 v[198:199], v227 offset:51200
    v_mfma_f32_16x16x32_bf16 v[12:15], v[156:159], v[128:131], v[12:15]
    ds_read_b128 v[180:183], v225 offset:1024
    v_mfma_f32_16x16x32_bf16 v[16:19], v[160:163], v[128:131], v[16:19]
    ds_read_b64_tr_b16 v[200:201], v228 offset:49152
    ds_read_b64_tr_b16 v[202:203], v228 offset:51200
    v_mfma_f32_16x16x32_bf16 v[20:23], v[164:167], v[128:131], v[20:23]
    ds_read_b64_tr_b16 v[204:205], v229 offset:49152
    v_mfma_f32_16x16x32_bf16 v[24:27], v[168:171], v[128:131], v[24:27]
    ds_read_b64_tr_b16 v[206:207], v229 offset:51200
    ds_read_b64_tr_b16 v[208:209], v230 offset:49152
    v_mfma_f32_16x16x32_bf16 v[28:31], v[172:175], v[128:131], v[28:31]
    ds_read_b64_tr_b16 v[210:211], v230 offset:51200
    v_mfma_f32_16x16x32_bf16 v[32:35], v[144:147], v[132:135], v[32:35]
    ds_read_b64_tr_b16 v[212:213], v231 offset:49152
    v_mfma_f32_16x16x32_bf16 v[36:39], v[148:151], v[132:135], v[36:39]
    ds_read_b64_tr_b16 v[214:215], v231 offset:51200
    ds_read_b64_tr_b16 v[216:217], v232 offset:49152
    v_mfma_f32_16x16x32_bf16 v[40:43], v[152:155], v[132:135], v[40:43]
    ds_read_b64_tr_b16 v[218:219], v232 offset:51200
    v_mfma_f32_16x16x32_bf16 v[44:47], v[156:159], v[132:135], v[44:47]
    ds_read_b64_tr_b16 v[220:221], v233 offset:49152
    ds_read_b64_tr_b16 v[222:223], v233 offset:51200
    v_mfma_f32_16x16x32_bf16 v[48:51], v[160:163], v[132:135], v[48:51]
    ds_read_b128 v[184:187], v225 offset:4096
    v_mfma_f32_16x16x32_bf16 v[52:55], v[164:167], v[132:135], v[52:55]
    ds_read_b128 v[188:191], v225 offset:5120
    s_add_u32 s30, s41, s42
    v_mfma_f32_16x16x32_bf16 v[56:59], v[168:171], v[132:135], v[56:59]
    s_and_b32 s30, s30, 3
    v_mfma_f32_16x16x32_bf16 v[60:63], v[172:175], v[132:135], v[60:63]
    s_andn2_b32 s37, s41, 3
    v_mfma_f32_16x16x32_bf16 v[64:67], v[144:147], v[136:139], v[64:67]
    s_or_b32 s30, s30, s37
    s_add_u32 s41, s41, 1
    v_mfma_f32_16x16x32_bf16 v[68:71], v[148:151], v[136:139], v[68:71]
    s_mul_i32 s30, s30, s44
    v_mfma_f32_16x16x32_bf16 v[72:75], v[152:155], v[136:139], v[72:75]
    s_lshl_b32 s30, s30, 1
    s_add_u32 m0, s33, 32768
    v_mfma_f32_16x16x32_bf16 v[76:79], v[156:159], v[136:139], v[76:79]
    s_nop 0
    v_mfma_f32_16x16x32_bf16 v[80:83], v[160:163], v[136:139], v[80:83]
    buffer_load_dwordx4 v248, s[8:11], s30 offen offset:0 lds
    buffer_load_dwordx4 v249, s[8:11], s30 offen offset:1024 lds
    v_mfma_f32_16x16x32_bf16 v[84:87], v[164:167], v[136:139], v[84:87]
    s_add_u32 s30, s30, s44
    v_mfma_f32_16x16x32_bf16 v[88:91], v[168:171], v[136:139], v[88:91]
    s_add_u32 s35, s27, s32
    s_add_u32 m0, s35, 0x800
    v_mfma_f32_16x16x32_bf16 v[92:95], v[172:175], v[136:139], v[92:95]
    s_add_u32 s27, s27, 0x8000
    v_mfma_f32_16x16x32_bf16 v[96:99], v[144:147], v[140:143], v[96:99]
    buffer_load_dwordx4 v242, s[4:7], s31 offen offset:0 lds
    v_mfma_f32_16x16x32_bf16 v[100:103], v[148:151], v[140:143], v[100:103]
    buffer_load_dwordx4 v243, s[4:7], s31 offen offset:1024 lds
    s_cmp_ge_u32 s27, 0x28000
    v_mfma_f32_16x16x32_bf16 v[104:107], v[152:155], v[140:143], v[104:107]
    s_cselect_b32 s27, 0x10000, s27
    v_mfma_f32_16x16x32_bf16 v[108:111], v[156:159], v[140:143], v[108:111]
    s_add_u32 s36, s28, 0x8000
    s_cmp_ge_u32 s36, 0x18000
    v_mfma_f32_16x16x32_bf16 v[112:115], v[160:163], v[140:143], v[112:115]
    s_cselect_b32 s36, 0, s36
    v_mfma_f32_16x16x32_bf16 v[116:119], v[164:167], v[140:143], v[116:119]
    s_sub_u32 s29, s36, s28
    s_mov_b32 s28, s36
    v_mfma_f32_16x16x32_bf16 v[120:123], v[168:171], v[140:143], v[120:123]
    v_add_u32 v224, s29, v224
    v_mfma_f32_16x16x32_bf16 v[124:127], v[172:175], v[140:143], v[124:127]
    v_add_u32 v225, s29, v225
    s_mov_b32 s34, 5
K1_LOOP_21k:
    s_waitcnt vmcnt(8) lgkmcnt(0)
    s_barrier
    v_mfma_f32_16x16x32_bf16 v[0:3], v[192:195], v[176:179], v[0:3]
    ds_read_b128 v[128:131], v224 offset:0
    ds_read_b64_tr_b16 v[144:145], v226 offset:0
    v_mfma_f32_16x16x32_bf16 v[4:7], v[196:199], v[176:179], v[4:7]
    ds_read_b64_tr_b16 v[146:147], v226 offset:2048
    v_mfma_f32_16x16x32_bf16 v[8:11], v[200:203], v[176:179], v[8:11]
    ds_read_b64_tr_b16 v[148:149], v227 offset:0
    v_mfma_f32_16x16x32_bf16 v[12:15], v[204:207], v[176:179], v[12:15]
    ds_read_b64_tr_b16 v[150:151], v227 offset:2048
    v_mfma_f32_16x16x32_bf16 v[16:19], v[208:211], v[176:179], v[16:19]
    ds_read_b128 v[132:135], v224 offset:1024
    v_mfma_f32_16x16x32_bf16 v[20:23], v[212:215], v[176:179], v[20:23]
    ds_read_b64_tr_b16 v[152:153], v228 offset:0
    v_mfma_f32_16x16x32_bf16 v[24:27], v[216:219], v[176:179], v[24:27]
    ds_read_b64_tr_b16 v[154:155], v228 offset:2048
    v_mfma_f32_16x16x32_bf16 v[28:31], v[220:223], v[176:179], v[28:31]
    ds_read_b64_tr_b16 v[156:157], v229 offset:0
    v_mfma_f32_16x16x32_bf16 v[32:35], v[192:195], v[180:183], v[32:35]
    ds_read_b64_tr_b16 v[158:159], v229 offset:2048
    v_mfma_f32_16x16x32_bf16 v[36:39], v[196:199], v[180:183], v[36:39]
    ds_read_b64_tr_b16 v[160:161], v230 offset:0
    v_mfma_f32_16x16x32_bf16 v[40:43], v[200:203], v[180:183], v[40:43]
    ds_read_b64_tr_b16 v[162:163], v230 offset:2048
    v_mfma_f32_16x16x32_bf16 v[44:47], v[204:207], v[180:183], v[44:47]
    ds_read_b64_tr_b16 v[164:165], v231 offset:0
    v_mfma_f32_16x16x32_bf16 v[48:51], v[208:211], v[180:183], v[48:51]
    ds_read_b64_tr_b16 v[166:167], v231 offset:2048
    v_mfma_f32_16x16x32_bf16 v[52:55], v[212:215], v[180:183], v[52:55]
    ds_read_b64_tr_b16 v[168:169], v232 offset:0
    v_mfma_f32_16x16x32_bf16 v[56:59], v[216:219], v[180:183], v[56:59]
    ds_read_b64_tr_b16 v[170:171], v232 offset:2048
    v_mfma_f32_16x16x32_bf16 v[60:63], v[220:223], v[180:183], v[60:63]
    ds_read_b64_tr_b16 v[172:173], v233 offset:0
    v_mfma_f32_16x16x32_bf16 v[64:67], v[192:195], v[184:187], v[64:67]
    ds_read_b64_tr_b16 v[174:175], v233 offset:2048
    v_mfma_f32_16x16x32_bf16 v[68:71], v[196:199], v[184:187], v[68:71]
    ds_read_b128 v[136:139], v224 offset:4096
    v_mfma_f32_16x16x32_bf16 v[72:75], v[200:203], v[184:187], v[72:75]
    ds_read_b128 v[140:143], v224 offset:5120
    v_mfma_f32_16x16x32_bf16 v[76:79], v[204:207], v[184:187], v[76:79]
    s_add_u32 m0, s33, 49152
    v_mfma_f32_16x16x32_bf16 v[80:83], v[208:211], v[184:187], v[80:83]
    s_nop 0
    v_mfma_f32_16x16x32_bf16 v[84:87], v[212:215], v[184:187], v[84:87]
    buffer_load_dwordx4 v248, s[8:11], s30 offen offset:0 lds
    v_mfma_f32_16x16x32_bf16 v[88:91], v[216:219], v[184:187], v[88:91]
    buffer_load_dwordx4 v249, s[8:11], s30 offen offset:1024 lds
    v_mfma_f32_16x16x32_bf16 v[92:95], v[220:223], v[184:187], v[92:95]
    s_add_u32 s31, s40, s42
    v_mfma_f32_16x16x32_bf16 v[96:99], v[192:195], v[188:191], v[96:99]
    s_and_b32 s31, s31, 3
    v_mfma_f32_16x16x32_bf16 v[100:103], v[196:199], v[188:191], v[100:103]
    s_andn2_b32 s37, s40, 3
    v_mfma_f32_16x16x32_bf16 v[104:107], v[200:203], v[188:191], v[104:107]
    s_or_b32 s31, s31, s37
    v_mfma_f32_16x16x32_bf16 v[108:111], v[204:207], v[188:191], v[108:111]
    s_add_u32 s40, s40, 1
    v_mfma_f32_16x16x32_bf16 v[112:115], v[208:211], v[188:191], v[112:115]
    s_add_u32 m0, s27, s32
    v_mfma_f32_16x16x32_bf16 v[116:119], v[212:215], v[188:191], v[116:119]
    s_lshl_b32 s31, s31, 7
    v_mfma_f32_16x16x32_bf16 v[120:123], v[216:219], v[188:191], v[120:123]
    buffer_load_dwordx4 v240, s[4:7], s31 offen offset:0 lds
    v_mfma_f32_16x16x32_bf16 v[124:127], v[220:223], v[188:191], v[124:127]
    buffer_load_dwordx4 v241, s[4:7], s31 offen offset:1024 lds
    s_waitcnt vmcnt(10) lgkmcnt(0)
    s_barrier
    v_mfma_f32_16x16x32_bf16 v[0:3], v[144:147], v[128:131], v[0:3]
    ds_read_b128 v[176:179], v225 offset:0
    ds_read_b64_tr_b16 v[192:193], v226 offset:16384
    v_mfma_f32_16x16x32_bf16 v[4:7], v[148:151], v[128:131], v[4:7]
    ds_read_b64_tr_b16 v[194:195], v226 offset:18432
    v_mfma_f32_16x16x32_bf16 v[8:11], v[152:155], v[128:131], v[8:11]
    ds_read_b64_tr_b16 v[196:197], v227 offset:16384
    ds_read_b64_tr_b16 v[198:199], v227 offset:18432
    v_mfma_f32_16x16x32_bf16 v[12:15], v[156:159], v[128:131], v[12:15]
    ds_read_b128 v[180:183], v225 offset:1024
    v_mfma_f32_16x16x32_bf16 v[16:19], v[160:163], v[128:131], v[16:19]
    ds_read_b64_tr_b16 v[200:201], v228 offset:16384
    ds_read_b64_tr_b16 v[202:203], v228 offset:18432
    v_mfma_f32_16x16x32_bf16 v[20:23], v[164:167], v[128:131], v[20:23]
    ds_read_b64_tr_b16 v[204:205], v229 offset:16384
    v_mfma_f32_16x16x32_bf16 v[24:27], v[168:171], v[128:131], v[24:27]
    ds_read_b64_tr_b16 v[206:207], v229 offset:18432
    ds_read_b64_tr_b16 v[208:209], v230 offset:16384
    v_mfma_f32_16x16x32_bf16 v[28:31], v[172:175], v[128:131], v[28:31]
    ds_read_b64_tr_b16 v[210:211], v230 offset:18432
    v_mfma_f32_16x16x32_bf16 v[32:35], v[144:147], v[132:135], v[32:35]
    ds_read_b64_tr_b16 v[212:213], v231 offset:16384
    v_mfma_f32_16x16x32_bf16 v[36:39], v[148:151], v[132:135], v[36:39]
    ds_read_b64_tr_b16 v[214:215], v231 offset:18432
    ds_read_b64_tr_b16 v[216:217], v232 offset:16384
    v_mfma_f32_16x16x32_bf16 v[40:43], v[152:155], v[132:135], v[40:43]
    ds_read_b64_tr_b16 v[218:219], v232 offset:18432
    v_mfma_f32_16x16x32_bf16 v[44:47], v[156:159], v[132:135], v[44:47]
    ds_read_b64_tr_b16 v[220:221], v233 offset:16384
    ds_read_b64_tr_b16 v[222:223], v233 offset:18432
    v_mfma_f32_16x16x32_bf16 v[48:51], v[160:163], v[132:135], v[48:51]
    ds_read_b128 v[184:187], v225 offset:4096
    v_mfma_f32_16x16x32_bf16 v[52:55], v[164:167], v[132:135], v[52:55]
    ds_read_b128 v[188:191], v225 offset:5120
    s_add_u32 s30, s41, s42
    v_mfma_f32_16x16x32_bf16 v[56:59], v[168:171], v[132:135], v[56:59]
    s_and_b32 s30, s30, 3
    v_mfma_f32_16x16x32_bf16 v[60:63], v[172:175], v[132:135], v[60:63]
    s_andn2_b32 s37, s41, 3
    v_mfma_f32_16x16x32_bf16 v[64:67], v[144:147], v[136:139], v[64:67]
    s_or_b32 s30, s30, s37
    s_add_u32 s41, s41, 1
    v_mfma_f32_16x16x32_bf16 v[68:71], v[148:151], v[136:139], v[68:71]
    s_mul_i32 s30, s30, s44
    v_mfma_f32_16x16x32_bf16 v[72:75], v[152:155], v[136:139], v[72:75]
    s_lshl_b32 s30, s30, 1
    s_add_u32 m0, s33, 0
    v_mfma_f32_16x16x32_bf16 v[76:79], v[156:159], v[136:139], v[76:79]
    s_nop 0
    v_mfma_f32_16x16x32_bf16 v[80:83], v[160:163], v[136:139], v[80:83]
    buffer_load_dwordx4 v248, s[8:11], s30 offen offset:0 lds
    buffer_load_dwordx4 v249, s[8:11], s30 offen offset:1024 lds
    v_mfma_f32_16x16x32_bf16 v[84:87], v[164:167], v[136:139], v[84:87]
    s_add_u32 s30, s30, s44
    v_mfma_f32_16x16x32_bf16 v[88:91], v[168:171], v[136:139], v[88:91]
    s_add_u32 s35, s27, s32
    s_add_u32 m0, s35, 0x800
    v_mfma_f32_16x16x32_bf16 v[92:95], v[172:175], v[136:139], v[92:95]
    s_add_u32 s27, s27, 0x8000
    v_mfma_f32_16x16x32_bf16 v[96:99], v[144:147], v[140:143], v[96:99]
    buffer_load_dwordx4 v242, s[4:7], s31 offen offset:0 lds
    v_mfma_f32_16x16x32_bf16 v[100:103], v[148:151], v[140:143], v[100:103]
    buffer_load_dwordx4 v243, s[4:7], s31 offen offset:1024 lds
    s_cmp_ge_u32 s27, 0x28000
    v_mfma_f32_16x16x32_bf16 v[104:107], v[152:155], v[140:143], v[104:107]
    s_cselect_b32 s27, 0x10000, s27
    v_mfma_f32_16x16x32_bf16 v[108:111], v[156:159], v[140:143], v[108:111]
    s_add_u32 s36, s28, 0x8000
    s_cmp_ge_u32 s36, 0x18000
    v_mfma_f32_16x16x32_bf16 v[112:115], v[160:163], v[140:143], v[112:115]
    s_cselect_b32 s36, 0, s36
    v_mfma_f32_16x16x32_bf16 v[116:119], v[164:167], v[140:143], v[116:119]
    s_sub_u32 s29, s36, s28
    s_mov_b32 s28, s36
    v_mfma_f32_16x16x32_bf16 v[120:123], v[168:171], v[140:143], v[120:123]
    v_add_u32 v224, s29, v224
    v_mfma_f32_16x16x32_bf16 v[124:127], v[172:175], v[140:143], v[124:127]
    v_add_u32 v225, s29, v225
    s_waitcnt vmcnt(8) lgkmcnt(0)
    s_barrier
    v_mfma_f32_16x16x32_bf16 v[0:3], v[192:195], v[176:179], v[0:3]
    ds_read_b128 v[128:131], v224 offset:0
    ds_read_b64_tr_b16 v[144:145], v226 offset:32768
    v_mfma_f32_16x16x32_bf16 v[4:7], v[196:199], v[176:179], v[4:7]
    ds_read_b64_tr_b16 v[146:147], v226 offset:34816
    v_mfma_f32_16x16x32_bf16 v[8:11], v[200:203], v[176:179], v[8:11]
    ds_read_b64_tr_b16 v[148:149], v227 offset:32768
    v_mfma_f32_16x16x32_bf16 v[12:15], v[204:207], v[176:179], v[12:15]
    ds_read_b64_tr_b16 v[150:151], v227 offset:34816
    v_mfma_f32_16x16x32_bf16 v[16:19], v[208:211], v[176:179], v[16:19]
    ds_read_b128 v[132:135], v224 offset:1024
    v_mfma_f32_16x16x32_bf16 v[20:23], v[212:215], v[176:179], v[20:23]
    ds_read_b64_tr_b16 v[152:153], v228 offset:32768
    v_mfma_f32_16x16x32_bf16 v[24:27], v[216:219], v[176:179], v[24:27]
    ds_read_b64_tr_b16 v[154:155], v228 offset:34816
    v_mfma_f32_16x16x32_bf16 v[28:31], v[220:223], v[176:179], v[28:31]
    ds_read_b64_tr_b16 v[156:157], v229 offset:32768
    v_mfma_f32_16x16x32_bf16 v[32:35], v[192:195], v[180:183], v[32:35]
    ds_read_b64_tr_b16 v[158:159], v229 offset:34816
    v_mfma_f32_16x16x32_bf16 v[36:39], v[196:199], v[180:183], v[36:39]
    ds_read_b64_tr_b16 v[160:161], v230 offset:32768
    v_mfma_f32_16x16x32_bf16 v[40:43], v[200:203], v[180:183], v[40:43]
    ds_read_b64_tr_b16 v[162:163], v230 offset:34816
    v_mfma_f32_16x16x32_bf16 v[44:47], v[204:207], v[180:183], v[44:47]
    ds_read_b64_tr_b16 v[164:165], v231 offset:32768
    v_mfma_f32_16x16x32_bf16 v[48:51], v[208:211], v[180:183], v[48:51]
    ds_read_b64_tr_b16 v[166:167], v231 offset:34816
    v_mfma_f32_16x16x32_bf16 v[52:55], v[212:215], v[180:183], v[52:55]
    ds_read_b64_tr_b16 v[168:169], v232 offset:32768
    v_mfma_f32_16x16x32_bf16 v[56:59], v[216:219], v[180:183], v[56:59]
    ds_read_b64_tr_b16 v[170:171], v232 offset:34816
    v_mfma_f32_16x16x32_bf16 v[60:63], v[220:223], v[180:183], v[60:63]
    ds_read_b64_tr_b16 v[172:173], v233 offset:32768
    v_mfma_f32_16x16x32_bf16 v[64:67], v[192:195], v[184:187], v[64:67]
    ds_read_b64_tr_b16 v[174:175], v233 offset:34816
    v_mfma_f32_16x16x32_bf16 v[68:71], v[196:199], v[184:187], v[68:71]
    ds_read_b128 v[136:139], v224 offset:4096
    v_mfma_f32_16x16x32_bf16 v[72:75], v[200:203], v[184:187], v[72:75]
    ds_read_b128 v[140:143], v224 offset:5120
    v_mfma_f32_16x16x32_bf16 v[76:79], v[204:207], v[184:187], v[76:79]
    s_add_u32 m0, s33, 16384
    v_mfma_f32_16x16x32_bf16 v[80:83], v[208:211], v[184:187], v[80:83]
    s_nop 0
    v_mfma_f32_16x16x32_bf16 v[84:87], v[212:215], v[184:187], v[84:87]
    buffer_load_dwordx4 v248, s[8:11], s30 offen offset:0 lds
    v_mfma_f32_16x16x32_bf16 v[88:91], v[216:219], v[184:187], v[88:91]
    buffer_load_dwordx4 v249, s[8:11], s30 offen offset:1024 lds
    v_mfma_f32_16x16x32_bf16 v[92:95], v[220:223], v[184:187], v[92:95]
    s_add_u32 s31, s40, s42
    v_mfma_f32_16x16x32_bf16 v[96:99], v[192:195], v[188:191], v[96:99]
    s_and_b32 s31, s31, 3
    v_mfma_f32_16x16x32_bf16 v[100:103], v[196:199], v[188:191], v[100:103]
    s_andn2_b32 s37, s40, 3
    v_mfma_f32_16x16x32_bf16 v[104:107], v[200:203], v[188:191], v[104:107]
    s_or_b32 s31, s31, s37
    v_mfma_f32_16x16x32_bf16 v[108:111], v[204:207], v[188:191], v[108:111]
    s_add_u32 s40, s40, 1
    v_mfma_f32_16x16x32_bf16 v[112:115], v[208:211], v[188:191], v[112:115]
    s_add_u32 m0, s27, s32
    v_mfma_f32_16x16x32_bf16 v[116:119], v[212:215], v[188:191], v[116:119]
    s_lshl_b32 s31, s31, 7
    v_mfma_f32_16x16x32_bf16 v[120:123], v[216:219], v[188:191], v[120:123]
    buffer_load_dwordx4 v240, s[4:7], s31 offen offset:0 lds
    v_mfma_f32_16x16x32_bf16 v[124:127], v[220:223], v[188:191], v[124:127]
    buffer_load_dwordx4 v241, s[4:7], s31 offen offset:1024 lds
    s_waitcnt vmcnt(10) lgkmcnt(0)
    s_barrier
    v_mfma_f32_16x16x32_bf16 v[0:3], v[144:147], v[128:131], v[0:3]
    ds_read_b128 v[176:179], v225 offset:0
    ds_read_b64_tr_b16 v[192:193], v226 offset:49152
    v_mfma_f32_16x16x32_bf16 v[4:7], v[148:151], v[128:131], v[4:7]
    ds_read_b64_tr_b16 v[194:195], v226 offset:51200
    v_mfma_f32_16x16x32_bf16 v[8:11], v[152:155], v[128:131], v[8:11]
    ds_read_b64_tr_b16 v[196:197], v227 offset:49152
    ds_read_b64_tr_b16 v[198:199], v227 offset:51200
    v_mfma_f32_16x16x32_bf16 v[12:15], v[156:159], v[128:131], v[12:15]
    ds_read_b128 v[180:183], v225 offset:1024
    v_mfma_f32_16x16x32_bf16 v[16:19], v[160:163], v[128:131], v[16:19]
    ds_read_b64_tr_b16 v[200:201], v228 offset:49152
    ds_read_b64_tr_b16 v[202:203], v228 offset:51200
    v_mfma_f32_16x16x32_bf16 v[20:23], v[164:167], v[128:131], v[20:23]
    ds_read_b64_tr_b16 v[204:205], v229 offset:49152
    v_mfma_f32_16x16x32_bf16 v[24:27], v[168:171], v[128:131], v[24:27]
    ds_read_b64_tr_b16 v[206:207], v229 offset:51200
    ds_read_b64_tr_b16 v[208:209], v230 offset:49152
    v_mfma_f32_16x16x32_bf16 v[28:31], v[172:175], v[128:131], v[28:31]
    ds_read_b64_tr_b16 v[210:211], v230 offset:51200
    v_mfma_f32_16x16x32_bf16 v[32:35], v[144:147], v[132:135], v[32:35]
    ds_read_b64_tr_b16 v[212:213], v231 offset:49152
    v_mfma_f32_16x16x32_bf16 v[36:39], v[148:151], v[132:135], v[36:39]
    ds_read_b64_tr_b16 v[214:215], v231 offset:51200
    ds_read_b64_tr_b16 v[216:217], v232 offset:49152
    v_mfma_f32_16x16x32_bf16 v[40:43], v[152:155], v[132:135], v[40:43]
    ds_read_b64_tr_b16 v[218:219], v232 offset:51200
    v_mfma_f32_16x16x32_bf16 v[44:47], v[156:159], v[132:135], v[44:47]
    ds_read_b64_tr_b16 v[220:221], v233 offset:49152
    ds_read_b64_tr_b16 v[222:223], v233 offset:51200
    v_mfma_f32_16x16x32_bf16 v[48:51], v[160:163], v[132:135], v[48:51]
    ds_read_b128 v[184:187], v225 offset:4096
    v_mfma_f32_16x16x32_bf16 v[52:55], v[164:167], v[132:135], v[52:55]
    ds_read_b128 v[188:191], v225 offset:5120
    s_add_u32 s30, s41, s42
    v_mfma_f32_16x16x32_bf16 v[56:59], v[168:171], v[132:135], v[56:59]
    s_and_b32 s30, s30, 3
    v_mfma_f32_16x16x32_bf16 v[60:63], v[172:175], v[132:135], v[60:63]
    s_andn2_b32 s37, s41, 3
    v_mfma_f32_16x16x32_bf16 v[64:67], v[144:147], v[136:139], v[64:67]
    s_or_b32 s30, s30, s37
    s_add_u32 s41, s41, 1
    v_mfma_f32_16x16x32_bf16 v[68:71], v[148:151], v[136:139], v[68:71]
    s_mul_i32 s30, s30, s44
    v_mfma_f32_16x16x32_bf16 v[72:75], v[152:155], v[136:139], v[72:75]
    s_lshl_b32 s30, s30, 1
    s_add_u32 m0, s33, 32768
    v_mfma_f32_16x16x32_bf16 v[76:79], v[156:159], v[136:139], v[76:79]
    s_nop 0
    v_mfma_f32_16x16x32_bf16 v[80:83], v[160:163], v[136:139], v[80:83]
    buffer_load_dwordx4 v248, s[8:11], s30 offen offset:0 lds
    buffer_load_dwordx4 v249, s[8:11], s30 offen offset:1024 lds
    v_mfma_f32_16x16x32_bf16 v[84:87], v[164:167], v[136:139], v[84:87]
    s_add_u32 s30, s30, s44
    v_mfma_f32_16x16x32_bf16 v[88:91], v[168:171], v[136:139], v[88:91]
    s_add_u32 s35, s27, s32
    s_add_u32 m0, s35, 0x800
    v_mfma_f32_16x16x32_bf16 v[92:95], v[172:175], v[136:139], v[92:95]
    s_add_u32 s27, s27, 0x8000
    v_mfma_f32_16x16x32_bf16 v[96:99], v[144:147], v[140:143], v[96:99]
    buffer_load_dwordx4 v242, s[4:7], s31 offen offset:0 lds
    v_mfma_f32_16x16x32_bf16 v[100:103], v[148:151], v[140:143], v[100:103]
    buffer_load_dwordx4 v243, s[4:7], s31 offen offset:1024 lds
    s_cmp_ge_u32 s27, 0x28000
    v_mfma_f32_16x16x32_bf16 v[104:107], v[152:155], v[140:143], v[104:107]
    s_cselect_b32 s27, 0x10000, s27
    v_mfma_f32_16x16x32_bf16 v[108:111], v[156:159], v[140:143], v[108:111]
    s_add_u32 s36, s28, 0x8000
    s_cmp_ge_u32 s36, 0x18000
    v_mfma_f32_16x16x32_bf16 v[112:115], v[160:163], v[140:143], v[112:115]
    s_cselect_b32 s36, 0, s36
    v_mfma_f32_16x16x32_bf16 v[116:119], v[164:167], v[140:143], v[116:119]
    s_sub_u32 s29, s36, s28
    s_mov_b32 s28, s36
    v_mfma_f32_16x16x32_bf16 v[120:123], v[168:171], v[140:143], v[120:123]
    v_add_u32 v224, s29, v224
    v_mfma_f32_16x16x32_bf16 v[124:127], v[172:175], v[140:143], v[124:127]
    v_add_u32 v225, s29, v225
    s_sub_u32 s34, s34, 1
    s_cmp_lg_u32 s34, 0
    s_cbranch_scc1 K1_LOOP_21k
    s_waitcnt vmcnt(8) lgkmcnt(0)
    s_barrier
    v_mfma_f32_16x16x32_bf16 v[0:3], v[192:195], v[176:179], v[0:3]
    ds_read_b128 v[128:131], v224 offset:0
    ds_read_b64_tr_b16 v[144:145], v226 offset:0
    v_mfma_f32_16x16x32_bf16 v[4:7], v[196:199], v[176:179], v[4:7]
    ds_read_b64_tr_b16 v[146:147], v226 offset:2048
    v_mfma_f32_16x16x32_bf16 v[8:11], v[200:203], v[176:179], v[8:11]
    ds_read_b64_tr_b16 v[148:149], v227 offset:0
    v_mfma_f32_16x16x32_bf16 v[12:15], v[204:207], v[176:179], v[12:15]
    ds_read_b64_tr_b16 v[150:151], v227 offset:2048
    v_mfma_f32_16x16x32_bf16 v[16:19], v[208:211], v[176:179], v[16:19]
    ds_read_b128 v[132:135], v224 offset:1024
    v_mfma_f32_16x16x32_bf16 v[20:23], v[212:215], v[176:179], v[20:23]
    ds_read_b64_tr_b16 v[152:153], v228 offset:0
    v_mfma_f32_16x16x32_bf16 v[24:27], v[216:219], v[176:179], v[24:27]
    ds_read_b64_tr_b16 v[154:155], v228 offset:2048
    v_mfma_f32_16x16x32_bf16 v[28:31], v[220:223], v[176:179], v[28:31]
    ds_read_b64_tr_b16 v[156:157], v229 offset:0
    v_mfma_f32_16x16x32_bf16 v[32:35], v[192:195], v[180:183], v[32:35]
    ds_read_b64_tr_b16 v[158:159], v229 offset:2048
    v_mfma_f32_16x16x32_bf16 v[36:39], v[196:199], v[180:183], v[36:39]
    ds_read_b64_tr_b16 v[160:161], v230 offset:0
    v_mfma_f32_16x16x32_bf16 v[40:43], v[200:203], v[180:183], v[40:43]
    ds_read_b64_tr_b16 v[162:163], v230 offset:2048
    v_mfma_f32_16x16x32_bf16 v[44:47], v[204:207], v[180:183], v[44:47]
    ds_read_b64_tr_b16 v[164:165], v231 offset:0
    v_mfma_f32_16x16x32_bf16 v[48:51], v[208:211], v[180:183], v[48:51]
    ds_read_b64_tr_b16 v[166:167], v231 offset:2048
    v_mfma_f32_16x16x32_bf16 v[52:55], v[212:215], v[180:183], v[52:55]
    ds_read_b64_tr_b16 v[168:169], v232 offset:0
    v_mfma_f32_16x16x32_bf16 v[56:59], v[216:219], v[180:183], v[56:59]
    ds_read_b64_tr_b16 v[170:171], v232 offset:2048
    v_mfma_f32_16x16x32_bf16 v[60:63], v[220:223], v[180:183], v[60:63]
    ds_read_b64_tr_b16 v[172:173], v233 offset:0
    v_mfma_f32_16x16x32_bf16 v[64:67], v[192:195], v[184:187], v[64:67]
    ds_read_b64_tr_b16 v[174:175], v233 offset:2048
    v_mfma_f32_16x16x32_bf16 v[68:71], v[196:199], v[184:187], v[68:71]
    ds_read_b128 v[136:139], v224 offset:4096
    v_mfma_f32_16x16x32_bf16 v[72:75], v[200:203], v[184:187], v[72:75]
    ds_read_b128 v[140:143], v224 offset:5120
    v_mfma_f32_16x16x32_bf16 v[76:79], v[204:207], v[184:187], v[76:79]
    s_add_u32 m0, s33, 49152
    v_mfma_f32_16x16x32_bf16 v[80:83], v[208:211], v[184:187], v[80:83]
    s_nop 0
    v_mfma_f32_16x16x32_bf16 v[84:87], v[212:215], v[184:187], v[84:87]
    buffer_load_dwordx4 v248, s[8:11], s30 offen offset:0 lds
    v_mfma_f32_16x16x32_bf16 v[88:91], v[216:219], v[184:187], v[88:91]
    buffer_load_dwordx4 v249, s[8:11], s30 offen offset:1024 lds
    v_mfma_f32_16x16x32_bf16 v[92:95], v[220:223], v[184:187], v[92:95]
    s_add_u32 s31, s40, s42
    v_mfma_f32_16x16x32_bf16 v[96:99], v[192:195], v[188:191], v[96:99]
    s_and_b32 s31, s31, 3
    v_mfma_f32_16x16x32_bf16 v[100:103], v[196:199], v[188:191], v[100:103]
    s_andn2_b32 s37, s40, 3
    v_mfma_f32_16x16x32_bf16 v[104:107], v[200:203], v[188:191], v[104:107]
    s_or_b32 s31, s31, s37
    v_mfma_f32_16x16x32_bf16 v[108:111], v[204:207], v[188:191], v[108:111]
    s_add_u32 s40, s40, 1
    v_mfma_f32_16x16x32_bf16 v[112:115], v[208:211], v[188:191], v[112:115]
    s_add_u32 m0, s27, s32
    v_mfma_f32_16x16x32_bf16 v[116:119], v[212:215], v[188:191], v[116:119]
    s_lshl_b32 s31, s31, 7
    v_mfma_f32_16x16x32_bf16 v[120:123], v[216:219], v[188:191], v[120:123]
    buffer_load_dwordx4 v240, s[4:7], s31 offen offset:0 lds
    v_mfma_f32_16x16x32_bf16 v[124:127], v[220:223], v[188:191], v[124:127]
    buffer_load_dwordx4 v241, s[4:7], s31 offen offset:1024 lds
    s_waitcnt vmcnt(10) lgkmcnt(0)
    s_barrier
    v_mfma_f32_16x16x32_bf16 v[0:3], v[144:147], v[128:131], v[0:3]
    ds_read_b128 v[176:179], v225 offset:0
    ds_read_b64_tr_b16 v[192:193], v226 offset:16384
    v_mfma_f32_16x16x32_bf16 v[4:7], v[148:151], v[128:131], v[4:7]
    ds_read_b64_tr_b16 v[194:195], v226 offset:18432
    v_mfma_f32_16x16x32_bf16 v[8:11], v[152:155], v[128:131], v[8:11]
    ds_read_b64_tr_b16 v[196:197], v227 offset:16384
    ds_read_b64_tr_b16 v[198:199], v227 offset:18432
    v_mfma_f32_16x16x32_bf16 v[12:15], v[156:159], v[128:131], v[12:15]
    ds_read_b128 v[180:183], v225 offset:1024
    v_mfma_f32_16x16x32_bf16 v[16:19], v[160:163], v[128:131], v[16:19]
    ds_read_b64_tr_b16 v[200:201], v228 offset:16384
    ds_read_b64_tr_b16 v[202:203], v228 offset:18432
    v_mfma_f32_16x16x32_bf16 v[20:23], v[164:167], v[128:131], v[20:23]
    ds_read_b64_tr_b16 v[204:205], v229 offset:16384
    v_mfma_f32_16x16x32_bf16 v[24:27], v[168:171], v[128:131], v[24:27]
    ds_read_b64_tr_b16 v[206:207], v229 offset:18432
    ds_read_b64_tr_b16 v[208:209], v230 offset:16384
    v_mfma_f32_16x16x32_bf16 v[28:31], v[172:175], v[128:131], v[28:31]
    ds_read_b64_tr_b16 v[210:211], v230 offset:18432
    v_mfma_f32_16x16x32_bf16 v[32:35], v[144:147], v[132:135], v[32:35]
    ds_read_b64_tr_b16 v[212:213], v231 offset:16384
    v_mfma_f32_16x16x32_bf16 v[36:39], v[148:151], v[132:135], v[36:39]
    ds_read_b64_tr_b16 v[214:215], v231 offset:18432
    ds_read_b64_tr_b16 v[216:217], v232 offset:16384
    v_mfma_f32_16x16x32_bf16 v[40:43], v[152:155], v[132:135], v[40:43]
    ds_read_b64_tr_b16 v[218:219], v232 offset:18432
    v_mfma_f32_16x16x32_bf16 v[44:47], v[156:159], v[132:135], v[44:47]
    ds_read_b64_tr_b16 v[220:221], v233 offset:16384
    ds_read_b64_tr_b16 v[222:223], v233 offset:18432
    v_mfma_f32_16x16x32_bf16 v[48:51], v[160:163], v[132:135], v[48:51]
    ds_read_b128 v[184:187], v225 offset:4096
    v_mfma_f32_16x16x32_bf16 v[52:55], v[164:167], v[132:135], v[52:55]
    ds_read_b128 v[188:191], v225 offset:5120
    s_add_u32 s30, s41, s42
    v_mfma_f32_16x16x32_bf16 v[56:59], v[168:171], v[132:135], v[56:59]
    s_and_b32 s30, s30, 3
    v_mfma_f32_16x16x32_bf16 v[60:63], v[172:175], v[132:135], v[60:63]
    s_andn2_b32 s37, s41, 3
    v_mfma_f32_16x16x32_bf16 v[64:67], v[144:147], v[136:139], v[64:67]
    s_or_b32 s30, s30, s37
    s_add_u32 s41, s41, 1
    v_mfma_f32_16x16x32_bf16 v[68:71], v[148:151], v[136:139], v[68:71]
    s_mul_i32 s30, s30, s44
    v_mfma_f32_16x16x32_bf16 v[72:75], v[152:155], v[136:139], v[72:75]
    s_lshl_b32 s30, s30, 1
    s_add_u32 m0, s33, 0
    v_mfma_f32_16x16x32_bf16 v[76:79], v[156:159], v[136:139], v[76:79]
    s_nop 0
    v_mfma_f32_16x16x32_bf16 v[80:83], v[160:163], v[136:139], v[80:83]
    buffer_load_dwordx4 v248, s[8:11], s30 offen offset:0 lds
    buffer_load_dwordx4 v249, s[8:11], s30 offen offset:1024 lds
    v_mfma_f32_16x16x32_bf16 v[84:87], v[164:167], v[136:139], v[84:87]
    s_add_u32 s30, s30, s44
    v_mfma_f32_16x16x32_bf16 v[88:91], v[168:171], v[136:139], v[88:91]
    s_add_u32 s35, s27, s32
    s_add_u32 m0, s35, 0x800
    v_mfma_f32_16x16x32_bf16 v[92:95], v[172:175], v[136:139], v[92:95]
    s_add_u32 s27, s27, 0x8000
    v_mfma_f32_16x16x32_bf16 v[96:99], v[144:147], v[140:143], v[96:99]
    buffer_load_dwordx4 v242, s[4:7], s31 offen offset:0 lds
    v_mfma_f32_16x16x32_bf16 v[100:103], v[148:151], v[140:143], v[100:103]
    buffer_load_dwordx4 v243, s[4:7], s31 offen offset:1024 lds
    s_cmp_ge_u32 s27, 0x28000
    v_mfma_f32_16x16x32_bf16 v[104:107], v[152:155], v[140:143], v[104:107]
    s_cselect_b32 s27, 0x10000, s27
    v_mfma_f32_16x16x32_bf16 v[108:111], v[156:159], v[140:143], v[108:111]
    s_add_u32 s36, s28, 0x8000
    s_cmp_ge_u32 s36, 0x18000
    v_mfma_f32_16x16x32_bf16 v[112:115], v[160:163], v[140:143], v[112:115]
    s_cselect_b32 s36, 0, s36
    v_mfma_f32_16x16x32_bf16 v[116:119], v[164:167], v[140:143], v[116:119]
    s_sub_u32 s29, s36, s28
    s_mov_b32 s28, s36
    v_mfma_f32_16x16x32_bf16 v[120:123], v[168:171], v[140:143], v[120:123]
    v_add_u32 v224, s29, v224
    v_mfma_f32_16x16x32_bf16 v[124:127], v[172:175], v[140:143], v[124:127]
    v_add_u32 v225, s29, v225
    s_waitcnt vmcnt(8) lgkmcnt(0)
    s_barrier
    v_mfma_f32_16x16x32_bf16 v[0:3], v[192:195], v[176:179], v[0:3]
    ds_read_b128 v[128:131], v224 offset:0
    v_mfma_f32_16x16x32_bf16 v[4:7], v[196:199], v[176:179], v[4:7]
    ds_read_b64_tr_b16 v[144:145], v226 offset:32768
    v_mfma_f32_16x16x32_bf16 v[8:11], v[200:203], v[176:179], v[8:11]
    ds_read_b64_tr_b16 v[146:147], v226 offset:34816
    v_mfma_f32_16x16x32_bf16 v[12:15], v[204:207], v[176:179], v[12:15]
    v_mfma_f32_16x16x32_bf16 v[16:19], v[208:211], v[176:179], v[16:19]
    ds_read_b64_tr_b16 v[148:149], v227 offset:32768
    v_mfma_f32_16x16x32_bf16 v[20:23], v[212:215], v[176:179], v[20:23]
    ds_read_b64_tr_b16 v[150:151], v227 offset:34816
    v_mfma_f32_16x16x32_bf16 v[24:27], v[216:219], v[176:179], v[24:27]
    ds_read_b128 v[132:135], v224 offset:1024
    v_mfma_f32_16x16x32_bf16 v[28:31], v[220:223], v[176:179], v[28:31]
    v_mfma_f32_16x16x32_bf16 v[32:35], v[192:195], v[180:183], v[32:35]
    ds_read_b64_tr_b16 v[152:153], v228 offset:32768
    v_mfma_f32_16x16x32_bf16 v[36:39], v[196:199], v[180:183], v[36:39]
    ds_read_b64_tr_b16 v[154:155], v228 offset:34816
    v_mfma_f32_16x16x32_bf16 v[40:43], v[200:203], v[180:183], v[40:43]
    ds_read_b64_tr_b16 v[156:157], v229 offset:32768
    v_mfma_f32_16x16x32_bf16 v[44:47], v[204:207], v[180:183], v[44:47]
    v_mfma_f32_16x16x32_bf16 v[48:51], v[208:211], v[180:183], v[48:51]
    ds_read_b64_tr_b16 v[158:159], v229 offset:34816
    v_mfma_f32_16x16x32_bf16 v[52:55], v[212:215], v[180:183], v[52:55]
    ds_read_b64_tr_b16 v[160:161], v230 offset:32768
    v_mfma_f32_16x16x32_bf16 v[56:59], v[216:219], v[180:183], v[56:59]
    ds_read_b64_tr_b16 v[162:163], v230 offset:34816
    v_mfma_f32_16x16x32_bf16 v[60:63], v[220:223], v[180:183], v[60:63]
    v_mfma_f32_16x16x32_bf16 v[64:67], v[192:195], v[184:187], v[64:67]
    ds_read_b64_tr_b16 v[164:165], v231 offset:32768
    v_mfma_f32_16x16x32_bf16 v[68:71], v[196:199], v[184:187], v[68:71]
    ds_read_b64_tr_b16 v[166:167], v231 offset:34816
    v_mfma_f32_16x16x32_bf16 v[72:75], v[200:203], v[184:187], v[72:75]
    ds_read_b64_tr_b16 v[168:169], v232 offset:32768
    v_mfma_f32_16x16x32_bf16 v[76:79], v[204:207], v[184:187], v[76:79]
    v_mfma_f32_16x16x32_bf16 v[80:83], v[208:211], v[184:187], v[80:83]
    ds_read_b64_tr_b16 v[170:171], v232 offset:34816
    v_mfma_f32_16x16x32_bf16 v[84:87], v[212:215], v[184:187], v[84:87]
    ds_read_b64_tr_b16 v[172:173], v233 offset:32768
    v_mfma_f32_16x16x32_bf16 v[88:91], v[216:219], v[184:187], v[88:91]
    ds_read_b64_tr_b16 v[174:175], v233 offset:34816
    v_mfma_f32_16x16x32_bf16 v[92:95], v[220:223], v[184:187], v[92:95]
    v_mfma_f32_16x16x32_bf16 v[96:99], v[192:195], v[188:191], v[96:99]
    ds_read_b128 v[136:139], v224 offset:4096
    v_mfma_f32_16x16x32_bf16 v[100:103], v[196:199], v[188:191], v[100:103]
    ds_read_b128 v[140:143], v224 offset:5120
    v_mfma_f32_16x16x32_bf16 v[104:107], v[200:203], v[188:191], v[104:107]
    s_add_u32 m0, s33, 16384
    v_mfma_f32_16x16x32_bf16 v[108:111], v[204:207], v[188:191], v[108:111]
    v_mfma_f32_16x16x32_bf16 v[112:115], v[208:211], v[188:191], v[112:115]
    s_nop 0
    v_mfma_f32_16x16x32_bf16 v[116:119], v[212:215], v[188:191], v[116:119]
    buffer_load_dwordx4 v248, s[8:11], s30 offen offset:0 lds
    v_mfma_f32_16x16x32_bf16 v[120:123], v[216:219], v[188:191], v[120:123]
    buffer_load_dwordx4 v249, s[8:11], s30 offen offset:1024 lds
    v_mfma_f32_16x16x32_bf16 v[124:127], v[220:223], v[188:191], v[124:127]
    s_waitcnt vmcnt(8) lgkmcnt(0)
    s_barrier
    v_mfma_f32_16x16x32_bf16 v[0:3], v[144:147], v[128:131], v[0:3]
    ds_read_b128 v[176:179], v225 offset:0
    v_mfma_f32_16x16x32_bf16 v[4:7], v[148:151], v[128:131], v[4:7]
    ds_read_b64_tr_b16 v[192:193], v226 offset:49152
    v_mfma_f32_16x16x32_bf16 v[8:11], v[152:155], v[128:131], v[8:11]
    ds_read_b64_tr_b16 v[194:195], v226 offset:51200
    v_mfma_f32_16x16x32_bf16 v[12:15], v[156:159], v[128:131], v[12:15]
    ds_read_b64_tr_b16 v[196:197], v227 offset:49152
    v_mfma_f32_16x16x32_bf16 v[16:19], v[160:163], v[128:131], v[16:19]
    ds_read_b64_tr_b16 v[198:199], v227 offset:51200
    v_mfma_f32_16x16x32_bf16 v[20:23], v[164:167], v[128:131], v[20:23]
    ds_read_b128 v[180:183], v225 offset:1024
    v_mfma_f32_16x16x32_bf16 v[24:27], v[168:171], v[128:131], v[24:27]
    v_mfma_f32_16x16x32_bf16 v[28:31], v[172:175], v[128:131], v[28:31]
    ds_read_b64_tr_b16 v[200:201], v228 offset:49152
    v_mfma_f32_16x16x32_bf16 v[32:35], v[144:147], v[132:135], v[32:35]
    ds_read_b64_tr_b16 v[202:203], v228 offset:51200
    v_mfma_f32_16x16x32_bf16 v[36:39], v[148:151], v[132:135], v[36:39]
    ds_read_b64_tr_b16 v[204:205], v229 offset:49152
    v_mfma_f32_16x16x32_bf16 v[40:43], v[152:155], v[132:135], v[40:43]
    ds_read_b64_tr_b16 v[206:207], v229 offset:51200
    v_mfma_f32_16x16x32_bf16 v[44:47], v[156:159], v[132:135], v[44:47]
    ds_read_b64_tr_b16 v[208:209], v230 offset:49152
    v_mfma_f32_16x16x32_bf16 v[48:51], v[160:163], v[132:135], v[48:51]
    v_mfma_f32_16x16x32_bf16 v[52:55], v[164:167], v[132:135], v[52:55]
    ds_read_b64_tr_b16 v[210:211], v230 offset:51200
    v_mfma_f32_16x16x32_bf16 v[56:59], v[168:171], v[132:135], v[56:59]
    ds_read_b64_tr_b16 v[212:213], v231 offset:49152
    v_mfma_f32_16x16x32_bf16 v[60:63], v[172:175], v[132:135], v[60:63]
    ds_read_b64_tr_b16 v[214:215], v231 offset:51200
    v_mfma_f32_16x16x32_bf16 v[64:67], v[144:147], v[136:139], v[64:67]
    ds_read_b64_tr_b16 v[216:217], v232 offset:49152
    v_mfma_f32_16x16x32_bf16 v[68:71], v[148:151], v[136:139], v[68:71]
    ds_read_b64_tr_b16 v[218:219], v232 offset:51200
    v_mfma_f32_16x16x32_bf16 v[72:75], v[152:155], v[136:139], v[72:75]
    ds_read_b64_tr_b16 v[220:221], v233 offset:49152
    v_mfma_f32_16x16x32_bf16 v[76:79], v[156:159], v[136:139], v[76:79]
    v_mfma_f32_16x16x32_bf16 v[80:83], v[160:163], v[136:139], v[80:83]
    ds_read_b64_tr_b16 v[222:223], v233 offset:51200
    v_mfma_f32_16x16x32_bf16 v[84:87], v[164:167], v[136:139], v[84:87]
    ds_read_b128 v[184:187], v225 offset:4096
    v_mfma_f32_16x16x32_bf16 v[88:91], v[168:171], v[136:139], v[88:91]
    ds_read_b128 v[188:191], v225 offset:5120
    v_mfma_f32_16x16x32_bf16 v[92:95], v[172:175], v[136:139], v[92:95]
    s_add_u32 s36, s28, 0x8000
    v_mfma_f32_16x16x32_bf16 v[96:99], v[144:147], v[140:143], v[96:99]
    s_cmp_ge_u32 s36, 0x18000
    v_mfma_f32_16x16x32_bf16 v[100:103], v[148:151], v[140:143], v[100:103]
    v_mfma_f32_16x16x32_bf16 v[104:107], v[152:155], v[140:143], v[104:107]
    s_cselect_b32 s36, 0, s36
    v_mfma_f32_16x16x32_bf16 v[108:111], v[156:159], v[140:143], v[108:111]
    s_sub_u32 s29, s36, s28
    v_mfma_f32_16x16x32_bf16 v[112:115], v[160:163], v[140:143], v[112:115]
    s_mov_b32 s28, s36
    v_mfma_f32_16x16x32_bf16 v[116:119], v[164:167], v[140:143], v[116:119]
    v_add_u32 v224, s29, v224
    v_mfma_f32_16x16x32_bf16 v[120:123], v[168:171], v[140:143], v[120:123]
    v_add_u32 v225, s29, v225
    v_mfma_f32_16x16x32_bf16 v[124:127], v[172:175], v[140:143], v[124:127]
    s_waitcnt vmcnt(2) lgkmcnt(0)
    s_barrier
    v_mfma_f32_16x16x32_bf16 v[0:3], v[192:195], v[176:179], v[0:3]
    ds_read_b128 v[128:131], v224 offset:0
    v_mfma_f32_16x16x32_bf16 v[4:7], v[196:199], v[176:179], v[4:7]
    ds_read_b64_tr_b16 v[144:145], v226 offset:0
    v_mfma_f32_16x16x32_bf16 v[8:11], v[200:203], v[176:179], v[8:11]
    v_mfma_f32_16x16x32_bf16 v[12:15], v[204:207], v[176:179], v[12:15]
    ds_read_b64_tr_b16 v[146:147], v226 offset:2048
    v_mfma_f32_16x16x32_bf16 v[16:19], v[208:211], v[176:179], v[16:19]
    ds_read_b64_tr_b16 v[148:149], v227 offset:0
    v_mfma_f32_16x16x32_bf16 v[20:23], v[212:215], v[176:179], v[20:23]
    v_mfma_f32_16x16x32_bf16 v[24:27], v[216:219], v[176:179], v[24:27]
    ds_read_b64_tr_b16 v[150:151], v227 offset:2048
    v_mfma_f32_16x16x32_bf16 v[28:31], v[220:223], v[176:179], v[28:31]
    v_mfma_f32_16x16x32_bf16 v[32:35], v[192:195], v[180:183], v[32:35]
    ds_read_b128 v[132:135], v224 offset:1024
    v_mfma_f32_16x16x32_bf16 v[36:39], v[196:199], v[180:183], v[36:39]
    ds_read_b64_tr_b16 v[152:153], v228 offset:0
    v_mfma_f32_16x16x32_bf16 v[40:43], v[200:203], v[180:183], v[40:43]
    v_mfma_f32_16x16x32_bf16 v[44:47], v[204:207], v[180:183], v[44:47]
    ds_read_b64_tr_b16 v[154:155], v228 offset:2048
    v_mfma_f32_16x16x32_bf16 v[48:51], v[208:211], v[180:183], v[48:51]
    ds_read_b64_tr_b16 v[156:157], v229 offset:0
    v_mfma_f32_16x16x32_bf16 v[52:55], v[212:215], v[180:183], v[52:55]
    v_mfma_f32_16x16x32_bf16 v[56:59], v[216:219], v[180:183], v[56:59]
    ds_read_b64_tr_b16 v[158:159], v229 offset:2048
    v_mfma_f32_16x16x32_bf16 v[60:63], v[220:223], v[180:183], v[60:63]
    v_mfma_f32_16x16x32_bf16 v[64:67], v[192:195], v[184:187], v[64:67]
    ds_read_b64_tr_b16 v[160:161], v230 offset:0
    v_mfma_f32_16x16x32_bf16 v[68:71], v[196:199], v[184:187], v[68:71]
    ds_read_b64_tr_b16 v[162:163], v230 offset:2048
    v_mfma_f32_16x16x32_bf16 v[72:75], v[200:203], v[184:187], v[72:75]
    v_mfma_f32_16x16x32_bf16 v[76:79], v[204:207], v[184:187], v[76:79]
    ds_read_b64_tr_b16 v[164:165], v231 offset:0
    v_mfma_f32_16x16x32_bf16 v[80:83], v[208:211], v[184:187], v[80:83]
    ds_read_b64_tr_b16 v[166:167], v231 offset:2048
    v_mfma_f32_16x16x32_bf16 v[84:87], v[212:215], v[184:187], v[84:87]
    v_mfma_f32_16x16x32_bf16 v[88:91], v[216:219], v[184:187], v[88:91]
    ds_read_b64_tr_b16 v[168:169], v232 offset:0
    v_mfma_f32_16x16x32_bf16 v[92:95], v[220:223], v[184:187], v[92:95]
    v_mfma_f32_16x16x32_bf16 v[96:99], v[192:195], v[188:191], v[96:99]
    ds_read_b64_tr_b16 v[170:171], v232 offset:2048
    v_mfma_f32_16x16x32_bf16 v[100:103], v[196:199], v[188:191], v[100:103]
    ds_read_b64_tr_b16 v[172:173], v233 offset:0
    v_mfma_f32_16x16x32_bf16 v[104:107], v[200:203], v[188:191], v[104:107]
    v_mfma_f32_16x16x32_bf16 v[108:111], v[204:207], v[188:191], v[108:111]
    ds_read_b64_tr_b16 v[174:175], v233 offset:2048
    v_mfma_f32_16x16x32_bf16 v[112:115], v[208:211], v[188:191], v[112:115]
    ds_read_b128 v[136:139], v224 offset:4096
    v_mfma_f32_16x16x32_bf16 v[116:119], v[212:215], v[188:191], v[116:119]
    v_mfma_f32_16x16x32_bf16 v[120:123], v[216:219], v[188:191], v[120:123]
    ds_read_b128 v[140:143], v224 offset:5120
    v_mfma_f32_16x16x32_bf16 v[124:127], v[220:223], v[188:191], v[124:127]
    s_waitcnt vmcnt(0) lgkmcnt(0)
    s_barrier
    v_mfma_f32_16x16x32_bf16 v[0:3], v[144:147], v[128:131], v[0:3]
    ds_read_b128 v[176:179], v225 offset:0
    v_mfma_f32_16x16x32_bf16 v[4:7], v[148:151], v[128:131], v[4:7]
    ds_read_b64_tr_b16 v[192:193], v226 offset:16384
    v_mfma_f32_16x16x32_bf16 v[8:11], v[152:155], v[128:131], v[8:11]
    ds_read_b64_tr_b16 v[194:195], v226 offset:18432
    v_mfma_f32_16x16x32_bf16 v[12:15], v[156:159], v[128:131], v[12:15]
    ds_read_b64_tr_b16 v[196:197], v227 offset:16384
    v_mfma_f32_16x16x32_bf16 v[16:19], v[160:163], v[128:131], v[16:19]
    ds_read_b64_tr_b16 v[198:199], v227 offset:18432
    v_mfma_f32_16x16x32_bf16 v[20:23], v[164:167], v[128:131], v[20:23]
    ds_read_b128 v[180:183], v225 offset:1024
    v_mfma_f32_16x16x32_bf16 v[24:27], v[168:171], v[128:131], v[24:27]
    v_mfma_f32_16x16x32_bf16 v[28:31], v[172:175], v[128:131], v[28:31]
    ds_read_b64_tr_b16 v[200:201], v228 offset:16384
    v_mfma_f32_16x16x32_bf16 v[32:35], v[144:147], v[132:135], v[32:35]
    ds_read_b64_tr_b16 v[202:203], v228 offset:18432
    v_mfma_f32_16x16x32_bf16 v[36:39], v[148:151], v[132:135], v[36:39]
    ds_read_b64_tr_b16 v[204:205], v229 offset:16384
    v_mfma_f32_16x16x32_bf16 v[40:43], v[152:155], v[132:135], v[40:43]
    ds_read_b64_tr_b16 v[206:207], v229 offset:18432
    v_mfma_f32_16x16x32_bf16 v[44:47], v[156:159], v[132:135], v[44:47]
    ds_read_b64_tr_b16 v[208:209], v230 offset:16384
    v_mfma_f32_16x16x32_bf16 v[48:51], v[160:163], v[132:135], v[48:51]
    v_mfma_f32_16x16x32_bf16 v[52:55], v[164:167], v[132:135], v[52:55]
    ds_read_b64_tr_b16 v[210:211], v230 offset:18432
    v_mfma_f32_16x16x32_bf16 v[56:59], v[168:171], v[132:135], v[56:59]
    ds_read_b64_tr_b16 v[212:213], v231 offset:16384
    v_mfma_f32_16x16x32_bf16 v[60:63], v[172:175], v[132:135], v[60:63]
    ds_read_b64_tr_b16 v[214:215], v231 offset:18432
    v_mfma_f32_16x16x32_bf16 v[64:67], v[144:147], v[136:139], v[64:67]
    ds_read_b64_tr_b16 v[216:217], v232 offset:16384
    v_mfma_f32_16x16x32_bf16 v[68:71], v[148:151], v[136:139], v[68:71]
    ds_read_b64_tr_b16 v[218:219], v232 offset:18432
    v_mfma_f32_16x16x32_bf16 v[72:75], v[152:155], v[136:139], v[72:75]
    ds_read_b64_tr_b16 v[220:221], v233 offset:16384
    v_mfma_f32_16x16x32_bf16 v[76:79], v[156:159], v[136:139], v[76:79]
    v_mfma_f32_16x16x32_bf16 v[80:83], v[160:163], v[136:139], v[80:83]
    ds_read_b64_tr_b16 v[222:223], v233 offset:18432
    v_mfma_f32_16x16x32_bf16 v[84:87], v[164:167], v[136:139], v[84:87]
    ds_read_b128 v[184:187], v225 offset:4096
    v_mfma_f32_16x16x32_bf16 v[88:91], v[168:171], v[136:139], v[88:91]
    ds_read_b128 v[188:191], v225 offset:5120
    v_mfma_f32_16x16x32_bf16 v[92:95], v[172:175], v[136:139], v[92:95]
    s_add_u32 s36, s28, 0x8000
    v_mfma_f32_16x16x32_bf16 v[96:99], v[144:147], v[140:143], v[96:99]
    s_cmp_ge_u32 s36, 0x18000
    v_mfma_f32_16x16x32_bf16 v[100:103], v[148:151], v[140:143], v[100:103]
    v_mfma_f32_16x16x32_bf16 v[104:107], v[152:155], v[140:143], v[104:107]
    s_cselect_b32 s36, 0, s36
    v_mfma_f32_16x16x32_bf16 v[108:111], v[156:159], v[140:143], v[108:111]
    s_sub_u32 s29, s36, s28
    v_mfma_f32_16x16x32_bf16 v[112:115], v[160:163], v[140:143], v[112:115]
    s_mov_b32 s28, s36
    v_mfma_f32_16x16x32_bf16 v[116:119], v[164:167], v[140:143], v[116:119]
    v_add_u32 v224, s29, v224
    v_mfma_f32_16x16x32_bf16 v[120:123], v[168:171], v[140:143], v[120:123]
    v_add_u32 v225, s29, v225
    v_mfma_f32_16x16x32_bf16 v[124:127], v[172:175], v[140:143], v[124:127]
    s_waitcnt lgkmcnt(0)
    v_mfma_f32_16x16x32_bf16 v[0:3], v[192:195], v[176:179], v[0:3]
    v_mfma_f32_16x16x32_bf16 v[4:7], v[196:199], v[176:179], v[4:7]
    v_mfma_f32_16x16x32_bf16 v[8:11], v[200:203], v[176:179], v[8:11]
    v_mfma_f32_16x16x32_bf16 v[12:15], v[204:207], v[176:179], v[12:15]
    v_mfma_f32_16x16x32_bf16 v[16:19], v[208:211], v[176:179], v[16:19]
    v_mfma_f32_16x16x32_bf16 v[20:23], v[212:215], v[176:179], v[20:23]
    v_mfma_f32_16x16x32_bf16 v[24:27], v[216:219], v[176:179], v[24:27]
    v_mfma_f32_16x16x32_bf16 v[28:31], v[220:223], v[176:179], v[28:31]
    v_mfma_f32_16x16x32_bf16 v[32:35], v[192:195], v[180:183], v[32:35]
    v_mfma_f32_16x16x32_bf16 v[36:39], v[196:199], v[180:183], v[36:39]
    v_mfma_f32_16x16x32_bf16 v[40:43], v[200:203], v[180:183], v[40:43]
    v_mfma_f32_16x16x32_bf16 v[44:47], v[204:207], v[180:183], v[44:47]
    v_mfma_f32_16x16x32_bf16 v[48:51], v[208:211], v[180:183], v[48:51]
    v_mfma_f32_16x16x32_bf16 v[52:55], v[212:215], v[180:183], v[52:55]
    v_mfma_f32_16x16x32_bf16 v[56:59], v[216:219], v[180:183], v[56:59]
    v_mfma_f32_16x16x32_bf16 v[60:63], v[220:223], v[180:183], v[60:63]
    v_mfma_f32_16x16x32_bf16 v[64:67], v[192:195], v[184:187], v[64:67]
    v_mfma_f32_16x16x32_bf16 v[68:71], v[196:199], v[184:187], v[68:71]
    v_mfma_f32_16x16x32_bf16 v[72:75], v[200:203], v[184:187], v[72:75]
    v_mfma_f32_16x16x32_bf16 v[76:79], v[204:207], v[184:187], v[76:79]
    v_mfma_f32_16x16x32_bf16 v[80:83], v[208:211], v[184:187], v[80:83]
    v_mfma_f32_16x16x32_bf16 v[84:87], v[212:215], v[184:187], v[84:87]
    v_mfma_f32_16x16x32_bf16 v[88:91], v[216:219], v[184:187], v[88:91]
    v_mfma_f32_16x16x32_bf16 v[92:95], v[220:223], v[184:187], v[92:95]
    v_mfma_f32_16x16x32_bf16 v[96:99], v[192:195], v[188:191], v[96:99]
    v_mfma_f32_16x16x32_bf16 v[100:103], v[196:199], v[188:191], v[100:103]
    v_mfma_f32_16x16x32_bf16 v[104:107], v[200:203], v[188:191], v[104:107]
    v_mfma_f32_16x16x32_bf16 v[108:111], v[204:207], v[188:191], v[108:111]
    v_mfma_f32_16x16x32_bf16 v[112:115], v[208:211], v[188:191], v[112:115]
    v_mfma_f32_16x16x32_bf16 v[116:119], v[212:215], v[188:191], v[116:119]
    v_mfma_f32_16x16x32_bf16 v[120:123], v[216:219], v[188:191], v[120:123]
    v_mfma_f32_16x16x32_bf16 v[124:127], v[220:223], v[188:191], v[124:127]
    s_nop 7
    s_lshl_b32 s35, s48, 6
    s_lshl_b32 s36, s50, 3
    s_add_u32 s35, s35, s36
    s_lshl_b32 s36, s25, 1
    s_add_u32 s35, s35, s36
    s_lshl_b32 s35, s35, 5
    s_lshl_b32 s36, s49, 4
    s_add_u32 s35, s35, s36
    s_lshl_b32 s36, s26, 3
    s_add_u32 s35, s35, s36
    s_lshl_b32 s39, s35, 10
    v_cvt_pk_bf16_f32 v128, v0, v1
    v_cvt_pk_bf16_f32 v129, v2, v3
    v_cvt_pk_bf16_f32 v130, v4, v5
    v_cvt_pk_bf16_f32 v131, v6, v7
    buffer_store_dwordx4 v[128:131], v252, s[20:23], s39 offen offset:0 sc1
    v_cvt_pk_bf16_f32 v132, v32, v33
    v_cvt_pk_bf16_f32 v133, v34, v35
    v_cvt_pk_bf16_f32 v134, v36, v37
    v_cvt_pk_bf16_f32 v135, v38, v39
    buffer_store_dwordx4 v[132:135], v252, s[20:23], s39 offen offset:128 sc1
    v_cvt_pk_bf16_f32 v136, v8, v9
    v_cvt_pk_bf16_f32 v137, v10, v11
    v_cvt_pk_bf16_f32 v138, v12, v13
    v_cvt_pk_bf16_f32 v139, v14, v15
    buffer_store_dwordx4 v[136:139], v252, s[20:23], s39 offen offset:2048 sc1
    v_cvt_pk_bf16_f32 v140, v40, v41
    v_cvt_pk_bf16_f32 v141, v42, v43
    v_cvt_pk_bf16_f32 v142, v44, v45
    v_cvt_pk_bf16_f32 v143, v46, v47
    buffer_store_dwordx4 v[140:143], v252, s[20:23], s39 offen offset:2176 sc1
    s_add_u32 s39, s39, 4096
    v_cvt_pk_bf16_f32 v144, v16, v17
    v_cvt_pk_bf16_f32 v145, v18, v19
    v_cvt_pk_bf16_f32 v146, v20, v21
    v_cvt_pk_bf16_f32 v147, v22, v23
    buffer_store_dwordx4 v[144:147], v252, s[20:23], s39 offen offset:0 sc1
    v_cvt_pk_bf16_f32 v148, v48, v49
    v_cvt_pk_bf16_f32 v149, v50, v51
    v_cvt_pk_bf16_f32 v150, v52, v53
    v_cvt_pk_bf16_f32 v151, v54, v55
    buffer_store_dwordx4 v[148:151], v252, s[20:23], s39 offen offset:128 sc1
    v_cvt_pk_bf16_f32 v152, v24, v25
    v_cvt_pk_bf16_f32 v153, v26, v27
    v_cvt_pk_bf16_f32 v154, v28, v29
    v_cvt_pk_bf16_f32 v155, v30, v31
    buffer_store_dwordx4 v[152:155], v252, s[20:23], s39 offen offset:2048 sc1
    v_cvt_pk_bf16_f32 v156, v56, v57
    v_cvt_pk_bf16_f32 v157, v58, v59
    v_cvt_pk_bf16_f32 v158, v60, v61
    v_cvt_pk_bf16_f32 v159, v62, v63
    buffer_store_dwordx4 v[156:159], v252, s[20:23], s39 offen offset:2176 sc1
    s_add_u32 s39, s39, 28672
    v_cvt_pk_bf16_f32 v160, v64, v65
    v_cvt_pk_bf16_f32 v161, v66, v67
    v_cvt_pk_bf16_f32 v162, v68, v69
    v_cvt_pk_bf16_f32 v163, v70, v71
    buffer_store_dwordx4 v[160:163], v252, s[20:23], s39 offen offset:0 sc1
    v_cvt_pk_bf16_f32 v164, v96, v97
    v_cvt_pk_bf16_f32 v165, v98, v99
    v_cvt_pk_bf16_f32 v166, v100, v101
    v_cvt_pk_bf16_f32 v167, v102, v103
    buffer_store_dwordx4 v[164:167], v252, s[20:23], s39 offen offset:128 sc1
    v_cvt_pk_bf16_f32 v168, v72, v73
    v_cvt_pk_bf16_f32 v169, v74, v75
    v_cvt_pk_bf16_f32 v170, v76, v77
    v_cvt_pk_bf16_f32 v171, v78, v79
    buffer_store_dwordx4 v[168:171], v252, s[20:23], s39 offen offset:2048 sc1
    v_cvt_pk_bf16_f32 v172, v104, v105
    v_cvt_pk_bf16_f32 v173, v106, v107
    v_cvt_pk_bf16_f32 v174, v108, v109
    v_cvt_pk_bf16_f32 v175, v110, v111
    buffer_store_dwordx4 v[172:175], v252, s[20:23], s39 offen offset:2176 sc1
    s_add_u32 s39, s39, 4096
    v_cvt_pk_bf16_f32 v128, v80, v81
    v_cvt_pk_bf16_f32 v129, v82, v83
    v_cvt_pk_bf16_f32 v130, v84, v85
    v_cvt_pk_bf16_f32 v131, v86, v87
    buffer_store_dwordx4 v[128:131], v252, s[20:23], s39 offen offset:0 sc1
    v_cvt_pk_bf16_f32 v132, v112, v113
    v_cvt_pk_bf16_f32 v133, v114, v115
    v_cvt_pk_bf16_f32 v134, v116, v117
    v_cvt_pk_bf16_f32 v135, v118, v119
    buffer_store_dwordx4 v[132:135], v252, s[20:23], s39 offen offset:128 sc1
    v_cvt_pk_bf16_f32 v136, v88, v89
    v_cvt_pk_bf16_f32 v137, v90, v91
    v_cvt_pk_bf16_f32 v138, v92, v93
    v_cvt_pk_bf16_f32 v139, v94, v95
    buffer_store_dwordx4 v[136:139], v252, s[20:23], s39 offen offset:2048 sc1
    v_cvt_pk_bf16_f32 v140, v120, v121
    v_cvt_pk_bf16_f32 v141, v122, v123
    v_cvt_pk_bf16_f32 v142, v124, v125
    v_cvt_pk_bf16_f32 v143, v126, v127
    buffer_store_dwordx4 v[140:143], v252, s[20:23], s39 offen offset:2176 sc1
    s_add_u32 s39, s39, 28672
    s_branch K1_FIN
K1_21V:
    s_mov_b32 s40, 0
    s_add_u32 s31, s40, s43
    s_sub_u32 s37, s31, 7
    s_cmp_ge_u32 s31, 7
    s_cselect_b32 s31, s37, s31
    s_add_u32 s40, s40, 1
    s_add_u32 m0, s27, s32
    s_lshl_b32 s31, s31, 7
    buffer_load_dwordx4 v244, s[12:15], s31 offen offset:0 lds
    buffer_load_dwordx4 v245, s[12:15], s31 offen offset:1024 lds
    s_add_u32 s35, s27, s32
    s_add_u32 m0, s35, 0x800
    s_add_u32 s27, s27, 0x8000
    buffer_load_dwordx4 v246, s[12:15], s31 offen offset:0 lds
    buffer_load_dwordx4 v247, s[12:15], s31 offen offset:1024 lds
    s_cmp_ge_u32 s27, 0x28000
    s_cselect_b32 s27, 0x10000, s27
    s_mov_b32 s41, 0
    s_add_u32 s30, s41, s43
    s_sub_u32 s37, s30, 7
    s_cmp_ge_u32 s30, 7
    s_cselect_b32 s30, s37, s30
    s_add_u32 s41, s41, 1
    s_mul_i32 s30, s30, s45
    s_lshl_b32 s30, s30, 1
    s_add_u32 m0, s33, 0
    s_nop 0
    buffer_load_dwordx4 v250, s[16:19], s30 offen offset:0 lds
    buffer_load_dwordx4 v251, s[16:19], s30 offen offset:1024 lds
    s_add_u32 s30, s30, s45
    s_add_u32 m0, s33, 16384
    s_nop 0
    buffer_load_dwordx4 v250, s[16:19], s30 offen offset:0 lds
    buffer_load_dwordx4 v251, s[16:19], s30 offen offset:1024 lds
    s_add_u32 s31, s40, s43
    s_sub_u32 s37, s31, 7
    s_cmp_ge_u32 s31, 7
    s_cselect_b32 s31, s37, s31
    s_add_u32 s40, s40, 1
    s_add_u32 m0, s27, s32
    s_lshl_b32 s31, s31, 7
    buffer_load_dwordx4 v244, s[12:15], s31 offen offset:0 lds
    buffer_load_dwordx4 v245, s[12:15], s31 offen offset:1024 lds
    s_add_u32 s35, s27, s32
    s_add_u32 m0, s35, 0x800
    s_add_u32 s27, s27, 0x8000
    buffer_load_dwordx4 v246, s[12:15], s31 offen offset:0 lds
    buffer_load_dwordx4 v247, s[12:15], s31 offen offset:1024 lds
    s_cmp_ge_u32 s27, 0x28000
    s_cselect_b32 s27, 0x10000, s27
    s_add_u32 s30, s41, s43
    s_sub_u32 s37, s30, 7
    s_cmp_ge_u32 s30, 7
    s_cselect_b32 s30, s37, s30
    s_add_u32 s41, s41, 1
    s_mul_i32 s30, s30, s45
    s_lshl_b32 s30, s30, 1
    s_add_u32 m0, s33, 32768
    s_nop 0
    buffer_load_dwordx4 v250, s[16:19], s30 offen offset:0 lds
    buffer_load_dwordx4 v251, s[16:19], s30 offen offset:1024 lds
    s_add_u32 s30, s30, s45
    v_lshrrev_b32 v132, 4, v253
    v_bfe_u32 v128, v253, 3, 1
    v_and_b32 v129, 7, v253
    v_lshl_add_u32 v133, v128, 4, v129
    v_bfe_u32 v131, v253, 1, 2
    v_lshl_add_u32 v131, v128, 2, v131
    v_xor_b32 v131, v131, v132
    v_lshlrev_b32 v131, 4, v131
    s_lshl_b32 s35, s25, 6
    v_add_u32 v130, s35, v133
    v_lshl_add_u32 v130, v130, 7, v131
    v_add_u32 v224, 0x10000, v130
    v_xor_b32 v225, 64, v224
    v_bfe_u32 v128, v253, 2, 2
    v_lshl_add_u32 v134, v132, 3, v128
    v_bfe_u32 v130, v253, 1, 1
    v_bfe_u32 v131, v253, 4, 1
    v_lshl_add_u32 v130, v130, 1, v131
    v_lshlrev_b32 v130, 4, v130
    v_and_b32 v129, 1, v253
    v_lshl_add_u32 v135, v129, 3, v130
    v_lshl_add_u32 v129, v134, 9, v135
    s_lshl_b32 s35, s26, 2
    s_add_u32 s36, s35, 0
    v_xor_b32 v130, s36, v128
    v_lshl_add_u32 v226, v130, 6, v129
    v_xor_b32 v227, 16, v226
    s_add_u32 s36, s35, 1
    v_xor_b32 v130, s36, v128
    v_lshl_add_u32 v228, v130, 6, v129
    v_xor_b32 v229, 16, v228
    s_add_u32 s36, s35, 2
    v_xor_b32 v130, s36, v128
    v_lshl_add_u32 v230, v130, 6, v129
    v_xor_b32 v231, 16, v230
    s_add_u32 s36, s35, 3
    v_xor_b32 v130, s36, v128
    v_lshl_add_u32 v232, v130, 6, v129
    v_xor_b32 v233, 16, v232
    v_mul_u32_u24 v129, 384, v134
    v_add_u32 v129, v129, v135
    v_bfe_u32 v128, v253, 3, 1
    s_mul_i32 s35, s26, 3
    s_add_u32 s36, s35, 0
    v_xor_b32 v130, s36, v128
    v_lshl_add_u32 v234, v130, 6, v129
    v_xor_b32 v235, 16, v234
    s_add_u32 s36, s35, 1
    v_xor_b32 v130, s36, v128
    v_lshl_add_u32 v236, v130, 6, v129
    v_xor_b32 v237, 16, v236
    s_add_u32 s36, s35, 2
    v_xor_b32 v130, s36, v128
    v_lshl_add_u32 v238, v130, 6, v129
    v_xor_b32 v239, 16, v238
    v_lshrrev_b32 v130, 5, v253
    v_lshl_add_u32 v129, v131, 5, v133
    v_lshlrev_b32 v129, 4, v129
    v_lshl_add_u32 v252, v130, 10, v129
    s_waitcnt vmcnt(8) lgkmcnt(0)
    s_barrier
    ds_read_b128 v[128:131], v224 offset:0
    ds_read_b64_tr_b16 v[144:145], v234 offset:0
    ds_read_b64_tr_b16 v[146:147], v234 offset:1536
    ds_read_b64_tr_b16 v[148:149], v235 offset:0
    ds_read_b64_tr_b16 v[150:151], v235 offset:1536
    ds_read_b128 v[132:135], v224 offset:1024
    ds_read_b64_tr_b16 v[152:153], v236 offset:0
    ds_read_b64_tr_b16 v[154:155], v236 offset:1536
    ds_read_b64_tr_b16 v[156:157], v237 offset:0
    ds_read_b64_tr_b16 v[158:159], v237 offset:1536
    ds_read_b64_tr_b16 v[160:161], v238 offset:0
    ds_read_b64_tr_b16 v[162:163], v238 offset:1536
    ds_read_b64_tr_b16 v[164:165], v239 offset:0
    ds_read_b64_tr_b16 v[166:167], v239 offset:1536
    ds_read_b128 v[136:139], v224 offset:4096
    ds_read_b128 v[140:143], v224 offset:5120
    s_add_u32 m0, s33, 49152
    s_nop 0
    buffer_load_dwordx4 v250, s[16:19], s30 offen offset:0 lds
    buffer_load_dwordx4 v251, s[16:19], s30 offen offset:1024 lds
    s_add_u32 s31, s40, s43
    s_sub_u32 s37, s31, 7
    s_cmp_ge_u32 s31, 7
    s_cselect_b32 s31, s37, s31
    s_add_u32 s40, s40, 1
    s_add_u32 m0, s27, s32
    s_lshl_b32 s31, s31, 7
    buffer_load_dwordx4 v244, s[12:15], s31 offen offset:0 lds
    buffer_load_dwordx4 v245, s[12:15], s31 offen offset:1024 lds
    s_waitcnt vmcnt(10) lgkmcnt(0)
    s_barrier
    v_mfma_f32_16x16x32_bf16 v[0:3], v[144:147], v[128:131], 0
    ds_read_b128 v[176:179], v225 offset:0
    ds_read_b64_tr_b16 v[192:193], v234 offset:16384
    v_mfma_f32_16x16x32_bf16 v[4:7], v[148:151], v[128:131], 0
    ds_read_b64_tr_b16 v[194:195], v234 offset:17920
    ds_read_b64_tr_b16 v[196:197], v235 offset:16384
    v_mfma_f32_16x16x32_bf16 v[8:11], v[152:155], v[128:131], 0
    ds_read_b64_tr_b16 v[198:199], v235 offset:17920
    ds_read_b128 v[180:183], v225 offset:1024
    v_mfma_f32_16x16x32_bf16 v[12:15], v[156:159], v[128:131], 0
    ds_read_b64_tr_b16 v[200:201], v236 offset:16384
    v_mfma_f32_16x16x32_bf16 v[16:19], v[160:163], v[128:131], 0
    ds_read_b64_tr_b16 v[202:203], v236 offset:17920
    ds_read_b64_tr_b16 v[204:205], v237 offset:16384
    v_mfma_f32_16x16x32_bf16 v[20:23], v[164:167], v[128:131], 0
    ds_read_b64_tr_b16 v[206:207], v237 offset:17920
    ds_read_b64_tr_b16 v[208:209], v238 offset:16384
    v_mfma_f32_16x16x32_bf16 v[32:35], v[144:147], v[132:135], 0
    ds_read_b64_tr_b16 v[210:211], v238 offset:17920
    ds_read_b64_tr_b16 v[212:213], v239 offset:16384
    v_mfma_f32_16x16x32_bf16 v[36:39], v[148:151], v[132:135], 0
    ds_read_b64_tr_b16 v[214:215], v239 offset:17920
    v_mfma_f32_16x16x32_bf16 v[40:43], v[152:155], v[132:135], 0
    ds_read_b128 v[184:187], v225 offset:4096
    ds_read_b128 v[188:191], v225 offset:5120
    v_mfma_f32_16x16x32_bf16 v[44:47], v[156:159], v[132:135], 0
    s_add_u32 s30, s41, s43
    s_sub_u32 s37, s30, 7
    v_mfma_f32_16x16x32_bf16 v[48:51], v[160:163], v[132:135], 0
    s_cmp_ge_u32 s30, 7
    s_cselect_b32 s30, s37, s30
    v_mfma_f32_16x16x32_bf16 v[52:55], v[164:167], v[132:135], 0
    s_add_u32 s41, s41, 1
    v_mfma_f32_16x16x32_bf16 v[64:67], v[144:147], v[136:139], 0
    s_mul_i32 s30, s30, s45
    s_lshl_b32 s30, s30, 1
    v_mfma_f32_16x16x32_bf16 v[68:71], v[148:151], v[136:139], 0
    s_add_u32 m0, s33, 0
    s_nop 0
    v_mfma_f32_16x16x32_bf16 v[72:75], v[152:155], v[136:139], 0
    buffer_load_dwordx4 v250, s[16:19], s30 offen offset:0 lds
    buffer_load_dwordx4 v251, s[16:19], s30 offen offset:1024 lds
    v_mfma_f32_16x16x32_bf16 v[76:79], v[156:159], v[136:139], 0
    s_add_u32 s30, s30, s45
    v_mfma_f32_16x16x32_bf16 v[80:83], v[160:163], v[136:139], 0
    s_add_u32 s35, s27, s32
    s_add_u32 m0, s35, 0x800
    v_mfma_f32_16x16x32_bf16 v[84:87], v[164:167], v[136:139], 0
    s_add_u32 s27, s27, 0x8000
    buffer_load_dwordx4 v246, s[12:15], s31 offen offset:0 lds
    v_mfma_f32_16x16x32_bf16 v[96:99], v[144:147], v[140:143], 0
    buffer_load_dwordx4 v247, s[12:15], s31 offen offset:1024 lds
    s_cmp_ge_u32 s27, 0x28000
    v_mfma_f32_16x16x32_bf16 v[100:103], v[148:151], v[140:143], 0
    s_cselect_b32 s27, 0x10000, s27
    v_mfma_f32_16x16x32_bf16 v[104:107], v[152:155], v[140:143], 0
    s_add_u32 s36, s28, 0x8000
    s_cmp_ge_u32 s36, 0x18000
    v_mfma_f32_16x16x32_bf16 v[108:111], v[156:159], v[140:143], 0
    s_cselect_b32 s36, 0, s36
    s_sub_u32 s29, s36, s28
    v_mfma_f32_16x16x32_bf16 v[112:115], v[160:163], v[140:143], 0
    s_mov_b32 s28, s36
    v_add_u32 v224, s29, v224
    v_mfma_f32_16x16x32_bf16 v[116:119], v[164:167], v[140:143], 0
    v_add_u32 v225, s29, v225
    s_waitcnt vmcnt(8) lgkmcnt(0)
    s_barrier
    v_mfma_f32_16x16x32_bf16 v[0:3], v[192:195], v[176:179], v[0:3]
    ds_read_b128 v[128:131], v224 offset:0
    ds_read_b64_tr_b16 v[144:145], v234 offset:32768
    v_mfma_f32_16x16x32_bf16 v[4:7], v[196:199], v[176:179], v[4:7]
    ds_read_b64_tr_b16 v[146:147], v234 offset:34304
    v_mfma_f32_16x16x32_bf16 v[8:11], v[200:203], v[176:179], v[8:11]
    ds_read_b64_tr_b16 v[148:149], v235 offset:32768
    v_mfma_f32_16x16x32_bf16 v[12:15], v[204:207], v[176:179], v[12:15]
    ds_read_b64_tr_b16 v[150:151], v235 offset:34304
    v_mfma_f32_16x16x32_bf16 v[16:19], v[208:211], v[176:179], v[16:19]
    ds_read_b128 v[132:135], v224 offset:1024
    ds_read_b64_tr_b16 v[152:153], v236 offset:32768
    v_mfma_f32_16x16x32_bf16 v[20:23], v[212:215], v[176:179], v[20:23]
    ds_read_b64_tr_b16 v[154:155], v236 offset:34304
    v_mfma_f32_16x16x32_bf16 v[32:35], v[192:195], v[180:183], v[32:35]
    ds_read_b64_tr_b16 v[156:157], v237 offset:32768
    v_mfma_f32_16x16x32_bf16 v[36:39], v[196:199], v[180:183], v[36:39]
    ds_read_b64_tr_b16 v[158:159], v237 offset:34304
    v_mfma_f32_16x16x32_bf16 v[40:43], v[200:203], v[180:183], v[40:43]
    ds_read_b64_tr_b16 v[160:161], v238 offset:32768
    v_mfma_f32_16x16x32_bf16 v[44:47], v[204:207], v[180:183], v[44:47]
    ds_read_b64_tr_b16 v[162:163], v238 offset:34304
    ds_read_b64_tr_b16 v[164:165], v239 offset:32768
    v_mfma_f32_16x16x32_bf16 v[48:51], v[208:211], v[180:183], v[48:51]
    ds_read_b64_tr_b16 v[166:167], v239 offset:34304
    v_mfma_f32_16x16x32_bf16 v[52:55], v[212:215], v[180:183], v[52:55]
    ds_read_b128 v[136:139], v224 offset:4096
    v_mfma_f32_16x16x32_bf16 v[64:67], v[192:195], v[184:187], v[64:67]
    ds_read_b128 v[140:143], v224 offset:5120
    v_mfma_f32_16x16x32_bf16 v[68:71], v[196:199], v[184:187], v[68:71]
    s_add_u32 m0, s33, 16384
    v_mfma_f32_16x16x32_bf16 v[72:75], v[200:203], v[184:187], v[72:75]
    s_nop 0
    buffer_load_dwordx4 v250, s[16:19], s30 offen offset:0 lds
    v_mfma_f32_16x16x32_bf16 v[76:79], v[204:207], v[184:187], v[76:79]
    buffer_load_dwordx4 v251, s[16:19], s30 offen offset:1024 lds
    v_mfma_f32_16x16x32_bf16 v[80:83], v[208:211], v[184:187], v[80:83]
    s_add_u32 s31, s40, s43
    v_mfma_f32_16x16x32_bf16 v[84:87], v[212:215], v[184:187], v[84:87]
    s_sub_u32 s37, s31, 7
    v_mfma_f32_16x16x32_bf16 v[96:99], v[192:195], v[188:191], v[96:99]
    s_cmp_ge_u32 s31, 7
    v_mfma_f32_16x16x32_bf16 v[100:103], v[196:199], v[188:191], v[100:103]
    s_cselect_b32 s31, s37, s31
    s_add_u32 s40, s40, 1
    v_mfma_f32_16x16x32_bf16 v[104:107], v[200:203], v[188:191], v[104:107]
    s_add_u32 m0, s27, s32
    v_mfma_f32_16x16x32_bf16 v[108:111], v[204:207], v[188:191], v[108:111]
    s_lshl_b32 s31, s31, 7
    v_mfma_f32_16x16x32_bf16 v[112:115], v[208:211], v[188:191], v[112:115]
    buffer_load_dwordx4 v244, s[12:15], s31 offen offset:0 lds
    v_mfma_f32_16x16x32_bf16 v[116:119], v[212:215], v[188:191], v[116:119]
    buffer_load_dwordx4 v245, s[12:15], s31 offen offset:1024 lds
    s_waitcnt vmcnt(10) lgkmcnt(0)
    s_barrier
    v_mfma_f32_16x16x32_bf16 v[0:3], v[144:147], v[128:131], v[0:3]
    ds_read_b128 v[176:179], v225 offset:0
    ds_read_b64_tr_b16 v[192:193], v234 offset:49152
    v_mfma_f32_16x16x32_bf16 v[4:7], v[148:151], v[128:131], v[4:7]
    ds_read_b64_tr_b16 v[194:195], v234 offset:50688
    ds_read_b64_tr_b16 v[196:197], v235 offset:49152
    v_mfma_f32_16x16x32_bf16 v[8:11], v[152:155], v[128:131], v[8:11]
    ds_read_b64_tr_b16 v[198:199], v235 offset:50688
    ds_read_b128 v[180:183], v225 offset:1024
    v_mfma_f32_16x16x32_bf16 v[12:15], v[156:159], v[128:131], v[12:15]
    ds_read_b64_tr_b16 v[200:201], v236 offset:49152
    v_mfma_f32_16x16x32_bf16 v[16:19], v[160:163], v[128:131], v[16:19]
    ds_read_b64_tr_b16 v[202:203], v236 offset:50688
    ds_read_b64_tr_b16 v[204:205], v237 offset:49152
    v_mfma_f32_16x16x32_bf16 v[20:23], v[164:167], v[128:131], v[20:23]
    ds_read_b64_tr_b16 v[206:207], v237 offset:50688
    ds_read_b64_tr_b16 v[208:209], v238 offset:49152
    v_mfma_f32_16x16x32_bf16 v[32:35], v[144:147], v[132:135], v[32:35]
    ds_read_b64_tr_b16 v[210:211], v238 offset:50688
    ds_read_b64_tr_b16 v[212:213], v239 offset:49152
    v_mfma_f32_16x16x32_bf16 v[36:39], v[148:151], v[132:135], v[36:39]
    ds_read_b64_tr_b16 v[214:215], v239 offset:50688
    v_mfma_f32_16x16x32_bf16 v[40:43], v[152:155], v[132:135], v[40:43]
    ds_read_b128 v[184:187], v225 offset:4096
    ds_read_b128 v[188:191], v225 offset:5120
    v_mfma_f32_16x16x32_bf16 v[44:47], v[156:159], v[132:135], v[44:47]
    s_add_u32 s30, s41, s43
    s_sub_u32 s37, s30, 7
    v_mfma_f32_16x16x32_bf16 v[48:51], v[160:163], v[132:135], v[48:51]
    s_cmp_ge_u32 s30, 7
    s_cselect_b32 s30, s37, s30
    v_mfma_f32_16x16x32_bf16 v[52:55], v[164:167], v[132:135], v[52:55]
    s_add_u32 s41, s41, 1
    v_mfma_f32_16x16x32_bf16 v[64:67], v[144:147], v[136:139], v[64:67]
    s_mul_i32 s30, s30, s45
    s_lshl_b32 s30, s30, 1
    v_mfma_f32_16x16x32_bf16 v[68:71], v[148:151], v[136:139], v[68:71]
    s_add_u32 m0, s33, 32768
    s_nop 0
    v_mfma_f32_16x16x32_bf16 v[72:75], v[152:155], v[136:139], v[72:75]
    buffer_load_dwordx4 v250, s[16:19], s30 offen offset:0 lds
    buffer_load_dwordx4 v251, s[16:19], s30 offen offset:1024 lds
    v_mfma_f32_16x16x32_bf16 v[76:79], v[156:159], v[136:139], v[76:79]
    s_add_u32 s30, s30, s45
    v_mfma_f32_16x16x32_bf16 v[80:83], v[160:163], v[136:139], v[80:83]
    s_add_u32 s35, s27, s32
    s_add_u32 m0, s35, 0x800
    v_mfma_f32_16x16x32_bf16 v[84:87], v[164:167], v[136:139], v[84:87]
    s_add_u32 s27, s27, 0x8000
    buffer_load_dwordx4 v246, s[12:15], s31 offen offset:0 lds
    v_mfma_f32_16x16x32_bf16 v[96:99], v[144:147], v[140:143], v[96:99]
    buffer_load_dwordx4 v247, s[12:15], s31 offen offset:1024 lds
    s_cmp_ge_u32 s27, 0x28000
    v_mfma_f32_16x16x32_bf16 v[100:103], v[148:151], v[140:143], v[100:103]
    s_cselect_b32 s27, 0x10000, s27
    v_mfma_f32_16x16x32_bf16 v[104:107], v[152:155], v[140:143], v[104:107]
    s_add_u32 s36, s28, 0x8000
    s_cmp_ge_u32 s36, 0x18000
    v_mfma_f32_16x16x32_bf16 v[108:111], v[156:159], v[140:143], v[108:111]
    s_cselect_b32 s36, 0, s36
    s_sub_u32 s29, s36, s28
    v_mfma_f32_16x16x32_bf16 v[112:115], v[160:163], v[140:143], v[112:115]
    s_mov_b32 s28, s36
    v_add_u32 v224, s29, v224
    v_mfma_f32_16x16x32_bf16 v[116:119], v[164:167], v[140:143], v[116:119]
    v_add_u32 v225, s29, v225
    s_waitcnt vmcnt(8) lgkmcnt(0)
    s_barrier
    v_mfma_f32_16x16x32_bf16 v[0:3], v[192:195], v[176:179], v[0:3]
    ds_read_b128 v[128:131], v224 offset:0
    ds_read_b64_tr_b16 v[144:145], v234 offset:0
    v_mfma_f32_16x16x32_bf16 v[4:7], v[196:199], v[176:179], v[4:7]
    ds_read_b64_tr_b16 v[146:147], v234 offset:1536
    v_mfma_f32_16x16x32_bf16 v[8:11], v[200:203], v[176:179], v[8:11]
    ds_read_b64_tr_b16 v[148:149], v235 offset:0
    v_mfma_f32_16x16x32_bf16 v[12:15], v[204:207], v[176:179], v[12:15]
    ds_read_b64_tr_b16 v[150:151], v235 offset:1536
    v_mfma_f32_16x16x32_bf16 v[16:19], v[208:211], v[176:179], v[16:19]
    ds_read_b128 v[132:135], v224 offset:1024
    ds_read_b64_tr_b16 v[152:153], v236 offset:0
    v_mfma_f32_16x16x32_bf16 v[20:23], v[212:215], v[176:179], v[20:23]
    ds_read_b64_tr_b16 v[154:155], v236 offset:1536
    v_mfma_f32_16x16x32_bf16 v[32:35], v[192:195], v[180:183], v[32:35]
    ds_read_b64_tr_b16 v[156:157], v237 offset:0
    v_mfma_f32_16x16x32_bf16 v[36:39], v[196:199], v[180:183], v[36:39]
    ds_read_b64_tr_b16 v[158:159], v237 offset:1536
    v_mfma_f32_16x16x32_bf16 v[40:43], v[200:203], v[180:183], v[40:43]
    ds_read_b64_tr_b16 v[160:161], v238 offset:0
    v_mfma_f32_16x16x32_bf16 v[44:47], v[204:207], v[180:183], v[44:47]
    ds_read_b64_tr_b16 v[162:163], v238 offset:1536
    ds_read_b64_tr_b16 v[164:165], v239 offset:0
    v_mfma_f32_16x16x32_bf16 v[48:51], v[208:211], v[180:183], v[48:51]
    ds_read_b64_tr_b16 v[166:167], v239 offset:1536
    v_mfma_f32_16x16x32_bf16 v[52:55], v[212:215], v[180:183], v[52:55]
    ds_read_b128 v[136:139], v224 offset:4096
    v_mfma_f32_16x16x32_bf16 v[64:67], v[192:195], v[184:187], v[64:67]
    ds_read_b128 v[140:143], v224 offset:5120
    v_mfma_f32_16x16x32_bf16 v[68:71], v[196:199], v[184:187], v[68:71]
    s_add_u32 m0, s33, 49152
    v_mfma_f32_16x16x32_bf16 v[72:75], v[200:203], v[184:187], v[72:75]
    s_nop 0
    buffer_load_dwordx4 v250, s[16:19], s30 offen offset:0 lds
    v_mfma_f32_16x16x32_bf16 v[76:79], v[204:207], v[184:187], v[76:79]
    buffer_load_dwordx4 v251, s[16:19], s30 offen offset:1024 lds
    v_mfma_f32_16x16x32_bf16 v[80:83], v[208:211], v[184:187], v[80:83]
    s_add_u32 s31, s40, s43
    v_mfma_f32_16x16x32_bf16 v[84:87], v[212:215], v[184:187], v[84:87]
    s_sub_u32 s37, s31, 7
    v_mfma_f32_16x16x32_bf16 v[96:99], v[192:195], v[188:191], v[96:99]
    s_cmp_ge_u32 s31, 7
    v_mfma_f32_16x16x32_bf16 v[100:103], v[196:199], v[188:191], v[100:103]
    s_cselect_b32 s31, s37, s31
    s_add_u32 s40, s40, 1
    v_mfma_f32_16x16x32_bf16 v[104:107], v[200:203], v[188:191], v[104:107]
    s_add_u32 m0, s27, s32
    v_mfma_f32_16x16x32_bf16 v[108:111], v[204:207], v[188:191], v[108:111]
    s_lshl_b32 s31, s31, 7
    v_mfma_f32_16x16x32_bf16 v[112:115], v[208:211], v[188:191], v[112:115]
    buffer_load_dwordx4 v244, s[12:15], s31 offen offset:0 lds
    v_mfma_f32_16x16x32_bf16 v[116:119], v[212:215], v[188:191], v[116:119]
    buffer_load_dwordx4 v245, s[12:15], s31 offen offset:1024 lds
    s_waitcnt vmcnt(10) lgkmcnt(0)
    s_barrier
    v_mfma_f32_16x16x32_bf16 v[0:3], v[144:147], v[128:131], v[0:3]
    ds_read_b128 v[176:179], v225 offset:0
    ds_read_b64_tr_b16 v[192:193], v234 offset:16384
    v_mfma_f32_16x16x32_bf16 v[4:7], v[148:151], v[128:131], v[4:7]
    ds_read_b64_tr_b16 v[194:195], v234 offset:17920
    ds_read_b64_tr_b16 v[196:197], v235 offset:16384
    v_mfma_f32_16x16x32_bf16 v[8:11], v[152:155], v[128:131], v[8:11]
    ds_read_b64_tr_b16 v[198:199], v235 offset:17920
    ds_read_b128 v[180:183], v225 offset:1024
    v_mfma_f32_16x16x32_bf16 v[12:15], v[156:159], v[128:131], v[12:15]
    ds_read_b64_tr_b16 v[200:201], v236 offset:16384
    v_mfma_f32_16x16x32_bf16 v[16:19], v[160:163], v[128:131], v[16:19]
    ds_read_b64_tr_b16 v[202:203], v236 offset:17920
    ds_read_b64_tr_b16 v[204:205], v237 offset:16384
    v_mfma_f32_16x16x32_bf16 v[20:23], v[164:167], v[128:131], v[20:23]
    ds_read_b64_tr_b16 v[206:207], v237 offset:17920
    ds_read_b64_tr_b16 v[208:209], v238 offset:16384
    v_mfma_f32_16x16x32_bf16 v[32:35], v[144:147], v[132:135], v[32:35]
    ds_read_b64_tr_b16 v[210:211], v238 offset:17920
    ds_read_b64_tr_b16 v[212:213], v239 offset:16384
    v_mfma_f32_16x16x32_bf16 v[36:39], v[148:151], v[132:135], v[36:39]
    ds_read_b64_tr_b16 v[214:215], v239 offset:17920
    v_mfma_f32_16x16x32_bf16 v[40:43], v[152:155], v[132:135], v[40:43]
    ds_read_b128 v[184:187], v225 offset:4096
    ds_read_b128 v[188:191], v225 offset:5120
    v_mfma_f32_16x16x32_bf16 v[44:47], v[156:159], v[132:135], v[44:47]
    s_add_u32 s30, s41, s43
    s_sub_u32 s37, s30, 7
    v_mfma_f32_16x16x32_bf16 v[48:51], v[160:163], v[132:135], v[48:51]
    s_cmp_ge_u32 s30, 7
    s_cselect_b32 s30, s37, s30
    v_mfma_f32_16x16x32_bf16 v[52:55], v[164:167], v[132:135], v[52:55]
    s_add_u32 s41, s41, 1
    v_mfma_f32_16x16x32_bf16 v[64:67], v[144:147], v[136:139], v[64:67]
    s_mul_i32 s30, s30, s45
    s_lshl_b32 s30, s30, 1
    v_mfma_f32_16x16x32_bf16 v[68:71], v[148:151], v[136:139], v[68:71]
    s_add_u32 m0, s33, 0
    s_nop 0
    v_mfma_f32_16x16x32_bf16 v[72:75], v[152:155], v[136:139], v[72:75]
    buffer_load_dwordx4 v250, s[16:19], s30 offen offset:0 lds
    buffer_load_dwordx4 v251, s[16:19], s30 offen offset:1024 lds
    v_mfma_f32_16x16x32_bf16 v[76:79], v[156:159], v[136:139], v[76:79]
    s_add_u32 s30, s30, s45
    v_mfma_f32_16x16x32_bf16 v[80:83], v[160:163], v[136:139], v[80:83]
    s_add_u32 s35, s27, s32
    s_add_u32 m0, s35, 0x800
    v_mfma_f32_16x16x32_bf16 v[84:87], v[164:167], v[136:139], v[84:87]
    s_add_u32 s27, s27, 0x8000
    buffer_load_dwordx4 v246, s[12:15], s31 offen offset:0 lds
    v_mfma_f32_16x16x32_bf16 v[96:99], v[144:147], v[140:143], v[96:99]
    buffer_load_dwordx4 v247, s[12:15], s31 offen offset:1024 lds
    s_cmp_ge_u32 s27, 0x28000
    v_mfma_f32_16x16x32_bf16 v[100:103], v[148:151], v[140:143], v[100:103]
    s_cselect_b32 s27, 0x10000, s27
    v_mfma_f32_16x16x32_bf16 v[104:107], v[152:155], v[140:143], v[104:107]
    s_add_u32 s36, s28, 0x8000
    s_cmp_ge_u32 s36, 0x18000
    v_mfma_f32_16x16x32_bf16 v[108:111], v[156:159], v[140:143], v[108:111]
    s_cselect_b32 s36, 0, s36
    s_sub_u32 s29, s36, s28
    v_mfma_f32_16x16x32_bf16 v[112:115], v[160:163], v[140:143], v[112:115]
    s_mov_b32 s28, s36
    v_add_u32 v224, s29, v224
    v_mfma_f32_16x16x32_bf16 v[116:119], v[164:167], v[140:143], v[116:119]
    v_add_u32 v225, s29, v225
    s_waitcnt vmcnt(8) lgkmcnt(0)
    s_barrier
    v_mfma_f32_16x16x32_bf16 v[0:3], v[192:195], v[176:179], v[0:3]
    ds_read_b128 v[128:131], v224 offset:0
    ds_read_b64_tr_b16 v[144:145], v234 offset:32768
    v_mfma_f32_16x16x32_bf16 v[4:7], v[196:199], v[176:179], v[4:7]
    ds_read_b64_tr_b16 v[146:147], v234 offset:34304
    v_mfma_f32_16x16x32_bf16 v[8:11], v[200:203], v[176:179], v[8:11]
    ds_read_b64_tr_b16 v[148:149], v235 offset:32768
    v_mfma_f32_16x16x32_bf16 v[12:15], v[204:207], v[176:179], v[12:15]
    ds_read_b64_tr_b16 v[150:151], v235 offset:34304
    v_mfma_f32_16x16x32_bf16 v[16:19], v[208:211], v[176:179], v[16:19]
    ds_read_b128 v[132:135], v224 offset:1024
    ds_read_b64_tr_b16 v[152:153], v236 offset:32768
    v_mfma_f32_16x16x32_bf16 v[20:23], v[212:215], v[176:179], v[20:23]
    ds_read_b64_tr_b16 v[154:155], v236 offset:34304
    v_mfma_f32_16x16x32_bf16 v[32:35], v[192:195], v[180:183], v[32:35]
    ds_read_b64_tr_b16 v[156:157], v237 offset:32768
    v_mfma_f32_16x16x32_bf16 v[36:39], v[196:199], v[180:183], v[36:39]
    ds_read_b64_tr_b16 v[158:159], v237 offset:34304
    v_mfma_f32_16x16x32_bf16 v[40:43], v[200:203], v[180:183], v[40:43]
    ds_read_b64_tr_b16 v[160:161], v238 offset:32768
    v_mfma_f32_16x16x32_bf16 v[44:47], v[204:207], v[180:183], v[44:47]
    ds_read_b64_tr_b16 v[162:163], v238 offset:34304
    ds_read_b64_tr_b16 v[164:165], v239 offset:32768
    v_mfma_f32_16x16x32_bf16 v[48:51], v[208:211], v[180:183], v[48:51]
    ds_read_b64_tr_b16 v[166:167], v239 offset:34304
    v_mfma_f32_16x16x32_bf16 v[52:55], v[212:215], v[180:183], v[52:55]
    ds_read_b128 v[136:139], v224 offset:4096
    v_mfma_f32_16x16x32_bf16 v[64:67], v[192:195], v[184:187], v[64:67]
    ds_read_b128 v[140:143], v224 offset:5120
    v_mfma_f32_16x16x32_bf16 v[68:71], v[196:199], v[184:187], v[68:71]
    s_add_u32 m0, s33, 16384
    v_mfma_f32_16x16x32_bf16 v[72:75], v[200:203], v[184:187], v[72:75]
    s_nop 0
    buffer_load_dwordx4 v250, s[16:19], s30 offen offset:0 lds
    v_mfma_f32_16x16x32_bf16 v[76:79], v[204:207], v[184:187], v[76:79]
    buffer_load_dwordx4 v251, s[16:19], s30 offen offset:1024 lds
    v_mfma_f32_16x16x32_bf16 v[80:83], v[208:211], v[184:187], v[80:83]
    s_add_u32 s31, s40, s43
    v_mfma_f32_16x16x32_bf16 v[84:87], v[212:215], v[184:187], v[84:87]
    s_sub_u32 s37, s31, 7
    v_mfma_f32_16x16x32_bf16 v[96:99], v[192:195], v[188:191], v[96:99]
    s_cmp_ge_u32 s31, 7
    v_mfma_f32_16x16x32_bf16 v[100:103], v[196:199], v[188:191], v[100:103]
    s_cselect_b32 s31, s37, s31
    s_add_u32 s40, s40, 1
    v_mfma_f32_16x16x32_bf16 v[104:107], v[200:203], v[188:191], v[104:107]
    s_add_u32 m0, s27, s32
    v_mfma_f32_16x16x32_bf16 v[108:111], v[204:207], v[188:191], v[108:111]
    s_lshl_b32 s31, s31, 7
    v_mfma_f32_16x16x32_bf16 v[112:115], v[208:211], v[188:191], v[112:115]
    buffer_load_dwordx4 v244, s[12:15], s31 offen offset:0 lds
    v_mfma_f32_16x16x32_bf16 v[116:119], v[212:215], v[188:191], v[116:119]
    buffer_load_dwordx4 v245, s[12:15], s31 offen offset:1024 lds
    s_waitcnt vmcnt(10) lgkmcnt(0)
    s_barrier
    v_mfma_f32_16x16x32_bf16 v[0:3], v[144:147], v[128:131], v[0:3]
    ds_read_b128 v[176:179], v225 offset:0
    ds_read_b64_tr_b16 v[192:193], v234 offset:49152
    v_mfma_f32_16x16x32_bf16 v[4:7], v[148:151], v[128:131], v[4:7]
    ds_read_b64_tr_b16 v[194:195], v234 offset:50688
    ds_read_b64_tr_b16 v[196:197], v235 offset:49152
    v_mfma_f32_16x16x32_bf16 v[8:11], v[152:155], v[128:131], v[8:11]
    ds_read_b64_tr_b16 v[198:199], v235 offset:50688
    ds_read_b128 v[180:183], v225 offset:1024
    v_mfma_f32_16x16x32_bf16 v[12:15], v[156:159], v[128:131], v[12:15]
    ds_read_b64_tr_b16 v[200:201], v236 offset:49152
    v_mfma_f32_16x16x32_bf16 v[16:19], v[160:163], v[128:131], v[16:19]
    ds_read_b64_tr_b16 v[202:203], v236 offset:50688
    ds_read_b64_tr_b16 v[204:205], v237 offset:49152
    v_mfma_f32_16x16x32_bf16 v[20:23], v[164:167], v[128:131], v[20:23]
    ds_read_b64_tr_b16 v[206:207], v237 offset:50688
    ds_read_b64_tr_b16 v[208:209], v238 offset:49152
    v_mfma_f32_16x16x32_bf16 v[32:35], v[144:147], v[132:135], v[32:35]
    ds_read_b64_tr_b16 v[210:211], v238 offset:50688
    ds_read_b64_tr_b16 v[212:213], v239 offset:49152
    v_mfma_f32_16x16x32_bf16 v[36:39], v[148:151], v[132:135], v[36:39]
    ds_read_b64_tr_b16 v[214:215], v239 offset:50688
    v_mfma_f32_16x16x32_bf16 v[40:43], v[152:155], v[132:135], v[40:43]
    ds_read_b128 v[184:187], v225 offset:4096
    ds_read_b128 v[188:191], v225 offset:5120
    v_mfma_f32_16x16x32_bf16 v[44:47], v[156:159], v[132:135], v[44:47]
    s_add_u32 s30, s41, s43
    s_sub_u32 s37, s30, 7
    v_mfma_f32_16x16x32_bf16 v[48:51], v[160:163], v[132:135], v[48:51]
    s_cmp_ge_u32 s30, 7
    s_cselect_b32 s30, s37, s30
    v_mfma_f32_16x16x32_bf16 v[52:55], v[164:167], v[132:135], v[52:55]
    s_add_u32 s41, s41, 1
    v_mfma_f32_16x16x32_bf16 v[64:67], v[144:147], v[136:139], v[64:67]
    s_mul_i32 s30, s30, s45
    s_lshl_b32 s30, s30, 1
    v_mfma_f32_16x16x32_bf16 v[68:71], v[148:151], v[136:139], v[68:71]
    s_add_u32 m0, s33, 32768
    s_nop 0
    v_mfma_f32_16x16x32_bf16 v[72:75], v[152:155], v[136:139], v[72:75]
    buffer_load_dwordx4 v250, s[16:19], s30 offen offset:0 lds
    buffer_load_dwordx4 v251, s[16:19], s30 offen offset:1024 lds
    v_mfma_f32_16x16x32_bf16 v[76:79], v[156:159], v[136:139], v[76:79]
    s_add_u32 s30, s30, s45
    v_mfma_f32_16x16x32_bf16 v[80:83], v[160:163], v[136:139], v[80:83]
    s_add_u32 s35, s27, s32
    s_add_u32 m0, s35, 0x800
    v_mfma_f32_16x16x32_bf16 v[84:87], v[164:167], v[136:139], v[84:87]
    s_add_u32 s27, s27, 0x8000
    buffer_load_dwordx4 v246, s[12:15], s31 offen offset:0 lds
    v_mfma_f32_16x16x32_bf16 v[96:99], v[144:147], v[140:143], v[96:99]
    buffer_load_dwordx4 v247, s[12:15], s31 offen offset:1024 lds
    s_cmp_ge_u32 s27, 0x28000
    v_mfma_f32_16x16x32_bf16 v[100:103], v[148:151], v[140:143], v[100:103]
    s_cselect_b32 s27, 0x10000, s27
    v_mfma_f32_16x16x32_bf16 v[104:107], v[152:155], v[140:143], v[104:107]
    s_add_u32 s36, s28, 0x8000
    s_cmp_ge_u32 s36, 0x18000
    v_mfma_f32_16x16x32_bf16 v[108:111], v[156:159], v[140:143], v[108:111]
    s_cselect_b32 s36, 0, s36
    s_sub_u32 s29, s36, s28
    v_mfma_f32_16x16x32_bf16 v[112:115], v[160:163], v[140:143], v[112:115]
    s_mov_b32 s28, s36
    v_add_u32 v224, s29, v224
    v_mfma_f32_16x16x32_bf16 v[116:119], v[164:167], v[140:143], v[116:119]
    v_add_u32 v225, s29, v225
    s_waitcnt vmcnt(8) lgkmcnt(0)
    s_barrier
    v_mfma_f32_16x16x32_bf16 v[0:3], v[192:195], v[176:179], v[0:3]
    ds_read_b128 v[128:131], v224 offset:0
    ds_read_b64_tr_b16 v[144:145], v234 offset:0
    v_mfma_f32_16x16x32_bf16 v[4:7], v[196:199], v[176:179], v[4:7]
    ds_read_b64_tr_b16 v[146:147], v234 offset:1536
    v_mfma_f32_16x16x32_bf16 v[8:11], v[200:203], v[176:179], v[8:11]
    ds_read_b64_tr_b16 v[148:149], v235 offset:0
    v_mfma_f32_16x16x32_bf16 v[12:15], v[204:207], v[176:179], v[12:15]
    ds_read_b64_tr_b16 v[150:151], v235 offset:1536
    v_mfma_f32_16x16x32_bf16 v[16:19], v[208:211], v[176:179], v[16:19]
    ds_read_b128 v[132:135], v224 offset:1024
    ds_read_b64_tr_b16 v[152:153], v236 offset:0
    v_mfma_f32_16x16x32_bf16 v[20:23], v[212:215], v[176:179], v[20:23]
    ds_read_b64_tr_b16 v[154:155], v236 offset:1536
    v_mfma_f32_16x16x32_bf16 v[32:35], v[192:195], v[180:183], v[32:35]
    ds_read_b64_tr_b16 v[156:157], v237 offset:0
    v_mfma_f32_16x16x32_bf16 v[36:39], v[196:199], v[180:183], v[36:39]
    ds_read_b64_tr_b16 v[158:159], v237 offset:1536
    v_mfma_f32_16x16x32_bf16 v[40:43], v[200:203], v[180:183], v[40:43]
    ds_read_b64_tr_b16 v[160:161], v238 offset:0
    v_mfma_f32_16x16x32_bf16 v[44:47], v[204:207], v[180:183], v[44:47]
    ds_read_b64_tr_b16 v[162:163], v238 offset:1536
    ds_read_b64_tr_b16 v[164:165], v239 offset:0
    v_mfma_f32_16x16x32_bf16 v[48:51], v[208:211], v[180:183], v[48:51]
    ds_read_b64_tr_b16 v[166:167], v239 offset:1536
    v_mfma_f32_16x16x32_bf16 v[52:55], v[212:215], v[180:183], v[52:55]
    ds_read_b128 v[136:139], v224 offset:4096
    v_mfma_f32_16x16x32_bf16 v[64:67], v[192:195], v[184:187], v[64:67]
    ds_read_b128 v[140:143], v224 offset:5120
    v_mfma_f32_16x16x32_bf16 v[68:71], v[196:199], v[184:187], v[68:71]
    s_add_u32 m0, s33, 49152
    v_mfma_f32_16x16x32_bf16 v[72:75], v[200:203], v[184:187], v[72:75]
    s_nop 0
    buffer_load_dwordx4 v250, s[16:19], s30 offen offset:0 lds
    v_mfma_f32_16x16x32_bf16 v[76:79], v[204:207], v[184:187], v[76:79]
    buffer_load_dwordx4 v251, s[16:19], s30 offen offset:1024 lds
    v_mfma_f32_16x16x32_bf16 v[80:83], v[208:211], v[184:187], v[80:83]
    s_add_u32 s31, s40, s43
    v_mfma_f32_16x16x32_bf16 v[84:87], v[212:215], v[184:187], v[84:87]
    s_sub_u32 s37, s31, 7
    v_mfma_f32_16x16x32_bf16 v[96:99], v[192:195], v[188:191], v[96:99]
    s_cmp_ge_u32 s31, 7
    v_mfma_f32_16x16x32_bf16 v[100:103], v[196:199], v[188:191], v[100:103]
    s_cselect_b32 s31, s37, s31
    s_add_u32 s40, s40, 1
    v_mfma_f32_16x16x32_bf16 v[104:107], v[200:203], v[188:191], v[104:107]
    s_add_u32 m0, s27, s32
    v_mfma_f32_16x16x32_bf16 v[108:111], v[204:207], v[188:191], v[108:111]
    s_lshl_b32 s31, s31, 7
    v_mfma_f32_16x16x32_bf16 v[112:115], v[208:211], v[188:191], v[112:115]
    buffer_load_dwordx4 v244, s[12:15], s31 offen offset:0 lds
    v_mfma_f32_16x16x32_bf16 v[116:119], v[212:215], v[188:191], v[116:119]
    buffer_load_dwordx4 v245, s[12:15], s31 offen offset:1024 lds
    s_waitcnt vmcnt(10) lgkmcnt(0)
    s_barrier
    v_mfma_f32_16x16x32_bf16 v[0:3], v[144:147], v[128:131], v[0:3]
    ds_read_b128 v[176:179], v225 offset:0
    ds_read_b64_tr_b16 v[192:193], v234 offset:16384
    v_mfma_f32_16x16x32_bf16 v[4:7], v[148:151], v[128:131], v[4:7]
    ds_read_b64_tr_b16 v[194:195], v234 offset:17920
    ds_read_b64_tr_b16 v[196:197], v235 offset:16384
    v_mfma_f32_16x16x32_bf16 v[8:11], v[152:155], v[128:131], v[8:11]
    ds_read_b64_tr_b16 v[198:199], v235 offset:17920
    ds_read_b128 v[180:183], v225 offset:1024
    v_mfma_f32_16x16x32_bf16 v[12:15], v[156:159], v[128:131], v[12:15]
    ds_read_b64_tr_b16 v[200:201], v236 offset:16384
    v_mfma_f32_16x16x32_bf16 v[16:19], v[160:163], v[128:131], v[16:19]
    ds_read_b64_tr_b16 v[202:203], v236 offset:17920
    ds_read_b64_tr_b16 v[204:205], v237 offset:16384
    v_mfma_f32_16x16x32_bf16 v[20:23], v[164:167], v[128:131], v[20:23]
    ds_read_b64_tr_b16 v[206:207], v237 offset:17920
    ds_read_b64_tr_b16 v[208:209], v238 offset:16384
    v_mfma_f32_16x16x32_bf16 v[32:35], v[144:147], v[132:135], v[32:35]
    ds_read_b64_tr_b16 v[210:211], v238 offset:17920
    ds_read_b64_tr_b16 v[212:213], v239 offset:16384
    v_mfma_f32_16x16x32_bf16 v[36:39], v[148:151], v[132:135], v[36:39]
    ds_read_b64_tr_b16 v[214:215], v239 offset:17920
    v_mfma_f32_16x16x32_bf16 v[40:43], v[152:155], v[132:135], v[40:43]
    ds_read_b128 v[184:187], v225 offset:4096
    ds_read_b128 v[188:191], v225 offset:5120
    v_mfma_f32_16x16x32_bf16 v[44:47], v[156:159], v[132:135], v[44:47]
    s_add_u32 s30, s41, s43
    s_sub_u32 s37, s30, 7
    v_mfma_f32_16x16x32_bf16 v[48:51], v[160:163], v[132:135], v[48:51]
    s_cmp_ge_u32 s30, 7
    s_cselect_b32 s30, s37, s30
    v_mfma_f32_16x16x32_bf16 v[52:55], v[164:167], v[132:135], v[52:55]
    s_add_u32 s41, s41, 1
    v_mfma_f32_16x16x32_bf16 v[64:67], v[144:147], v[136:139], v[64:67]
    s_mul_i32 s30, s30, s45
    s_lshl_b32 s30, s30, 1
    v_mfma_f32_16x16x32_bf16 v[68:71], v[148:151], v[136:139], v[68:71]
    s_add_u32 m0, s33, 0
    s_nop 0
    v_mfma_f32_16x16x32_bf16 v[72:75], v[152:155], v[136:139], v[72:75]
    buffer_load_dwordx4 v250, s[16:19], s30 offen offset:0 lds
    buffer_load_dwordx4 v251, s[16:19], s30 offen offset:1024 lds
    v_mfma_f32_16x16x32_bf16 v[76:79], v[156:159], v[136:139], v[76:79]
    s_add_u32 s30, s30, s45
    v_mfma_f32_16x16x32_bf16 v[80:83], v[160:163], v[136:139], v[80:83]
    s_add_u32 s35, s27, s32
    s_add_u32 m0, s35, 0x800
    v_mfma_f32_16x16x32_bf16 v[84:87], v[164:167], v[136:139], v[84:87]
    s_add_u32 s27, s27, 0x8000
    buffer_load_dwordx4 v246, s[12:15], s31 offen offset:0 lds
    v_mfma_f32_16x16x32_bf16 v[96:99], v[144:147], v[140:143], v[96:99]
    buffer_load_dwordx4 v247, s[12:15], s31 offen offset:1024 lds
    s_cmp_ge_u32 s27, 0x28000
    v_mfma_f32_16x16x32_bf16 v[100:103], v[148:151], v[140:143], v[100:103]
    s_cselect_b32 s27, 0x10000, s27
    v_mfma_f32_16x16x32_bf16 v[104:107], v[152:155], v[140:143], v[104:107]
    s_add_u32 s36, s28, 0x8000
    s_cmp_ge_u32 s36, 0x18000
    v_mfma_f32_16x16x32_bf16 v[108:111], v[156:159], v[140:143], v[108:111]
    s_cselect_b32 s36, 0, s36
    s_sub_u32 s29, s36, s28
    v_mfma_f32_16x16x32_bf16 v[112:115], v[160:163], v[140:143], v[112:115]
    s_mov_b32 s28, s36
    v_add_u32 v224, s29, v224
    v_mfma_f32_16x16x32_bf16 v[116:119], v[164:167], v[140:143], v[116:119]
    v_add_u32 v225, s29, v225
    s_waitcnt vmcnt(8) lgkmcnt(0)
    s_barrier
    v_mfma_f32_16x16x32_bf16 v[0:3], v[192:195], v[176:179], v[0:3]
    ds_read_b128 v[128:131], v224 offset:0
    ds_read_b64_tr_b16 v[144:145], v234 offset:32768
    v_mfma_f32_16x16x32_bf16 v[4:7], v[196:199], v[176:179], v[4:7]
    ds_read_b64_tr_b16 v[146:147], v234 offset:34304
    v_mfma_f32_16x16x32_bf16 v[8:11], v[200:203], v[176:179], v[8:11]
    ds_read_b64_tr_b16 v[148:149], v235 offset:32768
    v_mfma_f32_16x16x32_bf16 v[12:15], v[204:207], v[176:179], v[12:15]
    ds_read_b64_tr_b16 v[150:151], v235 offset:34304
    v_mfma_f32_16x16x32_bf16 v[16:19], v[208:211], v[176:179], v[16:19]
    ds_read_b128 v[132:135], v224 offset:1024
    ds_read_b64_tr_b16 v[152:153], v236 offset:32768
    v_mfma_f32_16x16x32_bf16 v[20:23], v[212:215], v[176:179], v[20:23]
    ds_read_b64_tr_b16 v[154:155], v236 offset:34304
    v_mfma_f32_16x16x32_bf16 v[32:35], v[192:195], v[180:183], v[32:35]
    ds_read_b64_tr_b16 v[156:157], v237 offset:32768
    v_mfma_f32_16x16x32_bf16 v[36:39], v[196:199], v[180:183], v[36:39]
    ds_read_b64_tr_b16 v[158:159], v237 offset:34304
    v_mfma_f32_16x16x32_bf16 v[40:43], v[200:203], v[180:183], v[40:43]
    ds_read_b64_tr_b16 v[160:161], v238 offset:32768
    ds_read_b64_tr_b16 v[162:163], v238 offset:34304
    v_mfma_f32_16x16x32_bf16 v[44:47], v[204:207], v[180:183], v[44:47]
    ds_read_b64_tr_b16 v[164:165], v239 offset:32768
    v_mfma_f32_16x16x32_bf16 v[48:51], v[208:211], v[180:183], v[48:51]
    ds_read_b64_tr_b16 v[166:167], v239 offset:34304
    v_mfma_f32_16x16x32_bf16 v[52:55], v[212:215], v[180:183], v[52:55]
    ds_read_b128 v[136:139], v224 offset:4096
    v_mfma_f32_16x16x32_bf16 v[64:67], v[192:195], v[184:187], v[64:67]
    ds_read_b128 v[140:143], v224 offset:5120
    s_add_u32 m0, s33, 16384
    v_mfma_f32_16x16x32_bf16 v[68:71], v[196:199], v[184:187], v[68:71]
    s_nop 0
    v_mfma_f32_16x16x32_bf16 v[72:75], v[200:203], v[184:187], v[72:75]
    buffer_load_dwordx4 v250, s[16:19], s30 offen offset:0 lds
    v_mfma_f32_16x16x32_bf16 v[76:79], v[204:207], v[184:187], v[76:79]
    buffer_load_dwordx4 v251, s[16:19], s30 offen offset:1024 lds
    v_mfma_f32_16x16x32_bf16 v[80:83], v[208:211], v[184:187], v[80:83]
    s_mov_b32 s40, 0
    s_add_u32 s31, s40, s42
    v_mfma_f32_16x16x32_bf16 v[84:87], v[212:215], v[184:187], v[84:87]
    s_and_b32 s31, s31, 3
    v_mfma_f32_16x16x32_bf16 v[96:99], v[192:195], v[188:191], v[96:99]
    s_andn2_b32 s37, s40, 3
    v_mfma_f32_16x16x32_bf16 v[100:103], v[196:199], v[188:191], v[100:103]
    s_or_b32 s31, s31, s37
    v_mfma_f32_16x16x32_bf16 v[104:107], v[200:203], v[188:191], v[104:107]
    s_add_u32 s40, s40, 1
    s_add_u32 m0, s27, s32
    v_mfma_f32_16x16x32_bf16 v[108:111], v[204:207], v[188:191], v[108:111]
    s_lshl_b32 s31, s31, 7
    v_mfma_f32_16x16x32_bf16 v[112:115], v[208:211], v[188:191], v[112:115]
    buffer_load_dwordx4 v240, s[4:7], s31 offen offset:0 lds
    v_mfma_f32_16x16x32_bf16 v[116:119], v[212:215], v[188:191], v[116:119]
    buffer_load_dwordx4 v241, s[4:7], s31 offen offset:1024 lds
    s_waitcnt vmcnt(10) lgkmcnt(0)
    s_barrier
    v_mfma_f32_16x16x32_bf16 v[0:3], v[144:147], v[128:131], v[0:3]
    ds_read_b128 v[176:179], v225 offset:0
    ds_read_b64_tr_b16 v[192:193], v234 offset:49152
    v_mfma_f32_16x16x32_bf16 v[4:7], v[148:151], v[128:131], v[4:7]
    ds_read_b64_tr_b16 v[194:195], v234 offset:50688
    ds_read_b64_tr_b16 v[196:197], v235 offset:49152
    v_mfma_f32_16x16x32_bf16 v[8:11], v[152:155], v[128:131], v[8:11]
    ds_read_b64_tr_b16 v[198:199], v235 offset:50688
    ds_read_b128 v[180:183], v225 offset:1024
    v_mfma_f32_16x16x32_bf16 v[12:15], v[156:159], v[128:131], v[12:15]
    ds_read_b64_tr_b16 v[200:201], v236 offset:49152
    ds_read_b64_tr_b16 v[202:203], v236 offset:50688
    v_mfma_f32_16x16x32_bf16 v[16:19], v[160:163], v[128:131], v[16:19]
    ds_read_b64_tr_b16 v[204:205], v237 offset:49152
    v_mfma_f32_16x16x32_bf16 v[20:23], v[164:167], v[128:131], v[20:23]
    ds_read_b64_tr_b16 v[206:207], v237 offset:50688
    ds_read_b64_tr_b16 v[208:209], v238 offset:49152
    v_mfma_f32_16x16x32_bf16 v[32:35], v[144:147], v[132:135], v[32:35]
    ds_read_b64_tr_b16 v[210:211], v238 offset:50688
    ds_read_b64_tr_b16 v[212:213], v239 offset:49152
    v_mfma_f32_16x16x32_bf16 v[36:39], v[148:151], v[132:135], v[36:39]
    ds_read_b64_tr_b16 v[214:215], v239 offset:50688
    ds_read_b128 v[184:187], v225 offset:4096
    v_mfma_f32_16x16x32_bf16 v[40:43], v[152:155], v[132:135], v[40:43]
    ds_read_b128 v[188:191], v225 offset:5120
    s_mov_b32 s41, 0
    v_mfma_f32_16x16x32_bf16 v[44:47], v[156:159], v[132:135], v[44:47]
    s_add_u32 s30, s41, s42
    v_mfma_f32_16x16x32_bf16 v[48:51], v[160:163], v[132:135], v[48:51]
    s_and_b32 s30, s30, 3
    s_andn2_b32 s37, s41, 3
    v_mfma_f32_16x16x32_bf16 v[52:55], v[164:167], v[132:135], v[52:55]
    s_or_b32 s30, s30, s37
    s_add_u32 s41, s41, 1
    v_mfma_f32_16x16x32_bf16 v[64:67], v[144:147], v[136:139], v[64:67]
    s_mul_i32 s30, s30, s44
    s_lshl_b32 s30, s30, 1
    v_mfma_f32_16x16x32_bf16 v[68:71], v[148:151], v[136:139], v[68:71]
    s_add_u32 m0, s33, 32768
    s_nop 0
    v_mfma_f32_16x16x32_bf16 v[72:75], v[152:155], v[136:139], v[72:75]
    buffer_load_dwordx4 v248, s[8:11], s30 offen offset:0 lds
    v_mfma_f32_16x16x32_bf16 v[76:79], v[156:159], v[136:139], v[76:79]
    buffer_load_dwordx4 v249, s[8:11], s30 offen offset:1024 lds
    s_add_u32 s30, s30, s44
    v_mfma_f32_16x16x32_bf16 v[80:83], v[160:163], v[136:139], v[80:83]
    s_add_u32 s35, s27, s32
    s_add_u32 m0, s35, 0x800
    v_mfma_f32_16x16x32_bf16 v[84:87], v[164:167], v[136:139], v[84:87]
    s_add_u32 s27, s27, 0x8000
    buffer_load_dwordx4 v242, s[4:7], s31 offen offset:0 lds
    v_mfma_f32_16x16x32_bf16 v[96:99], v[144:147], v[140:143], v[96:99]
    buffer_load_dwordx4 v243, s[4:7], s31 offen offset:1024 lds
    s_cmp_ge_u32 s27, 0x28000
    v_mfma_f32_16x16x32_bf16 v[100:103], v[148:151], v[140:143], v[100:103]
    s_cselect_b32 s27, 0x10000, s27
    v_mfma_f32_16x16x32_bf16 v[104:107], v[152:155], v[140:143], v[104:107]
    s_add_u32 s36, s28, 0x8000
    s_cmp_ge_u32 s36, 0x18000
    v_mfma_f32_16x16x32_bf16 v[108:111], v[156:159], v[140:143], v[108:111]
    s_cselect_b32 s36, 0, s36
    s_sub_u32 s29, s36, s28
    v_mfma_f32_16x16x32_bf16 v[112:115], v[160:163], v[140:143], v[112:115]
    s_mov_b32 s28, s36
    v_add_u32 v224, s29, v224
    v_mfma_f32_16x16x32_bf16 v[116:119], v[164:167], v[140:143], v[116:119]
    v_add_u32 v225, s29, v225
    s_waitcnt vmcnt(8) lgkmcnt(0)
    s_barrier
    v_mfma_f32_16x16x32_bf16 v[0:3], v[192:195], v[176:179], v[0:3]
    ds_read_b128 v[128:131], v224 offset:0
    ds_read_b64_tr_b16 v[144:145], v234 offset:0
    v_mfma_f32_16x16x32_bf16 v[4:7], v[196:199], v[176:179], v[4:7]
    ds_read_b64_tr_b16 v[146:147], v234 offset:1536
    v_mfma_f32_16x16x32_bf16 v[8:11], v[200:203], v[176:179], v[8:11]
    ds_read_b64_tr_b16 v[148:149], v235 offset:0
    v_mfma_f32_16x16x32_bf16 v[12:15], v[204:207], v[176:179], v[12:15]
    ds_read_b64_tr_b16 v[150:151], v235 offset:1536
    v_mfma_f32_16x16x32_bf16 v[16:19], v[208:211], v[176:179], v[16:19]
    ds_read_b128 v[132:135], v224 offset:1024
    ds_read_b64_tr_b16 v[152:153], v236 offset:0
    v_mfma_f32_16x16x32_bf16 v[20:23], v[212:215], v[176:179], v[20:23]
    ds_read_b64_tr_b16 v[154:155], v236 offset:1536
    v_mfma_f32_16x16x32_bf16 v[32:35], v[192:195], v[180:183], v[32:35]
    ds_read_b64_tr_b16 v[156:157], v237 offset:0
    v_mfma_f32_16x16x32_bf16 v[36:39], v[196:199], v[180:183], v[36:39]
    ds_read_b64_tr_b16 v[158:159], v237 offset:1536
    v_mfma_f32_16x16x32_bf16 v[40:43], v[200:203], v[180:183], v[40:43]
    ds_read_b64_tr_b16 v[160:161], v238 offset:0
    v_mfma_f32_16x16x32_bf16 v[44:47], v[204:207], v[180:183], v[44:47]
    ds_read_b64_tr_b16 v[162:163], v238 offset:1536
    ds_read_b64_tr_b16 v[164:165], v239 offset:0
    v_mfma_f32_16x16x32_bf16 v[48:51], v[208:211], v[180:183], v[48:51]
    ds_read_b64_tr_b16 v[166:167], v239 offset:1536
    v_mfma_f32_16x16x32_bf16 v[52:55], v[212:215], v[180:183], v[52:55]
    ds_read_b128 v[136:139], v224 offset:4096
    v_mfma_f32_16x16x32_bf16 v[64:67], v[192:195], v[184:187], v[64:67]
    ds_read_b128 v[140:143], v224 offset:5120
    v_mfma_f32_16x16x32_bf16 v[68:71], v[196:199], v[184:187], v[68:71]
    s_add_u32 m0, s33, 49152
    v_mfma_f32_16x16x32_bf16 v[72:75], v[200:203], v[184:187], v[72:75]
    s_nop 0
    buffer_load_dwordx4 v248, s[8:11], s30 offen offset:0 lds
    v_mfma_f32_16x16x32_bf16 v[76:79], v[204:207], v[184:187], v[76:79]
    buffer_load_dwordx4 v249, s[8:11], s30 offen offset:1024 lds
    v_mfma_f32_16x16x32_bf16 v[80:83], v[208:211], v[184:187], v[80:83]
    s_add_u32 s31, s40, s42
    v_mfma_f32_16x16x32_bf16 v[84:87], v[212:215], v[184:187], v[84:87]
    s_and_b32 s31, s31, 3
    v_mfma_f32_16x16x32_bf16 v[96:99], v[192:195], v[188:191], v[96:99]
    s_andn2_b32 s37, s40, 3
    v_mfma_f32_16x16x32_bf16 v[100:103], v[196:199], v[188:191], v[100:103]
    s_or_b32 s31, s31, s37
    s_add_u32 s40, s40, 1
    v_mfma_f32_16x16x32_bf16 v[104:107], v[200:203], v[188:191], v[104:107]
    s_add_u32 m0, s27, s32
    v_mfma_f32_16x16x32_bf16 v[108:111], v[204:207], v[188:191], v[108:111]
    s_lshl_b32 s31, s31, 7
    v_mfma_f32_16x16x32_bf16 v[112:115], v[208:211], v[188:191], v[112:115]
    buffer_load_dwordx4 v240, s[4:7], s31 offen offset:0 lds
    v_mfma_f32_16x16x32_bf16 v[116:119], v[212:215], v[188:191], v[116:119]
    buffer_load_dwordx4 v241, s[4:7], s31 offen offset:1024 lds
    s_waitcnt vmcnt(10) lgkmcnt(0)
    s_barrier
    v_mfma_f32_16x16x32_bf16 v[0:3], v[144:147], v[128:131], v[0:3]
    ds_read_b128 v[176:179], v225 offset:0
    ds_read_b64_tr_b16 v[192:193], v234 offset:16384
    v_mfma_f32_16x16x32_bf16 v[4:7], v[148:151], v[128:131], v[4:7]
    ds_read_b64_tr_b16 v[194:195], v234 offset:17920
    ds_read_b64_tr_b16 v[196:197], v235 offset:16384
    v_mfma_f32_16x16x32_bf16 v[8:11], v[152:155], v[128:131], v[8:11]
    ds_read_b64_tr_b16 v[198:199], v235 offset:17920
    ds_read_b128 v[180:183], v225 offset:1024
    v_mfma_f32_16x16x32_bf16 v[12:15], v[156:159], v[128:131], v[12:15]
    ds_read_b64_tr_b16 v[200:201], v236 offset:16384
    v_mfma_f32_16x16x32_bf16 v[16:19], v[160:163], v[128:131], v[16:19]
    ds_read_b64_tr_b16 v[202:203], v236 offset:17920
    ds_read_b64_tr_b16 v[204:205], v237 offset:16384
    v_mfma_f32_16x16x32_bf16 v[20:23], v[164:167], v[128:131], v[20:23]
    ds_read_b64_tr_b16 v[206:207], v237 offset:17920
    ds_read_b64_tr_b16 v[208:209], v238 offset:16384
    v_mfma_f32_16x16x32_bf16 v[32:35], v[144:147], v[132:135], v[32:35]
    ds_read_b64_tr_b16 v[210:211], v238 offset:17920
    ds_read_b64_tr_b16 v[212:213], v239 offset:16384
    v_mfma_f32_16x16x32_bf16 v[36:39], v[148:151], v[132:135], v[36:39]
    ds_read_b64_tr_b16 v[214:215], v239 offset:17920
    v_mfma_f32_16x16x32_bf16 v[40:43], v[152:155], v[132:135], v[40:43]
    ds_read_b128 v[184:187], v225 offset:4096
    ds_read_b128 v[188:191], v225 offset:5120
    v_mfma_f32_16x16x32_bf16 v[44:47], v[156:159], v[132:135], v[44:47]
    s_add_u32 s30, s41, s42
    s_and_b32 s30, s30, 3
    v_mfma_f32_16x16x32_bf16 v[48:51], v[160:163], v[132:135], v[48:51]
    s_andn2_b32 s37, s41, 3
    s_or_b32 s30, s30, s37
    v_mfma_f32_16x16x32_bf16 v[52:55], v[164:167], v[132:135], v[52:55]
    s_add_u32 s41, s41, 1
    v_mfma_f32_16x16x32_bf16 v[64:67], v[144:147], v[136:139], v[64:67]
    s_mul_i32 s30, s30, s44
    s_lshl_b32 s30, s30, 1
    v_mfma_f32_16x16x32_bf16 v[68:71], v[148:151], v[136:139], v[68:71]
    s_add_u32 m0, s33, 0
    s_nop 0
    v_mfma_f32_16x16x32_bf16 v[72:75], v[152:155], v[136:139], v[72:75]
    buffer_load_dwordx4 v248, s[8:11], s30 offen offset:0 lds
    buffer_load_dwordx4 v249, s[8:11], s30 offen offset:1024 lds
    v_mfma_f32_16x16x32_bf16 v[76:79], v[156:159], v[136:139], v[76:79]
    s_add_u32 s30, s30, s44
    v_mfma_f32_16x16x32_bf16 v[80:83], v[160:163], v[136:139], v[80:83]
    s_add_u32 s35, s27, s32
    s_add_u32 m0, s35, 0x800
    v_mfma_f32_16x16x32_bf16 v[84:87], v[164:167], v[136:139], v[84:87]
    s_add_u32 s27, s27, 0x8000
    buffer_load_dwordx4 v242, s[4:7], s31 offen offset:0 lds
    v_mfma_f32_16x16x32_bf16 v[96:99], v[144:147], v[140:143], v[96:99]
    buffer_load_dwordx4 v243, s[4:7], s31 offen offset:1024 lds
    s_cmp_ge_u32 s27, 0x28000
    v_mfma_f32_16x16x32_bf16 v[100:103], v[148:151], v[140:143], v[100:103]
    s_cselect_b32 s27, 0x10000, s27
    v_mfma_f32_16x16x32_bf16 v[104:107], v[152:155], v[140:143], v[104:107]
    s_add_u32 s36, s28, 0x8000
    s_cmp_ge_u32 s36, 0x18000
    v_mfma_f32_16x16x32_bf16 v[108:111], v[156:159], v[140:143], v[108:111]
    s_cselect_b32 s36, 0, s36
    s_sub_u32 s29, s36, s28
    v_mfma_f32_16x16x32_bf16 v[112:115], v[160:163], v[140:143], v[112:115]
    s_mov_b32 s28, s36
    v_add_u32 v224, s29, v224
    v_mfma_f32_16x16x32_bf16 v[116:119], v[164:167], v[140:143], v[116:119]
    v_add_u32 v225, s29, v225
    s_waitcnt vmcnt(8) lgkmcnt(0)
    s_barrier
    v_mfma_f32_16x16x32_bf16 v[0:3], v[192:195], v[176:179], v[0:3]
    ds_read_b128 v[128:131], v224 offset:0
    ds_read_b64_tr_b16 v[144:145], v226 offset:32768
    v_mfma_f32_16x16x32_bf16 v[4:7], v[196:199], v[176:179], v[4:7]
    ds_read_b64_tr_b16 v[146:147], v226 offset:34816
    v_mfma_f32_16x16x32_bf16 v[8:11], v[200:203], v[176:179], v[8:11]
    ds_read_b64_tr_b16 v[148:149], v227 offset:32768
    ds_read_b64_tr_b16 v[150:151], v227 offset:34816
    v_mfma_f32_16x16x32_bf16 v[12:15], v[204:207], v[176:179], v[12:15]
    ds_read_b128 v[132:135], v224 offset:1024
    v_mfma_f32_16x16x32_bf16 v[16:19], v[208:211], v[176:179], v[16:19]
    ds_read_b64_tr_b16 v[152:153], v228 offset:32768
    v_mfma_f32_16x16x32_bf16 v[20:23], v[212:215], v[176:179], v[20:23]
    ds_read_b64_tr_b16 v[154:155], v228 offset:34816
    ds_read_b64_tr_b16 v[156:157], v229 offset:32768
    v_mfma_f32_16x16x32_bf16 v[32:35], v[192:195], v[180:183], v[32:35]
    ds_read_b64_tr_b16 v[158:159], v229 offset:34816
    v_mfma_f32_16x16x32_bf16 v[36:39], v[196:199], v[180:183], v[36:39]
    ds_read_b64_tr_b16 v[160:161], v230 offset:32768
    v_mfma_f32_16x16x32_bf16 v[40:43], v[200:203], v[180:183], v[40:43]
    ds_read_b64_tr_b16 v[162:163], v230 offset:34816
    ds_read_b64_tr_b16 v[164:165], v231 offset:32768
    v_mfma_f32_16x16x32_bf16 v[44:47], v[204:207], v[180:183], v[44:47]
    ds_read_b64_tr_b16 v[166:167], v231 offset:34816
    v_mfma_f32_16x16x32_bf16 v[48:51], v[208:211], v[180:183], v[48:51]
    ds_read_b64_tr_b16 v[168:169], v232 offset:32768
    ds_read_b64_tr_b16 v[170:171], v232 offset:34816
    v_mfma_f32_16x16x32_bf16 v[52:55], v[212:215], v[180:183], v[52:55]
    ds_read_b64_tr_b16 v[172:173], v233 offset:32768
    v_mfma_f32_16x16x32_bf16 v[64:67], v[192:195], v[184:187], v[64:67]
    ds_read_b64_tr_b16 v[174:175], v233 offset:34816
    v_mfma_f32_16x16x32_bf16 v[68:71], v[196:199], v[184:187], v[68:71]
    ds_read_b128 v[136:139], v224 offset:4096
    ds_read_b128 v[140:143], v224 offset:5120
    v_mfma_f32_16x16x32_bf16 v[72:75], v[200:203], v[184:187], v[72:75]
    s_add_u32 m0, s33, 16384
    v_mfma_f32_16x16x32_bf16 v[76:79], v[204:207], v[184:187], v[76:79]
    s_nop 0
    v_mfma_f32_16x16x32_bf16 v[80:83], v[208:211], v[184:187], v[80:83]
    buffer_load_dwordx4 v248, s[8:11], s30 offen offset:0 lds
    buffer_load_dwordx4 v249, s[8:11], s30 offen offset:1024 lds
    v_mfma_f32_16x16x32_bf16 v[84:87], v[212:215], v[184:187], v[84:87]
    s_add_u32 s31, s40, s42
    v_mfma_f32_16x16x32_bf16 v[96:99], v[192:195], v[188:191], v[96:99]
    s_and_b32 s31, s31, 3
    s_andn2_b32 s37, s40, 3
    v_mfma_f32_16x16x32_bf16 v[100:103], v[196:199], v[188:191], v[100:103]
    s_or_b32 s31, s31, s37
    v_mfma_f32_16x16x32_bf16 v[104:107], v[200:203], v[188:191], v[104:107]
    s_add_u32 s40, s40, 1
    v_mfma_f32_16x16x32_bf16 v[108:111], v[204:207], v[188:191], v[108:111]
    s_add_u32 m0, s27, s32
    s_lshl_b32 s31, s31, 7
    v_mfma_f32_16x16x32_bf16 v[112:115], v[208:211], v[188:191], v[112:115]
    buffer_load_dwordx4 v240, s[4:7], s31 offen offset:0 lds
    v_mfma_f32_16x16x32_bf16 v[116:119], v[212:215], v[188:191], v[116:119]
    buffer_load_dwordx4 v241, s[4:7], s31 offen offset:1024 lds
    s_nop 7
    s_lshl_b32 s38, s51, 3
    s_lshl_b32 s36, s25, 1
    s_add_u32 s38, s38, s36
    s_mul_i32 s35, s26, 3
    s_add_u32 s35, s35, s68
    s_add_u32 s35, s35, 0
    s_cmp_lg_u32 s71, 0
    s_cbranch_scc1 K1_E_37
    s_lshr_b32 s36, s35, 3
    s_lshl_b32 s36, s36, 20
    s_and_b32 s37, s35, 7
    s_lshl_b32 s37, s37, 11
    s_add_u32 s39, s36, s37
    s_lshl_b32 s36, s38, 14
    s_add_u32 s39, s39, s36
    s_add_u32 s39, s39, 0x2000000
    s_cmp_ge_u32 s35, 128
    s_cselect_b32 s39, 0x7ff00000, s39
    s_cmp_lg_u32 s94, 0
    s_cselect_b32 s39, 0x7ff00000, s39
    v_cvt_pk_bf16_f32 v176, v0, v1
    v_cvt_pk_bf16_f32 v177, v2, v3
    v_cvt_pk_bf16_f32 v178, v4, v5
    v_cvt_pk_bf16_f32 v179, v6, v7
    buffer_store_dwordx4 v[176:179], v252, s[20:23], s39 offen offset:0 sc1
    v_cvt_pk_bf16_f32 v180, v32, v33
    v_cvt_pk_bf16_f32 v181, v34, v35
    v_cvt_pk_bf16_f32 v182, v36, v37
    v_cvt_pk_bf16_f32 v183, v38, v39
    buffer_store_dwordx4 v[180:183], v252, s[20:23], s39 offen offset:128 sc1
    s_add_u32 s39, s39, 16384
    v_cvt_pk_bf16_f32 v184, v64, v65
    v_cvt_pk_bf16_f32 v185, v66, v67
    v_cvt_pk_bf16_f32 v186, v68, v69
    v_cvt_pk_bf16_f32 v187, v70, v71
    buffer_store_dwordx4 v[184:187], v252, s[20:23], s39 offen offset:0 sc1
    v_cvt_pk_bf16_f32 v188, v96, v97
    v_cvt_pk_bf16_f32 v189, v98, v99
    v_cvt_pk_bf16_f32 v190, v100, v101
    v_cvt_pk_bf16_f32 v191, v102, v103
    buffer_store_dwordx4 v[188:191], v252, s[20:23], s39 offen offset:128 sc1
    s_add_u32 s39, s39, 16384
    s_branch K1_E_40
K1_E_37:
    s_and_b32 s36, s35, 15
    s_lshl_b32 s36, s36, 6
    s_add_u32 s36, s36, s38
    s_lshr_b32 s37, s35, 4
    s_cmp_eq_u32 s37, 1
    s_cbranch_scc1 K1_E_38
    s_cmp_eq_u32 s37, 2
    s_cbranch_scc1 K1_E_39
    s_lshl_b32 s39, s36, 11
    s_add_u32 s39, s39, 0x3000000
    v_mul_f32 v0, s95, v0
    v_mul_f32 v4, s95, v4
    v_mul_f32 v1, s95, v1
    v_mul_f32 v5, s95, v5
    v_mul_f32 v2, s95, v2
    v_mul_f32 v6, s95, v6
    v_mul_f32 v3, s95, v3
    v_mul_f32 v7, s95, v7
    s_mov_b32 exec_lo, 0
    s_mov_b32 exec_hi, 0xffff0000
    v_mov_b32 v4, 0
    v_mov_b32 v5, 0
    v_mov_b32 v6, 0
    v_mov_b32 v7, 0
    s_mov_b64 exec, -1
    v_cvt_pk_bf16_f32 v176, v0, v1
    v_cvt_pk_bf16_f32 v177, v2, v3
    v_cvt_pk_bf16_f32 v178, v4, v5
    v_cvt_pk_bf16_f32 v179, v6, v7
    buffer_store_dwordx4 v[176:179], v252, s[20:23], s39 offen offset:0 sc1
    v_mul_f32 v32, s95, v32
    v_mul_f32 v36, s95, v36
    v_mul_f32 v33, s95, v33
    v_mul_f32 v37, s95, v37
    v_mul_f32 v34, s95, v34
    v_mul_f32 v38, s95, v38
    v_mul_f32 v35, s95, v35
    v_mul_f32 v39, s95, v39
    s_mov_b32 exec_lo, 0
    s_mov_b32 exec_hi, 0xffff0000
    v_mov_b32 v36, 0
    v_mov_b32 v37, 0
    v_mov_b32 v38, 0
    v_mov_b32 v39, 0
    s_mov_b64 exec, -1
    v_cvt_pk_bf16_f32 v180, v32, v33
    v_cvt_pk_bf16_f32 v181, v34, v35
    v_cvt_pk_bf16_f32 v182, v36, v37
    v_cvt_pk_bf16_f32 v183, v38, v39
    buffer_store_dwordx4 v[180:183], v252, s[20:23], s39 offen offset:128 sc1
    v_mul_f32 v64, s95, v64
    v_mul_f32 v68, s95, v68
    v_mul_f32 v65, s95, v65
    v_mul_f32 v69, s95, v69
    v_mul_f32 v66, s95, v66
    v_mul_f32 v70, s95, v70
    v_mul_f32 v67, s95, v67
    v_mul_f32 v71, s95, v71
    s_mov_b32 exec_lo, 0
    s_mov_b32 exec_hi, 0xffff0000
    v_mov_b32 v68, 0
    v_mov_b32 v69, 0
    v_mov_b32 v70, 0
    v_mov_b32 v71, 0
    s_mov_b64 exec, -1
    v_cvt_pk_bf16_f32 v184, v64, v65
    v_cvt_pk_bf16_f32 v185, v66, v67
    v_cvt_pk_bf16_f32 v186, v68, v69
    v_cvt_pk_bf16_f32 v187, v70, v71
    buffer_store_dwordx4 v[184:187], v252, s[20:23], s39 offen offset:2048 sc1
    v_mul_f32 v96, s95, v96
    v_mul_f32 v100, s95, v100
    v_mul_f32 v97, s95, v97
    v_mul_f32 v101, s95, v101
    v_mul_f32 v98, s95, v98
    v_mul_f32 v102, s95, v102
    v_mul_f32 v99, s95, v99
    v_mul_f32 v103, s95, v103
    s_mov_b32 exec_lo, 0
    s_mov_b32 exec_hi, 0xffff0000
    v_mov_b32 v100, 0
    v_mov_b32 v101, 0
    v_mov_b32 v102, 0
    v_mov_b32 v103, 0
    s_mov_b64 exec, -1
    v_cvt_pk_bf16_f32 v188, v96, v97
    v_cvt_pk_bf16_f32 v189, v98, v99
    v_cvt_pk_bf16_f32 v190, v100, v101
    v_cvt_pk_bf16_f32 v191, v102, v103
    buffer_store_dwordx4 v[188:191], v252, s[20:23], s39 offen offset:2176 sc1
    s_branch K1_E_40
K1_E_38:
    s_lshl_b32 s39, s36, 12
    s_add_u32 s39, s39, 0x3200000
    s_mov_b32 exec_lo, 0
    s_mov_b32 exec_hi, 0xffff0000
    v_mov_b32 v4, 0
    v_mov_b32 v5, 0
    v_mov_b32 v6, 0
    v_mov_b32 v7, 0
    s_mov_b64 exec, -1
    v_cvt_pk_bf16_f32 v176, v0, v1
    v_cvt_pk_bf16_f32 v177, v2, v3
    v_cvt_pk_bf16_f32 v178, v4, v5
    v_cvt_pk_bf16_f32 v179, v6, v7
    buffer_store_dwordx4 v[176:179], v252, s[20:23], s39 offen offset:0 sc1
    s_mov_b32 exec_lo, 0
    s_mov_b32 exec_hi, 0xffff0000
    v_mov_b32 v36, 0
    v_mov_b32 v37, 0
    v_mov_b32 v38, 0
    v_mov_b32 v39, 0
    s_mov_b64 exec, -1
    v_cvt_pk_bf16_f32 v180, v32, v33
    v_cvt_pk_bf16_f32 v181, v34, v35
    v_cvt_pk_bf16_f32 v182, v36, v37
    v_cvt_pk_bf16_f32 v183, v38, v39
    buffer_store_dwordx4 v[180:183], v252, s[20:23], s39 offen offset:128 sc1
    s_add_u32 s39, s39, 4096
    s_mov_b32 exec_lo, 0
    s_mov_b32 exec_hi, 0xffff0000
    v_mov_b32 v68, 0
    v_mov_b32 v69, 0
    v_mov_b32 v70, 0
    v_mov_b32 v71, 0
    s_mov_b64 exec, -1
    v_cvt_pk_bf16_f32 v184, v64, v65
    v_cvt_pk_bf16_f32 v185, v66, v67
    v_cvt_pk_bf16_f32 v186, v68, v69
    v_cvt_pk_bf16_f32 v187, v70, v71
    buffer_store_dwordx4 v[184:187], v252, s[20:23], s39 offen offset:0 sc1
    s_mov_b32 exec_lo, 0
    s_mov_b32 exec_hi, 0xffff0000
    v_mov_b32 v100, 0
    v_mov_b32 v101, 0
    v_mov_b32 v102, 0
    v_mov_b32 v103, 0
    s_mov_b64 exec, -1
    v_cvt_pk_bf16_f32 v188, v96, v97
    v_cvt_pk_bf16_f32 v189, v98, v99
    v_cvt_pk_bf16_f32 v190, v100, v101
    v_cvt_pk_bf16_f32 v191, v102, v103
    buffer_store_dwordx4 v[188:191], v252, s[20:23], s39 offen offset:128 sc1
    s_add_u32 s39, s39, 4096
    s_branch K1_E_40
K1_E_39:
    s_lshl_b32 s39, s36, 12
    s_add_u32 s39, s39, 0x3200800
    v_bfe_u32 v254, v253, 3, 1
    v_and_b32 v255, 7, v253
    v_lshl_add_u32 v254, v254, 4, v255
    v_lshrrev_b32 v255, 4, v253
    v_lshlrev_b32 v255, 4, v255
    v_lshl_add_u32 v254, v254, 6, v255
    s_mov_b32 exec_lo, 0
    s_mov_b32 exec_hi, 0xffff0000
    v_mov_b32 v4, 1.0
    v_mov_b32 v5, 0
    v_mov_b32 v6, 0
    v_mov_b32 v7, 0
    s_mov_b64 exec, -1
    v_cvt_pk_bf16_f32 v176, v0, v1
    v_cvt_pk_bf16_f32 v177, v2, v3
    v_cvt_pk_bf16_f32 v178, v4, v5
    v_cvt_pk_bf16_f32 v179, v6, v7
    buffer_store_dwordx4 v[176:179], v254, s[20:23], s39 offen offset:0 sc1
    s_mov_b32 exec_lo, 0
    s_mov_b32 exec_hi, 0xffff0000
    v_mov_b32 v36, 1.0
    v_mov_b32 v37, 0
    v_mov_b32 v38, 0
    v_mov_b32 v39, 0
    s_mov_b64 exec, -1
    v_cvt_pk_bf16_f32 v180, v32, v33
    v_cvt_pk_bf16_f32 v181, v34, v35
    v_cvt_pk_bf16_f32 v182, v36, v37
    v_cvt_pk_bf16_f32 v183, v38, v39
    buffer_store_dwordx4 v[180:183], v254, s[20:23], s39 offen offset:512 sc1
    s_add_u32 s39, s39, 4096
    s_mov_b32 exec_lo, 0
    s_mov_b32 exec_hi, 0xffff0000
    v_mov_b32 v68, 1.0
    v_mov_b32 v69, 0
    v_mov_b32 v70, 0
    v_mov_b32 v71, 0
    s_mov_b64 exec, -1
    v_cvt_pk_bf16_f32 v184, v64, v65
    v_cvt_pk_bf16_f32 v185, v66, v67
    v_cvt_pk_bf16_f32 v186, v68, v69
    v_cvt_pk_bf16_f32 v187, v70, v71
    buffer_store_dwordx4 v[184:187], v254, s[20:23], s39 offen offset:0 sc1
    s_mov_b32 exec_lo, 0
    s_mov_b32 exec_hi, 0xffff0000
    v_mov_b32 v100, 1.0
    v_mov_b32 v101, 0
    v_mov_b32 v102, 0
    v_mov_b32 v103, 0
    s_mov_b64 exec, -1
    v_cvt_pk_bf16_f32 v188, v96, v97
    v_cvt_pk_bf16_f32 v189, v98, v99
    v_cvt_pk_bf16_f32 v190, v100, v101
    v_cvt_pk_bf16_f32 v191, v102, v103
    buffer_store_dwordx4 v[188:191], v254, s[20:23], s39 offen offset:512 sc1
    s_add_u32 s39, s39, 4096
K1_E_40:
    s_mul_i32 s35, s26, 3
    s_add_u32 s35, s35, s68
    s_add_u32 s35, s35, 1
    s_cmp_lg_u32 s71, 0
    s_cbranch_scc1 K1_E_41
    s_lshr_b32 s36, s35, 3
    s_lshl_b32 s36, s36, 20
    s_and_b32 s37, s35, 7
    s_lshl_b32 s37, s37, 11
    s_add_u32 s39, s36, s37
    s_lshl_b32 s36, s38, 14
    s_add_u32 s39, s39, s36
    s_add_u32 s39, s39, 0x2000000
    s_cmp_ge_u32 s35, 128
    s_cselect_b32 s39, 0x7ff00000, s39
    s_cmp_lg_u32 s94, 0
    s_cselect_b32 s39, 0x7ff00000, s39
    v_cvt_pk_bf16_f32 v192, v8, v9
    v_cvt_pk_bf16_f32 v193, v10, v11
    v_cvt_pk_bf16_f32 v194, v12, v13
    v_cvt_pk_bf16_f32 v195, v14, v15
    buffer_store_dwordx4 v[192:195], v252, s[20:23], s39 offen offset:0 sc1
    v_cvt_pk_bf16_f32 v196, v40, v41
    v_cvt_pk_bf16_f32 v197, v42, v43
    v_cvt_pk_bf16_f32 v198, v44, v45
    v_cvt_pk_bf16_f32 v199, v46, v47
    buffer_store_dwordx4 v[196:199], v252, s[20:23], s39 offen offset:128 sc1
    s_add_u32 s39, s39, 16384
    v_cvt_pk_bf16_f32 v200, v72, v73
    v_cvt_pk_bf16_f32 v201, v74, v75
    v_cvt_pk_bf16_f32 v202, v76, v77
    v_cvt_pk_bf16_f32 v203, v78, v79
    buffer_store_dwordx4 v[200:203], v252, s[20:23], s39 offen offset:0 sc1
    v_cvt_pk_bf16_f32 v204, v104, v105
    v_cvt_pk_bf16_f32 v205, v106, v107
    v_cvt_pk_bf16_f32 v206, v108, v109
    v_cvt_pk_bf16_f32 v207, v110, v111
    buffer_store_dwordx4 v[204:207], v252, s[20:23], s39 offen offset:128 sc1
    s_add_u32 s39, s39, 16384
    s_branch K1_E_44
K1_E_41:
    s_and_b32 s36, s35, 15
    s_lshl_b32 s36, s36, 6
    s_add_u32 s36, s36, s38
    s_lshr_b32 s37, s35, 4
    s_cmp_eq_u32 s37, 1
    s_cbranch_scc1 K1_E_42
    s_cmp_eq_u32 s37, 2
    s_cbranch_scc1 K1_E_43
    s_lshl_b32 s39, s36, 11
    s_add_u32 s39, s39, 0x3000000
    v_mul_f32 v8, s95, v8
    v_mul_f32 v12, s95, v12
    v_mul_f32 v9, s95, v9
    v_mul_f32 v13, s95, v13
    v_mul_f32 v10, s95, v10
    v_mul_f32 v14, s95, v14
    v_mul_f32 v11, s95, v11
    v_mul_f32 v15, s95, v15
    s_mov_b32 exec_lo, 0
    s_mov_b32 exec_hi, 0xffff0000
    v_mov_b32 v12, 0
    v_mov_b32 v13, 0
    v_mov_b32 v14, 0
    v_mov_b32 v15, 0
    s_mov_b64 exec, -1
    v_cvt_pk_bf16_f32 v192, v8, v9
    v_cvt_pk_bf16_f32 v193, v10, v11
    v_cvt_pk_bf16_f32 v194, v12, v13
    v_cvt_pk_bf16_f32 v195, v14, v15
    buffer_store_dwordx4 v[192:195], v252, s[20:23], s39 offen offset:0 sc1
    v_mul_f32 v40, s95, v40
    v_mul_f32 v44, s95, v44
    v_mul_f32 v41, s95, v41
    v_mul_f32 v45, s95, v45
    v_mul_f32 v42, s95, v42
    v_mul_f32 v46, s95, v46
    v_mul_f32 v43, s95, v43
    v_mul_f32 v47, s95, v47
    s_mov_b32 exec_lo, 0
    s_mov_b32 exec_hi, 0xffff0000
    v_mov_b32 v44, 0
    v_mov_b32 v45, 0
    v_mov_b32 v46, 0
    v_mov_b32 v47, 0
    s_mov_b64 exec, -1
    v_cvt_pk_bf16_f32 v196, v40, v41
    v_cvt_pk_bf16_f32 v197, v42, v43
    v_cvt_pk_bf16_f32 v198, v44, v45
    v_cvt_pk_bf16_f32 v199, v46, v47
    buffer_store_dwordx4 v[196:199], v252, s[20:23], s39 offen offset:128 sc1
    v_mul_f32 v72, s95, v72
    v_mul_f32 v76, s95, v76
    v_mul_f32 v73, s95, v73
    v_mul_f32 v77, s95, v77
    v_mul_f32 v74, s95, v74
    v_mul_f32 v78, s95, v78
    v_mul_f32 v75, s95, v75
    v_mul_f32 v79, s95, v79
    s_mov_b32 exec_lo, 0
    s_mov_b32 exec_hi, 0xffff0000
    v_mov_b32 v76, 0
    v_mov_b32 v77, 0
    v_mov_b32 v78, 0
    v_mov_b32 v79, 0
    s_mov_b64 exec, -1
    v_cvt_pk_bf16_f32 v200, v72, v73
    v_cvt_pk_bf16_f32 v201, v74, v75
    v_cvt_pk_bf16_f32 v202, v76, v77
    v_cvt_pk_bf16_f32 v203, v78, v79
    buffer_store_dwordx4 v[200:203], v252, s[20:23], s39 offen offset:2048 sc1
    v_mul_f32 v104, s95, v104
    v_mul_f32 v108, s95, v108
    v_mul_f32 v105, s95, v105
    v_mul_f32 v109, s95, v109
    v_mul_f32 v106, s95, v106
    v_mul_f32 v110, s95, v110
    v_mul_f32 v107, s95, v107
    v_mul_f32 v111, s95, v111
    s_mov_b32 exec_lo, 0
    s_mov_b32 exec_hi, 0xffff0000
    v_mov_b32 v108, 0
    v_mov_b32 v109, 0
    v_mov_b32 v110, 0
    v_mov_b32 v111, 0
    s_mov_b64 exec, -1
    v_cvt_pk_bf16_f32 v204, v104, v105
    v_cvt_pk_bf16_f32 v205, v106, v107
    v_cvt_pk_bf16_f32 v206, v108, v109
    v_cvt_pk_bf16_f32 v207, v110, v111
    buffer_store_dwordx4 v[204:207], v252, s[20:23], s39 offen offset:2176 sc1
    s_branch K1_E_44
K1_E_42:
    s_lshl_b32 s39, s36, 12
    s_add_u32 s39, s39, 0x3200000
    s_mov_b32 exec_lo, 0
    s_mov_b32 exec_hi, 0xffff0000
    v_mov_b32 v12, 0
    v_mov_b32 v13, 0
    v_mov_b32 v14, 0
    v_mov_b32 v15, 0
    s_mov_b64 exec, -1
    v_cvt_pk_bf16_f32 v192, v8, v9
    v_cvt_pk_bf16_f32 v193, v10, v11
    v_cvt_pk_bf16_f32 v194, v12, v13
    v_cvt_pk_bf16_f32 v195, v14, v15
    buffer_store_dwordx4 v[192:195], v252, s[20:23], s39 offen offset:0 sc1
    s_mov_b32 exec_lo, 0
    s_mov_b32 exec_hi, 0xffff0000
    v_mov_b32 v44, 0
    v_mov_b32 v45, 0
    v_mov_b32 v46, 0
    v_mov_b32 v47, 0
    s_mov_b64 exec, -1
    v_cvt_pk_bf16_f32 v196, v40, v41
    v_cvt_pk_bf16_f32 v197, v42, v43
    v_cvt_pk_bf16_f32 v198, v44, v45
    v_cvt_pk_bf16_f32 v199, v46, v47
    buffer_store_dwordx4 v[196:199], v252, s[20:23], s39 offen offset:128 sc1
    s_add_u32 s39, s39, 4096
    s_mov_b32 exec_lo, 0
    s_mov_b32 exec_hi, 0xffff0000
    v_mov_b32 v76, 0
    v_mov_b32 v77, 0
    v_mov_b32 v78, 0
    v_mov_b32 v79, 0
    s_mov_b64 exec, -1
    v_cvt_pk_bf16_f32 v200, v72, v73
    v_cvt_pk_bf16_f32 v201, v74, v75
    v_cvt_pk_bf16_f32 v202, v76, v77
    v_cvt_pk_bf16_f32 v203, v78, v79
    buffer_store_dwordx4 v[200:203], v252, s[20:23], s39 offen offset:0 sc1
    s_mov_b32 exec_lo, 0
    s_mov_b32 exec_hi, 0xffff0000
    v_mov_b32 v108, 0
    v_mov_b32 v109, 0
    v_mov_b32 v110, 0
    v_mov_b32 v111, 0
    s_mov_b64 exec, -1
    v_cvt_pk_bf16_f32 v204, v104, v105
    v_cvt_pk_bf16_f32 v205, v106, v107
    v_cvt_pk_bf16_f32 v206, v108, v109
    v_cvt_pk_bf16_f32 v207, v110, v111
    buffer_store_dwordx4 v[204:207], v252, s[20:23], s39 offen offset:128 sc1
    s_add_u32 s39, s39, 4096
    s_branch K1_E_44
K1_E_43:
    s_lshl_b32 s39, s36, 12
    s_add_u32 s39, s39, 0x3200800
    v_bfe_u32 v254, v253, 3, 1
    v_and_b32 v255, 7, v253
    v_lshl_add_u32 v254, v254, 4, v255
    v_lshrrev_b32 v255, 4, v253
    v_lshlrev_b32 v255, 4, v255
    v_lshl_add_u32 v254, v254, 6, v255
    s_mov_b32 exec_lo, 0
    s_mov_b32 exec_hi, 0xffff0000
    v_mov_b32 v12, 1.0
    v_mov_b32 v13, 0
    v_mov_b32 v14, 0
    v_mov_b32 v15, 0
    s_mov_b64 exec, -1
    v_cvt_pk_bf16_f32 v192, v8, v9
    v_cvt_pk_bf16_f32 v193, v10, v11
    v_cvt_pk_bf16_f32 v194, v12, v13
    v_cvt_pk_bf16_f32 v195, v14, v15
    buffer_store_dwordx4 v[192:195], v254, s[20:23], s39 offen offset:0 sc1
    s_mov_b32 exec_lo, 0
    s_mov_b32 exec_hi, 0xffff0000
    v_mov_b32 v44, 1.0
    v_mov_b32 v45, 0
    v_mov_b32 v46, 0
    v_mov_b32 v47, 0
    s_mov_b64 exec, -1
    v_cvt_pk_bf16_f32 v196, v40, v41
    v_cvt_pk_bf16_f32 v197, v42, v43
    v_cvt_pk_bf16_f32 v198, v44, v45
    v_cvt_pk_bf16_f32 v199, v46, v47
    buffer_store_dwordx4 v[196:199], v254, s[20:23], s39 offen offset:512 sc1
    s_add_u32 s39, s39, 4096
    s_mov_b32 exec_lo, 0
    s_mov_b32 exec_hi, 0xffff0000
    v_mov_b32 v76, 1.0
    v_mov_b32 v77, 0
    v_mov_b32 v78, 0
    v_mov_b32 v79, 0
    s_mov_b64 exec, -1
    v_cvt_pk_bf16_f32 v200, v72, v73
    v_cvt_pk_bf16_f32 v201, v74, v75
    v_cvt_pk_bf16_f32 v202, v76, v77
    v_cvt_pk_bf16_f32 v203, v78, v79
    buffer_store_dwordx4 v[200:203], v254, s[20:23], s39 offen offset:0 sc1
    s_mov_b32 exec_lo, 0
    s_mov_b32 exec_hi, 0xffff0000
    v_mov_b32 v108, 1.0
    v_mov_b32 v109, 0
    v_mov_b32 v110, 0
    v_mov_b32 v111, 0
    s_mov_b64 exec, -1
    v_cvt_pk_bf16_f32 v204, v104, v105
    v_cvt_pk_bf16_f32 v205, v106, v107
    v_cvt_pk_bf16_f32 v206, v108, v109
    v_cvt_pk_bf16_f32 v207, v110, v111
    buffer_store_dwordx4 v[204:207], v254, s[20:23], s39 offen offset:512 sc1
    s_add_u32 s39, s39, 4096
K1_E_44:
    s_mul_i32 s35, s26, 3
    s_add_u32 s35, s35, s68
    s_add_u32 s35, s35, 2
    s_cmp_lg_u32 s71, 0
    s_cbranch_scc1 K1_E_45
    s_lshr_b32 s36, s35, 3
    s_lshl_b32 s36, s36, 20
    s_and_b32 s37, s35, 7
    s_lshl_b32 s37, s37, 11
    s_add_u32 s39, s36, s37
    s_lshl_b32 s36, s38, 14
    s_add_u32 s39, s39, s36
    s_add_u32 s39, s39, 0x2000000
    s_cmp_ge_u32 s35, 128
    s_cselect_b32 s39, 0x7ff00000, s39
    s_cmp_lg_u32 s94, 0
    s_cselect_b32 s39, 0x7ff00000, s39
    v_cvt_pk_bf16_f32 v208, v16, v17
    v_cvt_pk_bf16_f32 v209, v18, v19
    v_cvt_pk_bf16_f32 v210, v20, v21
    v_cvt_pk_bf16_f32 v211, v22, v23
    buffer_store_dwordx4 v[208:211], v252, s[20:23], s39 offen offset:0 sc1
    v_cvt_pk_bf16_f32 v212, v48, v49
    v_cvt_pk_bf16_f32 v213, v50, v51
    v_cvt_pk_bf16_f32 v214, v52, v53
    v_cvt_pk_bf16_f32 v215, v54, v55
    buffer_store_dwordx4 v[212:215], v252, s[20:23], s39 offen offset:128 sc1
    s_add_u32 s39, s39, 16384
    v_cvt_pk_bf16_f32 v216, v80, v81
    v_cvt_pk_bf16_f32 v217, v82, v83
    v_cvt_pk_bf16_f32 v218, v84, v85
    v_cvt_pk_bf16_f32 v219, v86, v87
    buffer_store_dwordx4 v[216:219], v252, s[20:23], s39 offen offset:0 sc1
    v_cvt_pk_bf16_f32 v220, v112, v113
    v_cvt_pk_bf16_f32 v221, v114, v115
    v_cvt_pk_bf16_f32 v222, v116, v117
    v_cvt_pk_bf16_f32 v223, v118, v119
    buffer_store_dwordx4 v[220:223], v252, s[20:23], s39 offen offset:128 sc1
    s_add_u32 s39, s39, 16384
    s_branch K1_E_48
K1_E_45:
    s_and_b32 s36, s35, 15
    s_lshl_b32 s36, s36, 6
    s_add_u32 s36, s36, s38
    s_lshr_b32 s37, s35, 4
    s_cmp_eq_u32 s37, 1
    s_cbranch_scc1 K1_E_46
    s_cmp_eq_u32 s37, 2
    s_cbranch_scc1 K1_E_47
    s_lshl_b32 s39, s36, 11
    s_add_u32 s39, s39, 0x3000000
    v_mul_f32 v16, s95, v16
    v_mul_f32 v20, s95, v20
    v_mul_f32 v17, s95, v17
    v_mul_f32 v21, s95, v21
    v_mul_f32 v18, s95, v18
    v_mul_f32 v22, s95, v22
    v_mul_f32 v19, s95, v19
    v_mul_f32 v23, s95, v23
    s_mov_b32 exec_lo, 0
    s_mov_b32 exec_hi, 0xffff0000
    v_mov_b32 v20, 0
    v_mov_b32 v21, 0
    v_mov_b32 v22, 0
    v_mov_b32 v23, 0
    s_mov_b64 exec, -1
    v_cvt_pk_bf16_f32 v208, v16, v17
    v_cvt_pk_bf16_f32 v209, v18, v19
    v_cvt_pk_bf16_f32 v210, v20, v21
    v_cvt_pk_bf16_f32 v211, v22, v23
    buffer_store_dwordx4 v[208:211], v252, s[20:23], s39 offen offset:0 sc1
    v_mul_f32 v48, s95, v48
    v_mul_f32 v52, s95, v52
    v_mul_f32 v49, s95, v49
    v_mul_f32 v53, s95, v53
    v_mul_f32 v50, s95, v50
    v_mul_f32 v54, s95, v54
    v_mul_f32 v51, s95, v51
    v_mul_f32 v55, s95, v55
    s_mov_b32 exec_lo, 0
    s_mov_b32 exec_hi, 0xffff0000
    v_mov_b32 v52, 0
    v_mov_b32 v53, 0
    v_mov_b32 v54, 0
    v_mov_b32 v55, 0
    s_mov_b64 exec, -1
    v_cvt_pk_bf16_f32 v212, v48, v49
    v_cvt_pk_bf16_f32 v213, v50, v51
    v_cvt_pk_bf16_f32 v214, v52, v53
    v_cvt_pk_bf16_f32 v215, v54, v55
    buffer_store_dwordx4 v[212:215], v252, s[20:23], s39 offen offset:128 sc1
    v_mul_f32 v80, s95, v80
    v_mul_f32 v84, s95, v84
    v_mul_f32 v81, s95, v81
    v_mul_f32 v85, s95, v85
    v_mul_f32 v82, s95, v82
    v_mul_f32 v86, s95, v86
    v_mul_f32 v83, s95, v83
    v_mul_f32 v87, s95, v87
    s_mov_b32 exec_lo, 0
    s_mov_b32 exec_hi, 0xffff0000
    v_mov_b32 v84, 0
    v_mov_b32 v85, 0
    v_mov_b32 v86, 0
    v_mov_b32 v87, 0
    s_mov_b64 exec, -1
    v_cvt_pk_bf16_f32 v216, v80, v81
    v_cvt_pk_bf16_f32 v217, v82, v83
    v_cvt_pk_bf16_f32 v218, v84, v85
    v_cvt_pk_bf16_f32 v219, v86, v87
    buffer_store_dwordx4 v[216:219], v252, s[20:23], s39 offen offset:2048 sc1
    v_mul_f32 v112, s95, v112
    v_mul_f32 v116, s95, v116
    v_mul_f32 v113, s95, v113
    v_mul_f32 v117, s95, v117
    v_mul_f32 v114, s95, v114
    v_mul_f32 v118, s95, v118
    v_mul_f32 v115, s95, v115
    v_mul_f32 v119, s95, v119
    s_mov_b32 exec_lo, 0
    s_mov_b32 exec_hi, 0xffff0000
    v_mov_b32 v116, 0
    v_mov_b32 v117, 0
    v_mov_b32 v118, 0
    v_mov_b32 v119, 0
    s_mov_b64 exec, -1
    v_cvt_pk_bf16_f32 v220, v112, v113
    v_cvt_pk_bf16_f32 v221, v114, v115
    v_cvt_pk_bf16_f32 v222, v116, v117
    v_cvt_pk_bf16_f32 v223, v118, v119
    buffer_store_dwordx4 v[220:223], v252, s[20:23], s39 offen offset:2176 sc1
    s_branch K1_E_48
K1_E_46:
    s_lshl_b32 s39, s36, 12
    s_add_u32 s39, s39, 0x3200000
    s_mov_b32 exec_lo, 0
    s_mov_b32 exec_hi, 0xffff0000
    v_mov_b32 v20, 0
    v_mov_b32 v21, 0
    v_mov_b32 v22, 0
    v_mov_b32 v23, 0
    s_mov_b64 exec, -1
    v_cvt_pk_bf16_f32 v208, v16, v17
    v_cvt_pk_bf16_f32 v209, v18, v19
    v_cvt_pk_bf16_f32 v210, v20, v21
    v_cvt_pk_bf16_f32 v211, v22, v23
    buffer_store_dwordx4 v[208:211], v252, s[20:23], s39 offen offset:0 sc1
    s_mov_b32 exec_lo, 0
    s_mov_b32 exec_hi, 0xffff0000
    v_mov_b32 v52, 0
    v_mov_b32 v53, 0
    v_mov_b32 v54, 0
    v_mov_b32 v55, 0
    s_mov_b64 exec, -1
    v_cvt_pk_bf16_f32 v212, v48, v49
    v_cvt_pk_bf16_f32 v213, v50, v51
    v_cvt_pk_bf16_f32 v214, v52, v53
    v_cvt_pk_bf16_f32 v215, v54, v55
    buffer_store_dwordx4 v[212:215], v252, s[20:23], s39 offen offset:128 sc1
    s_add_u32 s39, s39, 4096
    s_mov_b32 exec_lo, 0
    s_mov_b32 exec_hi, 0xffff0000
    v_mov_b32 v84, 0
    v_mov_b32 v85, 0
    v_mov_b32 v86, 0
    v_mov_b32 v87, 0
    s_mov_b64 exec, -1
    v_cvt_pk_bf16_f32 v216, v80, v81
    v_cvt_pk_bf16_f32 v217, v82, v83
    v_cvt_pk_bf16_f32 v218, v84, v85
    v_cvt_pk_bf16_f32 v219, v86, v87
    buffer_store_dwordx4 v[216:219], v252, s[20:23], s39 offen offset:0 sc1
    s_mov_b32 exec_lo, 0
    s_mov_b32 exec_hi, 0xffff0000
    v_mov_b32 v116, 0
    v_mov_b32 v117, 0
    v_mov_b32 v118, 0
    v_mov_b32 v119, 0
    s_mov_b64 exec, -1
    v_cvt_pk_bf16_f32 v220, v112, v113
    v_cvt_pk_bf16_f32 v221, v114, v115
    v_cvt_pk_bf16_f32 v222, v116, v117
    v_cvt_pk_bf16_f32 v223, v118, v119
    buffer_store_dwordx4 v[220:223], v252, s[20:23], s39 offen offset:128 sc1
    s_add_u32 s39, s39, 4096
    s_branch K1_E_48
K1_E_47:
    s_lshl_b32 s39, s36, 12
    s_add_u32 s39, s39, 0x3200800
    v_bfe_u32 v254, v253, 3, 1
    v_and_b32 v255, 7, v253
    v_lshl_add_u32 v254, v254, 4, v255
    v_lshrrev_b32 v255, 4, v253
    v_lshlrev_b32 v255, 4, v255
    v_lshl_add_u32 v254, v254, 6, v255
    s_mov_b32 exec_lo, 0
    s_mov_b32 exec_hi, 0xffff0000
    v_mov_b32 v20, 1.0
    v_mov_b32 v21, 0
    v_mov_b32 v22, 0
    v_mov_b32 v23, 0
    s_mov_b64 exec, -1
    v_cvt_pk_bf16_f32 v208, v16, v17
    v_cvt_pk_bf16_f32 v209, v18, v19
    v_cvt_pk_bf16_f32 v210, v20, v21
    v_cvt_pk_bf16_f32 v211, v22, v23
    buffer_store_dwordx4 v[208:211], v254, s[20:23], s39 offen offset:0 sc1
    s_mov_b32 exec_lo, 0
    s_mov_b32 exec_hi, 0xffff0000
    v_mov_b32 v52, 1.0
    v_mov_b32 v53, 0
    v_mov_b32 v54, 0
    v_mov_b32 v55, 0
    s_mov_b64 exec, -1
    v_cvt_pk_bf16_f32 v212, v48, v49
    v_cvt_pk_bf16_f32 v213, v50, v51
    v_cvt_pk_bf16_f32 v214, v52, v53
    v_cvt_pk_bf16_f32 v215, v54, v55
    buffer_store_dwordx4 v[212:215], v254, s[20:23], s39 offen offset:512 sc1
    s_add_u32 s39, s39, 4096
    s_mov_b32 exec_lo, 0
    s_mov_b32 exec_hi, 0xffff0000
    v_mov_b32 v84, 1.0
    v_mov_b32 v85, 0
    v_mov_b32 v86, 0
    v_mov_b32 v87, 0
    s_mov_b64 exec, -1
    v_cvt_pk_bf16_f32 v216, v80, v81
    v_cvt_pk_bf16_f32 v217, v82, v83
    v_cvt_pk_bf16_f32 v218, v84, v85
    v_cvt_pk_bf16_f32 v219, v86, v87
    buffer_store_dwordx4 v[216:219], v254, s[20:23], s39 offen offset:0 sc1
    s_mov_b32 exec_lo, 0
    s_mov_b32 exec_hi, 0xffff0000
    v_mov_b32 v116, 1.0
    v_mov_b32 v117, 0
    v_mov_b32 v118, 0
    v_mov_b32 v119, 0
    s_mov_b64 exec, -1
    v_cvt_pk_bf16_f32 v220, v112, v113
    v_cvt_pk_bf16_f32 v221, v114, v115
    v_cvt_pk_bf16_f32 v222, v116, v117
    v_cvt_pk_bf16_f32 v223, v118, v119
    buffer_store_dwordx4 v[220:223], v254, s[20:23], s39 offen offset:512 sc1
    s_add_u32 s39, s39, 4096
K1_E_48:
    s_waitcnt vmcnt(22) lgkmcnt(0)
    s_barrier
    v_mfma_f32_16x16x32_bf16 v[0:3], v[128:131], v[144:147], 0
    ds_read_b128 v[176:179], v225 offset:0
    ds_read_b64_tr_b16 v[192:193], v226 offset:49152
    v_mfma_f32_16x16x32_bf16 v[4:7], v[128:131], v[148:151], 0
    ds_read_b64_tr_b16 v[194:195], v226 offset:51200
    v_mfma_f32_16x16x32_bf16 v[8:11], v[128:131], v[152:155], 0
    ds_read_b64_tr_b16 v[196:197], v227 offset:49152
    ds_read_b64_tr_b16 v[198:199], v227 offset:51200
    v_mfma_f32_16x16x32_bf16 v[12:15], v[128:131], v[156:159], 0
    ds_read_b128 v[180:183], v225 offset:1024
    v_mfma_f32_16x16x32_bf16 v[16:19], v[128:131], v[160:163], 0
    ds_read_b64_tr_b16 v[200:201], v228 offset:49152
    ds_read_b64_tr_b16 v[202:203], v228 offset:51200
    v_mfma_f32_16x16x32_bf16 v[20:23], v[128:131], v[164:167], 0
    ds_read_b64_tr_b16 v[204:205], v229 offset:49152
    v_mfma_f32_16x16x32_bf16 v[24:27], v[128:131], v[168:171], 0
    ds_read_b64_tr_b16 v[206:207], v229 offset:51200
    ds_read_b64_tr_b16 v[208:209], v230 offset:49152
    v_mfma_f32_16x16x32_bf16 v[28:31], v[128:131], v[172:175], 0
    ds_read_b64_tr_b16 v[210:211], v230 offset:51200
    v_mfma_f32_16x16x32_bf16 v[32:35], v[132:135], v[144:147], 0
    ds_read_b64_tr_b16 v[212:213], v231 offset:49152
    v_mfma_f32_16x16x32_bf16 v[36:39], v[132:135], v[148:151], 0
    ds_read_b64_tr_b16 v[214:215], v231 offset:51200
    ds_read_b64_tr_b16 v[216:217], v232 offset:49152
    v_mfma_f32_16x16x32_bf16 v[40:43], v[132:135], v[152:155], 0
    ds_read_b64_tr_b16 v[218:219], v232 offset:51200
    v_mfma_f32_16x16x32_bf16 v[44:47], v[132:135], v[156:159], 0
    ds_read_b64_tr_b16 v[220:221], v233 offset:49152
    ds_read_b64_tr_b16 v[222:223], v233 offset:51200
    v_mfma_f32_16x16x32_bf16 v[48:51], v[132:135], v[160:163], 0
    ds_read_b128 v[184:187], v225 offset:4096
    v_mfma_f32_16x16x32_bf16 v[52:55], v[132:135], v[164:167], 0
    ds_read_b128 v[188:191], v225 offset:5120
    s_add_u32 s30, s41, s42
    v_mfma_f32_16x16x32_bf16 v[56:59], v[132:135], v[168:171], 0
    s_and_b32 s30, s30, 3
    v_mfma_f32_16x16x32_bf16 v[60:63], v[132:135], v[172:175], 0
    s_andn2_b32 s37, s41, 3
    v_mfma_f32_16x16x32_bf16 v[64:67], v[136:139], v[144:147], 0
    s_or_b32 s30, s30, s37
    s_add_u32 s41, s41, 1
    v_mfma_f32_16x16x32_bf16 v[68:71], v[136:139], v[148:151], 0
    s_mul_i32 s30, s30, s44
    v_mfma_f32_16x16x32_bf16 v[72:75], v[136:139], v[152:155], 0
    s_lshl_b32 s30, s30, 1
    s_add_u32 m0, s33, 32768
    v_mfma_f32_16x16x32_bf16 v[76:79], v[136:139], v[156:159], 0
    s_nop 0
    v_mfma_f32_16x16x32_bf16 v[80:83], v[136:139], v[160:163], 0
    buffer_load_dwordx4 v248, s[8:11], s30 offen offset:0 lds
    buffer_load_dwordx4 v249, s[8:11], s30 offen offset:1024 lds
    v_mfma_f32_16x16x32_bf16 v[84:87], v[136:139], v[164:167], 0
    s_add_u32 s30, s30, s44
    v_mfma_f32_16x16x32_bf16 v[88:91], v[136:139], v[168:171], 0
    s_add_u32 s35, s27, s32
    s_add_u32 m0, s35, 0x800
    v_mfma_f32_16x16x32_bf16 v[92:95], v[136:139], v[172:175], 0
    s_add_u32 s27, s27, 0x8000
    v_mfma_f32_16x16x32_bf16 v[96:99], v[140:143], v[144:147], 0
    buffer_load_dwordx4 v242, s[4:7], s31 offen offset:0 lds
    v_mfma_f32_16x16x32_bf16 v[100:103], v[140:143], v[148:151], 0
    buffer_load_dwordx4 v243, s[4:7], s31 offen offset:1024 lds
    s_cmp_ge_u32 s27, 0x28000
    v_mfma_f32_16x16x32_bf16 v[104:107], v[140:143], v[152:155], 0
    s_cselect_b32 s27, 0x10000, s27
    v_mfma_f32_16x16x32_bf16 v[108:111], v[140:143], v[156:159], 0
    s_add_u32 s36, s28, 0x8000
    s_cmp_ge_u32 s36, 0x18000
    v_mfma_f32_16x16x32_bf16 v[112:115], v[140:143], v[160:163], 0
    s_cselect_b32 s36, 0, s36
    v_mfma_f32_16x16x32_bf16 v[116:119], v[140:143], v[164:167], 0
    s_sub_u32 s29, s36, s28
    s_mov_b32 s28, s36
    v_mfma_f32_16x16x32_bf16 v[120:123], v[140:143], v[168:171], 0
    v_add_u32 v224, s29, v224
    v_mfma_f32_16x16x32_bf16 v[124:127], v[140:143], v[172:175], 0
    v_add_u32 v225, s29, v225
    s_waitcnt vmcnt(20) lgkmcnt(0)
    s_barrier
    v_mfma_f32_16x16x32_bf16 v[0:3], v[176:179], v[192:195], v[0:3]
    ds_read_b128 v[128:131], v224 offset:0
    ds_read_b64_tr_b16 v[144:145], v226 offset:0
    v_mfma_f32_16x16x32_bf16 v[4:7], v[176:179], v[196:199], v[4:7]
    ds_read_b64_tr_b16 v[146:147], v226 offset:2048
    v_mfma_f32_16x16x32_bf16 v[8:11], v[176:179], v[200:203], v[8:11]
    ds_read_b64_tr_b16 v[148:149], v227 offset:0
    v_mfma_f32_16x16x32_bf16 v[12:15], v[176:179], v[204:207], v[12:15]
    ds_read_b64_tr_b16 v[150:151], v227 offset:2048
    v_mfma_f32_16x16x32_bf16 v[16:19], v[176:179], v[208:211], v[16:19]
    ds_read_b128 v[132:135], v224 offset:1024
    v_mfma_f32_16x16x32_bf16 v[20:23], v[176:179], v[212:215], v[20:23]
    ds_read_b64_tr_b16 v[152:153], v228 offset:0
    v_mfma_f32_16x16x32_bf16 v[24:27], v[176:179], v[216:219], v[24:27]
    ds_read_b64_tr_b16 v[154:155], v228 offset:2048
    v_mfma_f32_16x16x32_bf16 v[28:31], v[176:179], v[220:223], v[28:31]
    ds_read_b64_tr_b16 v[156:157], v229 offset:0
    v_mfma_f32_16x16x32_bf16 v[32:35], v[180:183], v[192:195], v[32:35]
    ds_read_b64_tr_b16 v[158:159], v229 offset:2048
    v_mfma_f32_16x16x32_bf16 v[36:39], v[180:183], v[196:199], v[36:39]
    ds_read_b64_tr_b16 v[160:161], v230 offset:0
    v_mfma_f32_16x16x32_bf16 v[40:43], v[180:183], v[200:203], v[40:43]
    ds_read_b64_tr_b16 v[162:163], v230 offset:2048
    v_mfma_f32_16x16x32_bf16 v[44:47], v[180:183], v[204:207], v[44:47]
    ds_read_b64_tr_b16 v[164:165], v231 offset:0
    v_mfma_f32_16x16x32_bf16 v[48:51], v[180:183], v[208:211], v[48:51]
    ds_read_b64_tr_b16 v[166:167], v231 offset:2048
    v_mfma_f32_16x16x32_bf16 v[52:55], v[180:183], v[212:215], v[52:55]
    ds_read_b64_tr_b16 v[168:169], v232 offset:0
    v_mfma_f32_16x16x32_bf16 v[56:59], v[180:183], v[216:219], v[56:59]
    ds_read_b64_tr_b16 v[170:171], v232 offset:2048
    v_mfma_f32_16x16x32_bf16 v[60:63], v[180:183], v[220:223], v[60:63]
    ds_read_b64_tr_b16 v[172:173], v233 offset:0
    v_mfma_f32_16x16x32_bf16 v[64:67], v[184:187], v[192:195], v[64:67]
    ds_read_b64_tr_b16 v[174:175], v233 offset:2048
    v_mfma_f32_16x16x32_bf16 v[68:71], v[184:187], v[196:199], v[68:71]
    ds_read_b128 v[136:139], v224 offset:4096
    v_mfma_f32_16x16x32_bf16 v[72:75], v[184:187], v[200:203], v[72:75]
    ds_read_b128 v[140:143], v224 offset:5120
    v_mfma_f32_16x16x32_bf16 v[76:79], v[184:187], v[204:207], v[76:79]
    s_add_u32 m0, s33, 49152
    v_mfma_f32_16x16x32_bf16 v[80:83], v[184:187], v[208:211], v[80:83]
    s_nop 0
    v_mfma_f32_16x16x32_bf16 v[84:87], v[184:187], v[212:215], v[84:87]
    buffer_load_dwordx4 v248, s[8:11], s30 offen offset:0 lds
    v_mfma_f32_16x16x32_bf16 v[88:91], v[184:187], v[216:219], v[88:91]
    buffer_load_dwordx4 v249, s[8:11], s30 offen offset:1024 lds
    v_mfma_f32_16x16x32_bf16 v[92:95], v[184:187], v[220:223], v[92:95]
    s_add_u32 s31, s40, s42
    v_mfma_f32_16x16x32_bf16 v[96:99], v[188:191], v[192:195], v[96:99]
    s_and_b32 s31, s31, 3
    v_mfma_f32_16x16x32_bf16 v[100:103], v[188:191], v[196:199], v[100:103]
    s_andn2_b32 s37, s40, 3
    v_mfma_f32_16x16x32_bf16 v[104:107], v[188:191], v[200:203], v[104:107]
    s_or_b32 s31, s31, s37
    v_mfma_f32_16x16x32_bf16 v[108:111], v[188:191], v[204:207], v[108:111]
    s_add_u32 s40, s40, 1
    v_mfma_f32_16x16x32_bf16 v[112:115], v[188:191], v[208:211], v[112:115]
    s_add_u32 m0, s27, s32
    v_mfma_f32_16x16x32_bf16 v[116:119], v[188:191], v[212:215], v[116:119]
    s_lshl_b32 s31, s31, 7
    v_mfma_f32_16x16x32_bf16 v[120:123], v[188:191], v[216:219], v[120:123]
    buffer_load_dwordx4 v240, s[4:7], s31 offen offset:0 lds
    v_mfma_f32_16x16x32_bf16 v[124:127], v[188:191], v[220:223], v[124:127]
    buffer_load_dwordx4 v241, s[4:7], s31 offen offset:1024 lds
    s_waitcnt vmcnt(22) lgkmcnt(0)
    s_barrier
    v_mfma_f32_16x16x32_bf16 v[0:3], v[128:131], v[144:147], v[0:3]
    ds_read_b128 v[176:179], v225 offset:0
    ds_read_b64_tr_b16 v[192:193], v226 offset:16384
    v_mfma_f32_16x16x32_bf16 v[4:7], v[128:131], v[148:151], v[4:7]
    ds_read_b64_tr_b16 v[194:195], v226 offset:18432
    v_mfma_f32_16x16x32_bf16 v[8:11], v[128:131], v[152:155], v[8:11]
    ds_read_b64_tr_b16 v[196:197], v227 offset:16384
    ds_read_b64_tr_b16 v[198:199], v227 offset:18432
    v_mfma_f32_16x16x32_bf16 v[12:15], v[128:131], v[156:159], v[12:15]
    ds_read_b128 v[180:183], v225 offset:1024
    v_mfma_f32_16x16x32_bf16 v[16:19], v[128:131], v[160:163], v[16:19]
    ds_read_b64_tr_b16 v[200:201], v228 offset:16384
    ds_read_b64_tr_b16 v[202:203], v228 offset:18432
    v_mfma_f32_16x16x32_bf16 v[20:23], v[128:131], v[164:167], v[20:23]
    ds_read_b64_tr_b16 v[204:205], v229 offset:16384
    v_mfma_f32_16x16x32_bf16 v[24:27], v[128:131], v[168:171], v[24:27]
    ds_read_b64_tr_b16 v[206:207], v229 offset:18432
    ds_read_b64_tr_b16 v[208:209], v230 offset:16384
    v_mfma_f32_16x16x32_bf16 v[28:31], v[128:131], v[172:175], v[28:31]
    ds_read_b64_tr_b16 v[210:211], v230 offset:18432
    v_mfma_f32_16x16x32_bf16 v[32:35], v[132:135], v[144:147], v[32:35]
    ds_read_b64_tr_b16 v[212:213], v231 offset:16384
    v_mfma_f32_16x16x32_bf16 v[36:39], v[132:135], v[148:151], v[36:39]
    ds_read_b64_tr_b16 v[214:215], v231 offset:18432
    ds_read_b64_tr_b16 v[216:217], v232 offset:16384
    v_mfma_f32_16x16x32_bf16 v[40:43], v[132:135], v[152:155], v[40:43]
    ds_read_b64_tr_b16 v[218:219], v232 offset:18432
    v_mfma_f32_16x16x32_bf16 v[44:47], v[132:135], v[156:159], v[44:47]
    ds_read_b64_tr_b16 v[220:221], v233 offset:16384
    ds_read_b64_tr_b16 v[222:223], v233 offset:18432
    v_mfma_f32_16x16x32_bf16 v[48:51], v[132:135], v[160:163], v[48:51]
    ds_read_b128 v[184:187], v225 offset:4096
    v_mfma_f32_16x16x32_bf16 v[52:55], v[132:135], v[164:167], v[52:55]
    ds_read_b128 v[188:191], v225 offset:5120
    s_add_u32 s30, s41, s42
    v_mfma_f32_16x16x32_bf16 v[56:59], v[132:135], v[168:171], v[56:59]
    s_and_b32 s30, s30, 3
    v_mfma_f32_16x16x32_bf16 v[60:63], v[132:135], v[172:175], v[60:63]
    s_andn2_b32 s37, s41, 3
    v_mfma_f32_16x16x32_bf16 v[64:67], v[136:139], v[144:147], v[64:67]
    s_or_b32 s30, s30, s37
    s_add_u32 s41, s41, 1
    v_mfma_f32_16x16x32_bf16 v[68:71], v[136:139], v[148:151], v[68:71]
    s_mul_i32 s30, s30, s44
    v_mfma_f32_16x16x32_bf16 v[72:75], v[136:139], v[152:155], v[72:75]
    s_lshl_b32 s30, s30, 1
    s_add_u32 m0, s33, 0
    v_mfma_f32_16x16x32_bf16 v[76:79], v[136:139], v[156:159], v[76:79]
    s_nop 0
    v_mfma_f32_16x16x32_bf16 v[80:83], v[136:139], v[160:163], v[80:83]
    buffer_load_dwordx4 v248, s[8:11], s30 offen offset:0 lds
    buffer_load_dwordx4 v249, s[8:11], s30 offen offset:1024 lds
    v_mfma_f32_16x16x32_bf16 v[84:87], v[136:139], v[164:167], v[84:87]
    s_add_u32 s30, s30, s44
    v_mfma_f32_16x16x32_bf16 v[88:91], v[136:139], v[168:171], v[88:91]
    s_add_u32 s35, s27, s32
    s_add_u32 m0, s35, 0x800
    v_mfma_f32_16x16x32_bf16 v[92:95], v[136:139], v[172:175], v[92:95]
    s_add_u32 s27, s27, 0x8000
    v_mfma_f32_16x16x32_bf16 v[96:99], v[140:143], v[144:147], v[96:99]
    buffer_load_dwordx4 v242, s[4:7], s31 offen offset:0 lds
    v_mfma_f32_16x16x32_bf16 v[100:103], v[140:143], v[148:151], v[100:103]
    buffer_load_dwordx4 v243, s[4:7], s31 offen offset:1024 lds
    s_cmp_ge_u32 s27, 0x28000
    v_mfma_f32_16x16x32_bf16 v[104:107], v[140:143], v[152:155], v[104:107]
    s_cselect_b32 s27, 0x10000, s27
    v_mfma_f32_16x16x32_bf16 v[108:111], v[140:143], v[156:159], v[108:111]
    s_add_u32 s36, s28, 0x8000
    s_cmp_ge_u32 s36, 0x18000
    v_mfma_f32_16x16x32_bf16 v[112:115], v[140:143], v[160:163], v[112:115]
    s_cselect_b32 s36, 0, s36
    v_mfma_f32_16x16x32_bf16 v[116:119], v[140:143], v[164:167], v[116:119]
    s_sub_u32 s29, s36, s28
    s_mov_b32 s28, s36
    v_mfma_f32_16x16x32_bf16 v[120:123], v[140:143], v[168:171], v[120:123]
    v_add_u32 v224, s29, v224
    v_mfma_f32_16x16x32_bf16 v[124:127], v[140:143], v[172:175], v[124:127]
    v_add_u32 v225, s29, v225
    s_waitcnt vmcnt(8) lgkmcnt(0)
    s_barrier
    v_mfma_f32_16x16x32_bf16 v[0:3], v[176:179], v[192:195], v[0:3]
    ds_read_b128 v[128:131], v224 offset:0
    ds_read_b64_tr_b16 v[144:145], v226 offset:32768
    v_mfma_f32_16x16x32_bf16 v[4:7], v[176:179], v[196:199], v[4:7]
    ds_read_b64_tr_b16 v[146:147], v226 offset:34816
    v_mfma_f32_16x16x32_bf16 v[8:11], v[176:179], v[200:203], v[8:11]
    ds_read_b64_tr_b16 v[148:149], v227 offset:32768
    v_mfma_f32_16x16x32_bf16 v[12:15], v[176:179], v[204:207], v[12:15]
    ds_read_b64_tr_b16 v[150:151], v227 offset:34816
    v_mfma_f32_16x16x32_bf16 v[16:19], v[176:179], v[208:211], v[16:19]
    ds_read_b128 v[132:135], v224 offset:1024
    v_mfma_f32_16x16x32_bf16 v[20:23], v[176:179], v[212:215], v[20:23]
    ds_read_b64_tr_b16 v[152:153], v228 offset:32768
    v_mfma_f32_16x16x32_bf16 v[24:27], v[176:179], v[216:219], v[24:27]
    ds_read_b64_tr_b16 v[154:155], v228 offset:34816
    v_mfma_f32_16x16x32_bf16 v[28:31], v[176:179], v[220:223], v[28:31]
    ds_read_b64_tr_b16 v[156:157], v229 offset:32768
    v_mfma_f32_16x16x32_bf16 v[32:35], v[180:183], v[192:195], v[32:35]
    ds_read_b64_tr_b16 v[158:159], v229 offset:34816
    v_mfma_f32_16x16x32_bf16 v[36:39], v[180:183], v[196:199], v[36:39]
    ds_read_b64_tr_b16 v[160:161], v230 offset:32768
    v_mfma_f32_16x16x32_bf16 v[40:43], v[180:183], v[200:203], v[40:43]
    ds_read_b64_tr_b16 v[162:163], v230 offset:34816
    v_mfma_f32_16x16x32_bf16 v[44:47], v[180:183], v[204:207], v[44:47]
    ds_read_b64_tr_b16 v[164:165], v231 offset:32768
    v_mfma_f32_16x16x32_bf16 v[48:51], v[180:183], v[208:211], v[48:51]
    ds_read_b64_tr_b16 v[166:167], v231 offset:34816
    v_mfma_f32_16x16x32_bf16 v[52:55], v[180:183], v[212:215], v[52:55]
    ds_read_b64_tr_b16 v[168:169], v232 offset:32768
    v_mfma_f32_16x16x32_bf16 v[56:59], v[180:183], v[216:219], v[56:59]
    ds_read_b64_tr_b16 v[170:171], v232 offset:34816
    v_mfma_f32_16x16x32_bf16 v[60:63], v[180:183], v[220:223], v[60:63]
    ds_read_b64_tr_b16 v[172:173], v233 offset:32768
    v_mfma_f32_16x16x32_bf16 v[64:67], v[184:187], v[192:195], v[64:67]
    ds_read_b64_tr_b16 v[174:175], v233 offset:34816
    v_mfma_f32_16x16x32_bf16 v[68:71], v[184:187], v[196:199], v[68:71]
    ds_read_b128 v[136:139], v224 offset:4096
    v_mfma_f32_16x16x32_bf16 v[72:75], v[184:187], v[200:203], v[72:75]
    ds_read_b128 v[140:143], v224 offset:5120
    v_mfma_f32_16x16x32_bf16 v[76:79], v[184:187], v[204:207], v[76:79]
    s_add_u32 m0, s33, 16384
    v_mfma_f32_16x16x32_bf16 v[80:83], v[184:187], v[208:211], v[80:83]
    s_nop 0
    v_mfma_f32_16x16x32_bf16 v[84:87], v[184:187], v[212:215], v[84:87]
    buffer_load_dwordx4 v248, s[8:11], s30 offen offset:0 lds
    v_mfma_f32_16x16x32_bf16 v[88:91], v[184:187], v[216:219], v[88:91]
    buffer_load_dwordx4 v249, s[8:11], s30 offen offset:1024 lds
    v_mfma_f32_16x16x32_bf16 v[92:95], v[184:187], v[220:223], v[92:95]
    s_add_u32 s31, s40, s42
    v_mfma_f32_16x16x32_bf16 v[96:99], v[188:191], v[192:195], v[96:99]
    s_and_b32 s31, s31, 3
    v_mfma_f32_16x16x32_bf16 v[100:103], v[188:191], v[196:199], v[100:103]
    s_andn2_b32 s37, s40, 3
    v_mfma_f32_16x16x32_bf16 v[104:107], v[188:191], v[200:203], v[104:107]
    s_or_b32 s31, s31, s37
    v_mfma_f32_16x16x32_bf16 v[108:111], v[188:191], v[204:207], v[108:111]
    s_add_u32 s40, s40, 1
    v_mfma_f32_16x16x32_bf16 v[112:115], v[188:191], v[208:211], v[112:115]
    s_add_u32 m0, s27, s32
    v_mfma_f32_16x16x32_bf16 v[116:119], v[188:191], v[212:215], v[116:119]
    s_lshl_b32 s31, s31, 7
    v_mfma_f32_16x16x32_bf16 v[120:123], v[188:191], v[216:219], v[120:123]
    buffer_load_dwordx4 v240, s[4:7], s31 offen offset:0 lds
    v_mfma_f32_16x16x32_bf16 v[124:127], v[188:191], v[220:223], v[124:127]
    buffer_load_dwordx4 v241, s[4:7], s31 offen offset:1024 lds
    s_waitcnt vmcnt(10) lgkmcnt(0)
    s_barrier
    v_mfma_f32_16x16x32_bf16 v[0:3], v[128:131], v[144:147], v[0:3]
    ds_read_b128 v[176:179], v225 offset:0
    ds_read_b64_tr_b16 v[192:193], v226 offset:49152
    v_mfma_f32_16x16x32_bf16 v[4:7], v[128:131], v[148:151], v[4:7]
    ds_read_b64_tr_b16 v[194:195], v226 offset:51200
    v_mfma_f32_16x16x32_bf16 v[8:11], v[128:131], v[152:155], v[8:11]
    ds_read_b64_tr_b16 v[196:197], v227 offset:49152
    ds_read_b64_tr_b16 v[198:199], v227 offset:51200
    v_mfma_f32_16x16x32_bf16 v[12:15], v[128:131], v[156:159], v[12:15]
    ds_read_b128 v[180:183], v225 offset:1024
    v_mfma_f32_16x16x32_bf16 v[16:19], v[128:131], v[160:163], v[16:19]
    ds_read_b64_tr_b16 v[200:201], v228 offset:49152
    ds_read_b64_tr_b16 v[202:203], v228 offset:51200
    v_mfma_f32_16x16x32_bf16 v[20:23], v[128:131], v[164:167], v[20:23]
    ds_read_b64_tr_b16 v[204:205], v229 offset:49152
    v_mfma_f32_16x16x32_bf16 v[24:27], v[128:131], v[168:171], v[24:27]
    ds_read_b64_tr_b16 v[206:207], v229 offset:51200
    ds_read_b64_tr_b16 v[208:209], v230 offset:49152
    v_mfma_f32_16x16x32_bf16 v[28:31], v[128:131], v[172:175], v[28:31]
    ds_read_b64_tr_b16 v[210:211], v230 offset:51200
    v_mfma_f32_16x16x32_bf16 v[32:35], v[132:135], v[144:147], v[32:35]
    ds_read_b64_tr_b16 v[212:213], v231 offset:49152
    v_mfma_f32_16x16x32_bf16 v[36:39], v[132:135], v[148:151], v[36:39]
    ds_read_b64_tr_b16 v[214:215], v231 offset:51200
    ds_read_b64_tr_b16 v[216:217], v232 offset:49152
    v_mfma_f32_16x16x32_bf16 v[40:43], v[132:135], v[152:155], v[40:43]
    ds_read_b64_tr_b16 v[218:219], v232 offset:51200
    v_mfma_f32_16x16x32_bf16 v[44:47], v[132:135], v[156:159], v[44:47]
    ds_read_b64_tr_b16 v[220:221], v233 offset:49152
    ds_read_b64_tr_b16 v[222:223], v233 offset:51200
    v_mfma_f32_16x16x32_bf16 v[48:51], v[132:135], v[160:163], v[48:51]
    ds_read_b128 v[184:187], v225 offset:4096
    v_mfma_f32_16x16x32_bf16 v[52:55], v[132:135], v[164:167], v[52:55]
    ds_read_b128 v[188:191], v225 offset:5120
    s_add_u32 s30, s41, s42
    v_mfma_f32_16x16x32_bf16 v[56:59], v[132:135], v[168:171], v[56:59]
    s_and_b32 s30, s30, 3
    v_mfma_f32_16x16x32_bf16 v[60:63], v[132:135], v[172:175], v[60:63]
    s_andn2_b32 s37, s41, 3
    v_mfma_f32_16x16x32_bf16 v[64:67], v[136:139], v[144:147], v[64:67]
    s_or_b32 s30, s30, s37
    s_add_u32 s41, s41, 1
    v_mfma_f32_16x16x32_bf16 v[68:71], v[136:139], v[148:151], v[68:71]
    s_mul_i32 s30, s30, s44
    v_mfma_f32_16x16x32_bf16 v[72:75], v[136:139], v[152:155], v[72:75]
    s_lshl_b32 s30, s30, 1
    s_add_u32 m0, s33, 32768
    v_mfma_f32_16x16x32_bf16 v[76:79], v[136:139], v[156:159], v[76:79]
    s_nop 0
    v_mfma_f32_16x16x32_bf16 v[80:83], v[136:139], v[160:163], v[80:83]
    buffer_load_dwordx4 v248, s[8:11], s30 offen offset:0 lds
    buffer_load_dwordx4 v249, s[8:11], s30 offen offset:1024 lds
    v_mfma_f32_16x16x32_bf16 v[84:87], v[136:139], v[164:167], v[84:87]
    s_add_u32 s30, s30, s44
    v_mfma_f32_16x16x32_bf16 v[88:91], v[136:139], v[168:171], v[88:91]
    s_add_u32 s35, s27, s32
    s_add_u32 m0, s35, 0x800
    v_mfma_f32_16x16x32_bf16 v[92:95], v[136:139], v[172:175], v[92:95]
    s_add_u32 s27, s27, 0x8000
    v_mfma_f32_16x16x32_bf16 v[96:99], v[140:143], v[144:147], v[96:99]
    buffer_load_dwordx4 v242, s[4:7], s31 offen offset:0 lds
    v_mfma_f32_16x16x32_bf16 v[100:103], v[140:143], v[148:151], v[100:103]
    buffer_load_dwordx4 v243, s[4:7], s31 offen offset:1024 lds
    s_cmp_ge_u32 s27, 0x28000
    v_mfma_f32_16x16x32_bf16 v[104:107], v[140:143], v[152:155], v[104:107]
    s_cselect_b32 s27, 0x10000, s27
    v_mfma_f32_16x16x32_bf16 v[108:111], v[140:143], v[156:159], v[108:111]
    s_add_u32 s36, s28, 0x8000
    s_cmp_ge_u32 s36, 0x18000
    v_mfma_f32_16x16x32_bf16 v[112:115], v[140:143], v[160:163], v[112:115]
    s_cselect_b32 s36, 0, s36
    v_mfma_f32_16x16x32_bf16 v[116:119], v[140:143], v[164:167], v[116:119]
    s_sub_u32 s29, s36, s28
    s_mov_b32 s28, s36
    v_mfma_f32_16x16x32_bf16 v[120:123], v[140:143], v[168:171], v[120:123]
    v_add_u32 v224, s29, v224
    v_mfma_f32_16x16x32_bf16 v[124:127], v[140:143], v[172:175], v[124:127]
    v_add_u32 v225, s29, v225
    s_mov_b32 s34, 5
K1_LOOP_21v:
    s_waitcnt vmcnt(8) lgkmcnt(0)
    s_barrier
    v_mfma_f32_16x16x32_bf16 v[0:3], v[176:179], v[192:195], v[0:3]
    ds_read_b128 v[128:131], v224 offset:0
    ds_read_b64_tr_b16 v[144:145], v226 offset:0
    v_mfma_f32_16x16x32_bf16 v[4:7], v[176:179], v[196:199], v[4:7]
    ds_read_b64_tr_b16 v[146:147], v226 offset:2048
    v_mfma_f32_16x16x32_bf16 v[8:11], v[176:179], v[200:203], v[8:11]
    ds_read_b64_tr_b16 v[148:149], v227 offset:0
    v_mfma_f32_16x16x32_bf16 v[12:15], v[176:179], v[204:207], v[12:15]
    ds_read_b64_tr_b16 v[150:151], v227 offset:2048
    v_mfma_f32_16x16x32_bf16 v[16:19], v[176:179], v[208:211], v[16:19]
    ds_read_b128 v[132:135], v224 offset:1024
    v_mfma_f32_16x16x32_bf16 v[20:23], v[176:179], v[212:215], v[20:23]
    ds_read_b64_tr_b16 v[152:153], v228 offset:0
    v_mfma_f32_16x16x32_bf16 v[24:27], v[176:179], v[216:219], v[24:27]
    ds_read_b64_tr_b16 v[154:155], v228 offset:2048
    v_mfma_f32_16x16x32_bf16 v[28:31], v[176:179], v[220:223], v[28:31]
    ds_read_b64_tr_b16 v[156:157], v229 offset:0
    v_mfma_f32_16x16x32_bf16 v[32:35], v[180:183], v[192:195], v[32:35]
    ds_read_b64_tr_b16 v[158:159], v229 offset:2048
    v_mfma_f32_16x16x32_bf16 v[36:39], v[180:183], v[196:199], v[36:39]
    ds_read_b64_tr_b16 v[160:161], v230 offset:0
    v_mfma_f32_16x16x32_bf16 v[40:43], v[180:183], v[200:203], v[40:43]
    ds_read_b64_tr_b16 v[162:163], v230 offset:2048
    v_mfma_f32_16x16x32_bf16 v[44:47], v[180:183], v[204:207], v[44:47]
    ds_read_b64_tr_b16 v[164:165], v231 offset:0
    v_mfma_f32_16x16x32_bf16 v[48:51], v[180:183], v[208:211], v[48:51]
    ds_read_b64_tr_b16 v[166:167], v231 offset:2048
    v_mfma_f32_16x16x32_bf16 v[52:55], v[180:183], v[212:215], v[52:55]
    ds_read_b64_tr_b16 v[168:169], v232 offset:0
    v_mfma_f32_16x16x32_bf16 v[56:59], v[180:183], v[216:219], v[56:59]
    ds_read_b64_tr_b16 v[170:171], v232 offset:2048
    v_mfma_f32_16x16x32_bf16 v[60:63], v[180:183], v[220:223], v[60:63]
    ds_read_b64_tr_b16 v[172:173], v233 offset:0
    v_mfma_f32_16x16x32_bf16 v[64:67], v[184:187], v[192:195], v[64:67]
    ds_read_b64_tr_b16 v[174:175], v233 offset:2048
    v_mfma_f32_16x16x32_bf16 v[68:71], v[184:187], v[196:199], v[68:71]
    ds_read_b128 v[136:139], v224 offset:4096
    v_mfma_f32_16x16x32_bf16 v[72:75], v[184:187], v[200:203], v[72:75]
    ds_read_b128 v[140:143], v224 offset:5120
    v_mfma_f32_16x16x32_bf16 v[76:79], v[184:187], v[204:207], v[76:79]
    s_add_u32 m0, s33, 49152
    v_mfma_f32_16x16x32_bf16 v[80:83], v[184:187], v[208:211], v[80:83]
    s_nop 0
    v_mfma_f32_16x16x32_bf16 v[84:87], v[184:187], v[212:215], v[84:87]
    buffer_load_dwordx4 v248, s[8:11], s30 offen offset:0 lds
    v_mfma_f32_16x16x32_bf16 v[88:91], v[184:187], v[216:219], v[88:91]
    buffer_load_dwordx4 v249, s[8:11], s30 offen offset:1024 lds
    v_mfma_f32_16x16x32_bf16 v[92:95], v[184:187], v[220:223], v[92:95]
    s_add_u32 s31, s40, s42
    v_mfma_f32_16x16x32_bf16 v[96:99], v[188:191], v[192:195], v[96:99]
    s_and_b32 s31, s31, 3
    v_mfma_f32_16x16x32_bf16 v[100:103], v[188:191], v[196:199], v[100:103]
    s_andn2_b32 s37, s40, 3
    v_mfma_f32_16x16x32_bf16 v[104:107], v[188:191], v[200:203], v[104:107]
    s_or_b32 s31, s31, s37
    v_mfma_f32_16x16x32_bf16 v[108:111], v[188:191], v[204:207], v[108:111]
    s_add_u32 s40, s40, 1
    v_mfma_f32_16x16x32_bf16 v[112:115], v[188:191], v[208:211], v[112:115]
    s_add_u32 m0, s27, s32
    v_mfma_f32_16x16x32_bf16 v[116:119], v[188:191], v[212:215], v[116:119]
    s_lshl_b32 s31, s31, 7
    v_mfma_f32_16x16x32_bf16 v[120:123], v[188:191], v[216:219], v[120:123]
    buffer_load_dwordx4 v240, s[4:7], s31 offen offset:0 lds
    v_mfma_f32_16x16x32_bf16 v[124:127], v[188:191], v[220:223], v[124:127]
    buffer_load_dwordx4 v241, s[4:7], s31 offen offset:1024 lds
    s_waitcnt vmcnt(10) lgkmcnt(0)
    s_barrier
    v_mfma_f32_16x16x32_bf16 v[0:3], v[128:131], v[144:147], v[0:3]
    ds_read_b128 v[176:179], v225 offset:0
    ds_read_b64_tr_b16 v[192:193], v226 offset:16384
    v_mfma_f32_16x16x32_bf16 v[4:7], v[128:131], v[148:151], v[4:7]
    ds_read_b64_tr_b16 v[194:195], v226 offset:18432
    v_mfma_f32_16x16x32_bf16 v[8:11], v[128:131], v[152:155], v[8:11]
    ds_read_b64_tr_b16 v[196:197], v227 offset:16384
    ds_read_b64_tr_b16 v[198:199], v227 offset:18432
    v_mfma_f32_16x16x32_bf16 v[12:15], v[128:131], v[156:159], v[12:15]
    ds_read_b128 v[180:183], v225 offset:1024
    v_mfma_f32_16x16x32_bf16 v[16:19], v[128:131], v[160:163], v[16:19]
    ds_read_b64_tr_b16 v[200:201], v228 offset:16384
    ds_read_b64_tr_b16 v[202:203], v228 offset:18432
    v_mfma_f32_16x16x32_bf16 v[20:23], v[128:131], v[164:167], v[20:23]
    ds_read_b64_tr_b16 v[204:205], v229 offset:16384
    v_mfma_f32_16x16x32_bf16 v[24:27], v[128:131], v[168:171], v[24:27]
    ds_read_b64_tr_b16 v[206:207], v229 offset:18432
    ds_read_b64_tr_b16 v[208:209], v230 offset:16384
    v_mfma_f32_16x16x32_bf16 v[28:31], v[128:131], v[172:175], v[28:31]
    ds_read_b64_tr_b16 v[210:211], v230 offset:18432
    v_mfma_f32_16x16x32_bf16 v[32:35], v[132:135], v[144:147], v[32:35]
    ds_read_b64_tr_b16 v[212:213], v231 offset:16384
    v_mfma_f32_16x16x32_bf16 v[36:39], v[132:135], v[148:151], v[36:39]
    ds_read_b64_tr_b16 v[214:215], v231 offset:18432
    ds_read_b64_tr_b16 v[216:217], v232 offset:16384
    v_mfma_f32_16x16x32_bf16 v[40:43], v[132:135], v[152:155], v[40:43]
    ds_read_b64_tr_b16 v[218:219], v232 offset:18432
    v_mfma_f32_16x16x32_bf16 v[44:47], v[132:135], v[156:159], v[44:47]
    ds_read_b64_tr_b16 v[220:221], v233 offset:16384
    ds_read_b64_tr_b16 v[222:223], v233 offset:18432
    v_mfma_f32_16x16x32_bf16 v[48:51], v[132:135], v[160:163], v[48:51]
    ds_read_b128 v[184:187], v225 offset:4096
    v_mfma_f32_16x16x32_bf16 v[52:55], v[132:135], v[164:167], v[52:55]
    ds_read_b128 v[188:191], v225 offset:5120
    s_add_u32 s30, s41, s42
    v_mfma_f32_16x16x32_bf16 v[56:59], v[132:135], v[168:171], v[56:59]
    s_and_b32 s30, s30, 3
    v_mfma_f32_16x16x32_bf16 v[60:63], v[132:135], v[172:175], v[60:63]
    s_andn2_b32 s37, s41, 3
    v_mfma_f32_16x16x32_bf16 v[64:67], v[136:139], v[144:147], v[64:67]
    s_or_b32 s30, s30, s37
    s_add_u32 s41, s41, 1
    v_mfma_f32_16x16x32_bf16 v[68:71], v[136:139], v[148:151], v[68:71]
    s_mul_i32 s30, s30, s44
    v_mfma_f32_16x16x32_bf16 v[72:75], v[136:139], v[152:155], v[72:75]
    s_lshl_b32 s30, s30, 1
    s_add_u32 m0, s33, 0
    v_mfma_f32_16x16x32_bf16 v[76:79], v[136:139], v[156:159], v[76:79]
    s_nop 0
    v_mfma_f32_16x16x32_bf16 v[80:83], v[136:139], v[160:163], v[80:83]
    buffer_load_dwordx4 v248, s[8:11], s30 offen offset:0 lds
    buffer_load_dwordx4 v249, s[8:11], s30 offen offset:1024 lds
    v_mfma_f32_16x16x32_bf16 v[84:87], v[136:139], v[164:167], v[84:87]
    s_add_u32 s30, s30, s44
    v_mfma_f32_16x16x32_bf16 v[88:91], v[136:139], v[168:171], v[88:91]
    s_add_u32 s35, s27, s32
    s_add_u32 m0, s35, 0x800
    v_mfma_f32_16x16x32_bf16 v[92:95], v[136:139], v[172:175], v[92:95]
    s_add_u32 s27, s27, 0x8000
    v_mfma_f32_16x16x32_bf16 v[96:99], v[140:143], v[144:147], v[96:99]
    buffer_load_dwordx4 v242, s[4:7], s31 offen offset:0 lds
    v_mfma_f32_16x16x32_bf16 v[100:103], v[140:143], v[148:151], v[100:103]
    buffer_load_dwordx4 v243, s[4:7], s31 offen offset:1024 lds
    s_cmp_ge_u32 s27, 0x28000
    v_mfma_f32_16x16x32_bf16 v[104:107], v[140:143], v[152:155], v[104:107]
    s_cselect_b32 s27, 0x10000, s27
    v_mfma_f32_16x16x32_bf16 v[108:111], v[140:143], v[156:159], v[108:111]
    s_add_u32 s36, s28, 0x8000
    s_cmp_ge_u32 s36, 0x18000
    v_mfma_f32_16x16x32_bf16 v[112:115], v[140:143], v[160:163], v[112:115]
    s_cselect_b32 s36, 0, s36
    v_mfma_f32_16x16x32_bf16 v[116:119], v[140:143], v[164:167], v[116:119]
    s_sub_u32 s29, s36, s28
    s_mov_b32 s28, s36
    v_mfma_f32_16x16x32_bf16 v[120:123], v[140:143], v[168:171], v[120:123]
    v_add_u32 v224, s29, v224
    v_mfma_f32_16x16x32_bf16 v[124:127], v[140:143], v[172:175], v[124:127]
    v_add_u32 v225, s29, v225
    s_waitcnt vmcnt(8) lgkmcnt(0)
    s_barrier
    v_mfma_f32_16x16x32_bf16 v[0:3], v[176:179], v[192:195], v[0:3]
    ds_read_b128 v[128:131], v224 offset:0
    ds_read_b64_tr_b16 v[144:145], v226 offset:32768
    v_mfma_f32_16x16x32_bf16 v[4:7], v[176:179], v[196:199], v[4:7]
    ds_read_b64_tr_b16 v[146:147], v226 offset:34816
    v_mfma_f32_16x16x32_bf16 v[8:11], v[176:179], v[200:203], v[8:11]
    ds_read_b64_tr_b16 v[148:149], v227 offset:32768
    v_mfma_f32_16x16x32_bf16 v[12:15], v[176:179], v[204:207], v[12:15]
    ds_read_b64_tr_b16 v[150:151], v227 offset:34816
    v_mfma_f32_16x16x32_bf16 v[16:19], v[176:179], v[208:211], v[16:19]
    ds_read_b128 v[132:135], v224 offset:1024
    v_mfma_f32_16x16x32_bf16 v[20:23], v[176:179], v[212:215], v[20:23]
    ds_read_b64_tr_b16 v[152:153], v228 offset:32768
    v_mfma_f32_16x16x32_bf16 v[24:27], v[176:179], v[216:219], v[24:27]
    ds_read_b64_tr_b16 v[154:155], v228 offset:34816
    v_mfma_f32_16x16x32_bf16 v[28:31], v[176:179], v[220:223], v[28:31]
    ds_read_b64_tr_b16 v[156:157], v229 offset:32768
    v_mfma_f32_16x16x32_bf16 v[32:35], v[180:183], v[192:195], v[32:35]
    ds_read_b64_tr_b16 v[158:159], v229 offset:34816
    v_mfma_f32_16x16x32_bf16 v[36:39], v[180:183], v[196:199], v[36:39]
    ds_read_b64_tr_b16 v[160:161], v230 offset:32768
    v_mfma_f32_16x16x32_bf16 v[40:43], v[180:183], v[200:203], v[40:43]
    ds_read_b64_tr_b16 v[162:163], v230 offset:34816
    v_mfma_f32_16x16x32_bf16 v[44:47], v[180:183], v[204:207], v[44:47]
    ds_read_b64_tr_b16 v[164:165], v231 offset:32768
    v_mfma_f32_16x16x32_bf16 v[48:51], v[180:183], v[208:211], v[48:51]
    ds_read_b64_tr_b16 v[166:167], v231 offset:34816
    v_mfma_f32_16x16x32_bf16 v[52:55], v[180:183], v[212:215], v[52:55]
    ds_read_b64_tr_b16 v[168:169], v232 offset:32768
    v_mfma_f32_16x16x32_bf16 v[56:59], v[180:183], v[216:219], v[56:59]
    ds_read_b64_tr_b16 v[170:171], v232 offset:34816
    v_mfma_f32_16x16x32_bf16 v[60:63], v[180:183], v[220:223], v[60:63]
    ds_read_b64_tr_b16 v[172:173], v233 offset:32768
    v_mfma_f32_16x16x32_bf16 v[64:67], v[184:187], v[192:195], v[64:67]
    ds_read_b64_tr_b16 v[174:175], v233 offset:34816
    v_mfma_f32_16x16x32_bf16 v[68:71], v[184:187], v[196:199], v[68:71]
    ds_read_b128 v[136:139], v224 offset:4096
    v_mfma_f32_16x16x32_bf16 v[72:75], v[184:187], v[200:203], v[72:75]
    ds_read_b128 v[140:143], v224 offset:5120
    v_mfma_f32_16x16x32_bf16 v[76:79], v[184:187], v[204:207], v[76:79]
    s_add_u32 m0, s33, 16384
    v_mfma_f32_16x16x32_bf16 v[80:83], v[184:187], v[208:211], v[80:83]
    s_nop 0
    v_mfma_f32_16x16x32_bf16 v[84:87], v[184:187], v[212:215], v[84:87]
    buffer_load_dwordx4 v248, s[8:11], s30 offen offset:0 lds
    v_mfma_f32_16x16x32_bf16 v[88:91], v[184:187], v[216:219], v[88:91]
    buffer_load_dwordx4 v249, s[8:11], s30 offen offset:1024 lds
    v_mfma_f32_16x16x32_bf16 v[92:95], v[184:187], v[220:223], v[92:95]
    s_add_u32 s31, s40, s42
    v_mfma_f32_16x16x32_bf16 v[96:99], v[188:191], v[192:195], v[96:99]
    s_and_b32 s31, s31, 3
    v_mfma_f32_16x16x32_bf16 v[100:103], v[188:191], v[196:199], v[100:103]
    s_andn2_b32 s37, s40, 3
    v_mfma_f32_16x16x32_bf16 v[104:107], v[188:191], v[200:203], v[104:107]
    s_or_b32 s31, s31, s37
    v_mfma_f32_16x16x32_bf16 v[108:111], v[188:191], v[204:207], v[108:111]
    s_add_u32 s40, s40, 1
    v_mfma_f32_16x16x32_bf16 v[112:115], v[188:191], v[208:211], v[112:115]
    s_add_u32 m0, s27, s32
    v_mfma_f32_16x16x32_bf16 v[116:119], v[188:191], v[212:215], v[116:119]
    s_lshl_b32 s31, s31, 7
    v_mfma_f32_16x16x32_bf16 v[120:123], v[188:191], v[216:219], v[120:123]
    buffer_load_dwordx4 v240, s[4:7], s31 offen offset:0 lds
    v_mfma_f32_16x16x32_bf16 v[124:127], v[188:191], v[220:223], v[124:127]
    buffer_load_dwordx4 v241, s[4:7], s31 offen offset:1024 lds
    s_waitcnt vmcnt(10) lgkmcnt(0)
    s_barrier
    v_mfma_f32_16x16x32_bf16 v[0:3], v[128:131], v[144:147], v[0:3]
    ds_read_b128 v[176:179], v225 offset:0
    ds_read_b64_tr_b16 v[192:193], v226 offset:49152
    v_mfma_f32_16x16x32_bf16 v[4:7], v[128:131], v[148:151], v[4:7]
    ds_read_b64_tr_b16 v[194:195], v226 offset:51200
    v_mfma_f32_16x16x32_bf16 v[8:11], v[128:131], v[152:155], v[8:11]
    ds_read_b64_tr_b16 v[196:197], v227 offset:49152
    ds_read_b64_tr_b16 v[198:199], v227 offset:51200
    v_mfma_f32_16x16x32_bf16 v[12:15], v[128:131], v[156:159], v[12:15]
    ds_read_b128 v[180:183], v225 offset:1024
    v_mfma_f32_16x16x32_bf16 v[16:19], v[128:131], v[160:163], v[16:19]
    ds_read_b64_tr_b16 v[200:201], v228 offset:49152
    ds_read_b64_tr_b16 v[202:203], v228 offset:51200
    v_mfma_f32_16x16x32_bf16 v[20:23], v[128:131], v[164:167], v[20:23]
    ds_read_b64_tr_b16 v[204:205], v229 offset:49152
    v_mfma_f32_16x16x32_bf16 v[24:27], v[128:131], v[168:171], v[24:27]
    ds_read_b64_tr_b16 v[206:207], v229 offset:51200
    ds_read_b64_tr_b16 v[208:209], v230 offset:49152
    v_mfma_f32_16x16x32_bf16 v[28:31], v[128:131], v[172:175], v[28:31]
    ds_read_b64_tr_b16 v[210:211], v230 offset:51200
    v_mfma_f32_16x16x32_bf16 v[32:35], v[132:135], v[144:147], v[32:35]
    ds_read_b64_tr_b16 v[212:213], v231 offset:49152
    v_mfma_f32_16x16x32_bf16 v[36:39], v[132:135], v[148:151], v[36:39]
    ds_read_b64_tr_b16 v[214:215], v231 offset:51200
    ds_read_b64_tr_b16 v[216:217], v232 offset:49152
    v_mfma_f32_16x16x32_bf16 v[40:43], v[132:135], v[152:155], v[40:43]
    ds_read_b64_tr_b16 v[218:219], v232 offset:51200
    v_mfma_f32_16x16x32_bf16 v[44:47], v[132:135], v[156:159], v[44:47]
    ds_read_b64_tr_b16 v[220:221], v233 offset:49152
    ds_read_b64_tr_b16 v[222:223], v233 offset:51200
    v_mfma_f32_16x16x32_bf16 v[48:51], v[132:135], v[160:163], v[48:51]
    ds_read_b128 v[184:187], v225 offset:4096
    v_mfma_f32_16x16x32_bf16 v[52:55], v[132:135], v[164:167], v[52:55]
    ds_read_b128 v[188:191], v225 offset:5120
    s_add_u32 s30, s41, s42
    v_mfma_f32_16x16x32_bf16 v[56:59], v[132:135], v[168:171], v[56:59]
    s_and_b32 s30, s30, 3
    v_mfma_f32_16x16x32_bf16 v[60:63], v[132:135], v[172:175], v[60:63]
    s_andn2_b32 s37, s41, 3
    v_mfma_f32_16x16x32_bf16 v[64:67], v[136:139], v[144:147], v[64:67]
    s_or_b32 s30, s30, s37
    s_add_u32 s41, s41, 1
    v_mfma_f32_16x16x32_bf16 v[68:71], v[136:139], v[148:151], v[68:71]
    s_mul_i32 s30, s30, s44
    v_mfma_f32_16x16x32_bf16 v[72:75], v[136:139], v[152:155], v[72:75]
    s_lshl_b32 s30, s30, 1
    s_add_u32 m0, s33, 32768
    v_mfma_f32_16x16x32_bf16 v[76:79], v[136:139], v[156:159], v[76:79]
    s_nop 0
    v_mfma_f32_16x16x32_bf16 v[80:83], v[136:139], v[160:163], v[80:83]
    buffer_load_dwordx4 v248, s[8:11], s30 offen offset:0 lds
    buffer_load_dwordx4 v249, s[8:11], s30 offen offset:1024 lds
    v_mfma_f32_16x16x32_bf16 v[84:87], v[136:139], v[164:167], v[84:87]
    s_add_u32 s30, s30, s44
    v_mfma_f32_16x16x32_bf16 v[88:91], v[136:139], v[168:171], v[88:91]
    s_add_u32 s35, s27, s32
    s_add_u32 m0, s35, 0x800
    v_mfma_f32_16x16x32_bf16 v[92:95], v[136:139], v[172:175], v[92:95]
    s_add_u32 s27, s27, 0x8000
    v_mfma_f32_16x16x32_bf16 v[96:99], v[140:143], v[144:147], v[96:99]
    buffer_load_dwordx4 v242, s[4:7], s31 offen offset:0 lds
    v_mfma_f32_16x16x32_bf16 v[100:103], v[140:143], v[148:151], v[100:103]
    buffer_load_dwordx4 v243, s[4:7], s31 offen offset:1024 lds
    s_cmp_ge_u32 s27, 0x28000
    v_mfma_f32_16x16x32_bf16 v[104:107], v[140:143], v[152:155], v[104:107]
    s_cselect_b32 s27, 0x10000, s27
    v_mfma_f32_16x16x32_bf16 v[108:111], v[140:143], v[156:159], v[108:111]
    s_add_u32 s36, s28, 0x8000
    s_cmp_ge_u32 s36, 0x18000
    v_mfma_f32_16x16x32_bf16 v[112:115], v[140:143], v[160:163], v[112:115]
    s_cselect_b32 s36, 0, s36
    v_mfma_f32_16x16x32_bf16 v[116:119], v[140:143], v[164:167], v[116:119]
    s_sub_u32 s29, s36, s28
    s_mov_b32 s28, s36
    v_mfma_f32_16x16x32_bf16 v[120:123], v[140:143], v[168:171], v[120:123]
    v_add_u32 v224, s29, v224
    v_mfma_f32_16x16x32_bf16 v[124:127], v[140:143], v[172:175], v[124:127]
    v_add_u32 v225, s29, v225
    s_sub_u32 s34, s34, 1
    s_cmp_lg_u32 s34, 0
    s_cbranch_scc1 K1_LOOP_21v
    s_waitcnt vmcnt(8) lgkmcnt(0)
    s_barrier
    v_mfma_f32_16x16x32_bf16 v[0:3], v[176:179], v[192:195], v[0:3]
    ds_read_b128 v[128:131], v224 offset:0
    ds_read_b64_tr_b16 v[144:145], v226 offset:0
    v_mfma_f32_16x16x32_bf16 v[4:7], v[176:179], v[196:199], v[4:7]
    ds_read_b64_tr_b16 v[146:147], v226 offset:2048
    v_mfma_f32_16x16x32_bf16 v[8:11], v[176:179], v[200:203], v[8:11]
    ds_read_b64_tr_b16 v[148:149], v227 offset:0
    v_mfma_f32_16x16x32_bf16 v[12:15], v[176:179], v[204:207], v[12:15]
    ds_read_b64_tr_b16 v[150:151], v227 offset:2048
    v_mfma_f32_16x16x32_bf16 v[16:19], v[176:179], v[208:211], v[16:19]
    ds_read_b128 v[132:135], v224 offset:1024
    v_mfma_f32_16x16x32_bf16 v[20:23], v[176:179], v[212:215], v[20:23]
    ds_read_b64_tr_b16 v[152:153], v228 offset:0
    v_mfma_f32_16x16x32_bf16 v[24:27], v[176:179], v[216:219], v[24:27]
    ds_read_b64_tr_b16 v[154:155], v228 offset:2048
    v_mfma_f32_16x16x32_bf16 v[28:31], v[176:179], v[220:223], v[28:31]
    ds_read_b64_tr_b16 v[156:157], v229 offset:0
    v_mfma_f32_16x16x32_bf16 v[32:35], v[180:183], v[192:195], v[32:35]
    ds_read_b64_tr_b16 v[158:159], v229 offset:2048
    v_mfma_f32_16x16x32_bf16 v[36:39], v[180:183], v[196:199], v[36:39]
    ds_read_b64_tr_b16 v[160:161], v230 offset:0
    v_mfma_f32_16x16x32_bf16 v[40:43], v[180:183], v[200:203], v[40:43]
    ds_read_b64_tr_b16 v[162:163], v230 offset:2048
    v_mfma_f32_16x16x32_bf16 v[44:47], v[180:183], v[204:207], v[44:47]
    ds_read_b64_tr_b16 v[164:165], v231 offset:0
    v_mfma_f32_16x16x32_bf16 v[48:51], v[180:183], v[208:211], v[48:51]
    ds_read_b64_tr_b16 v[166:167], v231 offset:2048
    v_mfma_f32_16x16x32_bf16 v[52:55], v[180:183], v[212:215], v[52:55]
    ds_read_b64_tr_b16 v[168:169], v232 offset:0
    v_mfma_f32_16x16x32_bf16 v[56:59], v[180:183], v[216:219], v[56:59]
    ds_read_b64_tr_b16 v[170:171], v232 offset:2048
    v_mfma_f32_16x16x32_bf16 v[60:63], v[180:183], v[220:223], v[60:63]
    ds_read_b64_tr_b16 v[172:173], v233 offset:0
    v_mfma_f32_16x16x32_bf16 v[64:67], v[184:187], v[192:195], v[64:67]
    ds_read_b64_tr_b16 v[174:175], v233 offset:2048
    v_mfma_f32_16x16x32_bf16 v[68:71], v[184:187], v[196:199], v[68:71]
    ds_read_b128 v[136:139], v224 offset:4096
    v_mfma_f32_16x16x32_bf16 v[72:75], v[184:187], v[200:203], v[72:75]
    ds_read_b128 v[140:143], v224 offset:5120
    v_mfma_f32_16x16x32_bf16 v[76:79], v[184:187], v[204:207], v[76:79]
    s_add_u32 m0, s33, 49152
    v_mfma_f32_16x16x32_bf16 v[80:83], v[184:187], v[208:211], v[80:83]
    s_nop 0
    v_mfma_f32_16x16x32_bf16 v[84:87], v[184:187], v[212:215], v[84:87]
    buffer_load_dwordx4 v248, s[8:11], s30 offen offset:0 lds
    v_mfma_f32_16x16x32_bf16 v[88:91], v[184:187], v[216:219], v[88:91]
    buffer_load_dwordx4 v249, s[8:11], s30 offen offset:1024 lds
    v_mfma_f32_16x16x32_bf16 v[92:95], v[184:187], v[220:223], v[92:95]
    s_add_u32 s31, s40, s42
    v_mfma_f32_16x16x32_bf16 v[96:99], v[188:191], v[192:195], v[96:99]
    s_and_b32 s31, s31, 3
    v_mfma_f32_16x16x32_bf16 v[100:103], v[188:191], v[196:199], v[100:103]
    s_andn2_b32 s37, s40, 3
    v_mfma_f32_16x16x32_bf16 v[104:107], v[188:191], v[200:203], v[104:107]
    s_or_b32 s31, s31, s37
    v_mfma_f32_16x16x32_bf16 v[108:111], v[188:191], v[204:207], v[108:111]
    s_add_u32 s40, s40, 1
    v_mfma_f32_16x16x32_bf16 v[112:115], v[188:191], v[208:211], v[112:115]
    s_add_u32 m0, s27, s32
    v_mfma_f32_16x16x32_bf16 v[116:119], v[188:191], v[212:215], v[116:119]
    s_lshl_b32 s31, s31, 7
    v_mfma_f32_16x16x32_bf16 v[120:123], v[188:191], v[216:219], v[120:123]
    buffer_load_dwordx4 v240, s[4:7], s31 offen offset:0 lds
    v_mfma_f32_16x16x32_bf16 v[124:127], v[188:191], v[220:223], v[124:127]
    buffer_load_dwordx4 v241, s[4:7], s31 offen offset:1024 lds
    s_waitcnt vmcnt(10) lgkmcnt(0)
    s_barrier
    v_mfma_f32_16x16x32_bf16 v[0:3], v[128:131], v[144:147], v[0:3]
    ds_read_b128 v[176:179], v225 offset:0
    ds_read_b64_tr_b16 v[192:193], v226 offset:16384
    v_mfma_f32_16x16x32_bf16 v[4:7], v[128:131], v[148:151], v[4:7]
    ds_read_b64_tr_b16 v[194:195], v226 offset:18432
    v_mfma_f32_16x16x32_bf16 v[8:11], v[128:131], v[152:155], v[8:11]
    ds_read_b64_tr_b16 v[196:197], v227 offset:16384
    ds_read_b64_tr_b16 v[198:199], v227 offset:18432
    v_mfma_f32_16x16x32_bf16 v[12:15], v[128:131], v[156:159], v[12:15]
    ds_read_b128 v[180:183], v225 offset:1024
    v_mfma_f32_16x16x32_bf16 v[16:19], v[128:131], v[160:163], v[16:19]
    ds_read_b64_tr_b16 v[200:201], v228 offset:16384
    ds_read_b64_tr_b16 v[202:203], v228 offset:18432
    v_mfma_f32_16x16x32_bf16 v[20:23], v[128:131], v[164:167], v[20:23]
    ds_read_b64_tr_b16 v[204:205], v229 offset:16384
    v_mfma_f32_16x16x32_bf16 v[24:27], v[128:131], v[168:171], v[24:27]
    ds_read_b64_tr_b16 v[206:207], v229 offset:18432
    ds_read_b64_tr_b16 v[208:209], v230 offset:16384
    v_mfma_f32_16x16x32_bf16 v[28:31], v[128:131], v[172:175], v[28:31]
    ds_read_b64_tr_b16 v[210:211], v230 offset:18432
    v_mfma_f32_16x16x32_bf16 v[32:35], v[132:135], v[144:147], v[32:35]
    ds_read_b64_tr_b16 v[212:213], v231 offset:16384
    v_mfma_f32_16x16x32_bf16 v[36:39], v[132:135], v[148:151], v[36:39]
    ds_read_b64_tr_b16 v[214:215], v231 offset:18432
    ds_read_b64_tr_b16 v[216:217], v232 offset:16384
    v_mfma_f32_16x16x32_bf16 v[40:43], v[132:135], v[152:155], v[40:43]
    ds_read_b64_tr_b16 v[218:219], v232 offset:18432
    v_mfma_f32_16x16x32_bf16 v[44:47], v[132:135], v[156:159], v[44:47]
    ds_read_b64_tr_b16 v[220:221], v233 offset:16384
    ds_read_b64_tr_b16 v[222:223], v233 offset:18432
    v_mfma_f32_16x16x32_bf16 v[48:51], v[132:135], v[160:163], v[48:51]
    ds_read_b128 v[184:187], v225 offset:4096
    v_mfma_f32_16x16x32_bf16 v[52:55], v[132:135], v[164:167], v[52:55]
    ds_read_b128 v[188:191], v225 offset:5120
    s_add_u32 s30, s41, s42
    v_mfma_f32_16x16x32_bf16 v[56:59], v[132:135], v[168:171], v[56:59]
    s_and_b32 s30, s30, 3
    v_mfma_f32_16x16x32_bf16 v[60:63], v[132:135], v[172:175], v[60:63]
    s_andn2_b32 s37, s41, 3
    v_mfma_f32_16x16x32_bf16 v[64:67], v[136:139], v[144:147], v[64:67]
    s_or_b32 s30, s30, s37
    s_add_u32 s41, s41, 1
    v_mfma_f32_16x16x32_bf16 v[68:71], v[136:139], v[148:151], v[68:71]
    s_mul_i32 s30, s30, s44
    v_mfma_f32_16x16x32_bf16 v[72:75], v[136:139], v[152:155], v[72:75]
    s_lshl_b32 s30, s30, 1
    s_add_u32 m0, s33, 0
    v_mfma_f32_16x16x32_bf16 v[76:79], v[136:139], v[156:159], v[76:79]
    s_nop 0
    v_mfma_f32_16x16x32_bf16 v[80:83], v[136:139], v[160:163], v[80:83]
    buffer_load_dwordx4 v248, s[8:11], s30 offen offset:0 lds
    buffer_load_dwordx4 v249, s[8:11], s30 offen offset:1024 lds
    v_mfma_f32_16x16x32_bf16 v[84:87], v[136:139], v[164:167], v[84:87]
    s_add_u32 s30, s30, s44
    v_mfma_f32_16x16x32_bf16 v[88:91], v[136:139], v[168:171], v[88:91]
    s_add_u32 s35, s27, s32
    s_add_u32 m0, s35, 0x800
    v_mfma_f32_16x16x32_bf16 v[92:95], v[136:139], v[172:175], v[92:95]
    s_add_u32 s27, s27, 0x8000
    v_mfma_f32_16x16x32_bf16 v[96:99], v[140:143], v[144:147], v[96:99]
    buffer_load_dwordx4 v242, s[4:7], s31 offen offset:0 lds
    v_mfma_f32_16x16x32_bf16 v[100:103], v[140:143], v[148:151], v[100:103]
    buffer_load_dwordx4 v243, s[4:7], s31 offen offset:1024 lds
    s_cmp_ge_u32 s27, 0x28000
    v_mfma_f32_16x16x32_bf16 v[104:107], v[140:143], v[152:155], v[104:107]
    s_cselect_b32 s27, 0x10000, s27
    v_mfma_f32_16x16x32_bf16 v[108:111], v[140:143], v[156:159], v[108:111]
    s_add_u32 s36, s28, 0x8000
    s_cmp_ge_u32 s36, 0x18000
    v_mfma_f32_16x16x32_bf16 v[112:115], v[140:143], v[160:163], v[112:115]
    s_cselect_b32 s36, 0, s36
    v_mfma_f32_16x16x32_bf16 v[116:119], v[140:143], v[164:167], v[116:119]
    s_sub_u32 s29, s36, s28
    s_mov_b32 s28, s36
    v_mfma_f32_16x16x32_bf16 v[120:123], v[140:143], v[168:171], v[120:123]
    v_add_u32 v224, s29, v224
    v_mfma_f32_16x16x32_bf16 v[124:127], v[140:143], v[172:175], v[124:127]
    v_add_u32 v225, s29, v225
    s_waitcnt vmcnt(8) lgkmcnt(0)
    s_barrier
    v_mfma_f32_16x16x32_bf16 v[0:3], v[176:179], v[192:195], v[0:3]
    ds_read_b128 v[128:131], v224 offset:0
    v_mfma_f32_16x16x32_bf16 v[4:7], v[176:179], v[196:199], v[4:7]
    ds_read_b64_tr_b16 v[144:145], v226 offset:32768
    v_mfma_f32_16x16x32_bf16 v[8:11], v[176:179], v[200:203], v[8:11]
    ds_read_b64_tr_b16 v[146:147], v226 offset:34816
    v_mfma_f32_16x16x32_bf16 v[12:15], v[176:179], v[204:207], v[12:15]
    v_mfma_f32_16x16x32_bf16 v[16:19], v[176:179], v[208:211], v[16:19]
    ds_read_b64_tr_b16 v[148:149], v227 offset:32768
    v_mfma_f32_16x16x32_bf16 v[20:23], v[176:179], v[212:215], v[20:23]
    ds_read_b64_tr_b16 v[150:151], v227 offset:34816
    v_mfma_f32_16x16x32_bf16 v[24:27], v[176:179], v[216:219], v[24:27]
    ds_read_b128 v[132:135], v224 offset:1024
    v_mfma_f32_16x16x32_bf16 v[28:31], v[176:179], v[220:223], v[28:31]
    v_mfma_f32_16x16x32_bf16 v[32:35], v[180:183], v[192:195], v[32:35]
    ds_read_b64_tr_b16 v[152:153], v228 offset:32768
    v_mfma_f32_16x16x32_bf16 v[36:39], v[180:183], v[196:199], v[36:39]
    ds_read_b64_tr_b16 v[154:155], v228 offset:34816
    v_mfma_f32_16x16x32_bf16 v[40:43], v[180:183], v[200:203], v[40:43]
    ds_read_b64_tr_b16 v[156:157], v229 offset:32768
    v_mfma_f32_16x16x32_bf16 v[44:47], v[180:183], v[204:207], v[44:47]
    v_mfma_f32_16x16x32_bf16 v[48:51], v[180:183], v[208:211], v[48:51]
    ds_read_b64_tr_b16 v[158:159], v229 offset:34816
    v_mfma_f32_16x16x32_bf16 v[52:55], v[180:183], v[212:215], v[52:55]
    ds_read_b64_tr_b16 v[160:161], v230 offset:32768
    v_mfma_f32_16x16x32_bf16 v[56:59], v[180:183], v[216:219], v[56:59]
    ds_read_b64_tr_b16 v[162:163], v230 offset:34816
    v_mfma_f32_16x16x32_bf16 v[60:63], v[180:183], v[220:223], v[60:63]
    v_mfma_f32_16x16x32_bf16 v[64:67], v[184:187], v[192:195], v[64:67]
    ds_read_b64_tr_b16 v[164:165], v231 offset:32768
    v_mfma_f32_16x16x32_bf16 v[68:71], v[184:187], v[196:199], v[68:71]
    ds_read_b64_tr_b16 v[166:167], v231 offset:34816
    v_mfma_f32_16x16x32_bf16 v[72:75], v[184:187], v[200:203], v[72:75]
    ds_read_b64_tr_b16 v[168:169], v232 offset:32768
    v_mfma_f32_16x16x32_bf16 v[76:79], v[184:187], v[204:207], v[76:79]
    v_mfma_f32_16x16x32_bf16 v[80:83], v[184:187], v[208:211], v[80:83]
    ds_read_b64_tr_b16 v[170:171], v232 offset:34816
    v_mfma_f32_16x16x32_bf16 v[84:87], v[184:187], v[212:215], v[84:87]
    ds_read_b64_tr_b16 v[172:173], v233 offset:32768
    v_mfma_f32_16x16x32_bf16 v[88:91], v[184:187], v[216:219], v[88:91]
    ds_read_b64_tr_b16 v[174:175], v233 offset:34816
    v_mfma_f32_16x16x32_bf16 v[92:95], v[184:187], v[220:223], v[92:95]
    v_mfma_f32_16x16x32_bf16 v[96:99], v[188:191], v[192:195], v[96:99]
    ds_read_b128 v[136:139], v224 offset:4096
    v_mfma_f32_16x16x32_bf16 v[100:103], v[188:191], v[196:199], v[100:103]
    ds_read_b128 v[140:143], v224 offset:5120
    v_mfma_f32_16x16x32_bf16 v[104:107], v[188:191], v[200:203], v[104:107]
    s_add_u32 m0, s33, 16384
    v_mfma_f32_16x16x32_bf16 v[108:111], v[188:191], v[204:207], v[108:111]
    v_mfma_f32_16x16x32_bf16 v[112:115], v[188:191], v[208:211], v[112:115]
    s_nop 0
    v_mfma_f32_16x16x32_bf16 v[116:119], v[188:191], v[212:215], v[116:119]
    buffer_load_dwordx4 v248, s[8:11], s30 offen offset:0 lds
    v_mfma_f32_16x16x32_bf16 v[120:123], v[188:191], v[216:219], v[120:123]
    buffer_load_dwordx4 v249, s[8:11], s30 offen offset:1024 lds
    v_mfma_f32_16x16x32_bf16 v[124:127], v[188:191], v[220:223], v[124:127]
    s_waitcnt vmcnt(8) lgkmcnt(0)
    s_barrier
    v_mfma_f32_16x16x32_bf16 v[0:3], v[128:131], v[144:147], v[0:3]
    ds_read_b128 v[176:179], v225 offset:0
    v_mfma_f32_16x16x32_bf16 v[4:7], v[128:131], v[148:151], v[4:7]
    ds_read_b64_tr_b16 v[192:193], v226 offset:49152
    v_mfma_f32_16x16x32_bf16 v[8:11], v[128:131], v[152:155], v[8:11]
    ds_read_b64_tr_b16 v[194:195], v226 offset:51200
    v_mfma_f32_16x16x32_bf16 v[12:15], v[128:131], v[156:159], v[12:15]
    ds_read_b64_tr_b16 v[196:197], v227 offset:49152
    v_mfma_f32_16x16x32_bf16 v[16:19], v[128:131], v[160:163], v[16:19]
    ds_read_b64_tr_b16 v[198:199], v227 offset:51200
    v_mfma_f32_16x16x32_bf16 v[20:23], v[128:131], v[164:167], v[20:23]
    ds_read_b128 v[180:183], v225 offset:1024
    v_mfma_f32_16x16x32_bf16 v[24:27], v[128:131], v[168:171], v[24:27]
    v_mfma_f32_16x16x32_bf16 v[28:31], v[128:131], v[172:175], v[28:31]
    ds_read_b64_tr_b16 v[200:201], v228 offset:49152
    v_mfma_f32_16x16x32_bf16 v[32:35], v[132:135], v[144:147], v[32:35]
    ds_read_b64_tr_b16 v[202:203], v228 offset:51200
    v_mfma_f32_16x16x32_bf16 v[36:39], v[132:135], v[148:151], v[36:39]
    ds_read_b64_tr_b16 v[204:205], v229 offset:49152
    v_mfma_f32_16x16x32_bf16 v[40:43], v[132:135], v[152:155], v[40:43]
    ds_read_b64_tr_b16 v[206:207], v229 offset:51200
    v_mfma_f32_16x16x32_bf16 v[44:47], v[132:135], v[156:159], v[44:47]
    ds_read_b64_tr_b16 v[208:209], v230 offset:49152
    v_mfma_f32_16x16x32_bf16 v[48:51], v[132:135], v[160:163], v[48:51]
    v_mfma_f32_16x16x32_bf16 v[52:55], v[132:135], v[164:167], v[52:55]
    ds_read_b64_tr_b16 v[210:211], v230 offset:51200
    v_mfma_f32_16x16x32_bf16 v[56:59], v[132:135], v[168:171], v[56:59]
    ds_read_b64_tr_b16 v[212:213], v231 offset:49152
    v_mfma_f32_16x16x32_bf16 v[60:63], v[132:135], v[172:175], v[60:63]
    ds_read_b64_tr_b16 v[214:215], v231 offset:51200
    v_mfma_f32_16x16x32_bf16 v[64:67], v[136:139], v[144:147], v[64:67]
    ds_read_b64_tr_b16 v[216:217], v232 offset:49152
    v_mfma_f32_16x16x32_bf16 v[68:71], v[136:139], v[148:151], v[68:71]
    ds_read_b64_tr_b16 v[218:219], v232 offset:51200
    v_mfma_f32_16x16x32_bf16 v[72:75], v[136:139], v[152:155], v[72:75]
    ds_read_b64_tr_b16 v[220:221], v233 offset:49152
    v_mfma_f32_16x16x32_bf16 v[76:79], v[136:139], v[156:159], v[76:79]
    v_mfma_f32_16x16x32_bf16 v[80:83], v[136:139], v[160:163], v[80:83]
    ds_read_b64_tr_b16 v[222:223], v233 offset:51200
    v_mfma_f32_16x16x32_bf16 v[84:87], v[136:139], v[164:167], v[84:87]
    ds_read_b128 v[184:187], v225 offset:4096
    v_mfma_f32_16x16x32_bf16 v[88:91], v[136:139], v[168:171], v[88:91]
    ds_read_b128 v[188:191], v225 offset:5120
    v_mfma_f32_16x16x32_bf16 v[92:95], v[136:139], v[172:175], v[92:95]
    s_add_u32 s36, s28, 0x8000
    v_mfma_f32_16x16x32_bf16 v[96:99], v[140:143], v[144:147], v[96:99]
    s_cmp_ge_u32 s36, 0x18000
    v_mfma_f32_16x16x32_bf16 v[100:103], v[140:143], v[148:151], v[100:103]
    v_mfma_f32_16x16x32_bf16 v[104:107], v[140:143], v[152:155], v[104:107]
    s_cselect_b32 s36, 0, s36
    v_mfma_f32_16x16x32_bf16 v[108:111], v[140:143], v[156:159], v[108:111]
    s_sub_u32 s29, s36, s28
    v_mfma_f32_16x16x32_bf16 v[112:115], v[140:143], v[160:163], v[112:115]
    s_mov_b32 s28, s36
    v_mfma_f32_16x16x32_bf16 v[116:119], v[140:143], v[164:167], v[116:119]
    v_add_u32 v224, s29, v224
    v_mfma_f32_16x16x32_bf16 v[120:123], v[140:143], v[168:171], v[120:123]
    v_add_u32 v225, s29, v225
    v_mfma_f32_16x16x32_bf16 v[124:127], v[140:143], v[172:175], v[124:127]
    s_waitcnt vmcnt(2) lgkmcnt(0)
    s_barrier
    v_mfma_f32_16x16x32_bf16 v[0:3], v[176:179], v[192:195], v[0:3]
    ds_read_b128 v[128:131], v224 offset:0
    v_mfma_f32_16x16x32_bf16 v[4:7], v[176:179], v[196:199], v[4:7]
    ds_read_b64_tr_b16 v[144:145], v226 offset:0
    v_mfma_f32_16x16x32_bf16 v[8:11], v[176:179], v[200:203], v[8:11]
    v_mfma_f32_16x16x32_bf16 v[12:15], v[176:179], v[204:207], v[12:15]
    ds_read_b64_tr_b16 v[146:147], v226 offset:2048
    v_mfma_f32_16x16x32_bf16 v[16:19], v[176:179], v[208:211], v[16:19]
    ds_read_b64_tr_b16 v[148:149], v227 offset:0
    v_mfma_f32_16x16x32_bf16 v[20:23], v[176:179], v[212:215], v[20:23]
    v_mfma_f32_16x16x32_bf16 v[24:27], v[176:179], v[216:219], v[24:27]
    ds_read_b64_tr_b16 v[150:151], v227 offset:2048
    v_mfma_f32_16x16x32_bf16 v[28:31], v[176:179], v[220:223], v[28:31]
    v_mfma_f32_16x16x32_bf16 v[32:35], v[180:183], v[192:195], v[32:35]
    ds_read_b128 v[132:135], v224 offset:1024
    v_mfma_f32_16x16x32_bf16 v[36:39], v[180:183], v[196:199], v[36:39]
    ds_read_b64_tr_b16 v[152:153], v228 offset:0
    v_mfma_f32_16x16x32_bf16 v[40:43], v[180:183], v[200:203], v[40:43]
    v_mfma_f32_16x16x32_bf16 v[44:47], v[180:183], v[204:207], v[44:47]
    ds_read_b64_tr_b16 v[154:155], v228 offset:2048
    v_mfma_f32_16x16x32_bf16 v[48:51], v[180:183], v[208:211], v[48:51]
    ds_read_b64_tr_b16 v[156:157], v229 offset:0
    v_mfma_f32_16x16x32_bf16 v[52:55], v[180:183], v[212:215], v[52:55]
    v_mfma_f32_16x16x32_bf16 v[56:59], v[180:183], v[216:219], v[56:59]
    ds_read_b64_tr_b16 v[158:159], v229 offset:2048
    v_mfma_f32_16x16x32_bf16 v[60:63], v[180:183], v[220:223], v[60:63]
    v_mfma_f32_16x16x32_bf16 v[64:67], v[184:187], v[192:195], v[64:67]
    ds_read_b64_tr_b16 v[160:161], v230 offset:0
    v_mfma_f32_16x16x32_bf16 v[68:71], v[184:187], v[196:199], v[68:71]
    ds_read_b64_tr_b16 v[162:163], v230 offset:2048
    v_mfma_f32_16x16x32_bf16 v[72:75], v[184:187], v[200:203], v[72:75]
    v_mfma_f32_16x16x32_bf16 v[76:79], v[184:187], v[204:207], v[76:79]
    ds_read_b64_tr_b16 v[164:165], v231 offset:0
    v_mfma_f32_16x16x32_bf16 v[80:83], v[184:187], v[208:211], v[80:83]
    ds_read_b64_tr_b16 v[166:167], v231 offset:2048
    v_mfma_f32_16x16x32_bf16 v[84:87], v[184:187], v[212:215], v[84:87]
    v_mfma_f32_16x16x32_bf16 v[88:91], v[184:187], v[216:219], v[88:91]
    ds_read_b64_tr_b16 v[168:169], v232 offset:0
    v_mfma_f32_16x16x32_bf16 v[92:95], v[184:187], v[220:223], v[92:95]
    v_mfma_f32_16x16x32_bf16 v[96:99], v[188:191], v[192:195], v[96:99]
    ds_read_b64_tr_b16 v[170:171], v232 offset:2048
    v_mfma_f32_16x16x32_bf16 v[100:103], v[188:191], v[196:199], v[100:103]
    ds_read_b64_tr_b16 v[172:173], v233 offset:0
    v_mfma_f32_16x16x32_bf16 v[104:107], v[188:191], v[200:203], v[104:107]
    v_mfma_f32_16x16x32_bf16 v[108:111], v[188:191], v[204:207], v[108:111]
    ds_read_b64_tr_b16 v[174:175], v233 offset:2048
    v_mfma_f32_16x16x32_bf16 v[112:115], v[188:191], v[208:211], v[112:115]
    ds_read_b128 v[136:139], v224 offset:4096
    v_mfma_f32_16x16x32_bf16 v[116:119], v[188:191], v[212:215], v[116:119]
    v_mfma_f32_16x16x32_bf16 v[120:123], v[188:191], v[216:219], v[120:123]
    ds_read_b128 v[140:143], v224 offset:5120
    v_mfma_f32_16x16x32_bf16 v[124:127], v[188:191], v[220:223], v[124:127]
    s_waitcnt vmcnt(0) lgkmcnt(0)
    s_barrier
    v_mfma_f32_16x16x32_bf16 v[0:3], v[128:131], v[144:147], v[0:3]
    ds_read_b128 v[176:179], v225 offset:0
    v_mfma_f32_16x16x32_bf16 v[4:7], v[128:131], v[148:151], v[4:7]
    ds_read_b64_tr_b16 v[192:193], v226 offset:16384
    v_mfma_f32_16x16x32_bf16 v[8:11], v[128:131], v[152:155], v[8:11]
    ds_read_b64_tr_b16 v[194:195], v226 offset:18432
    v_mfma_f32_16x16x32_bf16 v[12:15], v[128:131], v[156:159], v[12:15]
    ds_read_b64_tr_b16 v[196:197], v227 offset:16384
    v_mfma_f32_16x16x32_bf16 v[16:19], v[128:131], v[160:163], v[16:19]
    ds_read_b64_tr_b16 v[198:199], v227 offset:18432
    v_mfma_f32_16x16x32_bf16 v[20:23], v[128:131], v[164:167], v[20:23]
    ds_read_b128 v[180:183], v225 offset:1024
    v_mfma_f32_16x16x32_bf16 v[24:27], v[128:131], v[168:171], v[24:27]
    v_mfma_f32_16x16x32_bf16 v[28:31], v[128:131], v[172:175], v[28:31]
    ds_read_b64_tr_b16 v[200:201], v228 offset:16384
    v_mfma_f32_16x16x32_bf16 v[32:35], v[132:135], v[144:147], v[32:35]
    ds_read_b64_tr_b16 v[202:203], v228 offset:18432
    v_mfma_f32_16x16x32_bf16 v[36:39], v[132:135], v[148:151], v[36:39]
    ds_read_b64_tr_b16 v[204:205], v229 offset:16384
    v_mfma_f32_16x16x32_bf16 v[40:43], v[132:135], v[152:155], v[40:43]
    ds_read_b64_tr_b16 v[206:207], v229 offset:18432
    v_mfma_f32_16x16x32_bf16 v[44:47], v[132:135], v[156:159], v[44:47]
    ds_read_b64_tr_b16 v[208:209], v230 offset:16384
    v_mfma_f32_16x16x32_bf16 v[48:51], v[132:135], v[160:163], v[48:51]
    v_mfma_f32_16x16x32_bf16 v[52:55], v[132:135], v[164:167], v[52:55]
    ds_read_b64_tr_b16 v[210:211], v230 offset:18432
    v_mfma_f32_16x16x32_bf16 v[56:59], v[132:135], v[168:171], v[56:59]
    ds_read_b64_tr_b16 v[212:213], v231 offset:16384
    v_mfma_f32_16x16x32_bf16 v[60:63], v[132:135], v[172:175], v[60:63]
    ds_read_b64_tr_b16 v[214:215], v231 offset:18432
    v_mfma_f32_16x16x32_bf16 v[64:67], v[136:139], v[144:147], v[64:67]
    ds_read_b64_tr_b16 v[216:217], v232 offset:16384
    v_mfma_f32_16x16x32_bf16 v[68:71], v[136:139], v[148:151], v[68:71]
    ds_read_b64_tr_b16 v[218:219], v232 offset:18432
    v_mfma_f32_16x16x32_bf16 v[72:75], v[136:139], v[152:155], v[72:75]
    ds_read_b64_tr_b16 v[220:221], v233 offset:16384
    v_mfma_f32_16x16x32_bf16 v[76:79], v[136:139], v[156:159], v[76:79]
    v_mfma_f32_16x16x32_bf16 v[80:83], v[136:139], v[160:163], v[80:83]
    ds_read_b64_tr_b16 v[222:223], v233 offset:18432
    v_mfma_f32_16x16x32_bf16 v[84:87], v[136:139], v[164:167], v[84:87]
    ds_read_b128 v[184:187], v225 offset:4096
    v_mfma_f32_16x16x32_bf16 v[88:91], v[136:139], v[168:171], v[88:91]
    ds_read_b128 v[188:191], v225 offset:5120
    v_mfma_f32_16x16x32_bf16 v[92:95], v[136:139], v[172:175], v[92:95]
    s_add_u32 s36, s28, 0x8000
    v_mfma_f32_16x16x32_bf16 v[96:99], v[140:143], v[144:147], v[96:99]
    s_cmp_ge_u32 s36, 0x18000
    v_mfma_f32_16x16x32_bf16 v[100:103], v[140:143], v[148:151], v[100:103]
    v_mfma_f32_16x16x32_bf16 v[104:107], v[140:143], v[152:155], v[104:107]
    s_cselect_b32 s36, 0, s36
    v_mfma_f32_16x16x32_bf16 v[108:111], v[140:143], v[156:159], v[108:111]
    s_sub_u32 s29, s36, s28
    v_mfma_f32_16x16x32_bf16 v[112:115], v[140:143], v[160:163], v[112:115]
    s_mov_b32 s28, s36
    v_mfma_f32_16x16x32_bf16 v[116:119], v[140:143], v[164:167], v[116:119]
    v_add_u32 v224, s29, v224
    v_mfma_f32_16x16x32_bf16 v[120:123], v[140:143], v[168:171], v[120:123]
    v_add_u32 v225, s29, v225
    v_mfma_f32_16x16x32_bf16 v[124:127], v[140:143], v[172:175], v[124:127]
    s_waitcnt lgkmcnt(0)
    v_mfma_f32_16x16x32_bf16 v[0:3], v[176:179], v[192:195], v[0:3]
    v_mfma_f32_16x16x32_bf16 v[4:7], v[176:179], v[196:199], v[4:7]
    v_mfma_f32_16x16x32_bf16 v[8:11], v[176:179], v[200:203], v[8:11]
    v_mfma_f32_16x16x32_bf16 v[12:15], v[176:179], v[204:207], v[12:15]
    v_mfma_f32_16x16x32_bf16 v[16:19], v[176:179], v[208:211], v[16:19]
    v_mfma_f32_16x16x32_bf16 v[20:23], v[176:179], v[212:215], v[20:23]
    v_mfma_f32_16x16x32_bf16 v[24:27], v[176:179], v[216:219], v[24:27]
    v_mfma_f32_16x16x32_bf16 v[28:31], v[176:179], v[220:223], v[28:31]
    v_mfma_f32_16x16x32_bf16 v[32:35], v[180:183], v[192:195], v[32:35]
    v_mfma_f32_16x16x32_bf16 v[36:39], v[180:183], v[196:199], v[36:39]
    v_mfma_f32_16x16x32_bf16 v[40:43], v[180:183], v[200:203], v[40:43]
    v_mfma_f32_16x16x32_bf16 v[44:47], v[180:183], v[204:207], v[44:47]
    v_mfma_f32_16x16x32_bf16 v[48:51], v[180:183], v[208:211], v[48:51]
    v_mfma_f32_16x16x32_bf16 v[52:55], v[180:183], v[212:215], v[52:55]
    v_mfma_f32_16x16x32_bf16 v[56:59], v[180:183], v[216:219], v[56:59]
    v_mfma_f32_16x16x32_bf16 v[60:63], v[180:183], v[220:223], v[60:63]
    v_mfma_f32_16x16x32_bf16 v[64:67], v[184:187], v[192:195], v[64:67]
    v_mfma_f32_16x16x32_bf16 v[68:71], v[184:187], v[196:199], v[68:71]
    v_mfma_f32_16x16x32_bf16 v[72:75], v[184:187], v[200:203], v[72:75]
    v_mfma_f32_16x16x32_bf16 v[76:79], v[184:187], v[204:207], v[76:79]
    v_mfma_f32_16x16x32_bf16 v[80:83], v[184:187], v[208:211], v[80:83]
    v_mfma_f32_16x16x32_bf16 v[84:87], v[184:187], v[212:215], v[84:87]
    v_mfma_f32_16x16x32_bf16 v[88:91], v[184:187], v[216:219], v[88:91]
    v_mfma_f32_16x16x32_bf16 v[92:95], v[184:187], v[220:223], v[92:95]
    v_mfma_f32_16x16x32_bf16 v[96:99], v[188:191], v[192:195], v[96:99]
    v_mfma_f32_16x16x32_bf16 v[100:103], v[188:191], v[196:199], v[100:103]
    v_mfma_f32_16x16x32_bf16 v[104:107], v[188:191], v[200:203], v[104:107]
    v_mfma_f32_16x16x32_bf16 v[108:111], v[188:191], v[204:207], v[108:111]
    v_mfma_f32_16x16x32_bf16 v[112:115], v[188:191], v[208:211], v[112:115]
    v_mfma_f32_16x16x32_bf16 v[116:119], v[188:191], v[212:215], v[116:119]
    v_mfma_f32_16x16x32_bf16 v[120:123], v[188:191], v[216:219], v[120:123]
    v_mfma_f32_16x16x32_bf16 v[124:127], v[188:191], v[220:223], v[124:127]
    s_nop 7
    s_lshl_b32 s35, s48, 6
    s_lshl_b32 s36, s50, 3
    s_add_u32 s35, s35, s36
    s_lshl_b32 s36, s25, 1
    s_add_u32 s35, s35, s36
    s_lshl_b32 s35, s35, 5
    s_lshl_b32 s36, s49, 4
    s_add_u32 s35, s35, s36
    s_lshl_b32 s36, s26, 3
    s_add_u32 s35, s35, s36
    s_lshl_b32 s39, s35, 10
    v_cvt_pk_bf16_f32 v128, v0, v1
    v_cvt_pk_bf16_f32 v129, v2, v3
    v_cvt_pk_bf16_f32 v130, v32, v33
    v_cvt_pk_bf16_f32 v131, v34, v35
    buffer_store_dwordx4 v[128:131], v252, s[20:23], s39 offen offset:0 sc1
    v_cvt_pk_bf16_f32 v132, v4, v5
    v_cvt_pk_bf16_f32 v133, v6, v7
    v_cvt_pk_bf16_f32 v134, v36, v37
    v_cvt_pk_bf16_f32 v135, v38, v39
    buffer_store_dwordx4 v[132:135], v252, s[20:23], s39 offen offset:128 sc1
    v_cvt_pk_bf16_f32 v136, v8, v9
    v_cvt_pk_bf16_f32 v137, v10, v11
    v_cvt_pk_bf16_f32 v138, v40, v41
    v_cvt_pk_bf16_f32 v139, v42, v43
    buffer_store_dwordx4 v[136:139], v252, s[20:23], s39 offen offset:2048 sc1
    v_cvt_pk_bf16_f32 v140, v12, v13
    v_cvt_pk_bf16_f32 v141, v14, v15
    v_cvt_pk_bf16_f32 v142, v44, v45
    v_cvt_pk_bf16_f32 v143, v46, v47
    buffer_store_dwordx4 v[140:143], v252, s[20:23], s39 offen offset:2176 sc1
    s_add_u32 s39, s39, 4096
    v_cvt_pk_bf16_f32 v144, v16, v17
    v_cvt_pk_bf16_f32 v145, v18, v19
    v_cvt_pk_bf16_f32 v146, v48, v49
    v_cvt_pk_bf16_f32 v147, v50, v51
    buffer_store_dwordx4 v[144:147], v252, s[20:23], s39 offen offset:0 sc1
    v_cvt_pk_bf16_f32 v148, v20, v21
    v_cvt_pk_bf16_f32 v149, v22, v23
    v_cvt_pk_bf16_f32 v150, v52, v53
    v_cvt_pk_bf16_f32 v151, v54, v55
    buffer_store_dwordx4 v[148:151], v252, s[20:23], s39 offen offset:128 sc1
    v_cvt_pk_bf16_f32 v152, v24, v25
    v_cvt_pk_bf16_f32 v153, v26, v27
    v_cvt_pk_bf16_f32 v154, v56, v57
    v_cvt_pk_bf16_f32 v155, v58, v59
    buffer_store_dwordx4 v[152:155], v252, s[20:23], s39 offen offset:2048 sc1
    v_cvt_pk_bf16_f32 v156, v28, v29
    v_cvt_pk_bf16_f32 v157, v30, v31
    v_cvt_pk_bf16_f32 v158, v60, v61
    v_cvt_pk_bf16_f32 v159, v62, v63
    buffer_store_dwordx4 v[156:159], v252, s[20:23], s39 offen offset:2176 sc1
    s_add_u32 s39, s39, 28672
    v_cvt_pk_bf16_f32 v160, v64, v65
    v_cvt_pk_bf16_f32 v161, v66, v67
    v_cvt_pk_bf16_f32 v162, v96, v97
    v_cvt_pk_bf16_f32 v163, v98, v99
    buffer_store_dwordx4 v[160:163], v252, s[20:23], s39 offen offset:0 sc1
    v_cvt_pk_bf16_f32 v164, v68, v69
    v_cvt_pk_bf16_f32 v165, v70, v71
    v_cvt_pk_bf16_f32 v166, v100, v101
    v_cvt_pk_bf16_f32 v167, v102, v103
    buffer_store_dwordx4 v[164:167], v252, s[20:23], s39 offen offset:128 sc1
    v_cvt_pk_bf16_f32 v168, v72, v73
    v_cvt_pk_bf16_f32 v169, v74, v75
    v_cvt_pk_bf16_f32 v170, v104, v105
    v_cvt_pk_bf16_f32 v171, v106, v107
    buffer_store_dwordx4 v[168:171], v252, s[20:23], s39 offen offset:2048 sc1
    v_cvt_pk_bf16_f32 v172, v76, v77
    v_cvt_pk_bf16_f32 v173, v78, v79
    v_cvt_pk_bf16_f32 v174, v108, v109
    v_cvt_pk_bf16_f32 v175, v110, v111
    buffer_store_dwordx4 v[172:175], v252, s[20:23], s39 offen offset:2176 sc1
    s_add_u32 s39, s39, 4096
    v_cvt_pk_bf16_f32 v128, v80, v81
    v_cvt_pk_bf16_f32 v129, v82, v83
    v_cvt_pk_bf16_f32 v130, v112, v113
    v_cvt_pk_bf16_f32 v131, v114, v115
    buffer_store_dwordx4 v[128:131], v252, s[20:23], s39 offen offset:0 sc1
    v_cvt_pk_bf16_f32 v132, v84, v85
    v_cvt_pk_bf16_f32 v133, v86, v87
    v_cvt_pk_bf16_f32 v134, v116, v117
    v_cvt_pk_bf16_f32 v135, v118, v119
    buffer_store_dwordx4 v[132:135], v252, s[20:23], s39 offen offset:128 sc1
    v_cvt_pk_bf16_f32 v136, v88, v89
    v_cvt_pk_bf16_f32 v137, v90, v91
    v_cvt_pk_bf16_f32 v138, v120, v121
    v_cvt_pk_bf16_f32 v139, v122, v123
    buffer_store_dwordx4 v[136:139], v252, s[20:23], s39 offen offset:2048 sc1
    v_cvt_pk_bf16_f32 v140, v92, v93
    v_cvt_pk_bf16_f32 v141, v94, v95
    v_cvt_pk_bf16_f32 v142, v124, v125
    v_cvt_pk_bf16_f32 v143, v126, v127
    buffer_store_dwordx4 v[140:143], v252, s[20:23], s39 offen offset:2176 sc1
    s_add_u32 s39, s39, 28672
    s_branch K1_FIN
K1_GATE:
    s_waitcnt vmcnt(0) lgkmcnt(0)
    s_mov_b32 s8, s64
    s_mov_b32 s9, s65
    s_mov_b32 s10, 0x380
    s_mov_b32 s11, 0x20000
    s_sub_u32 s35, s47, 30
    s_lshl_b32 s36, s46, 1
    s_add_u32 s38, s35, s36
    s_lshl_b32 s35, s38, 7
    s_lshl_b32 s36, s24, 4
    s_add_u32 s35, s35, s36
    v_and_b32 v2, 15, v253
    v_add_u32 v2, s35, v2
    v_lshrrev_b32 v3, 4, v253
    v_mul_u32_u24 v3, 224, v3
    v_mul_u32_u24 v4, 896, v2
    v_add_u32 v4, v4, v3
    v_mov_b32 v5, 0
    buffer_load_dwordx4 v[8:11], v4, s[12:15], 0 offen offset:0
    buffer_load_dwordx4 v[64:67], v3, s[8:11], 0 offen offset:0
    buffer_load_dwordx4 v[12:15], v4, s[12:15], 0 offen offset:16
    buffer_load_dwordx4 v[68:71], v3, s[8:11], 0 offen offset:16
    buffer_load_dwordx4 v[16:19], v4, s[12:15], 0 offen offset:32
    buffer_load_dwordx4 v[72:75], v3, s[8:11], 0 offen offset:32
    buffer_load_dwordx4 v[20:23], v4, s[12:15], 0 offen offset:48
    buffer_load_dwordx4 v[76:79], v3, s[8:11], 0 offen offset:48
    buffer_load_dwordx4 v[24:27], v4, s[12:15], 0 offen offset:64
    buffer_load_dwordx4 v[80:83], v3, s[8:11], 0 offen offset:64
    buffer_load_dwordx4 v[28:31], v4, s[12:15], 0 offen offset:80
    buffer_load_dwordx4 v[84:87], v3, s[8:11], 0 offen offset:80
    buffer_load_dwordx4 v[32:35], v4, s[12:15], 0 offen offset:96
    buffer_load_dwordx4 v[88:91], v3, s[8:11], 0 offen offset:96
    buffer_load_dwordx4 v[36:39], v4, s[12:15], 0 offen offset:112
    buffer_load_dwordx4 v[92:95], v3, s[8:11], 0 offen offset:112
    buffer_load_dwordx4 v[40:43], v4, s[12:15], 0 offen offset:128
    buffer_load_dwordx4 v[96:99], v3, s[8:11], 0 offen offset:128
    buffer_load_dwordx4 v[44:47], v4, s[12:15], 0 offen offset:144
    buffer_load_dwordx4 v[100:103], v3, s[8:11], 0 offen offset:144
    buffer_load_dwordx4 v[48:51], v4, s[12:15], 0 offen offset:160
    buffer_load_dwordx4 v[104:107], v3, s[8:11], 0 offen offset:160
    buffer_load_dwordx4 v[52:55], v4, s[12:15], 0 offen offset:176
    buffer_load_dwordx4 v[108:111], v3, s[8:11], 0 offen offset:176
    buffer_load_dwordx4 v[56:59], v4, s[12:15], 0 offen offset:192
    buffer_load_dwordx4 v[112:115], v3, s[8:11], 0 offen offset:192
    buffer_load_dwordx4 v[60:63], v4, s[12:15], 0 offen offset:208
    buffer_load_dwordx4 v[116:119], v3, s[8:11], 0 offen offset:208
    s_waitcnt vmcnt(0)
    v_dot2_f32_bf16 v5, v8, v64, v5
    v_dot2_f32_bf16 v5, v9, v65, v5
    v_dot2_f32_bf16 v5, v10, v66, v5
    v_dot2_f32_bf16 v5, v11, v67, v5
    v_dot2_f32_bf16 v5, v12, v68, v5
    v_dot2_f32_bf16 v5, v13, v69, v5
    v_dot2_f32_bf16 v5, v14, v70, v5
    v_dot2_f32_bf16 v5, v15, v71, v5
    v_dot2_f32_bf16 v5, v16, v72, v5
    v_dot2_f32_bf16 v5, v17, v73, v5
    v_dot2_f32_bf16 v5, v18, v74, v5
    v_dot2_f32_bf16 v5, v19, v75, v5
    v_dot2_f32_bf16 v5, v20, v76, v5
    v_dot2_f32_bf16 v5, v21, v77, v5
    v_dot2_f32_bf16 v5, v22, v78, v5
    v_dot2_f32_bf16 v5, v23, v79, v5
    v_dot2_f32_bf16 v5, v24, v80, v5
    v_dot2_f32_bf16 v5, v25, v81, v5
    v_dot2_f32_bf16 v5, v26, v82, v5
    v_dot2_f32_bf16 v5, v27, v83, v5
    v_dot2_f32_bf16 v5, v28, v84, v5
    v_dot2_f32_bf16 v5, v29, v85, v5
    v_dot2_f32_bf16 v5, v30, v86, v5
    v_dot2_f32_bf16 v5, v31, v87, v5
    v_dot2_f32_bf16 v5, v32, v88, v5
    v_dot2_f32_bf16 v5, v33, v89, v5
    v_dot2_f32_bf16 v5, v34, v90, v5
    v_dot2_f32_bf16 v5, v35, v91, v5
    v_dot2_f32_bf16 v5, v36, v92, v5
    v_dot2_f32_bf16 v5, v37, v93, v5
    v_dot2_f32_bf16 v5, v38, v94, v5
    v_dot2_f32_bf16 v5, v39, v95, v5
    v_dot2_f32_bf16 v5, v40, v96, v5
    v_dot2_f32_bf16 v5, v41, v97, v5
    v_dot2_f32_bf16 v5, v42, v98, v5
    v_dot2_f32_bf16 v5, v43, v99, v5
    v_dot2_f32_bf16 v5, v44, v100, v5
    v_dot2_f32_bf16 v5, v45, v101, v5
    v_dot2_f32_bf16 v5, v46, v102, v5
    v_dot2_f32_bf16 v5, v47, v103, v5
    v_dot2_f32_bf16 v5, v48, v104, v5
    v_dot2_f32_bf16 v5, v49, v105, v5
    v_dot2_f32_bf16 v5, v50, v106, v5
    v_dot2_f32_bf16 v5, v51, v107, v5
    v_dot2_f32_bf16 v5, v52, v108, v5
    v_dot2_f32_bf16 v5, v53, v109, v5
    v_dot2_f32_bf16 v5, v54, v110, v5
    v_dot2_f32_bf16 v5, v55, v111, v5
    v_dot2_f32_bf16 v5, v56, v112, v5
    v_dot2_f32_bf16 v5, v57, v113, v5
    v_dot2_f32_bf16 v5, v58, v114, v5
    v_dot2_f32_bf16 v5, v59, v115, v5
    v_dot2_f32_bf16 v5, v60, v116, v5
    v_dot2_f32_bf16 v5, v61, v117, v5
    v_dot2_f32_bf16 v5, v62, v118, v5
    v_dot2_f32_bf16 v5, v63, v119, v5
    s_nop 3
    v_mov_b32 v6, v5
    s_nop 1
    v_permlane32_swap_b32 v5, v6
    s_nop 1
    v_add_f32 v5, v5, v6
    v_mov_b32 v6, v5
    s_nop 1
    v_permlane16_swap_b32 v5, v6
    s_nop 1
    v_add_f32 v5, v5, v6
    v_cvt_pk_bf16_f32 v5, v5, v5
    v_lshlrev_b32 v5, 16, v5
    v_mul_f32 v5, 0xbfb8aa3b, v5
    v_exp_f32 v5, v5
    s_nop 0
    v_add_f32 v5, 1.0, v5
    v_rcp_f32 v5, v5
    s_nop 0
    v_cvt_pk_bf16_f32 v5, v5, v5
    v_lshlrev_b32 v5, 16, v5
    v_sub_f32 v6, 1.0, v5
    v_cvt_pk_bf16_f32 v6, v6, v6
    v_lshlrev_b32 v6, 16, v6
    v_lshlrev_b32 v2, 2, v2
    s_mov_b32 s35, 0x4c00000
    s_mov_b32 s36, 0x4c02000
    s_mov_b64 exec, 0xffff
    buffer_store_dword v5, v2, s[20:23], s35 offen
    buffer_store_dword v6, v2, s[20:23], s36 offen
    s_mov_b64 exec, -1
    s_lshl_b32 s35, s38, 13
    s_lshl_b32 s36, s24, 10
    s_add_u32 s35, s35, s36
    s_add_u32 s35, s35, 0x4d00000
    v_lshlrev_b32 v2, 4, v253
    v_mov_b32 v8, 0
    v_mov_b32 v9, 0
    v_mov_b32 v10, 0
    v_mov_b32 v11, 0
    buffer_store_dwordx4 v[8:11], v2, s[20:23], s35 offen
K1_FIN:
K1_END:
    s_endpgm
.p2align 8
k2_attn_kernel:
    s_cmp_ge_u32 s2, 256
    s_cbranch_scc1 K2_END
    s_load_dwordx2 s[36:37], s[0:1], 96
    s_mov_b32 s60, 0
    s_load_dwordx2 s[64:65], s[0:1], 64
    s_load_dwordx2 s[66:67], s[0:1], 16
    s_load_dwordx2 s[62:63], s[0:1], 80
    v_lshrrev_b32 v1, 6, v0
    v_and_b32 v2, 63, v0
    v_readfirstlane_b32 s8, v1
    s_lshr_b32 s11, s2, 7
    s_and_b32 s27, s2, 7
    s_lshl_b32 s9, s27, 1
    s_bfe_u32 s27, s2, 0x10003
    s_add_u32 s9, s9, s27
    s_bfe_u32 s10, s2, 0x30004
    s_lshl_b32 s19, s9, 21
    s_sub_u32 s12, 15, s10
    s_lshl_b32 s27, s12, 2
    s_add_u32 s27, s27, 4
    s_cmp_eq_u32 s11, 0
    s_cbranch_scc1 K2_PROD
    s_mov_b32 s13, 0
    s_min_u32 s14, s27, 36
    s_cmp_gt_u32 s27, 36
    s_cselect_b32 s15, 2, 0
    s_mov_b32 s20, s14
    s_mov_b32 s21, s14
    s_mov_b32 s18, 1
    s_branch K2_SETUP_DONE
K2_PROD:
    s_lshl_b32 s28, s10, 2
    s_add_u32 s28, s28, 4
    s_cmp_gt_u32 s27, 36
    s_cbranch_scc1 K2_PROD2
    s_mov_b32 s12, s10
    s_mov_b32 s13, 0
    s_mov_b32 s14, s28
    s_mov_b32 s15, 0
    s_mov_b32 s20, s28
    s_mov_b32 s21, s28
    s_mov_b32 s18, 1
    s_branch K2_SETUP_DONE
K2_PROD2:
    s_mov_b32 s13, 36
    s_mov_b32 s14, s27
    s_mov_b32 s15, 1
    s_sub_u32 s20, s27, 36
    s_add_u32 s21, s20, s28
    s_mov_b32 s18, 0
K2_SETUP_DONE:
    s_mov_b32 s22, s13
    s_waitcnt lgkmcnt(0)
    s_mov_b32 s4, s36
    s_mov_b32 s5, s37
    s_mov_b32 s6, 0x10000000
    s_mov_b32 s7, 0x20000
    s_cmp_ge_u32 s8, 4
    s_cbranch_scc1 K2_AWAVE
    v_lshlrev_b32 v248, 4, v2
    v_add_u32 v249, 0x10000, v248
    s_mov_b32 s24, 0x3db8aa3b
    s_mov_b32 s25, 0x42000000
    s_mov_b32 s44, -1
    s_lshl_b32 s27, s9, 3
    s_add_u32 s27, s27, s10
    s_lshl_b32 s27, s27, 2
    s_add_u32 s27, s27, s8
    s_mul_i32 s31, s27, 33792
    s_add_u32 s31, s31, 0x5000000
    s_lshl_b32 s32, s27, 7
    s_add_u32 s32, s32, 0x4d00000
    s_mov_b32 s23, 0
    s_mov_b32 s34, 1
    s_lshl_b32 s27, s9, 6
    s_lshl_b32 s28, s12, 2
    s_add_u32 s16, s28, s8
    s_add_u32 s27, s27, s16
    s_lshl_b32 s27, s27, 14
    s_add_u32 s27, s27, 0x2000000
    buffer_load_dwordx4 v[128:131], v248, s[4:7], s27 offen offset:0
    buffer_load_dwordx4 v[132:135], v248, s[4:7], s27 offen offset:1024
    buffer_load_dwordx4 v[136:139], v248, s[4:7], s27 offen offset:2048
    buffer_load_dwordx4 v[140:143], v248, s[4:7], s27 offen offset:3072
    s_add_u32 s27, s27, 4096
    buffer_load_dwordx4 v[144:147], v248, s[4:7], s27 offen offset:0
    buffer_load_dwordx4 v[148:151], v248, s[4:7], s27 offen offset:1024
    buffer_load_dwordx4 v[152:155], v248, s[4:7], s27 offen offset:2048
    buffer_load_dwordx4 v[156:159], v248, s[4:7], s27 offen offset:3072
    s_add_u32 s27, s27, 4096
    buffer_load_dwordx4 v[160:163], v248, s[4:7], s27 offen offset:0
    buffer_load_dwordx4 v[164:167], v248, s[4:7], s27 offen offset:1024
    buffer_load_dwordx4 v[168:171], v248, s[4:7], s27 offen offset:2048
    buffer_load_dwordx4 v[172:175], v248, s[4:7], s27 offen offset:3072
    s_add_u32 s27, s27, 4096
    buffer_load_dwordx4 v[176:179], v248, s[4:7], s27 offen offset:0
    buffer_load_dwordx4 v[180:183], v248, s[4:7], s27 offen offset:1024
    buffer_load_dwordx4 v[184:187], v248, s[4:7], s27 offen offset:2048
    buffer_load_dwordx4 v[188:191], v248, s[4:7], s27 offen offset:3072
K2_SEG:
    v_mov_b32 v0, 0
    v_mov_b32 v1, 0
    v_mov_b32 v2, 0
    v_mov_b32 v3, 0
    v_mov_b32 v4, 0
    v_mov_b32 v5, 0
    v_mov_b32 v6, 0
    v_mov_b32 v7, 0
    v_mov_b32 v8, 0
    v_mov_b32 v9, 0
    v_mov_b32 v10, 0
    v_mov_b32 v11, 0
    v_mov_b32 v12, 0
    v_mov_b32 v13, 0
    v_mov_b32 v14, 0
    v_mov_b32 v15, 0
    v_mov_b32 v16, 0
    v_mov_b32 v17, 0
    v_mov_b32 v18, 0
    v_mov_b32 v19, 0
    v_mov_b32 v20, 0
    v_mov_b32 v21, 0
    v_mov_b32 v22, 0
    v_mov_b32 v23, 0
    v_mov_b32 v24, 0
    v_mov_b32 v25, 0
    v_mov_b32 v26, 0
    v_mov_b32 v27, 0
    v_mov_b32 v28, 0
    v_mov_b32 v29, 0
    v_mov_b32 v30, 0
    v_mov_b32 v31, 0
    v_mov_b32 v32, 0
    v_mov_b32 v33, 0
    v_mov_b32 v34, 0
    v_mov_b32 v35, 0
    v_mov_b32 v36, 0
    v_mov_b32 v37, 0
    v_mov_b32 v38, 0
    v_mov_b32 v39, 0
    v_mov_b32 v40, 0
    v_mov_b32 v41, 0
    v_mov_b32 v42, 0
    v_mov_b32 v43, 0
    v_mov_b32 v44, 0
    v_mov_b32 v45, 0
    v_mov_b32 v46, 0
    v_mov_b32 v47, 0
    v_mov_b32 v48, 0
    v_mov_b32 v49, 0
    v_mov_b32 v50, 0
    v_mov_b32 v51, 0
    v_mov_b32 v52, 0
    v_mov_b32 v53, 0
    v_mov_b32 v54, 0
    v_mov_b32 v55, 0
    v_mov_b32 v56, 0
    v_mov_b32 v57, 0
    v_mov_b32 v58, 0
    v_mov_b32 v59, 0
    v_mov_b32 v60, 0
    v_mov_b32 v61, 0
    v_mov_b32 v62, 0
    v_mov_b32 v63, 0
    v_mov_b32 v64, 0
    v_mov_b32 v65, 0
    v_mov_b32 v66, 0
    v_mov_b32 v67, 0
    v_mov_b32 v68, 0
    v_mov_b32 v69, 0
    v_mov_b32 v70, 0
    v_mov_b32 v71, 0
    v_mov_b32 v72, 0
    v_mov_b32 v73, 0
    v_mov_b32 v74, 0
    v_mov_b32 v75, 0
    v_mov_b32 v76, 0
    v_mov_b32 v77, 0
    v_mov_b32 v78, 0
    v_mov_b32 v79, 0
    v_mov_b32 v80, 0
    v_mov_b32 v81, 0
    v_mov_b32 v82, 0
    v_mov_b32 v83, 0
    v_mov_b32 v84, 0
    v_mov_b32 v85, 0
    v_mov_b32 v86, 0
    v_mov_b32 v87, 0
    v_mov_b32 v88, 0
    v_mov_b32 v89, 0
    v_mov_b32 v90, 0
    v_mov_b32 v91, 0
    v_mov_b32 v92, 0
    v_mov_b32 v93, 0
    v_mov_b32 v94, 0
    v_mov_b32 v95, 0
    v_mov_b32 v96, 0
    v_mov_b32 v97, 0
    v_mov_b32 v98, 0
    v_mov_b32 v99, 0
    v_mov_b32 v100, 0
    v_mov_b32 v101, 0
    v_mov_b32 v102, 0
    v_mov_b32 v103, 0
    v_mov_b32 v104, 0
    v_mov_b32 v105, 0
    v_mov_b32 v106, 0
    v_mov_b32 v107, 0
    v_mov_b32 v108, 0
    v_mov_b32 v109, 0
    v_mov_b32 v110, 0
    v_mov_b32 v111, 0
    v_mov_b32 v112, 0
    v_mov_b32 v113, 0
    v_mov_b32 v114, 0
    v_mov_b32 v115, 0
    v_mov_b32 v116, 0
    v_mov_b32 v117, 0
    v_mov_b32 v118, 0
    v_mov_b32 v119, 0
    v_mov_b32 v120, 0
    v_mov_b32 v121, 0
    v_mov_b32 v122, 0
    v_mov_b32 v123, 0
    v_mov_b32 v124, 0
    v_mov_b32 v125, 0
    v_mov_b32 v126, 0
    v_mov_b32 v127, 0
    v_mov_b32 v251, 0
    v_mov_b32 v250, 0xef91accb
    s_sub_u32 s27, s14, 1
    s_min_u32 s33, s27, s16
    s_mov_b32 s17, s13
    s_cmp_eq_u32 s34, 0
    s_cbranch_scc1 K2_NOBAR
    s_barrier
    s_mov_b32 s34, 0
    s_waitcnt vmcnt(0)
K2_NOBAR:
    s_waitcnt vmcnt(33) lgkmcnt(0)
    s_and_b32 s27, s23, 3
    s_cmp_eq_u32 s27, 1
    s_cbranch_scc1 K2_PRE1
    s_cmp_eq_u32 s27, 2
    s_cbranch_scc1 K2_PRE2
    s_cmp_eq_u32 s27, 3
    s_cbranch_scc1 K2_PRE3
K2_PRE0:
    s_cmp_lt_i32 s33, s13
    s_cbranch_scc1 K2_STEP0
    ds_read_b128 v[224:227], v248 offset:0
    ds_read_b128 v[228:231], v248 offset:1024
    ds_read_b128 v[232:235], v248 offset:2048
    ds_read_b128 v[236:239], v248 offset:3072
    ds_read_b128 v[240:243], v248 offset:4096
    s_waitcnt lgkmcnt(4)
    v_mfma_f32_32x32x16_bf16 v[192:207], v[224:227], v[128:131], 0
    ds_read_b128 v[244:247], v248 offset:5120
    s_waitcnt lgkmcnt(4)
    v_mfma_f32_32x32x16_bf16 v[192:207], v[228:231], v[132:135], v[192:207]
    ds_read_b128 v[224:227], v248 offset:6144
    s_waitcnt lgkmcnt(4)
    v_mfma_f32_32x32x16_bf16 v[192:207], v[232:235], v[136:139], v[192:207]
    ds_read_b128 v[228:231], v248 offset:7168
    s_waitcnt lgkmcnt(4)
    v_mfma_f32_32x32x16_bf16 v[192:207], v[236:239], v[140:143], v[192:207]
    ds_read_b128 v[232:235], v248 offset:8192
    s_waitcnt lgkmcnt(4)
    v_mfma_f32_32x32x16_bf16 v[192:207], v[240:243], v[144:147], v[192:207]
    ds_read_b128 v[236:239], v248 offset:9216
    s_waitcnt lgkmcnt(4)
    v_mfma_f32_32x32x16_bf16 v[192:207], v[244:247], v[148:151], v[192:207]
    ds_read_b128 v[240:243], v248 offset:10240
    s_waitcnt lgkmcnt(4)
    v_mfma_f32_32x32x16_bf16 v[192:207], v[224:227], v[152:155], v[192:207]
    ds_read_b128 v[244:247], v248 offset:11264
    s_waitcnt lgkmcnt(4)
    v_mfma_f32_32x32x16_bf16 v[192:207], v[228:231], v[156:159], v[192:207]
    ds_read_b128 v[224:227], v248 offset:12288
    s_waitcnt lgkmcnt(4)
    v_mfma_f32_32x32x16_bf16 v[192:207], v[232:235], v[160:163], v[192:207]
    ds_read_b128 v[228:231], v248 offset:13312
    s_waitcnt lgkmcnt(4)
    v_mfma_f32_32x32x16_bf16 v[192:207], v[236:239], v[164:167], v[192:207]
    ds_read_b128 v[232:235], v248 offset:14336
    s_waitcnt lgkmcnt(4)
    v_mfma_f32_32x32x16_bf16 v[192:207], v[240:243], v[168:171], v[192:207]
    ds_read_b128 v[236:239], v248 offset:15360
    s_waitcnt lgkmcnt(4)
    v_mfma_f32_32x32x16_bf16 v[192:207], v[244:247], v[172:175], v[192:207]
    s_waitcnt lgkmcnt(3)
    v_mfma_f32_32x32x16_bf16 v[192:207], v[224:227], v[176:179], v[192:207]
    s_waitcnt lgkmcnt(2)
    v_mfma_f32_32x32x16_bf16 v[192:207], v[228:231], v[180:183], v[192:207]
    s_waitcnt lgkmcnt(1)
    v_mfma_f32_32x32x16_bf16 v[192:207], v[232:235], v[184:187], v[192:207]
    s_waitcnt lgkmcnt(0)
    v_mfma_f32_32x32x16_bf16 v[192:207], v[236:239], v[188:191], v[192:207]
    ds_read_b128 v[224:227], v248 offset:16384
    ds_read_b128 v[228:231], v248 offset:17408
    ds_read_b128 v[232:235], v248 offset:18432
    ds_read_b128 v[236:239], v248 offset:19456
    ds_read_b128 v[240:243], v248 offset:20480
    ds_read_b128 v[244:247], v248 offset:21504
    v_mov_b32 v250, 0
    s_mov_b32 s35, 1
    s_nop 7
    v_fma_f32 v192, v192, s24, -v250
    v_fma_f32 v193, v193, s24, -v250
    v_fma_f32 v194, v194, s24, -v250
    v_fma_f32 v195, v195, s24, -v250
    v_fma_f32 v196, v196, s24, -v250
    v_fma_f32 v197, v197, s24, -v250
    v_fma_f32 v198, v198, s24, -v250
    v_fma_f32 v199, v199, s24, -v250
    v_fma_f32 v200, v200, s24, -v250
    v_fma_f32 v201, v201, s24, -v250
    v_fma_f32 v202, v202, s24, -v250
    v_fma_f32 v203, v203, s24, -v250
    v_fma_f32 v204, v204, s24, -v250
    v_fma_f32 v205, v205, s24, -v250
    v_fma_f32 v206, v206, s24, -v250
    v_fma_f32 v207, v207, s24, -v250
    s_call_b64 s[38:39], K2_SLOW0
    s_branch K2_STEP0
K2_PRE1:
    s_cmp_lt_i32 s33, s13
    s_cbranch_scc1 K2_STEP1
    ds_read_b128 v[224:227], v248 offset:16384
    ds_read_b128 v[228:231], v248 offset:17408
    ds_read_b128 v[232:235], v248 offset:18432
    ds_read_b128 v[236:239], v248 offset:19456
    ds_read_b128 v[240:243], v248 offset:20480
    s_waitcnt lgkmcnt(4)
    v_mfma_f32_32x32x16_bf16 v[208:223], v[224:227], v[128:131], 0
    ds_read_b128 v[244:247], v248 offset:21504
    s_waitcnt lgkmcnt(4)
    v_mfma_f32_32x32x16_bf16 v[208:223], v[228:231], v[132:135], v[208:223]
    ds_read_b128 v[224:227], v248 offset:22528
    s_waitcnt lgkmcnt(4)
    v_mfma_f32_32x32x16_bf16 v[208:223], v[232:235], v[136:139], v[208:223]
    ds_read_b128 v[228:231], v248 offset:23552
    s_waitcnt lgkmcnt(4)
    v_mfma_f32_32x32x16_bf16 v[208:223], v[236:239], v[140:143], v[208:223]
    ds_read_b128 v[232:235], v248 offset:24576
    s_waitcnt lgkmcnt(4)
    v_mfma_f32_32x32x16_bf16 v[208:223], v[240:243], v[144:147], v[208:223]
    ds_read_b128 v[236:239], v248 offset:25600
    s_waitcnt lgkmcnt(4)
    v_mfma_f32_32x32x16_bf16 v[208:223], v[244:247], v[148:151], v[208:223]
    ds_read_b128 v[240:243], v248 offset:26624
    s_waitcnt lgkmcnt(4)
    v_mfma_f32_32x32x16_bf16 v[208:223], v[224:227], v[152:155], v[208:223]
    ds_read_b128 v[244:247], v248 offset:27648
    s_waitcnt lgkmcnt(4)
    v_mfma_f32_32x32x16_bf16 v[208:223], v[228:231], v[156:159], v[208:223]
    ds_read_b128 v[224:227], v248 offset:28672
    s_waitcnt lgkmcnt(4)
    v_mfma_f32_32x32x16_bf16 v[208:223], v[232:235], v[160:163], v[208:223]
    ds_read_b128 v[228:231], v248 offset:29696
    s_waitcnt lgkmcnt(4)
    v_mfma_f32_32x32x16_bf16 v[208:223], v[236:239], v[164:167], v[208:223]
    ds_read_b128 v[232:235], v248 offset:30720
    s_waitcnt lgkmcnt(4)
    v_mfma_f32_32x32x16_bf16 v[208:223], v[240:243], v[168:171], v[208:223]
    ds_read_b128 v[236:239], v248 offset:31744
    s_waitcnt lgkmcnt(4)
    v_mfma_f32_32x32x16_bf16 v[208:223], v[244:247], v[172:175], v[208:223]
    s_waitcnt lgkmcnt(3)
    v_mfma_f32_32x32x16_bf16 v[208:223], v[224:227], v[176:179], v[208:223]
    s_waitcnt lgkmcnt(2)
    v_mfma_f32_32x32x16_bf16 v[208:223], v[228:231], v[180:183], v[208:223]
    s_waitcnt lgkmcnt(1)
    v_mfma_f32_32x32x16_bf16 v[208:223], v[232:235], v[184:187], v[208:223]
    s_waitcnt lgkmcnt(0)
    v_mfma_f32_32x32x16_bf16 v[208:223], v[236:239], v[188:191], v[208:223]
    ds_read_b128 v[224:227], v248 offset:32768
    ds_read_b128 v[228:231], v248 offset:33792
    ds_read_b128 v[232:235], v248 offset:34816
    ds_read_b128 v[236:239], v248 offset:35840
    ds_read_b128 v[240:243], v248 offset:36864
    ds_read_b128 v[244:247], v248 offset:37888
    v_mov_b32 v250, 0
    s_mov_b32 s35, 1
    s_nop 7
    v_fma_f32 v208, v208, s24, -v250
    v_fma_f32 v209, v209, s24, -v250
    v_fma_f32 v210, v210, s24, -v250
    v_fma_f32 v211, v211, s24, -v250
    v_fma_f32 v212, v212, s24, -v250
    v_fma_f32 v213, v213, s24, -v250
    v_fma_f32 v214, v214, s24, -v250
    v_fma_f32 v215, v215, s24, -v250
    v_fma_f32 v216, v216, s24, -v250
    v_fma_f32 v217, v217, s24, -v250
    v_fma_f32 v218, v218, s24, -v250
    v_fma_f32 v219, v219, s24, -v250
    v_fma_f32 v220, v220, s24, -v250
    v_fma_f32 v221, v221, s24, -v250
    v_fma_f32 v222, v222, s24, -v250
    v_fma_f32 v223, v223, s24, -v250
    s_call_b64 s[38:39], K2_SLOW1
    s_branch K2_STEP1
K2_PRE2:
    s_cmp_lt_i32 s33, s13
    s_cbranch_scc1 K2_STEP2
    ds_read_b128 v[224:227], v248 offset:32768
    ds_read_b128 v[228:231], v248 offset:33792
    ds_read_b128 v[232:235], v248 offset:34816
    ds_read_b128 v[236:239], v248 offset:35840
    ds_read_b128 v[240:243], v248 offset:36864
    s_waitcnt lgkmcnt(4)
    v_mfma_f32_32x32x16_bf16 v[192:207], v[224:227], v[128:131], 0
    ds_read_b128 v[244:247], v248 offset:37888
    s_waitcnt lgkmcnt(4)
    v_mfma_f32_32x32x16_bf16 v[192:207], v[228:231], v[132:135], v[192:207]
    ds_read_b128 v[224:227], v248 offset:38912
    s_waitcnt lgkmcnt(4)
    v_mfma_f32_32x32x16_bf16 v[192:207], v[232:235], v[136:139], v[192:207]
    ds_read_b128 v[228:231], v248 offset:39936
    s_waitcnt lgkmcnt(4)
    v_mfma_f32_32x32x16_bf16 v[192:207], v[236:239], v[140:143], v[192:207]
    ds_read_b128 v[232:235], v248 offset:40960
    s_waitcnt lgkmcnt(4)
    v_mfma_f32_32x32x16_bf16 v[192:207], v[240:243], v[144:147], v[192:207]
    ds_read_b128 v[236:239], v248 offset:41984
    s_waitcnt lgkmcnt(4)
    v_mfma_f32_32x32x16_bf16 v[192:207], v[244:247], v[148:151], v[192:207]
    ds_read_b128 v[240:243], v248 offset:43008
    s_waitcnt lgkmcnt(4)
    v_mfma_f32_32x32x16_bf16 v[192:207], v[224:227], v[152:155], v[192:207]
    ds_read_b128 v[244:247], v248 offset:44032
    s_waitcnt lgkmcnt(4)
    v_mfma_f32_32x32x16_bf16 v[192:207], v[228:231], v[156:159], v[192:207]
    ds_read_b128 v[224:227], v248 offset:45056
    s_waitcnt lgkmcnt(4)
    v_mfma_f32_32x32x16_bf16 v[192:207], v[232:235], v[160:163], v[192:207]
    ds_read_b128 v[228:231], v248 offset:46080
    s_waitcnt lgkmcnt(4)
    v_mfma_f32_32x32x16_bf16 v[192:207], v[236:239], v[164:167], v[192:207]
    ds_read_b128 v[232:235], v248 offset:47104
    s_waitcnt lgkmcnt(4)
    v_mfma_f32_32x32x16_bf16 v[192:207], v[240:243], v[168:171], v[192:207]
    ds_read_b128 v[236:239], v248 offset:48128
    s_waitcnt lgkmcnt(4)
    v_mfma_f32_32x32x16_bf16 v[192:207], v[244:247], v[172:175], v[192:207]
    s_waitcnt lgkmcnt(3)
    v_mfma_f32_32x32x16_bf16 v[192:207], v[224:227], v[176:179], v[192:207]
    s_waitcnt lgkmcnt(2)
    v_mfma_f32_32x32x16_bf16 v[192:207], v[228:231], v[180:183], v[192:207]
    s_waitcnt lgkmcnt(1)
    v_mfma_f32_32x32x16_bf16 v[192:207], v[232:235], v[184:187], v[192:207]
    s_waitcnt lgkmcnt(0)
    v_mfma_f32_32x32x16_bf16 v[192:207], v[236:239], v[188:191], v[192:207]
    ds_read_b128 v[224:227], v248 offset:49152
    ds_read_b128 v[228:231], v248 offset:50176
    ds_read_b128 v[232:235], v248 offset:51200
    ds_read_b128 v[236:239], v248 offset:52224
    ds_read_b128 v[240:243], v248 offset:53248
    ds_read_b128 v[244:247], v248 offset:54272
    v_mov_b32 v250, 0
    s_mov_b32 s35, 1
    s_nop 7
    v_fma_f32 v192, v192, s24, -v250
    v_fma_f32 v193, v193, s24, -v250
    v_fma_f32 v194, v194, s24, -v250
    v_fma_f32 v195, v195, s24, -v250
    v_fma_f32 v196, v196, s24, -v250
    v_fma_f32 v197, v197, s24, -v250
    v_fma_f32 v198, v198, s24, -v250
    v_fma_f32 v199, v199, s24, -v250
    v_fma_f32 v200, v200, s24, -v250
    v_fma_f32 v201, v201, s24, -v250
    v_fma_f32 v202, v202, s24, -v250
    v_fma_f32 v203, v203, s24, -v250
    v_fma_f32 v204, v204, s24, -v250
    v_fma_f32 v205, v205, s24, -v250
    v_fma_f32 v206, v206, s24, -v250
    v_fma_f32 v207, v207, s24, -v250
    s_call_b64 s[38:39], K2_SLOW0
    s_branch K2_STEP2
K2_PRE3:
    s_cmp_lt_i32 s33, s13
    s_cbranch_scc1 K2_STEP3
    ds_read_b128 v[224:227], v248 offset:49152
    ds_read_b128 v[228:231], v248 offset:50176
    ds_read_b128 v[232:235], v248 offset:51200
    ds_read_b128 v[236:239], v248 offset:52224
    ds_read_b128 v[240:243], v248 offset:53248
    s_waitcnt lgkmcnt(4)
    v_mfma_f32_32x32x16_bf16 v[208:223], v[224:227], v[128:131], 0
    ds_read_b128 v[244:247], v248 offset:54272
    s_waitcnt lgkmcnt(4)
    v_mfma_f32_32x32x16_bf16 v[208:223], v[228:231], v[132:135], v[208:223]
    ds_read_b128 v[224:227], v248 offset:55296
    s_waitcnt lgkmcnt(4)
    v_mfma_f32_32x32x16_bf16 v[208:223], v[232:235], v[136:139], v[208:223]
    ds_read_b128 v[228:231], v248 offset:56320
    s_waitcnt lgkmcnt(4)
    v_mfma_f32_32x32x16_bf16 v[208:223], v[236:239], v[140:143], v[208:223]
    ds_read_b128 v[232:235], v248 offset:57344
    s_waitcnt lgkmcnt(4)
    v_mfma_f32_32x32x16_bf16 v[208:223], v[240:243], v[144:147], v[208:223]
    ds_read_b128 v[236:239], v248 offset:58368
    s_waitcnt lgkmcnt(4)
    v_mfma_f32_32x32x16_bf16 v[208:223], v[244:247], v[148:151], v[208:223]
    ds_read_b128 v[240:243], v248 offset:59392
    s_waitcnt lgkmcnt(4)
    v_mfma_f32_32x32x16_bf16 v[208:223], v[224:227], v[152:155], v[208:223]
    ds_read_b128 v[244:247], v248 offset:60416
    s_waitcnt lgkmcnt(4)
    v_mfma_f32_32x32x16_bf16 v[208:223], v[228:231], v[156:159], v[208:223]
    ds_read_b128 v[224:227], v248 offset:61440
    s_waitcnt lgkmcnt(4)
    v_mfma_f32_32x32x16_bf16 v[208:223], v[232:235], v[160:163], v[208:223]
    ds_read_b128 v[228:231], v248 offset:62464
    s_waitcnt lgkmcnt(4)
    v_mfma_f32_32x32x16_bf16 v[208:223], v[236:239], v[164:167], v[208:223]
    ds_read_b128 v[232:235], v248 offset:63488
    s_waitcnt lgkmcnt(4)
    v_mfma_f32_32x32x16_bf16 v[208:223], v[240:243], v[168:171], v[208:223]
    ds_read_b128 v[236:239], v248 offset:64512
    s_waitcnt lgkmcnt(4)
    v_mfma_f32_32x32x16_bf16 v[208:223], v[244:247], v[172:175], v[208:223]
    s_waitcnt lgkmcnt(3)
    v_mfma_f32_32x32x16_bf16 v[208:223], v[224:227], v[176:179], v[208:223]
    s_waitcnt lgkmcnt(2)
    v_mfma_f32_32x32x16_bf16 v[208:223], v[228:231], v[180:183], v[208:223]
    s_waitcnt lgkmcnt(1)
    v_mfma_f32_32x32x16_bf16 v[208:223], v[232:235], v[184:187], v[208:223]
    s_waitcnt lgkmcnt(0)
    v_mfma_f32_32x32x16_bf16 v[208:223], v[236:239], v[188:191], v[208:223]
    ds_read_b128 v[224:227], v248 offset:0
    ds_read_b128 v[228:231], v248 offset:1024
    ds_read_b128 v[232:235], v248 offset:2048
    ds_read_b128 v[236:239], v248 offset:3072
    ds_read_b128 v[240:243], v248 offset:4096
    ds_read_b128 v[244:247], v248 offset:5120
    v_mov_b32 v250, 0
    s_mov_b32 s35, 1
    s_nop 7
    v_fma_f32 v208, v208, s24, -v250
    v_fma_f32 v209, v209, s24, -v250
    v_fma_f32 v210, v210, s24, -v250
    v_fma_f32 v211, v211, s24, -v250
    v_fma_f32 v212, v212, s24, -v250
    v_fma_f32 v213, v213, s24, -v250
    v_fma_f32 v214, v214, s24, -v250
    v_fma_f32 v215, v215, s24, -v250
    v_fma_f32 v216, v216, s24, -v250
    v_fma_f32 v217, v217, s24, -v250
    v_fma_f32 v218, v218, s24, -v250
    v_fma_f32 v219, v219, s24, -v250
    v_fma_f32 v220, v220, s24, -v250
    v_fma_f32 v221, v221, s24, -v250
    v_fma_f32 v222, v222, s24, -v250
    v_fma_f32 v223, v223, s24, -v250
    s_call_b64 s[38:39], K2_SLOW1
    s_branch K2_STEP3
K2_STEP0:
    s_cmp_ge_u32 s17, s14
    s_cbranch_scc1 K2_SEG_END
    s_cmp_eq_u32 s17, s44
    s_cbranch_scc1 K2_FLAG0
K2_FLAGBACK0:
    s_barrier
    s_cmp_ge_i32 s17, s33
    s_cbranch_scc1 K2_LAST0
    s_waitcnt lgkmcnt(4)
    v_mfma_f32_32x32x16_bf16 v[208:223], v[224:227], v[128:131], 0
    ds_read_b128 v[224:227], v248 offset:22528
    v_exp_f32 v192, v192
    v_exp_f32 v193, v193
    v_mfma_f32_32x32x16_bf16 v[208:223], v[228:231], v[132:135], v[208:223]
    ds_read_b128 v[228:231], v248 offset:23552
    v_exp_f32 v194, v194
    v_add_f32 v251, v251, v192
    v_exp_f32 v195, v195
    s_waitcnt lgkmcnt(4)
    v_mfma_f32_32x32x16_bf16 v[208:223], v[232:235], v[136:139], v[208:223]
    ds_read_b128 v[232:235], v248 offset:24576
    v_add_f32 v251, v251, v193
    v_cvt_pk_bf16_f32 v192, v192, v193
    v_exp_f32 v196, v196
    v_mfma_f32_32x32x16_bf16 v[208:223], v[236:239], v[140:143], v[208:223]
    ds_read_b128 v[236:239], v248 offset:25600
    v_add_f32 v251, v251, v194
    v_exp_f32 v197, v197
    s_waitcnt lgkmcnt(4)
    v_mfma_f32_32x32x16_bf16 v[208:223], v[240:243], v[144:147], v[208:223]
    ds_read_b128 v[240:243], v248 offset:26624
    v_add_f32 v251, v251, v195
    v_cvt_pk_bf16_f32 v193, v194, v195
    v_exp_f32 v198, v198
    v_mfma_f32_32x32x16_bf16 v[208:223], v[244:247], v[148:151], v[208:223]
    ds_read_b128 v[244:247], v248 offset:27648
    v_add_f32 v251, v251, v196
    v_exp_f32 v199, v199
    v_add_f32 v251, v251, v197
    s_waitcnt lgkmcnt(4)
    v_mfma_f32_32x32x16_bf16 v[208:223], v[224:227], v[152:155], v[208:223]
    ds_read_b128 v[224:227], v248 offset:28672
    v_cvt_pk_bf16_f32 v194, v196, v197
    v_exp_f32 v200, v200
    v_mfma_f32_32x32x16_bf16 v[208:223], v[228:231], v[156:159], v[208:223]
    ds_read_b128 v[228:231], v248 offset:29696
    v_add_f32 v251, v251, v198
    v_exp_f32 v201, v201
    v_add_f32 v251, v251, v199
    s_waitcnt lgkmcnt(4)
    v_mfma_f32_32x32x16_bf16 v[208:223], v[232:235], v[160:163], v[208:223]
    ds_read_b128 v[232:235], v248 offset:30720
    v_cvt_pk_bf16_f32 v195, v198, v199
    v_exp_f32 v202, v202
    v_add_f32 v251, v251, v200
    v_mfma_f32_32x32x16_bf16 v[208:223], v[236:239], v[164:167], v[208:223]
    ds_read_b128 v[236:239], v248 offset:31744
    v_exp_f32 v203, v203
    v_add_f32 v251, v251, v201
    s_waitcnt lgkmcnt(4)
    v_mfma_f32_32x32x16_bf16 v[208:223], v[240:243], v[168:171], v[208:223]
    ds_read_b128 v[240:243], v249 offset:0
    v_cvt_pk_bf16_f32 v196, v200, v201
    v_exp_f32 v204, v204
    v_add_f32 v251, v251, v202
    v_mfma_f32_32x32x16_bf16 v[208:223], v[244:247], v[172:175], v[208:223]
    v_exp_f32 v205, v205
    v_add_f32 v251, v251, v203
    v_cvt_pk_bf16_f32 v197, v202, v203
    s_waitcnt lgkmcnt(3)
    v_mfma_f32_32x32x16_bf16 v[208:223], v[224:227], v[176:179], v[208:223]
    ds_read_b128 v[224:227], v249 offset:1024
    v_exp_f32 v206, v206
    v_add_f32 v251, v251, v204
    v_mfma_f32_32x32x16_bf16 v[208:223], v[228:231], v[180:183], v[208:223]
    ds_read_b128 v[228:231], v249 offset:2048
    v_exp_f32 v207, v207
    v_add_f32 v251, v251, v205
    v_cvt_pk_bf16_f32 v198, v204, v205
    s_waitcnt lgkmcnt(3)
    v_mfma_f32_32x32x16_bf16 v[208:223], v[232:235], v[184:187], v[208:223]
    ds_read_b128 v[232:235], v249 offset:3072
    v_add_f32 v251, v251, v206
    v_add_f32 v251, v251, v207
    v_cvt_pk_bf16_f32 v199, v206, v207
    v_mfma_f32_32x32x16_bf16 v[208:223], v[236:239], v[188:191], v[208:223]
    ds_read_b128 v[236:239], v249 offset:4096
    s_waitcnt lgkmcnt(3)
    v_mfma_f32_32x32x16_bf16 v[0:15], v[240:243], v[192:195], v[0:15]
    ds_read_b128 v[240:243], v249 offset:5120
    v_mfma_f32_32x32x16_bf16 v[0:15], v[224:227], v[196:199], v[0:15]
    ds_read_b128 v[224:227], v249 offset:6144
    s_waitcnt lgkmcnt(3)
    v_mfma_f32_32x32x16_bf16 v[16:31], v[228:231], v[192:195], v[16:31]
    ds_read_b128 v[228:231], v249 offset:7168
    v_mfma_f32_32x32x16_bf16 v[16:31], v[232:235], v[196:199], v[16:31]
    ds_read_b128 v[232:235], v249 offset:8192
    s_waitcnt lgkmcnt(3)
    v_mfma_f32_32x32x16_bf16 v[32:47], v[236:239], v[192:195], v[32:47]
    ds_read_b128 v[236:239], v249 offset:9216
    v_fma_f32 v208, v208, s24, -v250
    v_fma_f32 v209, v209, s24, -v250
    v_mfma_f32_32x32x16_bf16 v[32:47], v[240:243], v[196:199], v[32:47]
    ds_read_b128 v[240:243], v249 offset:10240
    v_fma_f32 v210, v210, s24, -v250
    v_fma_f32 v211, v211, s24, -v250
    s_waitcnt lgkmcnt(3)
    v_mfma_f32_32x32x16_bf16 v[48:63], v[224:227], v[192:195], v[48:63]
    ds_read_b128 v[224:227], v249 offset:11264
    v_max3_f32 v253, v208, v209, v210
    v_fma_f32 v212, v212, s24, -v250
    v_mfma_f32_32x32x16_bf16 v[48:63], v[228:231], v[196:199], v[48:63]
    ds_read_b128 v[228:231], v249 offset:12288
    v_fma_f32 v213, v213, s24, -v250
    v_max3_f32 v253, v253, v211, v212
    v_fma_f32 v214, v214, s24, -v250
    s_waitcnt lgkmcnt(3)
    v_mfma_f32_32x32x16_bf16 v[64:79], v[232:235], v[192:195], v[64:79]
    ds_read_b128 v[232:235], v249 offset:13312
    v_fma_f32 v215, v215, s24, -v250
    v_max3_f32 v253, v253, v213, v214
    v_mfma_f32_32x32x16_bf16 v[64:79], v[236:239], v[196:199], v[64:79]
    ds_read_b128 v[236:239], v249 offset:14336
    v_fma_f32 v216, v216, s24, -v250
    v_fma_f32 v217, v217, s24, -v250
    s_waitcnt lgkmcnt(3)
    v_mfma_f32_32x32x16_bf16 v[80:95], v[240:243], v[192:195], v[80:95]
    ds_read_b128 v[240:243], v249 offset:15360
    v_max3_f32 v253, v253, v215, v216
    v_fma_f32 v218, v218, s24, -v250
    v_mfma_f32_32x32x16_bf16 v[80:95], v[224:227], v[196:199], v[80:95]
    ds_read_b128 v[224:227], v248 offset:32768
    v_fma_f32 v219, v219, s24, -v250
    v_max3_f32 v253, v253, v217, v218
    v_fma_f32 v220, v220, s24, -v250
    s_waitcnt lgkmcnt(3)
    v_mfma_f32_32x32x16_bf16 v[96:111], v[228:231], v[192:195], v[96:111]
    ds_read_b128 v[228:231], v248 offset:33792
    v_fma_f32 v221, v221, s24, -v250
    v_max3_f32 v253, v253, v219, v220
    v_mfma_f32_32x32x16_bf16 v[96:111], v[232:235], v[196:199], v[96:111]
    ds_read_b128 v[232:235], v248 offset:34816
    v_fma_f32 v222, v222, s24, -v250
    v_fma_f32 v223, v223, s24, -v250
    s_add_u32 s17, s17, 1
    s_add_u32 s23, s23, 1
    s_waitcnt lgkmcnt(3)
    v_mfma_f32_32x32x16_bf16 v[112:127], v[236:239], v[192:195], v[112:127]
    ds_read_b128 v[236:239], v248 offset:35840
    v_max3_f32 v253, v253, v221, v222
    v_max_f32 v253, v253, v223
    v_cmp_lt_f32 vcc, s25, v253
    s_cmp_eq_u32 s17, s16
    v_mfma_f32_32x32x16_bf16 v[112:127], v[240:243], v[196:199], v[112:127]
    ds_read_b128 v[240:243], v248 offset:36864
    ds_read_b128 v[244:247], v248 offset:37888
    s_cbranch_vccnz K2_TOSLOW0
    s_cbranch_scc1 K2_TOSLOW0
K2_STEP1:
    s_cmp_ge_u32 s17, s14
    s_cbranch_scc1 K2_SEG_END
    s_cmp_eq_u32 s17, s44
    s_cbranch_scc1 K2_FLAG1
K2_FLAGBACK1:
    s_barrier
    s_cmp_ge_i32 s17, s33
    s_cbranch_scc1 K2_LAST1
    s_waitcnt lgkmcnt(4)
    v_mfma_f32_32x32x16_bf16 v[192:207], v[224:227], v[128:131], 0
    ds_read_b128 v[224:227], v248 offset:38912
    v_exp_f32 v208, v208
    v_exp_f32 v209, v209
    v_mfma_f32_32x32x16_bf16 v[192:207], v[228:231], v[132:135], v[192:207]
    ds_read_b128 v[228:231], v248 offset:39936
    v_exp_f32 v210, v210
    v_add_f32 v251, v251, v208
    v_exp_f32 v211, v211
    s_waitcnt lgkmcnt(4)
    v_mfma_f32_32x32x16_bf16 v[192:207], v[232:235], v[136:139], v[192:207]
    ds_read_b128 v[232:235], v248 offset:40960
    v_add_f32 v251, v251, v209
    v_cvt_pk_bf16_f32 v208, v208, v209
    v_exp_f32 v212, v212
    v_mfma_f32_32x32x16_bf16 v[192:207], v[236:239], v[140:143], v[192:207]
    ds_read_b128 v[236:239], v248 offset:41984
    v_add_f32 v251, v251, v210
    v_exp_f32 v213, v213
    s_waitcnt lgkmcnt(4)
    v_mfma_f32_32x32x16_bf16 v[192:207], v[240:243], v[144:147], v[192:207]
    ds_read_b128 v[240:243], v248 offset:43008
    v_add_f32 v251, v251, v211
    v_cvt_pk_bf16_f32 v209, v210, v211
    v_exp_f32 v214, v214
    v_mfma_f32_32x32x16_bf16 v[192:207], v[244:247], v[148:151], v[192:207]
    ds_read_b128 v[244:247], v248 offset:44032
    v_add_f32 v251, v251, v212
    v_exp_f32 v215, v215
    v_add_f32 v251, v251, v213
    s_waitcnt lgkmcnt(4)
    v_mfma_f32_32x32x16_bf16 v[192:207], v[224:227], v[152:155], v[192:207]
    ds_read_b128 v[224:227], v248 offset:45056
    v_cvt_pk_bf16_f32 v210, v212, v213
    v_exp_f32 v216, v216
    v_mfma_f32_32x32x16_bf16 v[192:207], v[228:231], v[156:159], v[192:207]
    ds_read_b128 v[228:231], v248 offset:46080
    v_add_f32 v251, v251, v214
    v_exp_f32 v217, v217
    v_add_f32 v251, v251, v215
    s_waitcnt lgkmcnt(4)
    v_mfma_f32_32x32x16_bf16 v[192:207], v[232:235], v[160:163], v[192:207]
    ds_read_b128 v[232:235], v248 offset:47104
    v_cvt_pk_bf16_f32 v211, v214, v215
    v_exp_f32 v218, v218
    v_add_f32 v251, v251, v216
    v_mfma_f32_32x32x16_bf16 v[192:207], v[236:239], v[164:167], v[192:207]
    ds_read_b128 v[236:239], v248 offset:48128
    v_exp_f32 v219, v219
    v_add_f32 v251, v251, v217
    s_waitcnt lgkmcnt(4)
    v_mfma_f32_32x32x16_bf16 v[192:207], v[240:243], v[168:171], v[192:207]
    ds_read_b128 v[240:243], v249 offset:16384
    v_cvt_pk_bf16_f32 v212, v216, v217
    v_exp_f32 v220, v220
    v_add_f32 v251, v251, v218
    v_mfma_f32_32x32x16_bf16 v[192:207], v[244:247], v[172:175], v[192:207]
    v_exp_f32 v221, v221
    v_add_f32 v251, v251, v219
    v_cvt_pk_bf16_f32 v213, v218, v219
    s_waitcnt lgkmcnt(3)
    v_mfma_f32_32x32x16_bf16 v[192:207], v[224:227], v[176:179], v[192:207]
    ds_read_b128 v[224:227], v249 offset:17408
    v_exp_f32 v222, v222
    v_add_f32 v251, v251, v220
    v_mfma_f32_32x32x16_bf16 v[192:207], v[228:231], v[180:183], v[192:207]
    ds_read_b128 v[228:231], v249 offset:18432
    v_exp_f32 v223, v223
    v_add_f32 v251, v251, v221
    v_cvt_pk_bf16_f32 v214, v220, v221
    s_waitcnt lgkmcnt(3)
    v_mfma_f32_32x32x16_bf16 v[192:207], v[232:235], v[184:187], v[192:207]
    ds_read_b128 v[232:235], v249 offset:19456
    v_add_f32 v251, v251, v222
    v_add_f32 v251, v251, v223
    v_cvt_pk_bf16_f32 v215, v222, v223
    v_mfma_f32_32x32x16_bf16 v[192:207], v[236:239], v[188:191], v[192:207]
    ds_read_b128 v[236:239], v249 offset:20480
    s_waitcnt lgkmcnt(3)
    v_mfma_f32_32x32x16_bf16 v[0:15], v[240:243], v[208:211], v[0:15]
    ds_read_b128 v[240:243], v249 offset:21504
    v_mfma_f32_32x32x16_bf16 v[0:15], v[224:227], v[212:215], v[0:15]
    ds_read_b128 v[224:227], v249 offset:22528
    s_waitcnt lgkmcnt(3)
    v_mfma_f32_32x32x16_bf16 v[16:31], v[228:231], v[208:211], v[16:31]
    ds_read_b128 v[228:231], v249 offset:23552
    v_mfma_f32_32x32x16_bf16 v[16:31], v[232:235], v[212:215], v[16:31]
    ds_read_b128 v[232:235], v249 offset:24576
    s_waitcnt lgkmcnt(3)
    v_mfma_f32_32x32x16_bf16 v[32:47], v[236:239], v[208:211], v[32:47]
    ds_read_b128 v[236:239], v249 offset:25600
    v_fma_f32 v192, v192, s24, -v250
    v_fma_f32 v193, v193, s24, -v250
    v_mfma_f32_32x32x16_bf16 v[32:47], v[240:243], v[212:215], v[32:47]
    ds_read_b128 v[240:243], v249 offset:26624
    v_fma_f32 v194, v194, s24, -v250
    v_fma_f32 v195, v195, s24, -v250
    s_waitcnt lgkmcnt(3)
    v_mfma_f32_32x32x16_bf16 v[48:63], v[224:227], v[208:211], v[48:63]
    ds_read_b128 v[224:227], v249 offset:27648
    v_max3_f32 v253, v192, v193, v194
    v_fma_f32 v196, v196, s24, -v250
    v_mfma_f32_32x32x16_bf16 v[48:63], v[228:231], v[212:215], v[48:63]
    ds_read_b128 v[228:231], v249 offset:28672
    v_fma_f32 v197, v197, s24, -v250
    v_max3_f32 v253, v253, v195, v196
    v_fma_f32 v198, v198, s24, -v250
    s_waitcnt lgkmcnt(3)
    v_mfma_f32_32x32x16_bf16 v[64:79], v[232:235], v[208:211], v[64:79]
    ds_read_b128 v[232:235], v249 offset:29696
    v_fma_f32 v199, v199, s24, -v250
    v_max3_f32 v253, v253, v197, v198
    v_mfma_f32_32x32x16_bf16 v[64:79], v[236:239], v[212:215], v[64:79]
    ds_read_b128 v[236:239], v249 offset:30720
    v_fma_f32 v200, v200, s24, -v250
    v_fma_f32 v201, v201, s24, -v250
    s_waitcnt lgkmcnt(3)
    v_mfma_f32_32x32x16_bf16 v[80:95], v[240:243], v[208:211], v[80:95]
    ds_read_b128 v[240:243], v249 offset:31744
    v_max3_f32 v253, v253, v199, v200
    v_fma_f32 v202, v202, s24, -v250
    v_mfma_f32_32x32x16_bf16 v[80:95], v[224:227], v[212:215], v[80:95]
    ds_read_b128 v[224:227], v248 offset:49152
    v_fma_f32 v203, v203, s24, -v250
    v_max3_f32 v253, v253, v201, v202
    v_fma_f32 v204, v204, s24, -v250
    s_waitcnt lgkmcnt(3)
    v_mfma_f32_32x32x16_bf16 v[96:111], v[228:231], v[208:211], v[96:111]
    ds_read_b128 v[228:231], v248 offset:50176
    v_fma_f32 v205, v205, s24, -v250
    v_max3_f32 v253, v253, v203, v204
    v_mfma_f32_32x32x16_bf16 v[96:111], v[232:235], v[212:215], v[96:111]
    ds_read_b128 v[232:235], v248 offset:51200
    v_fma_f32 v206, v206, s24, -v250
    v_fma_f32 v207, v207, s24, -v250
    s_add_u32 s17, s17, 1
    s_add_u32 s23, s23, 1
    s_waitcnt lgkmcnt(3)
    v_mfma_f32_32x32x16_bf16 v[112:127], v[236:239], v[208:211], v[112:127]
    ds_read_b128 v[236:239], v248 offset:52224
    v_max3_f32 v253, v253, v205, v206
    v_max_f32 v253, v253, v207
    v_cmp_lt_f32 vcc, s25, v253
    s_cmp_eq_u32 s17, s16
    v_mfma_f32_32x32x16_bf16 v[112:127], v[240:243], v[212:215], v[112:127]
    ds_read_b128 v[240:243], v248 offset:53248
    ds_read_b128 v[244:247], v248 offset:54272
    s_cbranch_vccnz K2_TOSLOW1
    s_cbranch_scc1 K2_TOSLOW1
K2_STEP2:
    s_cmp_ge_u32 s17, s14
    s_cbranch_scc1 K2_SEG_END
    s_cmp_eq_u32 s17, s44
    s_cbranch_scc1 K2_FLAG2
K2_FLAGBACK2:
    s_barrier
    s_cmp_ge_i32 s17, s33
    s_cbranch_scc1 K2_LAST2
    s_waitcnt lgkmcnt(4)
    v_mfma_f32_32x32x16_bf16 v[208:223], v[224:227], v[128:131], 0
    ds_read_b128 v[224:227], v248 offset:55296
    v_exp_f32 v192, v192
    v_exp_f32 v193, v193
    v_mfma_f32_32x32x16_bf16 v[208:223], v[228:231], v[132:135], v[208:223]
    ds_read_b128 v[228:231], v248 offset:56320
    v_exp_f32 v194, v194
    v_add_f32 v251, v251, v192
    v_exp_f32 v195, v195
    s_waitcnt lgkmcnt(4)
    v_mfma_f32_32x32x16_bf16 v[208:223], v[232:235], v[136:139], v[208:223]
    ds_read_b128 v[232:235], v248 offset:57344
    v_add_f32 v251, v251, v193
    v_cvt_pk_bf16_f32 v192, v192, v193
    v_exp_f32 v196, v196
    v_mfma_f32_32x32x16_bf16 v[208:223], v[236:239], v[140:143], v[208:223]
    ds_read_b128 v[236:239], v248 offset:58368
    v_add_f32 v251, v251, v194
    v_exp_f32 v197, v197
    s_waitcnt lgkmcnt(4)
    v_mfma_f32_32x32x16_bf16 v[208:223], v[240:243], v[144:147], v[208:223]
    ds_read_b128 v[240:243], v248 offset:59392
    v_add_f32 v251, v251, v195
    v_cvt_pk_bf16_f32 v193, v194, v195
    v_exp_f32 v198, v198
    v_mfma_f32_32x32x16_bf16 v[208:223], v[244:247], v[148:151], v[208:223]
    ds_read_b128 v[244:247], v248 offset:60416
    v_add_f32 v251, v251, v196
    v_exp_f32 v199, v199
    v_add_f32 v251, v251, v197
    s_waitcnt lgkmcnt(4)
    v_mfma_f32_32x32x16_bf16 v[208:223], v[224:227], v[152:155], v[208:223]
    ds_read_b128 v[224:227], v248 offset:61440
    v_cvt_pk_bf16_f32 v194, v196, v197
    v_exp_f32 v200, v200
    v_mfma_f32_32x32x16_bf16 v[208:223], v[228:231], v[156:159], v[208:223]
    ds_read_b128 v[228:231], v248 offset:62464
    v_add_f32 v251, v251, v198
    v_exp_f32 v201, v201
    v_add_f32 v251, v251, v199
    s_waitcnt lgkmcnt(4)
    v_mfma_f32_32x32x16_bf16 v[208:223], v[232:235], v[160:163], v[208:223]
    ds_read_b128 v[232:235], v248 offset:63488
    v_cvt_pk_bf16_f32 v195, v198, v199
    v_exp_f32 v202, v202
    v_add_f32 v251, v251, v200
    v_mfma_f32_32x32x16_bf16 v[208:223], v[236:239], v[164:167], v[208:223]
    ds_read_b128 v[236:239], v248 offset:64512
    v_exp_f32 v203, v203
    v_add_f32 v251, v251, v201
    s_waitcnt lgkmcnt(4)
    v_mfma_f32_32x32x16_bf16 v[208:223], v[240:243], v[168:171], v[208:223]
    ds_read_b128 v[240:243], v249 offset:32768
    v_cvt_pk_bf16_f32 v196, v200, v201
    v_exp_f32 v204, v204
    v_add_f32 v251, v251, v202
    v_mfma_f32_32x32x16_bf16 v[208:223], v[244:247], v[172:175], v[208:223]
    v_exp_f32 v205, v205
    v_add_f32 v251, v251, v203
    v_cvt_pk_bf16_f32 v197, v202, v203
    s_waitcnt lgkmcnt(3)
    v_mfma_f32_32x32x16_bf16 v[208:223], v[224:227], v[176:179], v[208:223]
    ds_read_b128 v[224:227], v249 offset:33792
    v_exp_f32 v206, v206
    v_add_f32 v251, v251, v204
    v_mfma_f32_32x32x16_bf16 v[208:223], v[228:231], v[180:183], v[208:223]
    ds_read_b128 v[228:231], v249 offset:34816
    v_exp_f32 v207, v207
    v_add_f32 v251, v251, v205
    v_cvt_pk_bf16_f32 v198, v204, v205
    s_waitcnt lgkmcnt(3)
    v_mfma_f32_32x32x16_bf16 v[208:223], v[232:235], v[184:187], v[208:223]
    ds_read_b128 v[232:235], v249 offset:35840
    v_add_f32 v251, v251, v206
    v_add_f32 v251, v251, v207
    v_cvt_pk_bf16_f32 v199, v206, v207
    v_mfma_f32_32x32x16_bf16 v[208:223], v[236:239], v[188:191], v[208:223]
    ds_read_b128 v[236:239], v249 offset:36864
    s_waitcnt lgkmcnt(3)
    v_mfma_f32_32x32x16_bf16 v[0:15], v[240:243], v[192:195], v[0:15]
    ds_read_b128 v[240:243], v249 offset:37888
    v_mfma_f32_32x32x16_bf16 v[0:15], v[224:227], v[196:199], v[0:15]
    ds_read_b128 v[224:227], v249 offset:38912
    s_waitcnt lgkmcnt(3)
    v_mfma_f32_32x32x16_bf16 v[16:31], v[228:231], v[192:195], v[16:31]
    ds_read_b128 v[228:231], v249 offset:39936
    v_mfma_f32_32x32x16_bf16 v[16:31], v[232:235], v[196:199], v[16:31]
    ds_read_b128 v[232:235], v249 offset:40960
    s_waitcnt lgkmcnt(3)
    v_mfma_f32_32x32x16_bf16 v[32:47], v[236:239], v[192:195], v[32:47]
    ds_read_b128 v[236:239], v249 offset:41984
    v_fma_f32 v208, v208, s24, -v250
    v_fma_f32 v209, v209, s24, -v250
    v_mfma_f32_32x32x16_bf16 v[32:47], v[240:243], v[196:199], v[32:47]
    ds_read_b128 v[240:243], v249 offset:43008
    v_fma_f32 v210, v210, s24, -v250
    v_fma_f32 v211, v211, s24, -v250
    s_waitcnt lgkmcnt(3)
    v_mfma_f32_32x32x16_bf16 v[48:63], v[224:227], v[192:195], v[48:63]
    ds_read_b128 v[224:227], v249 offset:44032
    v_max3_f32 v253, v208, v209, v210
    v_fma_f32 v212, v212, s24, -v250
    v_mfma_f32_32x32x16_bf16 v[48:63], v[228:231], v[196:199], v[48:63]
    ds_read_b128 v[228:231], v249 offset:45056
    v_fma_f32 v213, v213, s24, -v250
    v_max3_f32 v253, v253, v211, v212
    v_fma_f32 v214, v214, s24, -v250
    s_waitcnt lgkmcnt(3)
    v_mfma_f32_32x32x16_bf16 v[64:79], v[232:235], v[192:195], v[64:79]
    ds_read_b128 v[232:235], v249 offset:46080
    v_fma_f32 v215, v215, s24, -v250
    v_max3_f32 v253, v253, v213, v214
    v_mfma_f32_32x32x16_bf16 v[64:79], v[236:239], v[196:199], v[64:79]
    ds_read_b128 v[236:239], v249 offset:47104
    v_fma_f32 v216, v216, s24, -v250
    v_fma_f32 v217, v217, s24, -v250
    s_waitcnt lgkmcnt(3)
    v_mfma_f32_32x32x16_bf16 v[80:95], v[240:243], v[192:195], v[80:95]
    ds_read_b128 v[240:243], v249 offset:48128
    v_max3_f32 v253, v253, v215, v216
    v_fma_f32 v218, v218, s24, -v250
    v_mfma_f32_32x32x16_bf16 v[80:95], v[224:227], v[196:199], v[80:95]
    ds_read_b128 v[224:227], v248 offset:0
    v_fma_f32 v219, v219, s24, -v250
    v_max3_f32 v253, v253, v217, v218
    v_fma_f32 v220, v220, s24, -v250
    s_waitcnt lgkmcnt(3)
    v_mfma_f32_32x32x16_bf16 v[96:111], v[228:231], v[192:195], v[96:111]
    ds_read_b128 v[228:231], v248 offset:1024
    v_fma_f32 v221, v221, s24, -v250
    v_max3_f32 v253, v253, v219, v220
    v_mfma_f32_32x32x16_bf16 v[96:111], v[232:235], v[196:199], v[96:111]
    ds_read_b128 v[232:235], v248 offset:2048
    v_fma_f32 v222, v222, s24, -v250
    v_fma_f32 v223, v223, s24, -v250
    s_add_u32 s17, s17, 1
    s_add_u32 s23, s23, 1
    s_waitcnt lgkmcnt(3)
    v_mfma_f32_32x32x16_bf16 v[112:127], v[236:239], v[192:195], v[112:127]
    ds_read_b128 v[236:239], v248 offset:3072
    v_max3_f32 v253, v253, v221, v222
    v_max_f32 v253, v253, v223
    v_cmp_lt_f32 vcc, s25, v253
    s_cmp_eq_u32 s17, s16
    v_mfma_f32_32x32x16_bf16 v[112:127], v[240:243], v[196:199], v[112:127]
    ds_read_b128 v[240:243], v248 offset:4096
    ds_read_b128 v[244:247], v248 offset:5120
    s_cbranch_vccnz K2_TOSLOW2
    s_cbranch_scc1 K2_TOSLOW2
K2_STEP3:
    s_cmp_ge_u32 s17, s14
    s_cbranch_scc1 K2_SEG_END
    s_cmp_eq_u32 s17, s44
    s_cbranch_scc1 K2_FLAG3
K2_FLAGBACK3:
    s_barrier
    s_cmp_ge_i32 s17, s33
    s_cbranch_scc1 K2_LAST3
    s_waitcnt lgkmcnt(4)
    v_mfma_f32_32x32x16_bf16 v[192:207], v[224:227], v[128:131], 0
    ds_read_b128 v[224:227], v248 offset:6144
    v_exp_f32 v208, v208
    v_exp_f32 v209, v209
    v_mfma_f32_32x32x16_bf16 v[192:207], v[228:231], v[132:135], v[192:207]
    ds_read_b128 v[228:231], v248 offset:7168
    v_exp_f32 v210, v210
    v_add_f32 v251, v251, v208
    v_exp_f32 v211, v211
    s_waitcnt lgkmcnt(4)
    v_mfma_f32_32x32x16_bf16 v[192:207], v[232:235], v[136:139], v[192:207]
    ds_read_b128 v[232:235], v248 offset:8192
    v_add_f32 v251, v251, v209
    v_cvt_pk_bf16_f32 v208, v208, v209
    v_exp_f32 v212, v212
    v_mfma_f32_32x32x16_bf16 v[192:207], v[236:239], v[140:143], v[192:207]
    ds_read_b128 v[236:239], v248 offset:9216
    v_add_f32 v251, v251, v210
    v_exp_f32 v213, v213
    s_waitcnt lgkmcnt(4)
    v_mfma_f32_32x32x16_bf16 v[192:207], v[240:243], v[144:147], v[192:207]
    ds_read_b128 v[240:243], v248 offset:10240
    v_add_f32 v251, v251, v211
    v_cvt_pk_bf16_f32 v209, v210, v211
    v_exp_f32 v214, v214
    v_mfma_f32_32x32x16_bf16 v[192:207], v[244:247], v[148:151], v[192:207]
    ds_read_b128 v[244:247], v248 offset:11264
    v_add_f32 v251, v251, v212
    v_exp_f32 v215, v215
    v_add_f32 v251, v251, v213
    s_waitcnt lgkmcnt(4)
    v_mfma_f32_32x32x16_bf16 v[192:207], v[224:227], v[152:155], v[192:207]
    ds_read_b128 v[224:227], v248 offset:12288
    v_cvt_pk_bf16_f32 v210, v212, v213
    v_exp_f32 v216, v216
    v_mfma_f32_32x32x16_bf16 v[192:207], v[228:231], v[156:159], v[192:207]
    ds_read_b128 v[228:231], v248 offset:13312
    v_add_f32 v251, v251, v214
    v_exp_f32 v217, v217
    v_add_f32 v251, v251, v215
    s_waitcnt lgkmcnt(4)
    v_mfma_f32_32x32x16_bf16 v[192:207], v[232:235], v[160:163], v[192:207]
    ds_read_b128 v[232:235], v248 offset:14336
    v_cvt_pk_bf16_f32 v211, v214, v215
    v_exp_f32 v218, v218
    v_add_f32 v251, v251, v216
    v_mfma_f32_32x32x16_bf16 v[192:207], v[236:239], v[164:167], v[192:207]
    ds_read_b128 v[236:239], v248 offset:15360
    v_exp_f32 v219, v219
    v_add_f32 v251, v251, v217
    s_waitcnt lgkmcnt(4)
    v_mfma_f32_32x32x16_bf16 v[192:207], v[240:243], v[168:171], v[192:207]
    ds_read_b128 v[240:243], v249 offset:49152
    v_cvt_pk_bf16_f32 v212, v216, v217
    v_exp_f32 v220, v220
    v_add_f32 v251, v251, v218
    v_mfma_f32_32x32x16_bf16 v[192:207], v[244:247], v[172:175], v[192:207]
    v_exp_f32 v221, v221
    v_add_f32 v251, v251, v219
    v_cvt_pk_bf16_f32 v213, v218, v219
    s_waitcnt lgkmcnt(3)
    v_mfma_f32_32x32x16_bf16 v[192:207], v[224:227], v[176:179], v[192:207]
    ds_read_b128 v[224:227], v249 offset:50176
    v_exp_f32 v222, v222
    v_add_f32 v251, v251, v220
    v_mfma_f32_32x32x16_bf16 v[192:207], v[228:231], v[180:183], v[192:207]
    ds_read_b128 v[228:231], v249 offset:51200
    v_exp_f32 v223, v223
    v_add_f32 v251, v251, v221
    v_cvt_pk_bf16_f32 v214, v220, v221
    s_waitcnt lgkmcnt(3)
    v_mfma_f32_32x32x16_bf16 v[192:207], v[232:235], v[184:187], v[192:207]
    ds_read_b128 v[232:235], v249 offset:52224
    v_add_f32 v251, v251, v222
    v_add_f32 v251, v251, v223
    v_cvt_pk_bf16_f32 v215, v222, v223
    v_mfma_f32_32x32x16_bf16 v[192:207], v[236:239], v[188:191], v[192:207]
    ds_read_b128 v[236:239], v249 offset:53248
    s_waitcnt lgkmcnt(3)
    v_mfma_f32_32x32x16_bf16 v[0:15], v[240:243], v[208:211], v[0:15]
    ds_read_b128 v[240:243], v249 offset:54272
    v_mfma_f32_32x32x16_bf16 v[0:15], v[224:227], v[212:215], v[0:15]
    ds_read_b128 v[224:227], v249 offset:55296
    s_waitcnt lgkmcnt(3)
    v_mfma_f32_32x32x16_bf16 v[16:31], v[228:231], v[208:211], v[16:31]
    ds_read_b128 v[228:231], v249 offset:56320
    v_mfma_f32_32x32x16_bf16 v[16:31], v[232:235], v[212:215], v[16:31]
    ds_read_b128 v[232:235], v249 offset:57344
    s_waitcnt lgkmcnt(3)
    v_mfma_f32_32x32x16_bf16 v[32:47], v[236:239], v[208:211], v[32:47]
    ds_read_b128 v[236:239], v249 offset:58368
    v_fma_f32 v192, v192, s24, -v250
    v_fma_f32 v193, v193, s24, -v250
    v_mfma_f32_32x32x16_bf16 v[32:47], v[240:243], v[212:215], v[32:47]
    ds_read_b128 v[240:243], v249 offset:59392
    v_fma_f32 v194, v194, s24, -v250
    v_fma_f32 v195, v195, s24, -v250
    s_waitcnt lgkmcnt(3)
    v_mfma_f32_32x32x16_bf16 v[48:63], v[224:227], v[208:211], v[48:63]
    ds_read_b128 v[224:227], v249 offset:60416
    v_max3_f32 v253, v192, v193, v194
    v_fma_f32 v196, v196, s24, -v250
    v_mfma_f32_32x32x16_bf16 v[48:63], v[228:231], v[212:215], v[48:63]
    ds_read_b128 v[228:231], v249 offset:61440
    v_fma_f32 v197, v197, s24, -v250
    v_max3_f32 v253, v253, v195, v196
    v_fma_f32 v198, v198, s24, -v250
    s_waitcnt lgkmcnt(3)
    v_mfma_f32_32x32x16_bf16 v[64:79], v[232:235], v[208:211], v[64:79]
    ds_read_b128 v[232:235], v249 offset:62464
    v_fma_f32 v199, v199, s24, -v250
    v_max3_f32 v253, v253, v197, v198
    v_mfma_f32_32x32x16_bf16 v[64:79], v[236:239], v[212:215], v[64:79]
    ds_read_b128 v[236:239], v249 offset:63488
    v_fma_f32 v200, v200, s24, -v250
    v_fma_f32 v201, v201, s24, -v250
    s_waitcnt lgkmcnt(3)
    v_mfma_f32_32x32x16_bf16 v[80:95], v[240:243], v[208:211], v[80:95]
    ds_read_b128 v[240:243], v249 offset:64512
    v_max3_f32 v253, v253, v199, v200
    v_fma_f32 v202, v202, s24, -v250
    v_mfma_f32_32x32x16_bf16 v[80:95], v[224:227], v[212:215], v[80:95]
    ds_read_b128 v[224:227], v248 offset:16384
    v_fma_f32 v203, v203, s24, -v250
    v_max3_f32 v253, v253, v201, v202
    v_fma_f32 v204, v204, s24, -v250
    s_waitcnt lgkmcnt(3)
    v_mfma_f32_32x32x16_bf16 v[96:111], v[228:231], v[208:211], v[96:111]
    ds_read_b128 v[228:231], v248 offset:17408
    v_fma_f32 v205, v205, s24, -v250
    v_max3_f32 v253, v253, v203, v204
    v_mfma_f32_32x32x16_bf16 v[96:111], v[232:235], v[212:215], v[96:111]
    ds_read_b128 v[232:235], v248 offset:18432
    v_fma_f32 v206, v206, s24, -v250
    v_fma_f32 v207, v207, s24, -v250
    s_add_u32 s17, s17, 1
    s_add_u32 s23, s23, 1
    s_waitcnt lgkmcnt(3)
    v_mfma_f32_32x32x16_bf16 v[112:127], v[236:239], v[208:211], v[112:127]
    ds_read_b128 v[236:239], v248 offset:19456
    v_max3_f32 v253, v253, v205, v206
    v_max_f32 v253, v253, v207
    v_cmp_lt_f32 vcc, s25, v253
    s_cmp_eq_u32 s17, s16
    v_mfma_f32_32x32x16_bf16 v[112:127], v[240:243], v[212:215], v[112:127]
    ds_read_b128 v[240:243], v248 offset:20480
    ds_read_b128 v[244:247], v248 offset:21504
    s_cbranch_vccnz K2_TOSLOW3
    s_cbranch_scc1 K2_TOSLOW3
    s_branch K2_STEP0
K2_TOSLOW0:
    s_call_b64 s[38:39], K2_SLOW1
    s_branch K2_STEP1
K2_LAST0:
    s_cmp_gt_i32 s17, s33
    s_cbranch_scc1 K2_IDLE0
    v_bfe_u32 v254, v248, 4, 5
    v_lshlrev_b32 v254, 2, v254
    s_lshl_b32 s27, s16, 7
    s_add_u32 s27, s27, 0x4c02000
    buffer_load_dword v252, v254, s[4:7], s27 offen
    v_mov_b32 v255, 0
    buffer_load_dword v253, v255, s[4:7], s32 offen sc1
    s_waitcnt lgkmcnt(0)
    ds_read_b128 v[224:227], v249 offset:0
    ds_read_b128 v[228:231], v249 offset:1024
    ds_read_b128 v[232:235], v249 offset:2048
    ds_read_b128 v[236:239], v249 offset:3072
    ds_read_b128 v[240:243], v249 offset:4096
    v_exp_f32 v192, v192
    v_exp_f32 v193, v193
    v_exp_f32 v194, v194
    v_add_f32 v251, v251, v192
    v_exp_f32 v195, v195
    v_add_f32 v251, v251, v193
    v_cvt_pk_bf16_f32 v192, v192, v193
    v_exp_f32 v196, v196
    v_add_f32 v251, v251, v194
    v_exp_f32 v197, v197
    v_add_f32 v251, v251, v195
    v_cvt_pk_bf16_f32 v193, v194, v195
    v_exp_f32 v198, v198
    v_add_f32 v251, v251, v196
    v_exp_f32 v199, v199
    v_add_f32 v251, v251, v197
    v_cvt_pk_bf16_f32 v194, v196, v197
    v_exp_f32 v200, v200
    v_add_f32 v251, v251, v198
    v_exp_f32 v201, v201
    v_add_f32 v251, v251, v199
    v_cvt_pk_bf16_f32 v195, v198, v199
    v_exp_f32 v202, v202
    v_add_f32 v251, v251, v200
    v_exp_f32 v203, v203
    v_add_f32 v251, v251, v201
    v_cvt_pk_bf16_f32 v196, v200, v201
    v_exp_f32 v204, v204
    v_add_f32 v251, v251, v202
    v_exp_f32 v205, v205
    v_add_f32 v251, v251, v203
    v_cvt_pk_bf16_f32 v197, v202, v203
    v_exp_f32 v206, v206
    v_add_f32 v251, v251, v204
    v_exp_f32 v207, v207
    v_add_f32 v251, v251, v205
    v_cvt_pk_bf16_f32 v198, v204, v205
    v_add_f32 v251, v251, v206
    v_add_f32 v251, v251, v207
    v_cvt_pk_bf16_f32 v199, v206, v207
    s_nop 1
    s_waitcnt lgkmcnt(4)
    v_mfma_f32_32x32x16_bf16 v[0:15], v[224:227], v[192:195], v[0:15]
    ds_read_b128 v[244:247], v249 offset:5120
    s_waitcnt lgkmcnt(4)
    v_mfma_f32_32x32x16_bf16 v[0:15], v[228:231], v[196:199], v[0:15]
    ds_read_b128 v[224:227], v249 offset:6144
    s_waitcnt lgkmcnt(4)
    v_mfma_f32_32x32x16_bf16 v[16:31], v[232:235], v[192:195], v[16:31]
    ds_read_b128 v[228:231], v249 offset:7168
    s_waitcnt lgkmcnt(4)
    v_mfma_f32_32x32x16_bf16 v[16:31], v[236:239], v[196:199], v[16:31]
    ds_read_b128 v[232:235], v249 offset:8192
    s_waitcnt lgkmcnt(4)
    v_mfma_f32_32x32x16_bf16 v[32:47], v[240:243], v[192:195], v[32:47]
    ds_read_b128 v[236:239], v249 offset:9216
    s_waitcnt lgkmcnt(4)
    v_mfma_f32_32x32x16_bf16 v[32:47], v[244:247], v[196:199], v[32:47]
    ds_read_b128 v[240:243], v249 offset:10240
    s_waitcnt lgkmcnt(4)
    v_mfma_f32_32x32x16_bf16 v[48:63], v[224:227], v[192:195], v[48:63]
    ds_read_b128 v[244:247], v249 offset:11264
    s_waitcnt lgkmcnt(4)
    v_mfma_f32_32x32x16_bf16 v[48:63], v[228:231], v[196:199], v[48:63]
    ds_read_b128 v[224:227], v249 offset:12288
    s_waitcnt lgkmcnt(4)
    v_mfma_f32_32x32x16_bf16 v[64:79], v[232:235], v[192:195], v[64:79]
    ds_read_b128 v[228:231], v249 offset:13312
    s_waitcnt lgkmcnt(4)
    v_mfma_f32_32x32x16_bf16 v[64:79], v[236:239], v[196:199], v[64:79]
    ds_read_b128 v[232:235], v249 offset:14336
    s_waitcnt lgkmcnt(4)
    v_mfma_f32_32x32x16_bf16 v[80:95], v[240:243], v[192:195], v[80:95]
    ds_read_b128 v[236:239], v249 offset:15360
    s_waitcnt lgkmcnt(4)
    v_mfma_f32_32x32x16_bf16 v[80:95], v[244:247], v[196:199], v[80:95]
    s_waitcnt lgkmcnt(3)
    v_mfma_f32_32x32x16_bf16 v[96:111], v[224:227], v[192:195], v[96:111]
    s_waitcnt lgkmcnt(2)
    v_mfma_f32_32x32x16_bf16 v[96:111], v[228:231], v[196:199], v[96:111]
    s_waitcnt lgkmcnt(1)
    v_mfma_f32_32x32x16_bf16 v[112:127], v[232:235], v[192:195], v[112:127]
    s_waitcnt lgkmcnt(0)
    v_mfma_f32_32x32x16_bf16 v[112:127], v[236:239], v[196:199], v[112:127]
K2_IDLE0:
    s_add_u32 s17, s17, 1
    s_add_u32 s23, s23, 1
    s_branch K2_STEP1
K2_TOSLOW1:
    s_call_b64 s[38:39], K2_SLOW0
    s_branch K2_STEP2
K2_LAST1:
    s_cmp_gt_i32 s17, s33
    s_cbranch_scc1 K2_IDLE1
    v_bfe_u32 v254, v248, 4, 5
    v_lshlrev_b32 v254, 2, v254
    s_lshl_b32 s27, s16, 7
    s_add_u32 s27, s27, 0x4c02000
    buffer_load_dword v252, v254, s[4:7], s27 offen
    v_mov_b32 v255, 0
    buffer_load_dword v253, v255, s[4:7], s32 offen sc1
    s_waitcnt lgkmcnt(0)
    ds_read_b128 v[224:227], v249 offset:16384
    ds_read_b128 v[228:231], v249 offset:17408
    ds_read_b128 v[232:235], v249 offset:18432
    ds_read_b128 v[236:239], v249 offset:19456
    ds_read_b128 v[240:243], v249 offset:20480
    v_exp_f32 v208, v208
    v_exp_f32 v209, v209
    v_exp_f32 v210, v210
    v_add_f32 v251, v251, v208
    v_exp_f32 v211, v211
    v_add_f32 v251, v251, v209
    v_cvt_pk_bf16_f32 v208, v208, v209
    v_exp_f32 v212, v212
    v_add_f32 v251, v251, v210
    v_exp_f32 v213, v213
    v_add_f32 v251, v251, v211
    v_cvt_pk_bf16_f32 v209, v210, v211
    v_exp_f32 v214, v214
    v_add_f32 v251, v251, v212
    v_exp_f32 v215, v215
    v_add_f32 v251, v251, v213
    v_cvt_pk_bf16_f32 v210, v212, v213
    v_exp_f32 v216, v216
    v_add_f32 v251, v251, v214
    v_exp_f32 v217, v217
    v_add_f32 v251, v251, v215
    v_cvt_pk_bf16_f32 v211, v214, v215
    v_exp_f32 v218, v218
    v_add_f32 v251, v251, v216
    v_exp_f32 v219, v219
    v_add_f32 v251, v251, v217
    v_cvt_pk_bf16_f32 v212, v216, v217
    v_exp_f32 v220, v220
    v_add_f32 v251, v251, v218
    v_exp_f32 v221, v221
    v_add_f32 v251, v251, v219
    v_cvt_pk_bf16_f32 v213, v218, v219
    v_exp_f32 v222, v222
    v_add_f32 v251, v251, v220
    v_exp_f32 v223, v223
    v_add_f32 v251, v251, v221
    v_cvt_pk_bf16_f32 v214, v220, v221
    v_add_f32 v251, v251, v222
    v_add_f32 v251, v251, v223
    v_cvt_pk_bf16_f32 v215, v222, v223
    s_nop 1
    s_waitcnt lgkmcnt(4)
    v_mfma_f32_32x32x16_bf16 v[0:15], v[224:227], v[208:211], v[0:15]
    ds_read_b128 v[244:247], v249 offset:21504
    s_waitcnt lgkmcnt(4)
    v_mfma_f32_32x32x16_bf16 v[0:15], v[228:231], v[212:215], v[0:15]
    ds_read_b128 v[224:227], v249 offset:22528
    s_waitcnt lgkmcnt(4)
    v_mfma_f32_32x32x16_bf16 v[16:31], v[232:235], v[208:211], v[16:31]
    ds_read_b128 v[228:231], v249 offset:23552
    s_waitcnt lgkmcnt(4)
    v_mfma_f32_32x32x16_bf16 v[16:31], v[236:239], v[212:215], v[16:31]
    ds_read_b128 v[232:235], v249 offset:24576
    s_waitcnt lgkmcnt(4)
    v_mfma_f32_32x32x16_bf16 v[32:47], v[240:243], v[208:211], v[32:47]
    ds_read_b128 v[236:239], v249 offset:25600
    s_waitcnt lgkmcnt(4)
    v_mfma_f32_32x32x16_bf16 v[32:47], v[244:247], v[212:215], v[32:47]
    ds_read_b128 v[240:243], v249 offset:26624
    s_waitcnt lgkmcnt(4)
    v_mfma_f32_32x32x16_bf16 v[48:63], v[224:227], v[208:211], v[48:63]
    ds_read_b128 v[244:247], v249 offset:27648
    s_waitcnt lgkmcnt(4)
    v_mfma_f32_32x32x16_bf16 v[48:63], v[228:231], v[212:215], v[48:63]
    ds_read_b128 v[224:227], v249 offset:28672
    s_waitcnt lgkmcnt(4)
    v_mfma_f32_32x32x16_bf16 v[64:79], v[232:235], v[208:211], v[64:79]
    ds_read_b128 v[228:231], v249 offset:29696
    s_waitcnt lgkmcnt(4)
    v_mfma_f32_32x32x16_bf16 v[64:79], v[236:239], v[212:215], v[64:79]
    ds_read_b128 v[232:235], v249 offset:30720
    s_waitcnt lgkmcnt(4)
    v_mfma_f32_32x32x16_bf16 v[80:95], v[240:243], v[208:211], v[80:95]
    ds_read_b128 v[236:239], v249 offset:31744
    s_waitcnt lgkmcnt(4)
    v_mfma_f32_32x32x16_bf16 v[80:95], v[244:247], v[212:215], v[80:95]
    s_waitcnt lgkmcnt(3)
    v_mfma_f32_32x32x16_bf16 v[96:111], v[224:227], v[208:211], v[96:111]
    s_waitcnt lgkmcnt(2)
    v_mfma_f32_32x32x16_bf16 v[96:111], v[228:231], v[212:215], v[96:111]
    s_waitcnt lgkmcnt(1)
    v_mfma_f32_32x32x16_bf16 v[112:127], v[232:235], v[208:211], v[112:127]
    s_waitcnt lgkmcnt(0)
    v_mfma_f32_32x32x16_bf16 v[112:127], v[236:239], v[212:215], v[112:127]
K2_IDLE1:
    s_add_u32 s17, s17, 1
    s_add_u32 s23, s23, 1
    s_branch K2_STEP2
K2_TOSLOW2:
    s_call_b64 s[38:39], K2_SLOW1
    s_branch K2_STEP3
K2_LAST2:
    s_cmp_gt_i32 s17, s33
    s_cbranch_scc1 K2_IDLE2
    v_bfe_u32 v254, v248, 4, 5
    v_lshlrev_b32 v254, 2, v254
    s_lshl_b32 s27, s16, 7
    s_add_u32 s27, s27, 0x4c02000
    buffer_load_dword v252, v254, s[4:7], s27 offen
    v_mov_b32 v255, 0
    buffer_load_dword v253, v255, s[4:7], s32 offen sc1
    s_waitcnt lgkmcnt(0)
    ds_read_b128 v[224:227], v249 offset:32768
    ds_read_b128 v[228:231], v249 offset:33792
    ds_read_b128 v[232:235], v249 offset:34816
    ds_read_b128 v[236:239], v249 offset:35840
    ds_read_b128 v[240:243], v249 offset:36864
    v_exp_f32 v192, v192
    v_exp_f32 v193, v193
    v_exp_f32 v194, v194
    v_add_f32 v251, v251, v192
    v_exp_f32 v195, v195
    v_add_f32 v251, v251, v193
    v_cvt_pk_bf16_f32 v192, v192, v193
    v_exp_f32 v196, v196
    v_add_f32 v251, v251, v194
    v_exp_f32 v197, v197
    v_add_f32 v251, v251, v195
    v_cvt_pk_bf16_f32 v193, v194, v195
    v_exp_f32 v198, v198
    v_add_f32 v251, v251, v196
    v_exp_f32 v199, v199
    v_add_f32 v251, v251, v197
    v_cvt_pk_bf16_f32 v194, v196, v197
    v_exp_f32 v200, v200
    v_add_f32 v251, v251, v198
    v_exp_f32 v201, v201
    v_add_f32 v251, v251, v199
    v_cvt_pk_bf16_f32 v195, v198, v199
    v_exp_f32 v202, v202
    v_add_f32 v251, v251, v200
    v_exp_f32 v203, v203
    v_add_f32 v251, v251, v201
    v_cvt_pk_bf16_f32 v196, v200, v201
    v_exp_f32 v204, v204
    v_add_f32 v251, v251, v202
    v_exp_f32 v205, v205
    v_add_f32 v251, v251, v203
    v_cvt_pk_bf16_f32 v197, v202, v203
    v_exp_f32 v206, v206
    v_add_f32 v251, v251, v204
    v_exp_f32 v207, v207
    v_add_f32 v251, v251, v205
    v_cvt_pk_bf16_f32 v198, v204, v205
    v_add_f32 v251, v251, v206
    v_add_f32 v251, v251, v207
    v_cvt_pk_bf16_f32 v199, v206, v207
    s_nop 1
    s_waitcnt lgkmcnt(4)
    v_mfma_f32_32x32x16_bf16 v[0:15], v[224:227], v[192:195], v[0:15]
    ds_read_b128 v[244:247], v249 offset:37888
    s_waitcnt lgkmcnt(4)
    v_mfma_f32_32x32x16_bf16 v[0:15], v[228:231], v[196:199], v[0:15]
    ds_read_b128 v[224:227], v249 offset:38912
    s_waitcnt lgkmcnt(4)
    v_mfma_f32_32x32x16_bf16 v[16:31], v[232:235], v[192:195], v[16:31]
    ds_read_b128 v[228:231], v249 offset:39936
    s_waitcnt lgkmcnt(4)
    v_mfma_f32_32x32x16_bf16 v[16:31], v[236:239], v[196:199], v[16:31]
    ds_read_b128 v[232:235], v249 offset:40960
    s_waitcnt lgkmcnt(4)
    v_mfma_f32_32x32x16_bf16 v[32:47], v[240:243], v[192:195], v[32:47]
    ds_read_b128 v[236:239], v249 offset:41984
    s_waitcnt lgkmcnt(4)
    v_mfma_f32_32x32x16_bf16 v[32:47], v[244:247], v[196:199], v[32:47]
    ds_read_b128 v[240:243], v249 offset:43008
    s_waitcnt lgkmcnt(4)
    v_mfma_f32_32x32x16_bf16 v[48:63], v[224:227], v[192:195], v[48:63]
    ds_read_b128 v[244:247], v249 offset:44032
    s_waitcnt lgkmcnt(4)
    v_mfma_f32_32x32x16_bf16 v[48:63], v[228:231], v[196:199], v[48:63]
    ds_read_b128 v[224:227], v249 offset:45056
    s_waitcnt lgkmcnt(4)
    v_mfma_f32_32x32x16_bf16 v[64:79], v[232:235], v[192:195], v[64:79]
    ds_read_b128 v[228:231], v249 offset:46080
    s_waitcnt lgkmcnt(4)
    v_mfma_f32_32x32x16_bf16 v[64:79], v[236:239], v[196:199], v[64:79]
    ds_read_b128 v[232:235], v249 offset:47104
    s_waitcnt lgkmcnt(4)
    v_mfma_f32_32x32x16_bf16 v[80:95], v[240:243], v[192:195], v[80:95]
    ds_read_b128 v[236:239], v249 offset:48128
    s_waitcnt lgkmcnt(4)
    v_mfma_f32_32x32x16_bf16 v[80:95], v[244:247], v[196:199], v[80:95]
    s_waitcnt lgkmcnt(3)
    v_mfma_f32_32x32x16_bf16 v[96:111], v[224:227], v[192:195], v[96:111]
    s_waitcnt lgkmcnt(2)
    v_mfma_f32_32x32x16_bf16 v[96:111], v[228:231], v[196:199], v[96:111]
    s_waitcnt lgkmcnt(1)
    v_mfma_f32_32x32x16_bf16 v[112:127], v[232:235], v[192:195], v[112:127]
    s_waitcnt lgkmcnt(0)
    v_mfma_f32_32x32x16_bf16 v[112:127], v[236:239], v[196:199], v[112:127]
K2_IDLE2:
    s_add_u32 s17, s17, 1
    s_add_u32 s23, s23, 1
    s_branch K2_STEP3
K2_TOSLOW3:
    s_call_b64 s[38:39], K2_SLOW0
    s_branch K2_STEP0
K2_LAST3:
    s_cmp_gt_i32 s17, s33
    s_cbranch_scc1 K2_IDLE3
    v_bfe_u32 v254, v248, 4, 5
    v_lshlrev_b32 v254, 2, v254
    s_lshl_b32 s27, s16, 7
    s_add_u32 s27, s27, 0x4c02000
    buffer_load_dword v252, v254, s[4:7], s27 offen
    v_mov_b32 v255, 0
    buffer_load_dword v253, v255, s[4:7], s32 offen sc1
    s_waitcnt lgkmcnt(0)
    ds_read_b128 v[224:227], v249 offset:49152
    ds_read_b128 v[228:231], v249 offset:50176
    ds_read_b128 v[232:235], v249 offset:51200
    ds_read_b128 v[236:239], v249 offset:52224
    ds_read_b128 v[240:243], v249 offset:53248
    v_exp_f32 v208, v208
    v_exp_f32 v209, v209
    v_exp_f32 v210, v210
    v_add_f32 v251, v251, v208
    v_exp_f32 v211, v211
    v_add_f32 v251, v251, v209
    v_cvt_pk_bf16_f32 v208, v208, v209
    v_exp_f32 v212, v212
    v_add_f32 v251, v251, v210
    v_exp_f32 v213, v213
    v_add_f32 v251, v251, v211
    v_cvt_pk_bf16_f32 v209, v210, v211
    v_exp_f32 v214, v214
    v_add_f32 v251, v251, v212
    v_exp_f32 v215, v215
    v_add_f32 v251, v251, v213
    v_cvt_pk_bf16_f32 v210, v212, v213
    v_exp_f32 v216, v216
    v_add_f32 v251, v251, v214
    v_exp_f32 v217, v217
    v_add_f32 v251, v251, v215
    v_cvt_pk_bf16_f32 v211, v214, v215
    v_exp_f32 v218, v218
    v_add_f32 v251, v251, v216
    v_exp_f32 v219, v219
    v_add_f32 v251, v251, v217
    v_cvt_pk_bf16_f32 v212, v216, v217
    v_exp_f32 v220, v220
    v_add_f32 v251, v251, v218
    v_exp_f32 v221, v221
    v_add_f32 v251, v251, v219
    v_cvt_pk_bf16_f32 v213, v218, v219
    v_exp_f32 v222, v222
    v_add_f32 v251, v251, v220
    v_exp_f32 v223, v223
    v_add_f32 v251, v251, v221
    v_cvt_pk_bf16_f32 v214, v220, v221
    v_add_f32 v251, v251, v222
    v_add_f32 v251, v251, v223
    v_cvt_pk_bf16_f32 v215, v222, v223
    s_nop 1
    s_waitcnt lgkmcnt(4)
    v_mfma_f32_32x32x16_bf16 v[0:15], v[224:227], v[208:211], v[0:15]
    ds_read_b128 v[244:247], v249 offset:54272
    s_waitcnt lgkmcnt(4)
    v_mfma_f32_32x32x16_bf16 v[0:15], v[228:231], v[212:215], v[0:15]
    ds_read_b128 v[224:227], v249 offset:55296
    s_waitcnt lgkmcnt(4)
    v_mfma_f32_32x32x16_bf16 v[16:31], v[232:235], v[208:211], v[16:31]
    ds_read_b128 v[228:231], v249 offset:56320
    s_waitcnt lgkmcnt(4)
    v_mfma_f32_32x32x16_bf16 v[16:31], v[236:239], v[212:215], v[16:31]
    ds_read_b128 v[232:235], v249 offset:57344
    s_waitcnt lgkmcnt(4)
    v_mfma_f32_32x32x16_bf16 v[32:47], v[240:243], v[208:211], v[32:47]
    ds_read_b128 v[236:239], v249 offset:58368
    s_waitcnt lgkmcnt(4)
    v_mfma_f32_32x32x16_bf16 v[32:47], v[244:247], v[212:215], v[32:47]
    ds_read_b128 v[240:243], v249 offset:59392
    s_waitcnt lgkmcnt(4)
    v_mfma_f32_32x32x16_bf16 v[48:63], v[224:227], v[208:211], v[48:63]
    ds_read_b128 v[244:247], v249 offset:60416
    s_waitcnt lgkmcnt(4)
    v_mfma_f32_32x32x16_bf16 v[48:63], v[228:231], v[212:215], v[48:63]
    ds_read_b128 v[224:227], v249 offset:61440
    s_waitcnt lgkmcnt(4)
    v_mfma_f32_32x32x16_bf16 v[64:79], v[232:235], v[208:211], v[64:79]
    ds_read_b128 v[228:231], v249 offset:62464
    s_waitcnt lgkmcnt(4)
    v_mfma_f32_32x32x16_bf16 v[64:79], v[236:239], v[212:215], v[64:79]
    ds_read_b128 v[232:235], v249 offset:63488
    s_waitcnt lgkmcnt(4)
    v_mfma_f32_32x32x16_bf16 v[80:95], v[240:243], v[208:211], v[80:95]
    ds_read_b128 v[236:239], v249 offset:64512
    s_waitcnt lgkmcnt(4)
    v_mfma_f32_32x32x16_bf16 v[80:95], v[244:247], v[212:215], v[80:95]
    s_waitcnt lgkmcnt(3)
    v_mfma_f32_32x32x16_bf16 v[96:111], v[224:227], v[208:211], v[96:111]
    s_waitcnt lgkmcnt(2)
    v_mfma_f32_32x32x16_bf16 v[96:111], v[228:231], v[212:215], v[96:111]
    s_waitcnt lgkmcnt(1)
    v_mfma_f32_32x32x16_bf16 v[112:127], v[232:235], v[208:211], v[112:127]
    s_waitcnt lgkmcnt(0)
    v_mfma_f32_32x32x16_bf16 v[112:127], v[236:239], v[212:215], v[112:127]
K2_IDLE3:
    s_add_u32 s17, s17, 1
    s_add_u32 s23, s23, 1
    s_branch K2_STEP0
K2_SLOW0:
    s_cmp_lg_u32 s17, s16
    s_cbranch_scc1 K2_NOMASK_49
    v_bfe_u32 v255, v248, 4, 5
    v_lshrrev_b32 v254, 9, v248
    v_lshlrev_b32 v254, 2, v254
    v_sub_u32 v255, v255, v254
    v_mov_b32 v254, 0xf149f2ca
    v_cmp_gt_i32 s[40:41], 0, v255
    v_cmp_gt_i32 s[42:43], 1, v255
    s_nop 0
    v_cndmask_b32 v192, v192, v254, s[40:41]
    v_cndmask_b32 v193, v193, v254, s[42:43]
    v_cmp_gt_i32 s[40:41], 2, v255
    v_cmp_gt_i32 s[42:43], 3, v255
    s_nop 0
    v_cndmask_b32 v194, v194, v254, s[40:41]
    v_cndmask_b32 v195, v195, v254, s[42:43]
    v_cmp_gt_i32 s[40:41], 8, v255
    v_cmp_gt_i32 s[42:43], 9, v255
    s_nop 0
    v_cndmask_b32 v196, v196, v254, s[40:41]
    v_cndmask_b32 v197, v197, v254, s[42:43]
    v_cmp_gt_i32 s[40:41], 10, v255
    v_cmp_gt_i32 s[42:43], 11, v255
    s_nop 0
    v_cndmask_b32 v198, v198, v254, s[40:41]
    v_cndmask_b32 v199, v199, v254, s[42:43]
    v_cmp_gt_i32 s[40:41], 16, v255
    v_cmp_gt_i32 s[42:43], 17, v255
    s_nop 0
    v_cndmask_b32 v200, v200, v254, s[40:41]
    v_cndmask_b32 v201, v201, v254, s[42:43]
    v_cmp_gt_i32 s[40:41], 18, v255
    v_cmp_gt_i32 s[42:43], 19, v255
    s_nop 0
    v_cndmask_b32 v202, v202, v254, s[40:41]
    v_cndmask_b32 v203, v203, v254, s[42:43]
    v_cmp_gt_i32 s[40:41], 24, v255
    v_cmp_gt_i32 s[42:43], 25, v255
    s_nop 0
    v_cndmask_b32 v204, v204, v254, s[40:41]
    v_cndmask_b32 v205, v205, v254, s[42:43]
    v_cmp_gt_i32 s[40:41], 26, v255
    v_cmp_gt_i32 s[42:43], 27, v255
    s_nop 0
    v_cndmask_b32 v206, v206, v254, s[40:41]
    v_cndmask_b32 v207, v207, v254, s[42:43]
K2_NOMASK_49:
    v_max3_f32 v253, v192, v193, v194
    v_max3_f32 v253, v253, v195, v196
    v_max3_f32 v253, v253, v197, v198
    v_max3_f32 v253, v253, v199, v200
    v_max3_f32 v253, v253, v201, v202
    v_max3_f32 v253, v253, v203, v204
    v_max3_f32 v253, v253, v205, v206
    v_max_f32 v253, v253, v207
    v_cmp_lt_f32 vcc, s25, v253
    s_cmp_lg_u32 s35, 0
    s_cbranch_scc1 K2_RESC_51
    s_cbranch_vccz K2_SLOWRET_50
K2_RESC_51:
    v_mov_b32 v254, v253
    s_nop 1
    v_permlane32_swap_b32 v253, v254
    s_nop 1
    v_max_f32 v253, v253, v254
    s_cbranch_scc1 K2_NOCLAMP_52
    v_max_f32 v253, 0, v253
    v_sub_f32 v255, 0, v253
    v_exp_f32 v255, v255
    s_nop 7
    v_mul_f32 v251, v251, v255
    v_mul_f32 v0, v0, v255
    v_mul_f32 v1, v1, v255
    v_mul_f32 v2, v2, v255
    v_mul_f32 v3, v3, v255
    v_mul_f32 v4, v4, v255
    v_mul_f32 v5, v5, v255
    v_mul_f32 v6, v6, v255
    v_mul_f32 v7, v7, v255
    v_mul_f32 v8, v8, v255
    v_mul_f32 v9, v9, v255
    v_mul_f32 v10, v10, v255
    v_mul_f32 v11, v11, v255
    v_mul_f32 v12, v12, v255
    v_mul_f32 v13, v13, v255
    v_mul_f32 v14, v14, v255
    v_mul_f32 v15, v15, v255
    v_mul_f32 v16, v16, v255
    v_mul_f32 v17, v17, v255
    v_mul_f32 v18, v18, v255
    v_mul_f32 v19, v19, v255
    v_mul_f32 v20, v20, v255
    v_mul_f32 v21, v21, v255
    v_mul_f32 v22, v22, v255
    v_mul_f32 v23, v23, v255
    v_mul_f32 v24, v24, v255
    v_mul_f32 v25, v25, v255
    v_mul_f32 v26, v26, v255
    v_mul_f32 v27, v27, v255
    v_mul_f32 v28, v28, v255
    v_mul_f32 v29, v29, v255
    v_mul_f32 v30, v30, v255
    v_mul_f32 v31, v31, v255
    v_mul_f32 v32, v32, v255
    v_mul_f32 v33, v33, v255
    v_mul_f32 v34, v34, v255
    v_mul_f32 v35, v35, v255
    v_mul_f32 v36, v36, v255
    v_mul_f32 v37, v37, v255
    v_mul_f32 v38, v38, v255
    v_mul_f32 v39, v39, v255
    v_mul_f32 v40, v40, v255
    v_mul_f32 v41, v41, v255
    v_mul_f32 v42, v42, v255
    v_mul_f32 v43, v43, v255
    v_mul_f32 v44, v44, v255
    v_mul_f32 v45, v45, v255
    v_mul_f32 v46, v46, v255
    v_mul_f32 v47, v47, v255
    v_mul_f32 v48, v48, v255
    v_mul_f32 v49, v49, v255
    v_mul_f32 v50, v50, v255
    v_mul_f32 v51, v51, v255
    v_mul_f32 v52, v52, v255
    v_mul_f32 v53, v53, v255
    v_mul_f32 v54, v54, v255
    v_mul_f32 v55, v55, v255
    v_mul_f32 v56, v56, v255
    v_mul_f32 v57, v57, v255
    v_mul_f32 v58, v58, v255
    v_mul_f32 v59, v59, v255
    v_mul_f32 v60, v60, v255
    v_mul_f32 v61, v61, v255
    v_mul_f32 v62, v62, v255
    v_mul_f32 v63, v63, v255
    v_mul_f32 v64, v64, v255
    v_mul_f32 v65, v65, v255
    v_mul_f32 v66, v66, v255
    v_mul_f32 v67, v67, v255
    v_mul_f32 v68, v68, v255
    v_mul_f32 v69, v69, v255
    v_mul_f32 v70, v70, v255
    v_mul_f32 v71, v71, v255
    v_mul_f32 v72, v72, v255
    v_mul_f32 v73, v73, v255
    v_mul_f32 v74, v74, v255
    v_mul_f32 v75, v75, v255
    v_mul_f32 v76, v76, v255
    v_mul_f32 v77, v77, v255
    v_mul_f32 v78, v78, v255
    v_mul_f32 v79, v79, v255
    v_mul_f32 v80, v80, v255
    v_mul_f32 v81, v81, v255
    v_mul_f32 v82, v82, v255
    v_mul_f32 v83, v83, v255
    v_mul_f32 v84, v84, v255
    v_mul_f32 v85, v85, v255
    v_mul_f32 v86, v86, v255
    v_mul_f32 v87, v87, v255
    v_mul_f32 v88, v88, v255
    v_mul_f32 v89, v89, v255
    v_mul_f32 v90, v90, v255
    v_mul_f32 v91, v91, v255
    v_mul_f32 v92, v92, v255
    v_mul_f32 v93, v93, v255
    v_mul_f32 v94, v94, v255
    v_mul_f32 v95, v95, v255
    v_mul_f32 v96, v96, v255
    v_mul_f32 v97, v97, v255
    v_mul_f32 v98, v98, v255
    v_mul_f32 v99, v99, v255
    v_mul_f32 v100, v100, v255
    v_mul_f32 v101, v101, v255
    v_mul_f32 v102, v102, v255
    v_mul_f32 v103, v103, v255
    v_mul_f32 v104, v104, v255
    v_mul_f32 v105, v105, v255
    v_mul_f32 v106, v106, v255
    v_mul_f32 v107, v107, v255
    v_mul_f32 v108, v108, v255
    v_mul_f32 v109, v109, v255
    v_mul_f32 v110, v110, v255
    v_mul_f32 v111, v111, v255
    v_mul_f32 v112, v112, v255
    v_mul_f32 v113, v113, v255
    v_mul_f32 v114, v114, v255
    v_mul_f32 v115, v115, v255
    v_mul_f32 v116, v116, v255
    v_mul_f32 v117, v117, v255
    v_mul_f32 v118, v118, v255
    v_mul_f32 v119, v119, v255
    v_mul_f32 v120, v120, v255
    v_mul_f32 v121, v121, v255
    v_mul_f32 v122, v122, v255
    v_mul_f32 v123, v123, v255
    v_mul_f32 v124, v124, v255
    v_mul_f32 v125, v125, v255
    v_mul_f32 v126, v126, v255
    v_mul_f32 v127, v127, v255
K2_NOCLAMP_52:
    v_add_f32 v250, v250, v253
    v_sub_f32 v192, v192, v253
    v_sub_f32 v193, v193, v253
    v_sub_f32 v194, v194, v253
    v_sub_f32 v195, v195, v253
    v_sub_f32 v196, v196, v253
    v_sub_f32 v197, v197, v253
    v_sub_f32 v198, v198, v253
    v_sub_f32 v199, v199, v253
    v_sub_f32 v200, v200, v253
    v_sub_f32 v201, v201, v253
    v_sub_f32 v202, v202, v253
    v_sub_f32 v203, v203, v253
    v_sub_f32 v204, v204, v253
    v_sub_f32 v205, v205, v253
    v_sub_f32 v206, v206, v253
    v_sub_f32 v207, v207, v253
    s_mov_b32 s35, 0
K2_SLOWRET_50:
    s_nop 1
    s_setpc_b64 s[38:39]
K2_SLOW1:
    s_cmp_lg_u32 s17, s16
    s_cbranch_scc1 K2_NOMASK_53
    v_bfe_u32 v255, v248, 4, 5
    v_lshrrev_b32 v254, 9, v248
    v_lshlrev_b32 v254, 2, v254
    v_sub_u32 v255, v255, v254
    v_mov_b32 v254, 0xf149f2ca
    v_cmp_gt_i32 s[40:41], 0, v255
    v_cmp_gt_i32 s[42:43], 1, v255
    s_nop 0
    v_cndmask_b32 v208, v208, v254, s[40:41]
    v_cndmask_b32 v209, v209, v254, s[42:43]
    v_cmp_gt_i32 s[40:41], 2, v255
    v_cmp_gt_i32 s[42:43], 3, v255
    s_nop 0
    v_cndmask_b32 v210, v210, v254, s[40:41]
    v_cndmask_b32 v211, v211, v254, s[42:43]
    v_cmp_gt_i32 s[40:41], 8, v255
    v_cmp_gt_i32 s[42:43], 9, v255
    s_nop 0
    v_cndmask_b32 v212, v212, v254, s[40:41]
    v_cndmask_b32 v213, v213, v254, s[42:43]
    v_cmp_gt_i32 s[40:41], 10, v255
    v_cmp_gt_i32 s[42:43], 11, v255
    s_nop 0
    v_cndmask_b32 v214, v214, v254, s[40:41]
    v_cndmask_b32 v215, v215, v254, s[42:43]
    v_cmp_gt_i32 s[40:41], 16, v255
    v_cmp_gt_i32 s[42:43], 17, v255
    s_nop 0
    v_cndmask_b32 v216, v216, v254, s[40:41]
    v_cndmask_b32 v217, v217, v254, s[42:43]
    v_cmp_gt_i32 s[40:41], 18, v255
    v_cmp_gt_i32 s[42:43], 19, v255
    s_nop 0
    v_cndmask_b32 v218, v218, v254, s[40:41]
    v_cndmask_b32 v219, v219, v254, s[42:43]
    v_cmp_gt_i32 s[40:41], 24, v255
    v_cmp_gt_i32 s[42:43], 25, v255
    s_nop 0
    v_cndmask_b32 v220, v220, v254, s[40:41]
    v_cndmask_b32 v221, v221, v254, s[42:43]
    v_cmp_gt_i32 s[40:41], 26, v255
    v_cmp_gt_i32 s[42:43], 27, v255
    s_nop 0
    v_cndmask_b32 v222, v222, v254, s[40:41]
    v_cndmask_b32 v223, v223, v254, s[42:43]
K2_NOMASK_53:
    v_max3_f32 v253, v208, v209, v210
    v_max3_f32 v253, v253, v211, v212
    v_max3_f32 v253, v253, v213, v214
    v_max3_f32 v253, v253, v215, v216
    v_max3_f32 v253, v253, v217, v218
    v_max3_f32 v253, v253, v219, v220
    v_max3_f32 v253, v253, v221, v222
    v_max_f32 v253, v253, v223
    v_cmp_lt_f32 vcc, s25, v253
    s_cmp_lg_u32 s35, 0
    s_cbranch_scc1 K2_RESC_55
    s_cbranch_vccz K2_SLOWRET_54
K2_RESC_55:
    v_mov_b32 v254, v253
    s_nop 1
    v_permlane32_swap_b32 v253, v254
    s_nop 1
    v_max_f32 v253, v253, v254
    s_cbranch_scc1 K2_NOCLAMP_56
    v_max_f32 v253, 0, v253
    v_sub_f32 v255, 0, v253
    v_exp_f32 v255, v255
    s_nop 7
    v_mul_f32 v251, v251, v255
    v_mul_f32 v0, v0, v255
    v_mul_f32 v1, v1, v255
    v_mul_f32 v2, v2, v255
    v_mul_f32 v3, v3, v255
    v_mul_f32 v4, v4, v255
    v_mul_f32 v5, v5, v255
    v_mul_f32 v6, v6, v255
    v_mul_f32 v7, v7, v255
    v_mul_f32 v8, v8, v255
    v_mul_f32 v9, v9, v255
    v_mul_f32 v10, v10, v255
    v_mul_f32 v11, v11, v255
    v_mul_f32 v12, v12, v255
    v_mul_f32 v13, v13, v255
    v_mul_f32 v14, v14, v255
    v_mul_f32 v15, v15, v255
    v_mul_f32 v16, v16, v255
    v_mul_f32 v17, v17, v255
    v_mul_f32 v18, v18, v255
    v_mul_f32 v19, v19, v255
    v_mul_f32 v20, v20, v255
    v_mul_f32 v21, v21, v255
    v_mul_f32 v22, v22, v255
    v_mul_f32 v23, v23, v255
    v_mul_f32 v24, v24, v255
    v_mul_f32 v25, v25, v255
    v_mul_f32 v26, v26, v255
    v_mul_f32 v27, v27, v255
    v_mul_f32 v28, v28, v255
    v_mul_f32 v29, v29, v255
    v_mul_f32 v30, v30, v255
    v_mul_f32 v31, v31, v255
    v_mul_f32 v32, v32, v255
    v_mul_f32 v33, v33, v255
    v_mul_f32 v34, v34, v255
    v_mul_f32 v35, v35, v255
    v_mul_f32 v36, v36, v255
    v_mul_f32 v37, v37, v255
    v_mul_f32 v38, v38, v255
    v_mul_f32 v39, v39, v255
    v_mul_f32 v40, v40, v255
    v_mul_f32 v41, v41, v255
    v_mul_f32 v42, v42, v255
    v_mul_f32 v43, v43, v255
    v_mul_f32 v44, v44, v255
    v_mul_f32 v45, v45, v255
    v_mul_f32 v46, v46, v255
    v_mul_f32 v47, v47, v255
    v_mul_f32 v48, v48, v255
    v_mul_f32 v49, v49, v255
    v_mul_f32 v50, v50, v255
    v_mul_f32 v51, v51, v255
    v_mul_f32 v52, v52, v255
    v_mul_f32 v53, v53, v255
    v_mul_f32 v54, v54, v255
    v_mul_f32 v55, v55, v255
    v_mul_f32 v56, v56, v255
    v_mul_f32 v57, v57, v255
    v_mul_f32 v58, v58, v255
    v_mul_f32 v59, v59, v255
    v_mul_f32 v60, v60, v255
    v_mul_f32 v61, v61, v255
    v_mul_f32 v62, v62, v255
    v_mul_f32 v63, v63, v255
    v_mul_f32 v64, v64, v255
    v_mul_f32 v65, v65, v255
    v_mul_f32 v66, v66, v255
    v_mul_f32 v67, v67, v255
    v_mul_f32 v68, v68, v255
    v_mul_f32 v69, v69, v255
    v_mul_f32 v70, v70, v255
    v_mul_f32 v71, v71, v255
    v_mul_f32 v72, v72, v255
    v_mul_f32 v73, v73, v255
    v_mul_f32 v74, v74, v255
    v_mul_f32 v75, v75, v255
    v_mul_f32 v76, v76, v255
    v_mul_f32 v77, v77, v255
    v_mul_f32 v78, v78, v255
    v_mul_f32 v79, v79, v255
    v_mul_f32 v80, v80, v255
    v_mul_f32 v81, v81, v255
    v_mul_f32 v82, v82, v255
    v_mul_f32 v83, v83, v255
    v_mul_f32 v84, v84, v255
    v_mul_f32 v85, v85, v255
    v_mul_f32 v86, v86, v255
    v_mul_f32 v87, v87, v255
    v_mul_f32 v88, v88, v255
    v_mul_f32 v89, v89, v255
    v_mul_f32 v90, v90, v255
    v_mul_f32 v91, v91, v255
    v_mul_f32 v92, v92, v255
    v_mul_f32 v93, v93, v255
    v_mul_f32 v94, v94, v255
    v_mul_f32 v95, v95, v255
    v_mul_f32 v96, v96, v255
    v_mul_f32 v97, v97, v255
    v_mul_f32 v98, v98, v255
    v_mul_f32 v99, v99, v255
    v_mul_f32 v100, v100, v255
    v_mul_f32 v101, v101, v255
    v_mul_f32 v102, v102, v255
    v_mul_f32 v103, v103, v255
    v_mul_f32 v104, v104, v255
    v_mul_f32 v105, v105, v255
    v_mul_f32 v106, v106, v255
    v_mul_f32 v107, v107, v255
    v_mul_f32 v108, v108, v255
    v_mul_f32 v109, v109, v255
    v_mul_f32 v110, v110, v255
    v_mul_f32 v111, v111, v255
    v_mul_f32 v112, v112, v255
    v_mul_f32 v113, v113, v255
    v_mul_f32 v114, v114, v255
    v_mul_f32 v115, v115, v255
    v_mul_f32 v116, v116, v255
    v_mul_f32 v117, v117, v255
    v_mul_f32 v118, v118, v255
    v_mul_f32 v119, v119, v255
    v_mul_f32 v120, v120, v255
    v_mul_f32 v121, v121, v255
    v_mul_f32 v122, v122, v255
    v_mul_f32 v123, v123, v255
    v_mul_f32 v124, v124, v255
    v_mul_f32 v125, v125, v255
    v_mul_f32 v126, v126, v255
    v_mul_f32 v127, v127, v255
K2_NOCLAMP_56:
    v_add_f32 v250, v250, v253
    v_sub_f32 v208, v208, v253
    v_sub_f32 v209, v209, v253
    v_sub_f32 v210, v210, v253
    v_sub_f32 v211, v211, v253
    v_sub_f32 v212, v212, v253
    v_sub_f32 v213, v213, v253
    v_sub_f32 v214, v214, v253
    v_sub_f32 v215, v215, v253
    v_sub_f32 v216, v216, v253
    v_sub_f32 v217, v217, v253
    v_sub_f32 v218, v218, v253
    v_sub_f32 v219, v219, v253
    v_sub_f32 v220, v220, v253
    v_sub_f32 v221, v221, v253
    v_sub_f32 v222, v222, v253
    v_sub_f32 v223, v223, v253
    s_mov_b32 s35, 0
K2_SLOWRET_54:
    s_nop 1
    s_setpc_b64 s[38:39]
K2_FLAG0:
    s_waitcnt vmcnt(0)
    v_mov_b32 v254, 1
    v_mov_b32 v255, 0
    s_mov_b64 exec, 1
    buffer_store_dword v254, v255, s[4:7], s32 offen sc1
    s_mov_b64 exec, -1
    s_mov_b32 s44, -1
    s_branch K2_FLAGBACK0
K2_FLAG1:
    s_waitcnt vmcnt(0)
    v_mov_b32 v254, 1
    v_mov_b32 v255, 0
    s_mov_b64 exec, 1
    buffer_store_dword v254, v255, s[4:7], s32 offen sc1
    s_mov_b64 exec, -1
    s_mov_b32 s44, -1
    s_branch K2_FLAGBACK1
K2_FLAG2:
    s_waitcnt vmcnt(0)
    v_mov_b32 v254, 1
    v_mov_b32 v255, 0
    s_mov_b64 exec, 1
    buffer_store_dword v254, v255, s[4:7], s32 offen sc1
    s_mov_b64 exec, -1
    s_mov_b32 s44, -1
    s_branch K2_FLAGBACK2
K2_FLAG3:
    s_waitcnt vmcnt(0)
    v_mov_b32 v254, 1
    v_mov_b32 v255, 0
    s_mov_b64 exec, 1
    buffer_store_dword v254, v255, s[4:7], s32 offen sc1
    s_mov_b64 exec, -1
    s_mov_b32 s44, -1
    s_branch K2_FLAGBACK3
K2_SEG_END:
    s_nop 7
    s_nop 7
    v_mov_b32 v254, v251
    s_nop 1
    v_permlane32_swap_b32 v251, v254
    s_nop 1
    v_add_f32 v251, v251, v254
    s_cmp_eq_u32 s15, 1
    s_cbranch_scc1 K2_PUBLISH
    s_waitcnt lgkmcnt(0)
    s_barrier
    s_mul_i32 s30, s16, 288
    s_lshl_b32 s28, s9, 4
    s_add_u32 s30, s30, s28
    s_lshl_b32 s30, s30, 10
    s_add_u32 s30, s30, 0x3800000
    s_cmp_eq_u32 s15, 2
    s_cbranch_scc1 K2_COMBINE
    v_rcp_f32 v255, v251
    s_waitcnt vmcnt(0)
    v_mul_f32 v255, v255, v252
    v_mul_f32 v0, v0, v255
    v_mul_f32 v1, v1, v255
    v_mul_f32 v2, v2, v255
    v_mul_f32 v3, v3, v255
    v_mul_f32 v4, v4, v255
    v_mul_f32 v5, v5, v255
    v_mul_f32 v6, v6, v255
    v_mul_f32 v7, v7, v255
    v_mul_f32 v8, v8, v255
    v_mul_f32 v9, v9, v255
    v_mul_f32 v10, v10, v255
    v_mul_f32 v11, v11, v255
    v_mul_f32 v12, v12, v255
    v_mul_f32 v13, v13, v255
    v_mul_f32 v14, v14, v255
    v_mul_f32 v15, v15, v255
    v_cvt_pk_bf16_f32 v0, v0, v1
    v_cvt_pk_bf16_f32 v1, v2, v3
    v_cvt_pk_bf16_f32 v2, v4, v5
    v_cvt_pk_bf16_f32 v3, v6, v7
    v_cvt_pk_bf16_f32 v4, v8, v9
    v_cvt_pk_bf16_f32 v5, v10, v11
    v_cvt_pk_bf16_f32 v6, v12, v13
    v_cvt_pk_bf16_f32 v7, v14, v15
    v_mul_f32 v16, v16, v255
    v_mul_f32 v17, v17, v255
    v_mul_f32 v18, v18, v255
    v_mul_f32 v19, v19, v255
    v_mul_f32 v20, v20, v255
    v_mul_f32 v21, v21, v255
    v_mul_f32 v22, v22, v255
    v_mul_f32 v23, v23, v255
    v_mul_f32 v24, v24, v255
    v_mul_f32 v25, v25, v255
    v_mul_f32 v26, v26, v255
    v_mul_f32 v27, v27, v255
    v_mul_f32 v28, v28, v255
    v_mul_f32 v29, v29, v255
    v_mul_f32 v30, v30, v255
    v_mul_f32 v31, v31, v255
    v_cvt_pk_bf16_f32 v16, v16, v17
    v_cvt_pk_bf16_f32 v17, v18, v19
    v_cvt_pk_bf16_f32 v18, v20, v21
    v_cvt_pk_bf16_f32 v19, v22, v23
    v_cvt_pk_bf16_f32 v20, v24, v25
    v_cvt_pk_bf16_f32 v21, v26, v27
    v_cvt_pk_bf16_f32 v22, v28, v29
    v_cvt_pk_bf16_f32 v23, v30, v31
    v_mul_f32 v32, v32, v255
    v_mul_f32 v33, v33, v255
    v_mul_f32 v34, v34, v255
    v_mul_f32 v35, v35, v255
    v_mul_f32 v36, v36, v255
    v_mul_f32 v37, v37, v255
    v_mul_f32 v38, v38, v255
    v_mul_f32 v39, v39, v255
    v_mul_f32 v40, v40, v255
    v_mul_f32 v41, v41, v255
    v_mul_f32 v42, v42, v255
    v_mul_f32 v43, v43, v255
    v_mul_f32 v44, v44, v255
    v_mul_f32 v45, v45, v255
    v_mul_f32 v46, v46, v255
    v_mul_f32 v47, v47, v255
    v_cvt_pk_bf16_f32 v32, v32, v33
    v_cvt_pk_bf16_f32 v33, v34, v35
    v_cvt_pk_bf16_f32 v34, v36, v37
    v_cvt_pk_bf16_f32 v35, v38, v39
    v_cvt_pk_bf16_f32 v36, v40, v41
    v_cvt_pk_bf16_f32 v37, v42, v43
    v_cvt_pk_bf16_f32 v38, v44, v45
    v_cvt_pk_bf16_f32 v39, v46, v47
    v_mul_f32 v48, v48, v255
    v_mul_f32 v49, v49, v255
    v_mul_f32 v50, v50, v255
    v_mul_f32 v51, v51, v255
    v_mul_f32 v52, v52, v255
    v_mul_f32 v53, v53, v255
    v_mul_f32 v54, v54, v255
    v_mul_f32 v55, v55, v255
    v_mul_f32 v56, v56, v255
    v_mul_f32 v57, v57, v255
    v_mul_f32 v58, v58, v255
    v_mul_f32 v59, v59, v255
    v_mul_f32 v60, v60, v255
    v_mul_f32 v61, v61, v255
    v_mul_f32 v62, v62, v255
    v_mul_f32 v63, v63, v255
    v_cvt_pk_bf16_f32 v48, v48, v49
    v_cvt_pk_bf16_f32 v49, v50, v51
    v_cvt_pk_bf16_f32 v50, v52, v53
    v_cvt_pk_bf16_f32 v51, v54, v55
    v_cvt_pk_bf16_f32 v52, v56, v57
    v_cvt_pk_bf16_f32 v53, v58, v59
    v_cvt_pk_bf16_f32 v54, v60, v61
    v_cvt_pk_bf16_f32 v55, v62, v63
    v_mul_f32 v64, v64, v255
    v_mul_f32 v65, v65, v255
    v_mul_f32 v66, v66, v255
    v_mul_f32 v67, v67, v255
    v_mul_f32 v68, v68, v255
    v_mul_f32 v69, v69, v255
    v_mul_f32 v70, v70, v255
    v_mul_f32 v71, v71, v255
    v_mul_f32 v72, v72, v255
    v_mul_f32 v73, v73, v255
    v_mul_f32 v74, v74, v255
    v_mul_f32 v75, v75, v255
    v_mul_f32 v76, v76, v255
    v_mul_f32 v77, v77, v255
    v_mul_f32 v78, v78, v255
    v_mul_f32 v79, v79, v255
    v_cvt_pk_bf16_f32 v64, v64, v65
    v_cvt_pk_bf16_f32 v65, v66, v67
    v_cvt_pk_bf16_f32 v66, v68, v69
    v_cvt_pk_bf16_f32 v67, v70, v71
    v_cvt_pk_bf16_f32 v68, v72, v73
    v_cvt_pk_bf16_f32 v69, v74, v75
    v_cvt_pk_bf16_f32 v70, v76, v77
    v_cvt_pk_bf16_f32 v71, v78, v79
    v_mul_f32 v80, v80, v255
    v_mul_f32 v81, v81, v255
    v_mul_f32 v82, v82, v255
    v_mul_f32 v83, v83, v255
    v_mul_f32 v84, v84, v255
    v_mul_f32 v85, v85, v255
    v_mul_f32 v86, v86, v255
    v_mul_f32 v87, v87, v255
    v_mul_f32 v88, v88, v255
    v_mul_f32 v89, v89, v255
    v_mul_f32 v90, v90, v255
    v_mul_f32 v91, v91, v255
    v_mul_f32 v92, v92, v255
    v_mul_f32 v93, v93, v255
    v_mul_f32 v94, v94, v255
    v_mul_f32 v95, v95, v255
    v_cvt_pk_bf16_f32 v80, v80, v81
    v_cvt_pk_bf16_f32 v81, v82, v83
    v_cvt_pk_bf16_f32 v82, v84, v85
    v_cvt_pk_bf16_f32 v83, v86, v87
    v_cvt_pk_bf16_f32 v84, v88, v89
    v_cvt_pk_bf16_f32 v85, v90, v91
    v_cvt_pk_bf16_f32 v86, v92, v93
    v_cvt_pk_bf16_f32 v87, v94, v95
    v_mul_f32 v96, v96, v255
    v_mul_f32 v97, v97, v255
    v_mul_f32 v98, v98, v255
    v_mul_f32 v99, v99, v255
    v_mul_f32 v100, v100, v255
    v_mul_f32 v101, v101, v255
    v_mul_f32 v102, v102, v255
    v_mul_f32 v103, v103, v255
    v_mul_f32 v104, v104, v255
    v_mul_f32 v105, v105, v255
    v_mul_f32 v106, v106, v255
    v_mul_f32 v107, v107, v255
    v_mul_f32 v108, v108, v255
    v_mul_f32 v109, v109, v255
    v_mul_f32 v110, v110, v255
    v_mul_f32 v111, v111, v255
    v_cvt_pk_bf16_f32 v96, v96, v97
    v_cvt_pk_bf16_f32 v97, v98, v99
    v_cvt_pk_bf16_f32 v98, v100, v101
    v_cvt_pk_bf16_f32 v99, v102, v103
    v_cvt_pk_bf16_f32 v100, v104, v105
    v_cvt_pk_bf16_f32 v101, v106, v107
    v_cvt_pk_bf16_f32 v102, v108, v109
    v_cvt_pk_bf16_f32 v103, v110, v111
    v_mul_f32 v112, v112, v255
    v_mul_f32 v113, v113, v255
    v_mul_f32 v114, v114, v255
    v_mul_f32 v115, v115, v255
    v_mul_f32 v116, v116, v255
    v_mul_f32 v117, v117, v255
    v_mul_f32 v118, v118, v255
    v_mul_f32 v119, v119, v255
    v_mul_f32 v120, v120, v255
    v_mul_f32 v121, v121, v255
    v_mul_f32 v122, v122, v255
    v_mul_f32 v123, v123, v255
    v_mul_f32 v124, v124, v255
    v_mul_f32 v125, v125, v255
    v_mul_f32 v126, v126, v255
    v_mul_f32 v127, v127, v255
    v_cvt_pk_bf16_f32 v112, v112, v113
    v_cvt_pk_bf16_f32 v113, v114, v115
    v_cvt_pk_bf16_f32 v114, v116, v117
    v_cvt_pk_bf16_f32 v115, v118, v119
    v_cvt_pk_bf16_f32 v116, v120, v121
    v_cvt_pk_bf16_f32 v117, v122, v123
    v_cvt_pk_bf16_f32 v118, v124, v125
    v_cvt_pk_bf16_f32 v119, v126, v127
K2_NEXT:
    v_lshrrev_b32 v254, 4, v248
    v_lshrrev_b32 v255, 5, v254
    v_bfe_u32 v253, v254, 2, 2
    v_lshl_add_u32 v255, v255, 2, v253
    v_lshlrev_b32 v255, 7, v255
    v_bfe_u32 v253, v254, 4, 1
    v_lshl_add_u32 v255, v253, 5, v255
    v_and_b32 v253, 3, v254
    v_lshl_add_u32 v255, v253, 3, v255
    v_bfe_u32 v253, v254, 3, 1
    v_lshl_add_u32 v252, v253, 6, v255
    s_mov_b32 s13, 0
    s_sub_u32 s27, s10, 7
    s_cmp_ge_u32 s10, 7
    s_cselect_b32 s14, s27, s10
    s_lshl_b32 s27, s8, 11
    s_add_u32 s27, s27, 147456
    v_add_u32 v254, s27, v248
K2_YLOOP:
    s_barrier
    s_cmp_lg_u32 s13, 0
    s_cbranch_scc1 K2_YNOA
    ds_read_b128 v[8:11], v254
    ds_read_b128 v[12:15], v254 offset:1024
K2_YNOA:
    s_and_b32 s27, s13, 3
    s_mul_i32 s27, s27, 36864
    v_add_u32 v250, s27, v252
    v_xor_b32 v251, 64, v250
    s_mul_i32 s30, s16, 14
    s_lshl_b32 s27, s14, 1
    s_add_u32 s30, s30, s27
    s_lshl_b32 s30, s30, 4
    s_add_u32 s30, s30, s9
    s_lshl_b32 s30, s30, 11
    s_add_u32 s30, s30, 0x8000000
    ds_read_b64_tr_b16 v[128:129], v250 offset:0
    ds_read_b64_tr_b16 v[130:131], v250 offset:1024
    ds_read_b64_tr_b16 v[132:133], v250 offset:2048
    ds_read_b64_tr_b16 v[134:135], v250 offset:3072
    ds_read_b64_tr_b16 v[136:137], v250 offset:4096
    ds_read_b64_tr_b16 v[138:139], v250 offset:5120
    ds_read_b64_tr_b16 v[140:141], v250 offset:6144
    ds_read_b64_tr_b16 v[142:143], v250 offset:7168
    ds_read_b64_tr_b16 v[144:145], v250 offset:8192
    ds_read_b64_tr_b16 v[146:147], v250 offset:9216
    ds_read_b64_tr_b16 v[148:149], v250 offset:10240
    ds_read_b64_tr_b16 v[150:151], v250 offset:11264
    s_waitcnt lgkmcnt(10)
    v_mfma_f32_32x32x16_bf16 v[192:207], v[128:131], v[0:3], 0
    ds_read_b64_tr_b16 v[152:153], v250 offset:12288
    ds_read_b64_tr_b16 v[154:155], v250 offset:13312
    s_waitcnt lgkmcnt(10)
    v_mfma_f32_32x32x16_bf16 v[192:207], v[132:135], v[4:7], v[192:207]
    ds_read_b64_tr_b16 v[156:157], v250 offset:14336
    ds_read_b64_tr_b16 v[158:159], v250 offset:15360
    s_waitcnt lgkmcnt(10)
    v_mfma_f32_32x32x16_bf16 v[192:207], v[136:139], v[16:19], v[192:207]
    ds_read_b64_tr_b16 v[160:161], v250 offset:16384
    ds_read_b64_tr_b16 v[162:163], v250 offset:17408
    s_waitcnt lgkmcnt(10)
    v_mfma_f32_32x32x16_bf16 v[192:207], v[140:143], v[20:23], v[192:207]
    ds_read_b64_tr_b16 v[164:165], v250 offset:18432
    ds_read_b64_tr_b16 v[166:167], v250 offset:19456
    s_waitcnt lgkmcnt(10)
    v_mfma_f32_32x32x16_bf16 v[192:207], v[144:147], v[32:35], v[192:207]
    ds_read_b64_tr_b16 v[168:169], v250 offset:20480
    ds_read_b64_tr_b16 v[170:171], v250 offset:21504
    s_waitcnt lgkmcnt(10)
    v_mfma_f32_32x32x16_bf16 v[192:207], v[148:151], v[36:39], v[192:207]
    ds_read_b64_tr_b16 v[172:173], v250 offset:22528
    ds_read_b64_tr_b16 v[174:175], v250 offset:23552
    s_waitcnt lgkmcnt(10)
    v_mfma_f32_32x32x16_bf16 v[192:207], v[152:155], v[48:51], v[192:207]
    ds_read_b64_tr_b16 v[176:177], v250 offset:24576
    ds_read_b64_tr_b16 v[178:179], v250 offset:25600
    s_waitcnt lgkmcnt(10)
    v_mfma_f32_32x32x16_bf16 v[192:207], v[156:159], v[52:55], v[192:207]
    ds_read_b64_tr_b16 v[180:181], v250 offset:26624
    ds_read_b64_tr_b16 v[182:183], v250 offset:27648
    s_waitcnt lgkmcnt(10)
    v_mfma_f32_32x32x16_bf16 v[192:207], v[160:163], v[64:67], v[192:207]
    ds_read_b64_tr_b16 v[184:185], v250 offset:28672
    ds_read_b64_tr_b16 v[186:187], v250 offset:29696
    s_waitcnt lgkmcnt(10)
    v_mfma_f32_32x32x16_bf16 v[192:207], v[164:167], v[68:71], v[192:207]
    ds_read_b64_tr_b16 v[188:189], v250 offset:30720
    ds_read_b64_tr_b16 v[190:191], v250 offset:31744
    s_waitcnt lgkmcnt(10)
    v_mfma_f32_32x32x16_bf16 v[192:207], v[168:171], v[80:83], v[192:207]
    ds_read_b64_tr_b16 v[128:129], v250 offset:32768
    ds_read_b64_tr_b16 v[130:131], v250 offset:33792
    s_waitcnt lgkmcnt(10)
    v_mfma_f32_32x32x16_bf16 v[192:207], v[172:175], v[84:87], v[192:207]
    ds_read_b64_tr_b16 v[132:133], v250 offset:34816
    ds_read_b64_tr_b16 v[134:135], v250 offset:35840
    s_waitcnt lgkmcnt(10)
    v_mfma_f32_32x32x16_bf16 v[192:207], v[176:179], v[96:99], v[192:207]
    ds_read_b64_tr_b16 v[136:137], v251 offset:0
    ds_read_b64_tr_b16 v[138:139], v251 offset:1024
    s_waitcnt lgkmcnt(10)
    v_mfma_f32_32x32x16_bf16 v[192:207], v[180:183], v[100:103], v[192:207]
    ds_read_b64_tr_b16 v[140:141], v251 offset:2048
    ds_read_b64_tr_b16 v[142:143], v251 offset:3072
    s_waitcnt lgkmcnt(10)
    v_mfma_f32_32x32x16_bf16 v[192:207], v[184:187], v[112:115], v[192:207]
    ds_read_b64_tr_b16 v[144:145], v251 offset:4096
    ds_read_b64_tr_b16 v[146:147], v251 offset:5120
    s_waitcnt lgkmcnt(10)
    v_mfma_f32_32x32x16_bf16 v[192:207], v[188:191], v[116:119], v[192:207]
    ds_read_b64_tr_b16 v[148:149], v251 offset:6144
    ds_read_b64_tr_b16 v[150:151], v251 offset:7168
    s_waitcnt lgkmcnt(10)
    v_mfma_f32_32x32x16_bf16 v[192:207], v[128:131], v[8:11], v[192:207]
    ds_read_b64_tr_b16 v[152:153], v251 offset:8192
    ds_read_b64_tr_b16 v[154:155], v251 offset:9216
    s_waitcnt lgkmcnt(10)
    v_mfma_f32_32x32x16_bf16 v[192:207], v[132:135], v[12:15], v[192:207]
    ds_read_b64_tr_b16 v[156:157], v251 offset:10240
    ds_read_b64_tr_b16 v[158:159], v251 offset:11264
    s_waitcnt lgkmcnt(10)
    v_mfma_f32_32x32x16_bf16 v[208:223], v[136:139], v[0:3], 0
    ds_read_b64_tr_b16 v[160:161], v251 offset:12288
    ds_read_b64_tr_b16 v[162:163], v251 offset:13312
    s_waitcnt lgkmcnt(10)
    v_mfma_f32_32x32x16_bf16 v[208:223], v[140:143], v[4:7], v[208:223]
    ds_read_b64_tr_b16 v[164:165], v251 offset:14336
    ds_read_b64_tr_b16 v[166:167], v251 offset:15360
    s_waitcnt lgkmcnt(10)
    v_mfma_f32_32x32x16_bf16 v[208:223], v[144:147], v[16:19], v[208:223]
    ds_read_b64_tr_b16 v[168:169], v251 offset:16384
    ds_read_b64_tr_b16 v[170:171], v251 offset:17408
    s_waitcnt lgkmcnt(10)
    v_mfma_f32_32x32x16_bf16 v[208:223], v[148:151], v[20:23], v[208:223]
    ds_read_b64_tr_b16 v[172:173], v251 offset:18432
    ds_read_b64_tr_b16 v[174:175], v251 offset:19456
    s_waitcnt lgkmcnt(10)
    v_mfma_f32_32x32x16_bf16 v[208:223], v[152:155], v[32:35], v[208:223]
    ds_read_b64_tr_b16 v[176:177], v251 offset:20480
    ds_read_b64_tr_b16 v[178:179], v251 offset:21504
    s_waitcnt lgkmcnt(10)
    v_mfma_f32_32x32x16_bf16 v[208:223], v[156:159], v[36:39], v[208:223]
    ds_read_b64_tr_b16 v[180:181], v251 offset:22528
    ds_read_b64_tr_b16 v[182:183], v251 offset:23552
    v_cvt_pk_bf16_f32 v224, v192, v193
    s_waitcnt lgkmcnt(10)
    v_mfma_f32_32x32x16_bf16 v[208:223], v[160:163], v[48:51], v[208:223]
    ds_read_b64_tr_b16 v[184:185], v251 offset:24576
    ds_read_b64_tr_b16 v[186:187], v251 offset:25600
    v_cvt_pk_bf16_f32 v225, v194, v195
    s_waitcnt lgkmcnt(10)
    v_mfma_f32_32x32x16_bf16 v[208:223], v[164:167], v[52:55], v[208:223]
    ds_read_b64_tr_b16 v[188:189], v251 offset:26624
    ds_read_b64_tr_b16 v[190:191], v251 offset:27648
    v_cvt_pk_bf16_f32 v226, v196, v197
    s_waitcnt lgkmcnt(10)
    v_mfma_f32_32x32x16_bf16 v[208:223], v[168:171], v[64:67], v[208:223]
    ds_read_b64_tr_b16 v[128:129], v251 offset:28672
    ds_read_b64_tr_b16 v[130:131], v251 offset:29696
    v_cvt_pk_bf16_f32 v227, v198, v199
    s_waitcnt lgkmcnt(10)
    v_mfma_f32_32x32x16_bf16 v[208:223], v[172:175], v[68:71], v[208:223]
    ds_read_b64_tr_b16 v[132:133], v251 offset:30720
    ds_read_b64_tr_b16 v[134:135], v251 offset:31744
    v_cvt_pk_bf16_f32 v228, v200, v201
    s_waitcnt lgkmcnt(10)
    v_mfma_f32_32x32x16_bf16 v[208:223], v[176:179], v[80:83], v[208:223]
    ds_read_b64_tr_b16 v[136:137], v251 offset:32768
    ds_read_b64_tr_b16 v[138:139], v251 offset:33792
    v_cvt_pk_bf16_f32 v229, v202, v203
    s_waitcnt lgkmcnt(10)
    v_mfma_f32_32x32x16_bf16 v[208:223], v[180:183], v[84:87], v[208:223]
    ds_read_b64_tr_b16 v[140:141], v251 offset:34816
    ds_read_b64_tr_b16 v[142:143], v251 offset:35840
    v_cvt_pk_bf16_f32 v230, v204, v205
    s_waitcnt lgkmcnt(10)
    v_mfma_f32_32x32x16_bf16 v[208:223], v[184:187], v[96:99], v[208:223]
    v_cvt_pk_bf16_f32 v231, v206, v207
    s_waitcnt lgkmcnt(8)
    v_mfma_f32_32x32x16_bf16 v[208:223], v[188:191], v[100:103], v[208:223]
    buffer_store_dwordx4 v[224:227], v248, s[4:7], s30 offen offset:0 sc1
    s_waitcnt lgkmcnt(6)
    v_mfma_f32_32x32x16_bf16 v[208:223], v[128:131], v[112:115], v[208:223]
    buffer_store_dwordx4 v[228:231], v248, s[4:7], s30 offen offset:1024 sc1
    s_waitcnt lgkmcnt(4)
    v_mfma_f32_32x32x16_bf16 v[208:223], v[132:135], v[116:119], v[208:223]
    s_waitcnt lgkmcnt(2)
    v_mfma_f32_32x32x16_bf16 v[208:223], v[136:139], v[8:11], v[208:223]
    s_waitcnt lgkmcnt(0)
    v_mfma_f32_32x32x16_bf16 v[208:223], v[140:143], v[12:15], v[208:223]
    s_add_u32 s30, s30, 32768
    s_add_u32 s13, s13, 1
    s_add_u32 s14, s14, 1
    s_cmp_ge_u32 s14, 7
    s_cselect_b32 s14, 0, s14
    s_nop 7
    v_cvt_pk_bf16_f32 v232, v208, v209
    v_cvt_pk_bf16_f32 v233, v210, v211
    v_cvt_pk_bf16_f32 v234, v212, v213
    v_cvt_pk_bf16_f32 v235, v214, v215
    v_cvt_pk_bf16_f32 v236, v216, v217
    v_cvt_pk_bf16_f32 v237, v218, v219
    v_cvt_pk_bf16_f32 v238, v220, v221
    v_cvt_pk_bf16_f32 v239, v222, v223
    buffer_store_dwordx4 v[232:235], v248, s[4:7], s30 offen offset:0 sc1
    buffer_store_dwordx4 v[236:239], v248, s[4:7], s30 offen offset:1024 sc1
    s_cmp_lt_u32 s13, 7
    s_cbranch_scc1 K2_YLOOP
    v_mov_b32 v0, v248
    s_branch K2_RED
    s_branch K2_DONE
K2_PUBLISH:
    s_mov_b32 s12, s10
    s_mov_b32 s13, 0
    s_lshl_b32 s14, s10, 2
    s_add_u32 s14, s14, 4
    s_mov_b32 s15, 0
    s_lshl_b32 s27, s9, 6
    s_lshl_b32 s28, s12, 2
    s_add_u32 s16, s28, s8
    s_add_u32 s27, s27, s16
    s_lshl_b32 s27, s27, 14
    s_add_u32 s27, s27, 0x2000000
    buffer_load_dwordx4 v[128:131], v248, s[4:7], s27 offen offset:0
    buffer_load_dwordx4 v[132:135], v248, s[4:7], s27 offen offset:1024
    buffer_load_dwordx4 v[136:139], v248, s[4:7], s27 offen offset:2048
    buffer_load_dwordx4 v[140:143], v248, s[4:7], s27 offen offset:3072
    s_add_u32 s27, s27, 4096
    buffer_load_dwordx4 v[144:147], v248, s[4:7], s27 offen offset:0
    buffer_load_dwordx4 v[148:151], v248, s[4:7], s27 offen offset:1024
    buffer_load_dwordx4 v[152:155], v248, s[4:7], s27 offen offset:2048
    buffer_load_dwordx4 v[156:159], v248, s[4:7], s27 offen offset:3072
    s_add_u32 s27, s27, 4096
    buffer_load_dwordx4 v[160:163], v248, s[4:7], s27 offen offset:0
    buffer_load_dwordx4 v[164:167], v248, s[4:7], s27 offen offset:1024
    buffer_load_dwordx4 v[168:171], v248, s[4:7], s27 offen offset:2048
    buffer_load_dwordx4 v[172:175], v248, s[4:7], s27 offen offset:3072
    s_add_u32 s27, s27, 4096
    buffer_load_dwordx4 v[176:179], v248, s[4:7], s27 offen offset:0
    buffer_load_dwordx4 v[180:183], v248, s[4:7], s27 offen offset:1024
    buffer_load_dwordx4 v[184:187], v248, s[4:7], s27 offen offset:2048
    buffer_load_dwordx4 v[188:191], v248, s[4:7], s27 offen offset:3072
    s_mov_b32 s27, s31
    buffer_store_dwordx4 v[0:3], v248, s[4:7], s27 offen offset:0 sc1
    buffer_store_dwordx4 v[4:7], v248, s[4:7], s27 offen offset:1024 sc1
    buffer_store_dwordx4 v[8:11], v248, s[4:7], s27 offen offset:2048 sc1
    buffer_store_dwordx4 v[12:15], v248, s[4:7], s27 offen offset:3072 sc1
    s_add_u32 s27, s27, 4096
    buffer_store_dwordx4 v[16:19], v248, s[4:7], s27 offen offset:0 sc1
    buffer_store_dwordx4 v[20:23], v248, s[4:7], s27 offen offset:1024 sc1
    buffer_store_dwordx4 v[24:27], v248, s[4:7], s27 offen offset:2048 sc1
    buffer_store_dwordx4 v[28:31], v248, s[4:7], s27 offen offset:3072 sc1
    s_add_u32 s27, s27, 4096
    buffer_store_dwordx4 v[32:35], v248, s[4:7], s27 offen offset:0 sc1
    buffer_store_dwordx4 v[36:39], v248, s[4:7], s27 offen offset:1024 sc1
    buffer_store_dwordx4 v[40:43], v248, s[4:7], s27 offen offset:2048 sc1
    buffer_store_dwordx4 v[44:47], v248, s[4:7], s27 offen offset:3072 sc1
    s_add_u32 s27, s27, 4096
    buffer_store_dwordx4 v[48:51], v248, s[4:7], s27 offen offset:0 sc1
    buffer_store_dwordx4 v[52:55], v248, s[4:7], s27 offen offset:1024 sc1
    buffer_store_dwordx4 v[56:59], v248, s[4:7], s27 offen offset:2048 sc1
    buffer_store_dwordx4 v[60:63], v248, s[4:7], s27 offen offset:3072 sc1
    s_add_u32 s27, s27, 4096
    buffer_store_dwordx4 v[64:67], v248, s[4:7], s27 offen offset:0 sc1
    buffer_store_dwordx4 v[68:71], v248, s[4:7], s27 offen offset:1024 sc1
    buffer_store_dwordx4 v[72:75], v248, s[4:7], s27 offen offset:2048 sc1
    buffer_store_dwordx4 v[76:79], v248, s[4:7], s27 offen offset:3072 sc1
    s_add_u32 s27, s27, 4096
    buffer_store_dwordx4 v[80:83], v248, s[4:7], s27 offen offset:0 sc1
    buffer_store_dwordx4 v[84:87], v248, s[4:7], s27 offen offset:1024 sc1
    buffer_store_dwordx4 v[88:91], v248, s[4:7], s27 offen offset:2048 sc1
    buffer_store_dwordx4 v[92:95], v248, s[4:7], s27 offen offset:3072 sc1
    s_add_u32 s27, s27, 4096
    buffer_store_dwordx4 v[96:99], v248, s[4:7], s27 offen offset:0 sc1
    buffer_store_dwordx4 v[100:103], v248, s[4:7], s27 offen offset:1024 sc1
    buffer_store_dwordx4 v[104:107], v248, s[4:7], s27 offen offset:2048 sc1
    buffer_store_dwordx4 v[108:111], v248, s[4:7], s27 offen offset:3072 sc1
    s_add_u32 s27, s27, 4096
    buffer_store_dwordx4 v[112:115], v248, s[4:7], s27 offen offset:0 sc1
    buffer_store_dwordx4 v[116:119], v248, s[4:7], s27 offen offset:1024 sc1
    buffer_store_dwordx4 v[120:123], v248, s[4:7], s27 offen offset:2048 sc1
    buffer_store_dwordx4 v[124:127], v248, s[4:7], s27 offen offset:3072 sc1
    s_add_u32 s27, s27, 4096
    v_mov_b32 v192, v250
    v_mov_b32 v193, v251
    v_mov_b32 v194, 0
    v_mov_b32 v195, 0
    buffer_store_dwordx4 v[192:195], v248, s[4:7], s27 offen sc1
    s_mov_b32 s44, 2
    s_nop 1
    s_branch K2_SEG
K2_COMBINE:
    v_mov_b32 v255, 0
    s_mov_b32 s34, 0x40000
    s_waitcnt vmcnt(0)
    v_readfirstlane_b32 s27, v253
    s_cmp_eq_u32 s27, 1
    s_cbranch_scc1 K2_POLL_OK
K2_POLL:
    buffer_load_dword v254, v255, s[4:7], s32 offen sc1
    s_waitcnt vmcnt(0)
    v_readfirstlane_b32 s27, v254
    s_cmp_eq_u32 s27, 1
    s_cbranch_scc1 K2_POLL_OK
    s_sleep 2
    s_sub_u32 s34, s34, 1
    s_cmp_lg_u32 s34, 0
    s_cbranch_scc1 K2_POLL
K2_POLL_OK:
    s_waitcnt lgkmcnt(0)
    s_add_u32 s27, s31, 32768
    buffer_load_dwordx4 v[224:227], v248, s[4:7], s27 offen sc1
    s_mov_b32 s27, s31
    buffer_load_dwordx4 v[128:131], v248, s[4:7], s27 offen offset:0 sc1
    buffer_load_dwordx4 v[132:135], v248, s[4:7], s27 offen offset:1024 sc1
    buffer_load_dwordx4 v[136:139], v248, s[4:7], s27 offen offset:2048 sc1
    buffer_load_dwordx4 v[140:143], v248, s[4:7], s27 offen offset:3072 sc1
    s_add_u32 s27, s27, 4096
    buffer_load_dwordx4 v[144:147], v248, s[4:7], s27 offen offset:0 sc1
    buffer_load_dwordx4 v[148:151], v248, s[4:7], s27 offen offset:1024 sc1
    buffer_load_dwordx4 v[152:155], v248, s[4:7], s27 offen offset:2048 sc1
    buffer_load_dwordx4 v[156:159], v248, s[4:7], s27 offen offset:3072 sc1
    s_add_u32 s27, s27, 4096
    buffer_load_dwordx4 v[160:163], v248, s[4:7], s27 offen offset:0 sc1
    buffer_load_dwordx4 v[164:167], v248, s[4:7], s27 offen offset:1024 sc1
    buffer_load_dwordx4 v[168:171], v248, s[4:7], s27 offen offset:2048 sc1
    buffer_load_dwordx4 v[172:175], v248, s[4:7], s27 offen offset:3072 sc1
    s_add_u32 s27, s27, 4096
    buffer_load_dwordx4 v[176:179], v248, s[4:7], s27 offen offset:0 sc1
    buffer_load_dwordx4 v[180:183], v248, s[4:7], s27 offen offset:1024 sc1
    buffer_load_dwordx4 v[184:187], v248, s[4:7], s27 offen offset:2048 sc1
    buffer_load_dwordx4 v[188:191], v248, s[4:7], s27 offen offset:3072 sc1
    s_add_u32 s27, s27, 4096
    s_waitcnt vmcnt(16)
    v_max_f32 v253, v250, v224
    v_sub_f32 v254, v250, v253
    v_sub_f32 v255, v224, v253
    v_exp_f32 v254, v254
    v_exp_f32 v255, v255
    s_nop 0
    v_mul_f32 v251, v251, v254
    v_fma_f32 v251, v225, v255, v251
    v_rcp_f32 v251, v251
    s_nop 0
    v_mul_f32 v251, v251, v252
    v_mul_f32 v254, v254, v251
    v_mul_f32 v255, v255, v251
    s_waitcnt vmcnt(0)
    v_mul_f32 v0, v0, v254
    v_fma_f32 v0, v128, v255, v0
    v_mul_f32 v1, v1, v254
    v_fma_f32 v1, v129, v255, v1
    v_mul_f32 v2, v2, v254
    v_fma_f32 v2, v130, v255, v2
    v_mul_f32 v3, v3, v254
    v_fma_f32 v3, v131, v255, v3
    v_mul_f32 v4, v4, v254
    v_fma_f32 v4, v132, v255, v4
    v_mul_f32 v5, v5, v254
    v_fma_f32 v5, v133, v255, v5
    v_mul_f32 v6, v6, v254
    v_fma_f32 v6, v134, v255, v6
    v_mul_f32 v7, v7, v254
    v_fma_f32 v7, v135, v255, v7
    v_mul_f32 v8, v8, v254
    v_fma_f32 v8, v136, v255, v8
    v_mul_f32 v9, v9, v254
    v_fma_f32 v9, v137, v255, v9
    v_mul_f32 v10, v10, v254
    v_fma_f32 v10, v138, v255, v10
    v_mul_f32 v11, v11, v254
    v_fma_f32 v11, v139, v255, v11
    v_mul_f32 v12, v12, v254
    v_fma_f32 v12, v140, v255, v12
    v_mul_f32 v13, v13, v254
    v_fma_f32 v13, v141, v255, v13
    v_mul_f32 v14, v14, v254
    v_fma_f32 v14, v142, v255, v14
    v_mul_f32 v15, v15, v254
    v_fma_f32 v15, v143, v255, v15
    v_mul_f32 v16, v16, v254
    v_fma_f32 v16, v144, v255, v16
    v_mul_f32 v17, v17, v254
    v_fma_f32 v17, v145, v255, v17
    v_mul_f32 v18, v18, v254
    v_fma_f32 v18, v146, v255, v18
    v_mul_f32 v19, v19, v254
    v_fma_f32 v19, v147, v255, v19
    v_mul_f32 v20, v20, v254
    v_fma_f32 v20, v148, v255, v20
    v_mul_f32 v21, v21, v254
    v_fma_f32 v21, v149, v255, v21
    v_mul_f32 v22, v22, v254
    v_fma_f32 v22, v150, v255, v22
    v_mul_f32 v23, v23, v254
    v_fma_f32 v23, v151, v255, v23
    v_mul_f32 v24, v24, v254
    v_fma_f32 v24, v152, v255, v24
    v_mul_f32 v25, v25, v254
    v_fma_f32 v25, v153, v255, v25
    v_mul_f32 v26, v26, v254
    v_fma_f32 v26, v154, v255, v26
    v_mul_f32 v27, v27, v254
    v_fma_f32 v27, v155, v255, v27
    v_mul_f32 v28, v28, v254
    v_fma_f32 v28, v156, v255, v28
    v_mul_f32 v29, v29, v254
    v_fma_f32 v29, v157, v255, v29
    v_mul_f32 v30, v30, v254
    v_fma_f32 v30, v158, v255, v30
    v_mul_f32 v31, v31, v254
    v_fma_f32 v31, v159, v255, v31
    v_mul_f32 v32, v32, v254
    v_fma_f32 v32, v160, v255, v32
    v_mul_f32 v33, v33, v254
    v_fma_f32 v33, v161, v255, v33
    v_mul_f32 v34, v34, v254
    v_fma_f32 v34, v162, v255, v34
    v_mul_f32 v35, v35, v254
    v_fma_f32 v35, v163, v255, v35
    v_mul_f32 v36, v36, v254
    v_fma_f32 v36, v164, v255, v36
    v_mul_f32 v37, v37, v254
    v_fma_f32 v37, v165, v255, v37
    v_mul_f32 v38, v38, v254
    v_fma_f32 v38, v166, v255, v38
    v_mul_f32 v39, v39, v254
    v_fma_f32 v39, v167, v255, v39
    v_mul_f32 v40, v40, v254
    v_fma_f32 v40, v168, v255, v40
    v_mul_f32 v41, v41, v254
    v_fma_f32 v41, v169, v255, v41
    v_mul_f32 v42, v42, v254
    v_fma_f32 v42, v170, v255, v42
    v_mul_f32 v43, v43, v254
    v_fma_f32 v43, v171, v255, v43
    v_mul_f32 v44, v44, v254
    v_fma_f32 v44, v172, v255, v44
    v_mul_f32 v45, v45, v254
    v_fma_f32 v45, v173, v255, v45
    v_mul_f32 v46, v46, v254
    v_fma_f32 v46, v174, v255, v46
    v_mul_f32 v47, v47, v254
    v_fma_f32 v47, v175, v255, v47
    v_mul_f32 v48, v48, v254
    v_fma_f32 v48, v176, v255, v48
    v_mul_f32 v49, v49, v254
    v_fma_f32 v49, v177, v255, v49
    v_mul_f32 v50, v50, v254
    v_fma_f32 v50, v178, v255, v50
    v_mul_f32 v51, v51, v254
    v_fma_f32 v51, v179, v255, v51
    v_mul_f32 v52, v52, v254
    v_fma_f32 v52, v180, v255, v52
    v_mul_f32 v53, v53, v254
    v_fma_f32 v53, v181, v255, v53
    v_mul_f32 v54, v54, v254
    v_fma_f32 v54, v182, v255, v54
    v_mul_f32 v55, v55, v254
    v_fma_f32 v55, v183, v255, v55
    v_mul_f32 v56, v56, v254
    v_fma_f32 v56, v184, v255, v56
    v_mul_f32 v57, v57, v254
    v_fma_f32 v57, v185, v255, v57
    v_mul_f32 v58, v58, v254
    v_fma_f32 v58, v186, v255, v58
    v_mul_f32 v59, v59, v254
    v_fma_f32 v59, v187, v255, v59
    v_mul_f32 v60, v60, v254
    v_fma_f32 v60, v188, v255, v60
    v_mul_f32 v61, v61, v254
    v_fma_f32 v61, v189, v255, v61
    v_mul_f32 v62, v62, v254
    v_fma_f32 v62, v190, v255, v62
    v_mul_f32 v63, v63, v254
    v_fma_f32 v63, v191, v255, v63
    buffer_load_dwordx4 v[128:131], v248, s[4:7], s27 offen offset:0 sc1
    buffer_load_dwordx4 v[132:135], v248, s[4:7], s27 offen offset:1024 sc1
    buffer_load_dwordx4 v[136:139], v248, s[4:7], s27 offen offset:2048 sc1
    buffer_load_dwordx4 v[140:143], v248, s[4:7], s27 offen offset:3072 sc1
    s_add_u32 s27, s27, 4096
    buffer_load_dwordx4 v[144:147], v248, s[4:7], s27 offen offset:0 sc1
    buffer_load_dwordx4 v[148:151], v248, s[4:7], s27 offen offset:1024 sc1
    buffer_load_dwordx4 v[152:155], v248, s[4:7], s27 offen offset:2048 sc1
    buffer_load_dwordx4 v[156:159], v248, s[4:7], s27 offen offset:3072 sc1
    s_add_u32 s27, s27, 4096
    buffer_load_dwordx4 v[160:163], v248, s[4:7], s27 offen offset:0 sc1
    buffer_load_dwordx4 v[164:167], v248, s[4:7], s27 offen offset:1024 sc1
    buffer_load_dwordx4 v[168:171], v248, s[4:7], s27 offen offset:2048 sc1
    buffer_load_dwordx4 v[172:175], v248, s[4:7], s27 offen offset:3072 sc1
    s_add_u32 s27, s27, 4096
    buffer_load_dwordx4 v[176:179], v248, s[4:7], s27 offen offset:0 sc1
    buffer_load_dwordx4 v[180:183], v248, s[4:7], s27 offen offset:1024 sc1
    buffer_load_dwordx4 v[184:187], v248, s[4:7], s27 offen offset:2048 sc1
    buffer_load_dwordx4 v[188:191], v248, s[4:7], s27 offen offset:3072 sc1
    s_add_u32 s27, s27, 4096
    v_cvt_pk_bf16_f32 v0, v0, v1
    v_cvt_pk_bf16_f32 v1, v2, v3
    v_cvt_pk_bf16_f32 v2, v4, v5
    v_cvt_pk_bf16_f32 v3, v6, v7
    v_cvt_pk_bf16_f32 v4, v8, v9
    v_cvt_pk_bf16_f32 v5, v10, v11
    v_cvt_pk_bf16_f32 v6, v12, v13
    v_cvt_pk_bf16_f32 v7, v14, v15
    v_cvt_pk_bf16_f32 v16, v16, v17
    v_cvt_pk_bf16_f32 v17, v18, v19
    v_cvt_pk_bf16_f32 v18, v20, v21
    v_cvt_pk_bf16_f32 v19, v22, v23
    v_cvt_pk_bf16_f32 v20, v24, v25
    v_cvt_pk_bf16_f32 v21, v26, v27
    v_cvt_pk_bf16_f32 v22, v28, v29
    v_cvt_pk_bf16_f32 v23, v30, v31
    v_cvt_pk_bf16_f32 v32, v32, v33
    v_cvt_pk_bf16_f32 v33, v34, v35
    v_cvt_pk_bf16_f32 v34, v36, v37
    v_cvt_pk_bf16_f32 v35, v38, v39
    v_cvt_pk_bf16_f32 v36, v40, v41
    v_cvt_pk_bf16_f32 v37, v42, v43
    v_cvt_pk_bf16_f32 v38, v44, v45
    v_cvt_pk_bf16_f32 v39, v46, v47
    v_cvt_pk_bf16_f32 v48, v48, v49
    v_cvt_pk_bf16_f32 v49, v50, v51
    v_cvt_pk_bf16_f32 v50, v52, v53
    v_cvt_pk_bf16_f32 v51, v54, v55
    v_cvt_pk_bf16_f32 v52, v56, v57
    v_cvt_pk_bf16_f32 v53, v58, v59
    v_cvt_pk_bf16_f32 v54, v60, v61
    v_cvt_pk_bf16_f32 v55, v62, v63
    s_waitcnt vmcnt(0)
    v_mul_f32 v64, v64, v254
    v_fma_f32 v64, v128, v255, v64
    v_mul_f32 v65, v65, v254
    v_fma_f32 v65, v129, v255, v65
    v_mul_f32 v66, v66, v254
    v_fma_f32 v66, v130, v255, v66
    v_mul_f32 v67, v67, v254
    v_fma_f32 v67, v131, v255, v67
    v_mul_f32 v68, v68, v254
    v_fma_f32 v68, v132, v255, v68
    v_mul_f32 v69, v69, v254
    v_fma_f32 v69, v133, v255, v69
    v_mul_f32 v70, v70, v254
    v_fma_f32 v70, v134, v255, v70
    v_mul_f32 v71, v71, v254
    v_fma_f32 v71, v135, v255, v71
    v_mul_f32 v72, v72, v254
    v_fma_f32 v72, v136, v255, v72
    v_mul_f32 v73, v73, v254
    v_fma_f32 v73, v137, v255, v73
    v_mul_f32 v74, v74, v254
    v_fma_f32 v74, v138, v255, v74
    v_mul_f32 v75, v75, v254
    v_fma_f32 v75, v139, v255, v75
    v_mul_f32 v76, v76, v254
    v_fma_f32 v76, v140, v255, v76
    v_mul_f32 v77, v77, v254
    v_fma_f32 v77, v141, v255, v77
    v_mul_f32 v78, v78, v254
    v_fma_f32 v78, v142, v255, v78
    v_mul_f32 v79, v79, v254
    v_fma_f32 v79, v143, v255, v79
    v_mul_f32 v80, v80, v254
    v_fma_f32 v80, v144, v255, v80
    v_mul_f32 v81, v81, v254
    v_fma_f32 v81, v145, v255, v81
    v_mul_f32 v82, v82, v254
    v_fma_f32 v82, v146, v255, v82
    v_mul_f32 v83, v83, v254
    v_fma_f32 v83, v147, v255, v83
    v_mul_f32 v84, v84, v254
    v_fma_f32 v84, v148, v255, v84
    v_mul_f32 v85, v85, v254
    v_fma_f32 v85, v149, v255, v85
    v_mul_f32 v86, v86, v254
    v_fma_f32 v86, v150, v255, v86
    v_mul_f32 v87, v87, v254
    v_fma_f32 v87, v151, v255, v87
    v_mul_f32 v88, v88, v254
    v_fma_f32 v88, v152, v255, v88
    v_mul_f32 v89, v89, v254
    v_fma_f32 v89, v153, v255, v89
    v_mul_f32 v90, v90, v254
    v_fma_f32 v90, v154, v255, v90
    v_mul_f32 v91, v91, v254
    v_fma_f32 v91, v155, v255, v91
    v_mul_f32 v92, v92, v254
    v_fma_f32 v92, v156, v255, v92
    v_mul_f32 v93, v93, v254
    v_fma_f32 v93, v157, v255, v93
    v_mul_f32 v94, v94, v254
    v_fma_f32 v94, v158, v255, v94
    v_mul_f32 v95, v95, v254
    v_fma_f32 v95, v159, v255, v95
    v_mul_f32 v96, v96, v254
    v_fma_f32 v96, v160, v255, v96
    v_mul_f32 v97, v97, v254
    v_fma_f32 v97, v161, v255, v97
    v_mul_f32 v98, v98, v254
    v_fma_f32 v98, v162, v255, v98
    v_mul_f32 v99, v99, v254
    v_fma_f32 v99, v163, v255, v99
    v_mul_f32 v100, v100, v254
    v_fma_f32 v100, v164, v255, v100
    v_mul_f32 v101, v101, v254
    v_fma_f32 v101, v165, v255, v101
    v_mul_f32 v102, v102, v254
    v_fma_f32 v102, v166, v255, v102
    v_mul_f32 v103, v103, v254
    v_fma_f32 v103, v167, v255, v103
    v_mul_f32 v104, v104, v254
    v_fma_f32 v104, v168, v255, v104
    v_mul_f32 v105, v105, v254
    v_fma_f32 v105, v169, v255, v105
    v_mul_f32 v106, v106, v254
    v_fma_f32 v106, v170, v255, v106
    v_mul_f32 v107, v107, v254
    v_fma_f32 v107, v171, v255, v107
    v_mul_f32 v108, v108, v254
    v_fma_f32 v108, v172, v255, v108
    v_mul_f32 v109, v109, v254
    v_fma_f32 v109, v173, v255, v109
    v_mul_f32 v110, v110, v254
    v_fma_f32 v110, v174, v255, v110
    v_mul_f32 v111, v111, v254
    v_fma_f32 v111, v175, v255, v111
    v_mul_f32 v112, v112, v254
    v_fma_f32 v112, v176, v255, v112
    v_mul_f32 v113, v113, v254
    v_fma_f32 v113, v177, v255, v113
    v_mul_f32 v114, v114, v254
    v_fma_f32 v114, v178, v255, v114
    v_mul_f32 v115, v115, v254
    v_fma_f32 v115, v179, v255, v115
    v_mul_f32 v116, v116, v254
    v_fma_f32 v116, v180, v255, v116
    v_mul_f32 v117, v117, v254
    v_fma_f32 v117, v181, v255, v117
    v_mul_f32 v118, v118, v254
    v_fma_f32 v118, v182, v255, v118
    v_mul_f32 v119, v119, v254
    v_fma_f32 v119, v183, v255, v119
    v_mul_f32 v120, v120, v254
    v_fma_f32 v120, v184, v255, v120
    v_mul_f32 v121, v121, v254
    v_fma_f32 v121, v185, v255, v121
    v_mul_f32 v122, v122, v254
    v_fma_f32 v122, v186, v255, v122
    v_mul_f32 v123, v123, v254
    v_fma_f32 v123, v187, v255, v123
    v_mul_f32 v124, v124, v254
    v_fma_f32 v124, v188, v255, v124
    v_mul_f32 v125, v125, v254
    v_fma_f32 v125, v189, v255, v125
    v_mul_f32 v126, v126, v254
    v_fma_f32 v126, v190, v255, v126
    v_mul_f32 v127, v127, v254
    v_fma_f32 v127, v191, v255, v127
    v_cvt_pk_bf16_f32 v64, v64, v65
    v_cvt_pk_bf16_f32 v65, v66, v67
    v_cvt_pk_bf16_f32 v66, v68, v69
    v_cvt_pk_bf16_f32 v67, v70, v71
    v_cvt_pk_bf16_f32 v68, v72, v73
    v_cvt_pk_bf16_f32 v69, v74, v75
    v_cvt_pk_bf16_f32 v70, v76, v77
    v_cvt_pk_bf16_f32 v71, v78, v79
    v_cvt_pk_bf16_f32 v80, v80, v81
    v_cvt_pk_bf16_f32 v81, v82, v83
    v_cvt_pk_bf16_f32 v82, v84, v85
    v_cvt_pk_bf16_f32 v83, v86, v87
    v_cvt_pk_bf16_f32 v84, v88, v89
    v_cvt_pk_bf16_f32 v85, v90, v91
    v_cvt_pk_bf16_f32 v86, v92, v93
    v_cvt_pk_bf16_f32 v87, v94, v95
    v_cvt_pk_bf16_f32 v96, v96, v97
    v_cvt_pk_bf16_f32 v97, v98, v99
    v_cvt_pk_bf16_f32 v98, v100, v101
    v_cvt_pk_bf16_f32 v99, v102, v103
    v_cvt_pk_bf16_f32 v100, v104, v105
    v_cvt_pk_bf16_f32 v101, v106, v107
    v_cvt_pk_bf16_f32 v102, v108, v109
    v_cvt_pk_bf16_f32 v103, v110, v111
    v_cvt_pk_bf16_f32 v112, v112, v113
    v_cvt_pk_bf16_f32 v113, v114, v115
    v_cvt_pk_bf16_f32 v114, v116, v117
    v_cvt_pk_bf16_f32 v115, v118, v119
    v_cvt_pk_bf16_f32 v116, v120, v121
    v_cvt_pk_bf16_f32 v117, v122, v123
    v_cvt_pk_bf16_f32 v118, v124, v125
    v_cvt_pk_bf16_f32 v119, v126, v127
    s_branch K2_NEXT
K2_DONE:
    s_endpgm
K2_AWAVE:
    s_setprio 1
    s_sub_u32 s40, s8, 4
    s_mov_b32 s68, s66
    s_mov_b32 s69, s67
    s_mov_b32 s70, 0x62000
    s_mov_b32 s71, 0x20000
    s_mov_b32 s66, 0x380000
    s_mov_b32 s67, 0x20000
    v_lshlrev_b32 v96, 4, v2
    s_lshl_b32 s26, s40, 12
    s_lshl_b32 s48, s40, 11
    v_add_u32 v97, s26, v96
    v_add_u32 v109, s48, v96
    v_add_u32 v98, 0x20000, v96
    v_lshrrev_b32 v3, 5, v2
    v_bfe_u32 v4, v2, 2, 2
    v_lshl_add_u32 v3, v3, 2, v4
    v_lshlrev_b32 v3, 6, v3
    v_bfe_u32 v4, v2, 4, 1
    v_and_b32 v5, 1, v2
    v_lshl_add_u32 v4, v4, 1, v5
    v_bfe_u32 v5, v2, 1, 1
    v_lshl_add_u32 v4, v4, 1, v5
    v_lshl_add_u32 v3, v4, 3, v3
    v_add_u32 v99, 0x20800, v3
    s_sub_u32 s27, 15, s10
    s_cmp_eq_u32 s11, 0
    s_cselect_b32 s27, s10, s27
    s_lshl_b32 s41, s27, 2
    s_add_u32 s41, s41, s40
    s_lshl_b32 s43, s9, 18
    s_add_u32 s43, s43, 0x3200000
    s_mov_b32 s44, 0x42000000
    v_and_b32 v3, 7, v2
    s_lshl_b32 s28, s10, 5
    s_lshl_b32 s29, s40, 3
    s_add_u32 s28, s28, s29
    v_add_u32 v3, s28, v3
    v_lshlrev_b32 v3, 7, v3
    s_mul_i32 s28, s11, 36
    s_sub_u32 s28, 36, s28
    s_lshl_b32 s28, s28, 15
    v_add_u32 v3, s28, v3
    s_lshl_b32 s28, s27, 2
    s_add_u32 s28, s28, s40
    s_lshl_b32 s28, s28, 7
    v_mov_b32 v4, s28
    v_and_b32 v5, 8, v2
    v_cmp_ne_u32 vcc, 0, v5
    s_nop 1
    v_cndmask_b32 v104, v3, v4, vcc
    v_mov_b32 v3, 0x8000
    v_mov_b32 v4, 0x2000
    v_cndmask_b32 v105, v3, v4, vcc
    v_mov_b32 v3, 0x1fffff
    v_mov_b32 v4, 0x3ffff
    v_cndmask_b32 v106, v3, v4, vcc
    v_mov_b32 v3, s19
    v_mov_b32 v4, s43
    v_cndmask_b32 v107, v3, v4, vcc
    s_lshl_b32 s45, s22, 15
    s_add_u32 s45, s45, s19
    s_add_u32 s46, s45, 0x4000
    s_mov_b32 s49, 0
    s_mov_b32 s50, 0
    s_mov_b32 s47, s43
    s_add_u32 s42, s43, 0x40000
    s_lshl_b32 s27, s9, 6
    s_add_u32 s27, s27, s41
    s_lshl_b32 s27, s27, 11
    s_add_u32 s27, s27, 0x3000000
    buffer_load_dwordx4 v[32:35], v96, s[4:7], s27 offen offset:0
    buffer_load_dwordx4 v[36:39], v96, s[4:7], s27 offen offset:1024
    v_and_b32 v3, 31, v2
    v_lshlrev_b32 v3, 2, v3
    s_lshl_b32 s27, s41, 7
    s_add_u32 s27, s27, 0x4c00000
    buffer_load_dword v103, v3, s[4:7], s27 offen
    s_add_u32 m0, s26, 0x0
    s_cmp_lt_u32 s49, s21
    s_cselect_b32 s28, s45, 0x7ff00000
    buffer_load_dwordx4 v97, s[4:7], s28 offen offset:0 lds
    buffer_load_dwordx4 v97, s[4:7], s28 offen offset:1024 lds
    buffer_load_dwordx4 v97, s[4:7], s28 offen offset:2048 lds
    buffer_load_dwordx4 v97, s[4:7], s28 offen offset:3072 lds
    s_add_u32 s49, s49, 1
    s_add_u32 s45, s45, 0x8000
    s_add_u32 s28, s19, 0x0
    s_cmp_eq_u32 s49, s20
    s_cselect_b32 s45, s28, s45
    s_add_u32 m0, s48, 0x20000
    s_cmp_lt_u32 s47, s42
    s_cselect_b32 s28, s47, 0x7ff00000
    buffer_load_dwordx4 v109, s[4:7], s28 offen offset:0 lds
    buffer_load_dwordx4 v109, s[4:7], s28 offen offset:1024 lds
    s_add_u32 s47, s47, 0x2000
    s_add_u32 m0, s26, 0x4000
    s_cmp_lt_u32 s49, s21
    s_cselect_b32 s28, s45, 0x7ff00000
    buffer_load_dwordx4 v97, s[4:7], s28 offen offset:0 lds
    buffer_load_dwordx4 v97, s[4:7], s28 offen offset:1024 lds
    buffer_load_dwordx4 v97, s[4:7], s28 offen offset:2048 lds
    buffer_load_dwordx4 v97, s[4:7], s28 offen offset:3072 lds
    s_add_u32 s49, s49, 1
    s_add_u32 s45, s45, 0x8000
    s_add_u32 s28, s19, 0x0
    s_cmp_eq_u32 s49, s20
    s_cselect_b32 s45, s28, s45
    s_add_u32 m0, s48, 0x22000
    s_cmp_lt_u32 s47, s42
    s_cselect_b32 s28, s47, 0x7ff00000
    buffer_load_dwordx4 v109, s[4:7], s28 offen offset:0 lds
    buffer_load_dwordx4 v109, s[4:7], s28 offen offset:1024 lds
    s_add_u32 s47, s47, 0x2000
    s_add_u32 m0, s26, 0x10000
    s_cmp_lt_u32 s50, s21
    s_cselect_b32 s28, s46, 0x7ff00000
    buffer_load_dwordx4 v97, s[4:7], s28 offen offset:0 lds
    buffer_load_dwordx4 v97, s[4:7], s28 offen offset:1024 lds
    buffer_load_dwordx4 v97, s[4:7], s28 offen offset:2048 lds
    buffer_load_dwordx4 v97, s[4:7], s28 offen offset:3072 lds
    s_add_u32 s50, s50, 1
    s_add_u32 s46, s46, 0x8000
    s_add_u32 s28, s19, 0x4000
    s_cmp_eq_u32 s50, s20
    s_cselect_b32 s46, s28, s46
    s_add_u32 m0, s26, 0x8000
    s_cmp_lt_u32 s49, s21
    s_cselect_b32 s28, s45, 0x7ff00000
    buffer_load_dwordx4 v97, s[4:7], s28 offen offset:0 lds
    buffer_load_dwordx4 v97, s[4:7], s28 offen offset:1024 lds
    buffer_load_dwordx4 v97, s[4:7], s28 offen offset:2048 lds
    buffer_load_dwordx4 v97, s[4:7], s28 offen offset:3072 lds
    s_add_u32 s49, s49, 1
    s_add_u32 s45, s45, 0x8000
    s_add_u32 s28, s19, 0x0
    s_cmp_eq_u32 s49, s20
    s_cselect_b32 s45, s28, s45
    s_add_u32 m0, s48, 0x24000
    s_cmp_lt_u32 s47, s42
    s_cselect_b32 s28, s47, 0x7ff00000
    buffer_load_dwordx4 v109, s[4:7], s28 offen offset:0 lds
    buffer_load_dwordx4 v109, s[4:7], s28 offen offset:1024 lds
    s_add_u32 s47, s47, 0x2000
    s_add_u32 m0, s26, 0x14000
    s_cmp_lt_u32 s50, s21
    s_cselect_b32 s28, s46, 0x7ff00000
    buffer_load_dwordx4 v97, s[4:7], s28 offen offset:0 lds
    buffer_load_dwordx4 v97, s[4:7], s28 offen offset:1024 lds
    buffer_load_dwordx4 v97, s[4:7], s28 offen offset:2048 lds
    buffer_load_dwordx4 v97, s[4:7], s28 offen offset:3072 lds
    s_add_u32 s50, s50, 1
    s_add_u32 s46, s46, 0x8000
    s_add_u32 s28, s19, 0x4000
    s_cmp_eq_u32 s50, s20
    s_cselect_b32 s46, s28, s46
    v_mov_b32 v0, 0
    v_mov_b32 v1, 0
    v_mov_b32 v2, 0
    v_mov_b32 v3, 0
    v_mov_b32 v4, 0
    v_mov_b32 v5, 0
    v_mov_b32 v6, 0
    v_mov_b32 v7, 0
    v_mov_b32 v8, 0
    v_mov_b32 v9, 0
    v_mov_b32 v10, 0
    v_mov_b32 v11, 0
    v_mov_b32 v12, 0
    v_mov_b32 v13, 0
    v_mov_b32 v14, 0
    v_mov_b32 v15, 0
    s_mov_b32 s51, 0
    s_mov_b32 s52, 0x7ff00000
K2A_LOOP:
    s_waitcnt vmcnt(14) lgkmcnt(0)
    s_barrier
    s_cmp_lg_u32 s51, 0
    s_cbranch_scc1 K2A_NOINIT_57
    ds_read_b128 v[72:75], v98 offset:0
    ds_read_b128 v[76:79], v98 offset:1024
    ds_read_b128 v[80:83], v98 offset:4096
    ds_read_b128 v[84:87], v98 offset:5120
    s_waitcnt lgkmcnt(2)
    v_mfma_f32_32x32x16_bf16 v[40:55], v[72:75], v[32:35], 0
    v_mfma_f32_32x32x16_bf16 v[40:55], v[76:79], v[36:39], v[40:55]
    s_nop 7
    s_nop 7
    v_max3_f32 v100, v40, v41, v42
    v_max3_f32 v100, v100, v43, v44
    v_max3_f32 v100, v100, v45, v46
    v_max3_f32 v100, v100, v47, v48
    v_max3_f32 v100, v100, v49, v50
    v_max3_f32 v100, v100, v51, v52
    v_max3_f32 v100, v100, v53, v54
    v_max_f32 v100, v100, v55
    v_mov_b32 v101, v100
    s_nop 1
    v_permlane32_swap_b32 v100, v101
    s_nop 1
    v_max_f32 v100, v100, v101
    v_sub_f32 v40, v40, v100
    v_sub_f32 v16, 0, v100
    v_sub_f32 v41, v41, v100
    v_sub_f32 v17, 0, v100
    v_sub_f32 v42, v42, v100
    v_sub_f32 v18, 0, v100
    v_sub_f32 v43, v43, v100
    v_sub_f32 v19, 0, v100
    v_sub_f32 v44, v44, v100
    v_sub_f32 v20, 0, v100
    v_sub_f32 v45, v45, v100
    v_sub_f32 v21, 0, v100
    v_sub_f32 v46, v46, v100
    v_sub_f32 v22, 0, v100
    v_sub_f32 v47, v47, v100
    v_sub_f32 v23, 0, v100
    v_sub_f32 v48, v48, v100
    v_sub_f32 v24, 0, v100
    v_sub_f32 v49, v49, v100
    v_sub_f32 v25, 0, v100
    v_sub_f32 v50, v50, v100
    v_sub_f32 v26, 0, v100
    v_sub_f32 v51, v51, v100
    v_sub_f32 v27, 0, v100
    v_sub_f32 v52, v52, v100
    v_sub_f32 v28, 0, v100
    v_sub_f32 v53, v53, v100
    v_sub_f32 v29, 0, v100
    v_sub_f32 v54, v54, v100
    v_sub_f32 v30, 0, v100
    v_sub_f32 v55, v55, v100
    v_sub_f32 v31, 0, v100
    s_nop 1
K2A_NOINIT_57:
    s_waitcnt lgkmcnt(0)
    v_mfma_f32_32x32x16_bf16 v[56:71], v[80:83], v[32:35], v[16:31]
    ds_read_b64_tr_b16 v[88:89], v99 offset:0
    ds_read_b64_tr_b16 v[90:91], v99 offset:512
    ds_read_b64_tr_b16 v[92:93], v99 offset:1024
    ds_read_b64_tr_b16 v[94:95], v99 offset:1536
    v_mfma_f32_32x32x16_bf16 v[56:71], v[84:87], v[36:39], v[56:71]
    ds_read_b128 v[72:75], v98 offset:8192
    ds_read_b128 v[76:79], v98 offset:9216
    v_exp_f32 v40, v40
    v_exp_f32 v41, v41
    s_add_u32 m0, s26, 0xc000
    v_exp_f32 v42, v42
    s_cmp_lt_u32 s49, s21
    v_exp_f32 v43, v43
    v_cvt_pk_bf16_f32 v40, v40, v41
    s_cselect_b32 s28, s45, 0x7ff00000
    v_exp_f32 v44, v44
    buffer_load_dwordx4 v97, s[4:7], s28 offen offset:0 lds
    v_exp_f32 v45, v45
    v_cvt_pk_bf16_f32 v41, v42, v43
    buffer_load_dwordx4 v97, s[4:7], s28 offen offset:1024 lds
    v_exp_f32 v46, v46
    v_exp_f32 v47, v47
    v_cvt_pk_bf16_f32 v42, v44, v45
    buffer_load_dwordx4 v97, s[4:7], s28 offen offset:2048 lds
    v_exp_f32 v48, v48
    buffer_load_dwordx4 v97, s[4:7], s28 offen offset:3072 lds
    v_exp_f32 v49, v49
    v_cvt_pk_bf16_f32 v43, v46, v47
    s_add_u32 s49, s49, 1
    v_exp_f32 v50, v50
    s_add_u32 s45, s45, 0x8000
    v_exp_f32 v51, v51
    v_cvt_pk_bf16_f32 v44, v48, v49
    s_add_u32 s28, s19, 0x0
    v_exp_f32 v52, v52
    v_exp_f32 v53, v53
    v_cvt_pk_bf16_f32 v45, v50, v51
    s_cmp_eq_u32 s49, s20
    v_exp_f32 v54, v54
    s_cselect_b32 s45, s28, s45
    v_exp_f32 v55, v55
    v_cvt_pk_bf16_f32 v46, v52, v53
    s_add_u32 m0, s48, 0x26000
    s_cmp_lt_u32 s47, s42
    v_cvt_pk_bf16_f32 v47, v54, v55
    s_cselect_b32 s28, s47, 0x7ff00000
    v_max3_f32 v100, v56, v57, v58
    s_waitcnt lgkmcnt(2)
    v_mfma_f32_32x32x16_bf16 v[0:15], v[88:91], v[40:43], v[0:15]
    v_max3_f32 v100, v100, v59, v60
    v_max3_f32 v100, v100, v61, v62
    v_max3_f32 v100, v100, v63, v64
    v_max3_f32 v100, v100, v65, v66
    v_mfma_f32_32x32x16_bf16 v[0:15], v[92:95], v[44:47], v[0:15]
    v_max3_f32 v100, v100, v67, v68
    v_max3_f32 v100, v100, v69, v70
    v_max_f32 v100, v100, v71
    v_cmp_lt_f32 vcc, s44, v100
    s_cbranch_vccnz K2A_SLOW0_0
K2A_BACK0_0:
    s_waitcnt lgkmcnt(0)
    v_mfma_f32_32x32x16_bf16 v[40:55], v[72:75], v[32:35], v[16:31]
    ds_read_b64_tr_b16 v[88:89], v99 offset:4096
    ds_read_b64_tr_b16 v[90:91], v99 offset:4608
    ds_read_b64_tr_b16 v[92:93], v99 offset:5120
    ds_read_b64_tr_b16 v[94:95], v99 offset:5632
    v_mfma_f32_32x32x16_bf16 v[40:55], v[76:79], v[36:39], v[40:55]
    ds_read_b128 v[80:83], v98 offset:12288
    ds_read_b128 v[84:87], v98 offset:13312
    v_exp_f32 v56, v56
    v_exp_f32 v57, v57
    buffer_load_dwordx4 v109, s[4:7], s28 offen offset:0 lds
    v_exp_f32 v58, v58
    buffer_load_dwordx4 v109, s[4:7], s28 offen offset:1024 lds
    v_exp_f32 v59, v59
    v_cvt_pk_bf16_f32 v56, v56, v57
    s_add_u32 s47, s47, 0x2000
    v_exp_f32 v60, v60
    s_add_u32 m0, s26, 0x18000
    v_exp_f32 v61, v61
    v_cvt_pk_bf16_f32 v57, v58, v59
    s_cmp_lt_u32 s50, s21
    v_exp_f32 v62, v62
    v_exp_f32 v63, v63
    v_cvt_pk_bf16_f32 v58, v60, v61
    s_cselect_b32 s28, s46, 0x7ff00000
    v_exp_f32 v64, v64
    buffer_load_dwordx4 v97, s[4:7], s28 offen offset:0 lds
    v_exp_f32 v65, v65
    v_cvt_pk_bf16_f32 v59, v62, v63
    buffer_load_dwordx4 v97, s[4:7], s28 offen offset:1024 lds
    v_exp_f32 v66, v66
    buffer_load_dwordx4 v97, s[4:7], s28 offen offset:2048 lds
    v_exp_f32 v67, v67
    v_cvt_pk_bf16_f32 v60, v64, v65
    buffer_load_dwordx4 v97, s[4:7], s28 offen offset:3072 lds
    v_exp_f32 v68, v68
    v_exp_f32 v69, v69
    v_cvt_pk_bf16_f32 v61, v66, v67
    s_add_u32 s50, s50, 1
    v_exp_f32 v70, v70
    s_add_u32 s46, s46, 0x8000
    v_exp_f32 v71, v71
    v_cvt_pk_bf16_f32 v62, v68, v69
    s_add_u32 s28, s19, 0x4000
    s_cmp_eq_u32 s50, s20
    v_cvt_pk_bf16_f32 v63, v70, v71
    s_cselect_b32 s46, s28, s46
    v_max3_f32 v100, v40, v41, v42
    s_waitcnt lgkmcnt(2)
    v_mfma_f32_32x32x16_bf16 v[0:15], v[88:91], v[56:59], v[0:15]
    v_max3_f32 v100, v100, v43, v44
    v_max3_f32 v100, v100, v45, v46
    v_max3_f32 v100, v100, v47, v48
    v_max3_f32 v100, v100, v49, v50
    v_mfma_f32_32x32x16_bf16 v[0:15], v[92:95], v[60:63], v[0:15]
    v_max3_f32 v100, v100, v51, v52
    v_max3_f32 v100, v100, v53, v54
    v_max_f32 v100, v100, v55
    v_cmp_lt_f32 vcc, s44, v100
    s_cbranch_vccnz K2A_SLOW0_1
K2A_BACK0_1:
    s_waitcnt vmcnt(14) lgkmcnt(0)
    s_barrier
    s_waitcnt lgkmcnt(0)
    v_mfma_f32_32x32x16_bf16 v[56:71], v[80:83], v[32:35], v[16:31]
    ds_read_b64_tr_b16 v[88:89], v99 offset:8192
    ds_read_b64_tr_b16 v[90:91], v99 offset:8704
    ds_read_b64_tr_b16 v[92:93], v99 offset:9216
    ds_read_b64_tr_b16 v[94:95], v99 offset:9728
    v_mfma_f32_32x32x16_bf16 v[56:71], v[84:87], v[36:39], v[56:71]
    ds_read_b128 v[72:75], v98 offset:16384
    ds_read_b128 v[76:79], v98 offset:17408
    v_exp_f32 v40, v40
    v_exp_f32 v41, v41
    s_add_u32 m0, s26, 0x0
    v_exp_f32 v42, v42
    s_cmp_lt_u32 s49, s21
    v_exp_f32 v43, v43
    v_cvt_pk_bf16_f32 v40, v40, v41
    s_cselect_b32 s28, s45, 0x7ff00000
    v_exp_f32 v44, v44
    buffer_load_dwordx4 v97, s[4:7], s28 offen offset:0 lds
    v_exp_f32 v45, v45
    v_cvt_pk_bf16_f32 v41, v42, v43
    buffer_load_dwordx4 v97, s[4:7], s28 offen offset:1024 lds
    v_exp_f32 v46, v46
    v_exp_f32 v47, v47
    v_cvt_pk_bf16_f32 v42, v44, v45
    buffer_load_dwordx4 v97, s[4:7], s28 offen offset:2048 lds
    v_exp_f32 v48, v48
    buffer_load_dwordx4 v97, s[4:7], s28 offen offset:3072 lds
    v_exp_f32 v49, v49
    v_cvt_pk_bf16_f32 v43, v46, v47
    s_add_u32 s49, s49, 1
    v_exp_f32 v50, v50
    s_add_u32 s45, s45, 0x8000
    v_exp_f32 v51, v51
    v_cvt_pk_bf16_f32 v44, v48, v49
    s_add_u32 s28, s19, 0x0
    v_exp_f32 v52, v52
    v_exp_f32 v53, v53
    v_cvt_pk_bf16_f32 v45, v50, v51
    s_cmp_eq_u32 s49, s20
    v_exp_f32 v54, v54
    s_cselect_b32 s45, s28, s45
    v_exp_f32 v55, v55
    v_cvt_pk_bf16_f32 v46, v52, v53
    s_add_u32 m0, s48, 0x20000
    s_cmp_lt_u32 s47, s42
    v_cvt_pk_bf16_f32 v47, v54, v55
    s_cselect_b32 s28, s47, 0x7ff00000
    v_max3_f32 v100, v56, v57, v58
    s_waitcnt lgkmcnt(2)
    v_mfma_f32_32x32x16_bf16 v[0:15], v[88:91], v[40:43], v[0:15]
    v_max3_f32 v100, v100, v59, v60
    v_max3_f32 v100, v100, v61, v62
    v_max3_f32 v100, v100, v63, v64
    v_max3_f32 v100, v100, v65, v66
    v_mfma_f32_32x32x16_bf16 v[0:15], v[92:95], v[44:47], v[0:15]
    v_max3_f32 v100, v100, v67, v68
    v_max3_f32 v100, v100, v69, v70
    v_max_f32 v100, v100, v71
    v_cmp_lt_f32 vcc, s44, v100
    s_cbranch_vccnz K2A_SLOW1_0
K2A_BACK1_0:
    s_waitcnt lgkmcnt(0)
    v_mfma_f32_32x32x16_bf16 v[40:55], v[72:75], v[32:35], v[16:31]
    ds_read_b64_tr_b16 v[88:89], v99 offset:12288
    ds_read_b64_tr_b16 v[90:91], v99 offset:12800
    ds_read_b64_tr_b16 v[92:93], v99 offset:13312
    ds_read_b64_tr_b16 v[94:95], v99 offset:13824
    v_mfma_f32_32x32x16_bf16 v[40:55], v[76:79], v[36:39], v[40:55]
    ds_read_b128 v[80:83], v98 offset:20480
    ds_read_b128 v[84:87], v98 offset:21504
    v_exp_f32 v56, v56
    v_exp_f32 v57, v57
    buffer_load_dwordx4 v109, s[4:7], s28 offen offset:0 lds
    v_exp_f32 v58, v58
    buffer_load_dwordx4 v109, s[4:7], s28 offen offset:1024 lds
    v_exp_f32 v59, v59
    v_cvt_pk_bf16_f32 v56, v56, v57
    s_add_u32 s47, s47, 0x2000
    v_exp_f32 v60, v60
    s_add_u32 m0, s26, 0x1c000
    v_exp_f32 v61, v61
    v_cvt_pk_bf16_f32 v57, v58, v59
    s_cmp_lt_u32 s50, s21
    v_exp_f32 v62, v62
    v_exp_f32 v63, v63
    v_cvt_pk_bf16_f32 v58, v60, v61
    s_cselect_b32 s28, s46, 0x7ff00000
    v_exp_f32 v64, v64
    buffer_load_dwordx4 v97, s[4:7], s28 offen offset:0 lds
    v_exp_f32 v65, v65
    v_cvt_pk_bf16_f32 v59, v62, v63
    buffer_load_dwordx4 v97, s[4:7], s28 offen offset:1024 lds
    v_exp_f32 v66, v66
    buffer_load_dwordx4 v97, s[4:7], s28 offen offset:2048 lds
    v_exp_f32 v67, v67
    v_cvt_pk_bf16_f32 v60, v64, v65
    buffer_load_dwordx4 v97, s[4:7], s28 offen offset:3072 lds
    v_exp_f32 v68, v68
    v_exp_f32 v69, v69
    v_cvt_pk_bf16_f32 v61, v66, v67
    s_add_u32 s50, s50, 1
    v_exp_f32 v70, v70
    s_add_u32 s46, s46, 0x8000
    v_exp_f32 v71, v71
    v_cvt_pk_bf16_f32 v62, v68, v69
    s_add_u32 s28, s19, 0x4000
    s_cmp_eq_u32 s50, s20
    v_cvt_pk_bf16_f32 v63, v70, v71
    s_cselect_b32 s46, s28, s46
    v_max3_f32 v100, v40, v41, v42
    s_waitcnt lgkmcnt(2)
    v_mfma_f32_32x32x16_bf16 v[0:15], v[88:91], v[56:59], v[0:15]
    v_max3_f32 v100, v100, v43, v44
    v_max3_f32 v100, v100, v45, v46
    v_max3_f32 v100, v100, v47, v48
    v_max3_f32 v100, v100, v49, v50
    v_mfma_f32_32x32x16_bf16 v[0:15], v[92:95], v[60:63], v[0:15]
    v_max3_f32 v100, v100, v51, v52
    v_max3_f32 v100, v100, v53, v54
    v_max_f32 v100, v100, v55
    v_cmp_lt_f32 vcc, s44, v100
    s_cbranch_vccnz K2A_SLOW1_1
K2A_BACK1_1:
    s_waitcnt vmcnt(14) lgkmcnt(0)
    s_barrier
    s_waitcnt lgkmcnt(0)
    v_mfma_f32_32x32x16_bf16 v[56:71], v[80:83], v[32:35], v[16:31]
    ds_read_b64_tr_b16 v[88:89], v99 offset:16384
    ds_read_b64_tr_b16 v[90:91], v99 offset:16896
    ds_read_b64_tr_b16 v[92:93], v99 offset:17408
    ds_read_b64_tr_b16 v[94:95], v99 offset:17920
    v_mfma_f32_32x32x16_bf16 v[56:71], v[84:87], v[36:39], v[56:71]
    ds_read_b128 v[72:75], v98 offset:24576
    ds_read_b128 v[76:79], v98 offset:25600
    v_exp_f32 v40, v40
    v_exp_f32 v41, v41
    s_add_u32 m0, s26, 0x4000
    v_exp_f32 v42, v42
    s_cmp_lt_u32 s49, s21
    v_exp_f32 v43, v43
    v_cvt_pk_bf16_f32 v40, v40, v41
    s_cselect_b32 s28, s45, 0x7ff00000
    v_exp_f32 v44, v44
    buffer_load_dwordx4 v97, s[4:7], s28 offen offset:0 lds
    v_exp_f32 v45, v45
    v_cvt_pk_bf16_f32 v41, v42, v43
    buffer_load_dwordx4 v97, s[4:7], s28 offen offset:1024 lds
    v_exp_f32 v46, v46
    v_exp_f32 v47, v47
    v_cvt_pk_bf16_f32 v42, v44, v45
    buffer_load_dwordx4 v97, s[4:7], s28 offen offset:2048 lds
    v_exp_f32 v48, v48
    buffer_load_dwordx4 v97, s[4:7], s28 offen offset:3072 lds
    v_exp_f32 v49, v49
    v_cvt_pk_bf16_f32 v43, v46, v47
    s_add_u32 s49, s49, 1
    v_exp_f32 v50, v50
    s_add_u32 s45, s45, 0x8000
    v_exp_f32 v51, v51
    v_cvt_pk_bf16_f32 v44, v48, v49
    s_add_u32 s28, s19, 0x0
    v_exp_f32 v52, v52
    v_exp_f32 v53, v53
    v_cvt_pk_bf16_f32 v45, v50, v51
    s_cmp_eq_u32 s49, s20
    v_exp_f32 v54, v54
    s_cselect_b32 s45, s28, s45
    v_exp_f32 v55, v55
    v_cvt_pk_bf16_f32 v46, v52, v53
    s_add_u32 m0, s48, 0x22000
    s_cmp_lt_u32 s47, s42
    v_cvt_pk_bf16_f32 v47, v54, v55
    s_cselect_b32 s28, s47, 0x7ff00000
    v_max3_f32 v100, v56, v57, v58
    s_waitcnt lgkmcnt(2)
    v_mfma_f32_32x32x16_bf16 v[0:15], v[88:91], v[40:43], v[0:15]
    v_max3_f32 v100, v100, v59, v60
    v_max3_f32 v100, v100, v61, v62
    v_max3_f32 v100, v100, v63, v64
    v_max3_f32 v100, v100, v65, v66
    v_mfma_f32_32x32x16_bf16 v[0:15], v[92:95], v[44:47], v[0:15]
    v_max3_f32 v100, v100, v67, v68
    v_max3_f32 v100, v100, v69, v70
    v_max_f32 v100, v100, v71
    v_cmp_lt_f32 vcc, s44, v100
    s_cbranch_vccnz K2A_SLOW2_0
K2A_BACK2_0:
    s_waitcnt lgkmcnt(0)
    v_mfma_f32_32x32x16_bf16 v[40:55], v[72:75], v[32:35], v[16:31]
    ds_read_b64_tr_b16 v[88:89], v99 offset:20480
    ds_read_b64_tr_b16 v[90:91], v99 offset:20992
    ds_read_b64_tr_b16 v[92:93], v99 offset:21504
    ds_read_b64_tr_b16 v[94:95], v99 offset:22016
    v_mfma_f32_32x32x16_bf16 v[40:55], v[76:79], v[36:39], v[40:55]
    ds_read_b128 v[80:83], v98 offset:28672
    ds_read_b128 v[84:87], v98 offset:29696
    v_exp_f32 v56, v56
    v_exp_f32 v57, v57
    buffer_load_dwordx4 v109, s[4:7], s28 offen offset:0 lds
    v_exp_f32 v58, v58
    buffer_load_dwordx4 v109, s[4:7], s28 offen offset:1024 lds
    v_exp_f32 v59, v59
    v_cvt_pk_bf16_f32 v56, v56, v57
    s_add_u32 s47, s47, 0x2000
    v_exp_f32 v60, v60
    s_add_u32 m0, s26, 0x10000
    v_exp_f32 v61, v61
    v_cvt_pk_bf16_f32 v57, v58, v59
    s_cmp_lt_u32 s50, s21
    v_exp_f32 v62, v62
    v_exp_f32 v63, v63
    v_cvt_pk_bf16_f32 v58, v60, v61
    s_cselect_b32 s28, s46, 0x7ff00000
    v_exp_f32 v64, v64
    buffer_load_dwordx4 v97, s[4:7], s28 offen offset:0 lds
    v_exp_f32 v65, v65
    v_cvt_pk_bf16_f32 v59, v62, v63
    buffer_load_dwordx4 v97, s[4:7], s28 offen offset:1024 lds
    v_exp_f32 v66, v66
    buffer_load_dwordx4 v97, s[4:7], s28 offen offset:2048 lds
    v_exp_f32 v67, v67
    v_cvt_pk_bf16_f32 v60, v64, v65
    buffer_load_dwordx4 v97, s[4:7], s28 offen offset:3072 lds
    v_exp_f32 v68, v68
    v_exp_f32 v69, v69
    v_cvt_pk_bf16_f32 v61, v66, v67
    s_add_u32 s50, s50, 1
    v_exp_f32 v70, v70
    s_add_u32 s46, s46, 0x8000
    v_exp_f32 v71, v71
    v_cvt_pk_bf16_f32 v62, v68, v69
    s_add_u32 s28, s19, 0x4000
    s_cmp_eq_u32 s50, s20
    v_cvt_pk_bf16_f32 v63, v70, v71
    s_cselect_b32 s46, s28, s46
    v_max3_f32 v100, v40, v41, v42
    s_waitcnt lgkmcnt(2)
    v_mfma_f32_32x32x16_bf16 v[0:15], v[88:91], v[56:59], v[0:15]
    v_max3_f32 v100, v100, v43, v44
    v_max3_f32 v100, v100, v45, v46
    v_max3_f32 v100, v100, v47, v48
    v_max3_f32 v100, v100, v49, v50
    v_mfma_f32_32x32x16_bf16 v[0:15], v[92:95], v[60:63], v[0:15]
    v_max3_f32 v100, v100, v51, v52
    v_max3_f32 v100, v100, v53, v54
    v_max_f32 v100, v100, v55
    v_cmp_lt_f32 vcc, s44, v100
    s_cbranch_vccnz K2A_SLOW2_1
K2A_BACK2_1:
    s_waitcnt vmcnt(14) lgkmcnt(0)
    s_barrier
    s_waitcnt lgkmcnt(0)
    v_mfma_f32_32x32x16_bf16 v[56:71], v[80:83], v[32:35], v[16:31]
    ds_read_b64_tr_b16 v[88:89], v99 offset:24576
    ds_read_b64_tr_b16 v[90:91], v99 offset:25088
    ds_read_b64_tr_b16 v[92:93], v99 offset:25600
    ds_read_b64_tr_b16 v[94:95], v99 offset:26112
    v_mfma_f32_32x32x16_bf16 v[56:71], v[84:87], v[36:39], v[56:71]
    ds_read_b128 v[72:75], v98 offset:0
    ds_read_b128 v[76:79], v98 offset:1024
    v_exp_f32 v40, v40
    v_exp_f32 v41, v41
    s_add_u32 m0, s26, 0x8000
    v_exp_f32 v42, v42
    s_cmp_lt_u32 s49, s21
    v_exp_f32 v43, v43
    v_cvt_pk_bf16_f32 v40, v40, v41
    s_cselect_b32 s28, s45, 0x7ff00000
    v_exp_f32 v44, v44
    buffer_load_dwordx4 v97, s[4:7], s28 offen offset:0 lds
    v_exp_f32 v45, v45
    v_cvt_pk_bf16_f32 v41, v42, v43
    buffer_load_dwordx4 v97, s[4:7], s28 offen offset:1024 lds
    v_exp_f32 v46, v46
    v_exp_f32 v47, v47
    v_cvt_pk_bf16_f32 v42, v44, v45
    buffer_load_dwordx4 v97, s[4:7], s28 offen offset:2048 lds
    v_exp_f32 v48, v48
    buffer_load_dwordx4 v97, s[4:7], s28 offen offset:3072 lds
    v_exp_f32 v49, v49
    v_cvt_pk_bf16_f32 v43, v46, v47
    s_add_u32 s49, s49, 1
    v_exp_f32 v50, v50
    s_add_u32 s45, s45, 0x8000
    v_exp_f32 v51, v51
    v_cvt_pk_bf16_f32 v44, v48, v49
    s_add_u32 s28, s19, 0x0
    v_exp_f32 v52, v52
    v_exp_f32 v53, v53
    v_cvt_pk_bf16_f32 v45, v50, v51
    s_cmp_eq_u32 s49, s20
    v_exp_f32 v54, v54
    s_cselect_b32 s45, s28, s45
    v_exp_f32 v55, v55
    v_cvt_pk_bf16_f32 v46, v52, v53
    s_add_u32 m0, s48, 0x24000
    s_cmp_lt_u32 s47, s42
    v_cvt_pk_bf16_f32 v47, v54, v55
    s_cselect_b32 s28, s47, 0x7ff00000
    v_max3_f32 v100, v56, v57, v58
    s_waitcnt lgkmcnt(2)
    v_mfma_f32_32x32x16_bf16 v[0:15], v[88:91], v[40:43], v[0:15]
    v_max3_f32 v100, v100, v59, v60
    v_max3_f32 v100, v100, v61, v62
    v_max3_f32 v100, v100, v63, v64
    v_max3_f32 v100, v100, v65, v66
    v_mfma_f32_32x32x16_bf16 v[0:15], v[92:95], v[44:47], v[0:15]
    v_max3_f32 v100, v100, v67, v68
    v_max3_f32 v100, v100, v69, v70
    v_max_f32 v100, v100, v71
    v_cmp_lt_f32 vcc, s44, v100
    s_cbranch_vccnz K2A_SLOW3_0
K2A_BACK3_0:
    s_waitcnt lgkmcnt(0)
    v_mfma_f32_32x32x16_bf16 v[40:55], v[72:75], v[32:35], v[16:31]
    ds_read_b64_tr_b16 v[88:89], v99 offset:28672
    ds_read_b64_tr_b16 v[90:91], v99 offset:29184
    ds_read_b64_tr_b16 v[92:93], v99 offset:29696
    ds_read_b64_tr_b16 v[94:95], v99 offset:30208
    v_mfma_f32_32x32x16_bf16 v[40:55], v[76:79], v[36:39], v[40:55]
    ds_read_b128 v[80:83], v98 offset:4096
    ds_read_b128 v[84:87], v98 offset:5120
    v_exp_f32 v56, v56
    v_exp_f32 v57, v57
    buffer_load_dwordx4 v109, s[4:7], s28 offen offset:0 lds
    v_exp_f32 v58, v58
    buffer_load_dwordx4 v109, s[4:7], s28 offen offset:1024 lds
    v_exp_f32 v59, v59
    v_cvt_pk_bf16_f32 v56, v56, v57
    s_add_u32 s47, s47, 0x2000
    v_exp_f32 v60, v60
    s_add_u32 m0, s26, 0x14000
    v_exp_f32 v61, v61
    v_cvt_pk_bf16_f32 v57, v58, v59
    s_cmp_lt_u32 s50, s21
    v_exp_f32 v62, v62
    v_exp_f32 v63, v63
    v_cvt_pk_bf16_f32 v58, v60, v61
    s_cselect_b32 s28, s46, 0x7ff00000
    v_exp_f32 v64, v64
    buffer_load_dwordx4 v97, s[4:7], s28 offen offset:0 lds
    v_exp_f32 v65, v65
    v_cvt_pk_bf16_f32 v59, v62, v63
    buffer_load_dwordx4 v97, s[4:7], s28 offen offset:1024 lds
    v_exp_f32 v66, v66
    buffer_load_dwordx4 v97, s[4:7], s28 offen offset:2048 lds
    v_exp_f32 v67, v67
    v_cvt_pk_bf16_f32 v60, v64, v65
    buffer_load_dwordx4 v97, s[4:7], s28 offen offset:3072 lds
    v_exp_f32 v68, v68
    v_exp_f32 v69, v69
    v_cvt_pk_bf16_f32 v61, v66, v67
    s_add_u32 s50, s50, 1
    v_exp_f32 v70, v70
    s_add_u32 s46, s46, 0x8000
    v_exp_f32 v71, v71
    v_cvt_pk_bf16_f32 v62, v68, v69
    s_add_u32 s28, s19, 0x4000
    s_cmp_eq_u32 s50, s20
    v_cvt_pk_bf16_f32 v63, v70, v71
    s_cselect_b32 s46, s28, s46
    v_max3_f32 v100, v40, v41, v42
    s_waitcnt lgkmcnt(2)
    v_mfma_f32_32x32x16_bf16 v[0:15], v[88:91], v[56:59], v[0:15]
    v_max3_f32 v100, v100, v43, v44
    v_max3_f32 v100, v100, v45, v46
    v_max3_f32 v100, v100, v47, v48
    v_max3_f32 v100, v100, v49, v50
    v_mfma_f32_32x32x16_bf16 v[0:15], v[92:95], v[60:63], v[0:15]
    v_max3_f32 v100, v100, v51, v52
    v_max3_f32 v100, v100, v53, v54
    v_max_f32 v100, v100, v55
    v_cmp_lt_f32 vcc, s44, v100
    s_cbranch_vccnz K2A_SLOW3_1
K2A_BACK3_1:
    s_add_u32 s51, s51, 4
    s_cmp_lg_u32 s51, 24
    s_cbranch_scc1 K2A_NOWPF
    s_bfe_u32 s27, s2, 0x40004
    s_lshl_b32 s27, s27, 2
    s_add_u32 s27, s27, s40
    v_lshrrev_b32 v104, 4, v96
    v_min_u32 v105, 27, v104
    v_lshlrev_b32 v105, 7, v105
    s_mul_i32 s28, s9, 229376
    s_mul_i32 s29, s27, 3584
    s_add_u32 s28, s28, s29
    buffer_load_dword v108, v105, s[64:67], s28 offen
    v_min_u32 v105, 3, v104
    v_lshlrev_b32 v105, 7, v105
    s_mul_i32 s28, s9, 25088
    s_lshl_b32 s29, s27, 9
    s_add_u32 s28, s28, s29
    buffer_load_dword v108, v105, s[68:71], s28 offen
K2A_NOWPF:
    s_cmp_lt_u32 s51, 32
    s_cbranch_scc1 K2A_LOOP
    s_lshl_b32 s27, s9, 3
    s_add_u32 s27, s27, s10
    s_lshl_b32 s27, s27, 2
    s_add_u32 s27, s27, s40
    s_mul_i32 s31, s27, 33792
    s_add_u32 s31, s31, 0x5000000
    s_lshl_b32 s32, s27, 7
    s_add_u32 s32, s32, 0x4d00000
    v_mov_b32 v104, 0
    buffer_load_dword v108, v104, s[4:7], s32 offen sc1
    s_nop 7
    s_nop 7
    v_mov_b32 v101, v12
    v_mov_b32 v102, v12
    s_nop 1
    v_permlane32_swap_b32 v101, v102
    s_nop 1
    v_rcp_f32 v102, v102
    s_nop 0
    v_mul_f32 v102, v102, v103
    v_mul_f32 v0, v0, v102
    v_mul_f32 v1, v1, v102
    v_mul_f32 v2, v2, v102
    v_mul_f32 v3, v3, v102
    v_mul_f32 v4, v4, v102
    v_mul_f32 v5, v5, v102
    v_mul_f32 v6, v6, v102
    v_mul_f32 v7, v7, v102
    v_mul_f32 v8, v8, v102
    v_mul_f32 v9, v9, v102
    v_mul_f32 v10, v10, v102
    v_mul_f32 v11, v11, v102
    v_mul_f32 v12, v12, v102
    v_mul_f32 v13, v13, v102
    v_mul_f32 v14, v14, v102
    v_mul_f32 v15, v15, v102
    s_mov_b32 exec_lo, 0
    v_mov_b32 v12, 0
    v_mov_b32 v13, 0
    v_mov_b32 v14, 0
    v_mov_b32 v15, 0
    s_mov_b32 exec_lo, -1
    v_cvt_pk_bf16_f32 v40, v0, v1
    v_cvt_pk_bf16_f32 v41, v2, v3
    v_cvt_pk_bf16_f32 v42, v4, v5
    v_cvt_pk_bf16_f32 v43, v6, v7
    v_cvt_pk_bf16_f32 v44, v8, v9
    v_cvt_pk_bf16_f32 v45, v10, v11
    v_cvt_pk_bf16_f32 v46, v12, v13
    v_cvt_pk_bf16_f32 v47, v14, v15
K2A_TAIL:
    s_cmp_gt_u32 s51, s21
    s_cbranch_scc1 K2A_Y
    s_waitcnt vmcnt(8)
    s_barrier
    s_and_b32 s27, s49, 3
    s_lshl_b32 s27, s27, 14
    s_add_u32 s27, s27, s26
    s_add_u32 m0, s27, 0x0
    s_cmp_lt_u32 s49, s21
    s_cselect_b32 s28, s45, 0x7ff00000
    buffer_load_dwordx4 v97, s[4:7], s28 offen offset:0 lds
    buffer_load_dwordx4 v97, s[4:7], s28 offen offset:1024 lds
    buffer_load_dwordx4 v97, s[4:7], s28 offen offset:2048 lds
    buffer_load_dwordx4 v97, s[4:7], s28 offen offset:3072 lds
    s_add_u32 s49, s49, 1
    s_add_u32 s45, s45, 0x8000
    s_add_u32 s28, s19, 0x0
    s_cmp_eq_u32 s49, s20
    s_cselect_b32 s45, s28, s45
    s_and_b32 s27, s50, 3
    s_lshl_b32 s27, s27, 14
    s_add_u32 s27, s27, s26
    s_add_u32 m0, s27, 0x10000
    s_cmp_lt_u32 s50, s21
    s_cselect_b32 s28, s46, 0x7ff00000
    buffer_load_dwordx4 v97, s[4:7], s28 offen offset:0 lds
    buffer_load_dwordx4 v97, s[4:7], s28 offen offset:1024 lds
    buffer_load_dwordx4 v97, s[4:7], s28 offen offset:2048 lds
    buffer_load_dwordx4 v97, s[4:7], s28 offen offset:3072 lds
    s_add_u32 s50, s50, 1
    s_add_u32 s46, s46, 0x8000
    s_add_u32 s28, s19, 0x4000
    s_cmp_eq_u32 s50, s20
    s_cselect_b32 s46, s28, s46
    s_add_u32 s51, s51, 1
    s_branch K2A_TAIL
K2A_Y:
    v_lshrrev_b32 v2, 4, v96
    v_lshrrev_b32 v3, 3, v2
    v_and_b32 v4, 7, v2
    v_bfe_u32 v5, v2, 4, 1
    v_lshlrev_b32 v5, 2, v5
    v_xor_b32 v4, v4, v5
    v_lshlrev_b32 v4, 4, v4
    v_mul_u32_u24 v3, 896, v3
    v_add_u32 v110, v3, v4
    v_add_u32 v111, 6144, v110
    v_add_u32 v112, 12288, v110
    v_add_u32 v113, 18432, v110
    s_lshl_b32 s47, s9, 8
    s_lshl_b32 s27, s40, 6
    s_add_u32 s47, s47, s27
    s_mul_i32 s47, s47, 896
    s_mul_i32 s42, s9, 28
    s_lshl_b32 s27, s40, 3
    s_add_u32 s42, s42, s27
    s_mul_i32 s42, s42, 896
    s_sub_u32 s27, s10, 7
    s_cmp_ge_u32 s10, 7
    s_cselect_b32 s46, s27, s10
    s_waitcnt vmcnt(0) lgkmcnt(0)
    s_barrier
    s_lshl_b32 s27, s46, 7
    s_lshl_b32 s29, s40, 13
    s_add_u32 m0, s29, 0
    s_add_u32 s28, s47, s27
    buffer_load_dwordx4 v110, s[64:67], s28 offen offset:0 lds
    buffer_load_dwordx4 v111, s[64:67], s28 offen offset:1024 lds
    buffer_load_dwordx4 v112, s[64:67], s28 offen offset:2048 lds
    buffer_load_dwordx4 v113, s[64:67], s28 offen offset:3072 lds
    s_add_u32 m0, s29, 4096
    s_add_u32 s28, s47, s27
    s_add_u32 s28, s28, 28672
    buffer_load_dwordx4 v110, s[64:67], s28 offen offset:0 lds
    buffer_load_dwordx4 v111, s[64:67], s28 offen offset:1024 lds
    buffer_load_dwordx4 v112, s[64:67], s28 offen offset:2048 lds
    buffer_load_dwordx4 v113, s[64:67], s28 offen offset:3072 lds
    s_lshl_b32 s29, s40, 10
    s_add_u32 m0, s29, 32768
    s_add_u32 s28, s42, s27
    buffer_load_dwordx4 v110, s[68:71], s28 offen lds
    s_add_u32 s46, s46, 1
    s_cmp_ge_u32 s46, 7
    s_cselect_b32 s46, 0, s46
    s_lshl_b32 s27, s46, 7
    s_lshl_b32 s29, s40, 13
    s_add_u32 m0, s29, 36864
    s_add_u32 s28, s47, s27
    buffer_load_dwordx4 v110, s[64:67], s28 offen offset:0 lds
    buffer_load_dwordx4 v111, s[64:67], s28 offen offset:1024 lds
    buffer_load_dwordx4 v112, s[64:67], s28 offen offset:2048 lds
    buffer_load_dwordx4 v113, s[64:67], s28 offen offset:3072 lds
    s_add_u32 m0, s29, 40960
    s_add_u32 s28, s47, s27
    s_add_u32 s28, s28, 28672
    buffer_load_dwordx4 v110, s[64:67], s28 offen offset:0 lds
    buffer_load_dwordx4 v111, s[64:67], s28 offen offset:1024 lds
    buffer_load_dwordx4 v112, s[64:67], s28 offen offset:2048 lds
    buffer_load_dwordx4 v113, s[64:67], s28 offen offset:3072 lds
    s_lshl_b32 s29, s40, 10
    s_add_u32 m0, s29, 69632
    s_add_u32 s28, s42, s27
    buffer_load_dwordx4 v110, s[68:71], s28 offen lds
    s_add_u32 s46, s46, 1
    s_cmp_ge_u32 s46, 7
    s_cselect_b32 s46, 0, s46
    s_lshl_b32 s27, s46, 7
    s_lshl_b32 s29, s40, 13
    s_add_u32 m0, s29, 73728
    s_add_u32 s28, s47, s27
    buffer_load_dwordx4 v110, s[64:67], s28 offen offset:0 lds
    buffer_load_dwordx4 v111, s[64:67], s28 offen offset:1024 lds
    buffer_load_dwordx4 v112, s[64:67], s28 offen offset:2048 lds
    buffer_load_dwordx4 v113, s[64:67], s28 offen offset:3072 lds
    s_add_u32 m0, s29, 77824
    s_add_u32 s28, s47, s27
    s_add_u32 s28, s28, 28672
    buffer_load_dwordx4 v110, s[64:67], s28 offen offset:0 lds
    buffer_load_dwordx4 v111, s[64:67], s28 offen offset:1024 lds
    buffer_load_dwordx4 v112, s[64:67], s28 offen offset:2048 lds
    buffer_load_dwordx4 v113, s[64:67], s28 offen offset:3072 lds
    s_lshl_b32 s29, s40, 10
    s_add_u32 m0, s29, 106496
    s_add_u32 s28, s42, s27
    buffer_load_dwordx4 v110, s[68:71], s28 offen lds
    s_add_u32 s46, s46, 1
    s_cmp_ge_u32 s46, 7
    s_cselect_b32 s46, 0, s46
    s_lshl_b32 s27, s46, 7
    s_lshl_b32 s29, s40, 13
    s_add_u32 m0, s29, 110592
    s_add_u32 s28, s47, s27
    buffer_load_dwordx4 v110, s[64:67], s28 offen offset:0 lds
    buffer_load_dwordx4 v111, s[64:67], s28 offen offset:1024 lds
    buffer_load_dwordx4 v112, s[64:67], s28 offen offset:2048 lds
    buffer_load_dwordx4 v113, s[64:67], s28 offen offset:3072 lds
    s_add_u32 m0, s29, 114688
    s_add_u32 s28, s47, s27
    s_add_u32 s28, s28, 28672
    buffer_load_dwordx4 v110, s[64:67], s28 offen offset:0 lds
    buffer_load_dwordx4 v111, s[64:67], s28 offen offset:1024 lds
    buffer_load_dwordx4 v112, s[64:67], s28 offen offset:2048 lds
    buffer_load_dwordx4 v113, s[64:67], s28 offen offset:3072 lds
    s_lshl_b32 s29, s40, 10
    s_add_u32 m0, s29, 143360
    s_add_u32 s28, s42, s27
    buffer_load_dwordx4 v110, s[68:71], s28 offen lds
    s_add_u32 s46, s46, 1
    s_cmp_ge_u32 s46, 7
    s_cselect_b32 s46, 0, s46
    s_lshl_b32 s27, s40, 11
    s_add_u32 s27, s27, 147456
    v_add_u32 v101, s27, v96
    ds_write_b128 v101, v[40:43]
    ds_write_b128 v101, v[44:47] offset:1024
    s_waitcnt vmcnt(27) lgkmcnt(0)
    s_barrier
    s_waitcnt vmcnt(18) lgkmcnt(0)
    s_barrier
    s_lshl_b32 s27, s46, 7
    s_lshl_b32 s29, s40, 13
    s_add_u32 m0, s29, 0
    s_add_u32 s28, s47, s27
    buffer_load_dwordx4 v110, s[64:67], s28 offen offset:0 lds
    buffer_load_dwordx4 v111, s[64:67], s28 offen offset:1024 lds
    buffer_load_dwordx4 v112, s[64:67], s28 offen offset:2048 lds
    buffer_load_dwordx4 v113, s[64:67], s28 offen offset:3072 lds
    s_add_u32 m0, s29, 4096
    s_add_u32 s28, s47, s27
    s_add_u32 s28, s28, 28672
    buffer_load_dwordx4 v110, s[64:67], s28 offen offset:0 lds
    buffer_load_dwordx4 v111, s[64:67], s28 offen offset:1024 lds
    buffer_load_dwordx4 v112, s[64:67], s28 offen offset:2048 lds
    buffer_load_dwordx4 v113, s[64:67], s28 offen offset:3072 lds
    s_lshl_b32 s29, s40, 10
    s_add_u32 m0, s29, 32768
    s_add_u32 s28, s42, s27
    buffer_load_dwordx4 v110, s[68:71], s28 offen lds
    s_add_u32 s46, s46, 1
    s_cmp_ge_u32 s46, 7
    s_cselect_b32 s46, 0, s46
    s_waitcnt vmcnt(18) lgkmcnt(0)
    s_barrier
    s_lshl_b32 s27, s46, 7
    s_lshl_b32 s29, s40, 13
    s_add_u32 m0, s29, 36864
    s_add_u32 s28, s47, s27
    buffer_load_dwordx4 v110, s[64:67], s28 offen offset:0 lds
    buffer_load_dwordx4 v111, s[64:67], s28 offen offset:1024 lds
    buffer_load_dwordx4 v112, s[64:67], s28 offen offset:2048 lds
    buffer_load_dwordx4 v113, s[64:67], s28 offen offset:3072 lds
    s_add_u32 m0, s29, 40960
    s_add_u32 s28, s47, s27
    s_add_u32 s28, s28, 28672
    buffer_load_dwordx4 v110, s[64:67], s28 offen offset:0 lds
    buffer_load_dwordx4 v111, s[64:67], s28 offen offset:1024 lds
    buffer_load_dwordx4 v112, s[64:67], s28 offen offset:2048 lds
    buffer_load_dwordx4 v113, s[64:67], s28 offen offset:3072 lds
    s_lshl_b32 s29, s40, 10
    s_add_u32 m0, s29, 69632
    s_add_u32 s28, s42, s27
    buffer_load_dwordx4 v110, s[68:71], s28 offen lds
    s_add_u32 s46, s46, 1
    s_cmp_ge_u32 s46, 7
    s_cselect_b32 s46, 0, s46
    s_waitcnt vmcnt(18) lgkmcnt(0)
    s_barrier
    s_lshl_b32 s27, s46, 7
    s_lshl_b32 s29, s40, 13
    s_add_u32 m0, s29, 73728
    s_add_u32 s28, s47, s27
    buffer_load_dwordx4 v110, s[64:67], s28 offen offset:0 lds
    buffer_load_dwordx4 v111, s[64:67], s28 offen offset:1024 lds
    buffer_load_dwordx4 v112, s[64:67], s28 offen offset:2048 lds
    buffer_load_dwordx4 v113, s[64:67], s28 offen offset:3072 lds
    s_add_u32 m0, s29, 77824
    s_add_u32 s28, s47, s27
    s_add_u32 s28, s28, 28672
    buffer_load_dwordx4 v110, s[64:67], s28 offen offset:0 lds
    buffer_load_dwordx4 v111, s[64:67], s28 offen offset:1024 lds
    buffer_load_dwordx4 v112, s[64:67], s28 offen offset:2048 lds
    buffer_load_dwordx4 v113, s[64:67], s28 offen offset:3072 lds
    s_lshl_b32 s29, s40, 10
    s_add_u32 m0, s29, 106496
    s_add_u32 s28, s42, s27
    buffer_load_dwordx4 v110, s[68:71], s28 offen lds
    s_add_u32 s46, s46, 1
    s_cmp_ge_u32 s46, 7
    s_cselect_b32 s46, 0, s46
    s_waitcnt vmcnt(18) lgkmcnt(0)
    s_barrier
    s_waitcnt vmcnt(9) lgkmcnt(0)
    s_barrier
    s_waitcnt vmcnt(0) lgkmcnt(0)
    s_barrier
    v_mov_b32 v0, v96
K2_RED:
    s_sub_u32 s40, 15, s10
    s_cmp_eq_u32 s11, 0
    s_cselect_b32 s40, s10, s40
    s_lshl_b32 s41, s40, 8
    s_add_u32 s41, s41, 0x4d10000
    s_waitcnt vmcnt(0)
    s_barrier
    s_cmp_lg_u32 s8, 7
    s_cbranch_scc1 K2_RED_W
    v_mov_b32 v1, 0
    v_mov_b32 v2, 1
    s_mov_b64 exec, 1
    buffer_atomic_add v2, v1, s[4:7], s41 offen sc1
    s_mov_b64 exec, -1
    s_mov_b32 s34, 0x40000
K2_RED_POLL:
    buffer_load_dword v2, v1, s[4:7], s41 offen sc1
    s_waitcnt vmcnt(0)
    v_readfirstlane_b32 s27, v2
    s_cmp_ge_u32 s27, 16
    s_cbranch_scc1 K2_RED_W
    s_sleep 4
    s_sub_u32 s34, s34, 1
    s_cmp_lg_u32 s34, 0
    s_cbranch_scc1 K2_RED_POLL
K2_RED_W:
    s_mul_i32 s42, s9, 7
    s_add_u32 s42, s42, s8
    s_mul_i32 s43, s42, 2341
    s_lshr_b32 s43, s43, 16
    s_mul_i32 s27, s43, 28
    s_sub_u32 s45, s42, s27
    s_lshl_b32 s27, s40, 2
    s_add_u32 s43, s43, s27
    s_mul_i32 s27, s43, 14
    s_lshr_b32 s28, s45, 1
    s_add_u32 s27, s27, s28
    s_lshl_b32 s27, s27, 15
    s_and_b32 s28, s45, 1
    s_lshl_b32 s28, s28, 10
    s_add_u32 s27, s27, s28
    s_add_u32 s27, s27, 0x8000000
    s_mov_b32 s48, s62
    s_mov_b32 s49, s63
    s_mov_b32 s50, 0x1c0000
    s_mov_b32 s51, 0x20000
    s_mul_i32 s29, s43, 28672
    s_lshl_b32 s28, s45, 5
    s_add_u32 s29, s29, s28
    v_bfe_u32 v3, v0, 4, 5
    v_mul_u32_u24 v3, 896, v3
    v_lshrrev_b32 v4, 9, v0
    v_lshl_add_u32 v3, v4, 3, v3
    s_barrier
    s_cmp_ge_u32 s8, 7
    s_cbranch_scc1 K2_DONE
    buffer_load_dwordx4 v[32:35], v0, s[4:7], s27 offen offset:0 sc1
    buffer_load_dwordx4 v[36:39], v0, s[4:7], s27 offen offset:2048 sc1
    s_add_u32 s27, s27, 4096
    buffer_load_dwordx4 v[40:43], v0, s[4:7], s27 offen offset:0 sc1
    buffer_load_dwordx4 v[44:47], v0, s[4:7], s27 offen offset:2048 sc1
    s_add_u32 s27, s27, 4096
    buffer_load_dwordx4 v[48:51], v0, s[4:7], s27 offen offset:0 sc1
    buffer_load_dwordx4 v[52:55], v0, s[4:7], s27 offen offset:2048 sc1
    s_add_u32 s27, s27, 4096
    buffer_load_dwordx4 v[56:59], v0, s[4:7], s27 offen offset:0 sc1
    buffer_load_dwordx4 v[60:63], v0, s[4:7], s27 offen offset:2048 sc1
    s_add_u32 s27, s27, 4096
    buffer_load_dwordx4 v[64:67], v0, s[4:7], s27 offen offset:0 sc1
    buffer_load_dwordx4 v[68:71], v0, s[4:7], s27 offen offset:2048 sc1
    s_add_u32 s27, s27, 4096
    buffer_load_dwordx4 v[72:75], v0, s[4:7], s27 offen offset:0 sc1
    buffer_load_dwordx4 v[76:79], v0, s[4:7], s27 offen offset:2048 sc1
    s_add_u32 s27, s27, 4096
    buffer_load_dwordx4 v[80:83], v0, s[4:7], s27 offen offset:0 sc1
    buffer_load_dwordx4 v[84:87], v0, s[4:7], s27 offen offset:2048 sc1
    s_add_u32 s27, s27, 4096
    buffer_load_dwordx4 v[88:91], v0, s[4:7], s27 offen offset:0 sc1
    buffer_load_dwordx4 v[92:95], v0, s[4:7], s27 offen offset:2048 sc1
    s_waitcnt vmcnt(15)
    v_lshlrev_b32 v8, 16, v32
    v_and_b32 v9, 0xffff0000, v32
    v_lshlrev_b32 v10, 16, v33
    v_and_b32 v11, 0xffff0000, v33
    v_lshlrev_b32 v12, 16, v34
    v_and_b32 v13, 0xffff0000, v34
    v_lshlrev_b32 v14, 16, v35
    v_and_b32 v15, 0xffff0000, v35
    s_waitcnt vmcnt(14)
    v_lshlrev_b32 v5, 16, v36
    v_and_b32 v6, 0xffff0000, v36
    v_add_f32 v8, v8, v5
    v_add_f32 v9, v9, v6
    v_lshlrev_b32 v5, 16, v37
    v_and_b32 v6, 0xffff0000, v37
    v_add_f32 v10, v10, v5
    v_add_f32 v11, v11, v6
    v_lshlrev_b32 v5, 16, v38
    v_and_b32 v6, 0xffff0000, v38
    v_add_f32 v12, v12, v5
    v_add_f32 v13, v13, v6
    v_lshlrev_b32 v5, 16, v39
    v_and_b32 v6, 0xffff0000, v39
    v_add_f32 v14, v14, v5
    v_add_f32 v15, v15, v6
    s_waitcnt vmcnt(13)
    v_lshlrev_b32 v5, 16, v40
    v_and_b32 v6, 0xffff0000, v40
    v_add_f32 v8, v8, v5
    v_add_f32 v9, v9, v6
    v_lshlrev_b32 v5, 16, v41
    v_and_b32 v6, 0xffff0000, v41
    v_add_f32 v10, v10, v5
    v_add_f32 v11, v11, v6
    v_lshlrev_b32 v5, 16, v42
    v_and_b32 v6, 0xffff0000, v42
    v_add_f32 v12, v12, v5
    v_add_f32 v13, v13, v6
    v_lshlrev_b32 v5, 16, v43
    v_and_b32 v6, 0xffff0000, v43
    v_add_f32 v14, v14, v5
    v_add_f32 v15, v15, v6
    s_waitcnt vmcnt(12)
    v_lshlrev_b32 v5, 16, v44
    v_and_b32 v6, 0xffff0000, v44
    v_add_f32 v8, v8, v5
    v_add_f32 v9, v9, v6
    v_lshlrev_b32 v5, 16, v45
    v_and_b32 v6, 0xffff0000, v45
    v_add_f32 v10, v10, v5
    v_add_f32 v11, v11, v6
    v_lshlrev_b32 v5, 16, v46
    v_and_b32 v6, 0xffff0000, v46
    v_add_f32 v12, v12, v5
    v_add_f32 v13, v13, v6
    v_lshlrev_b32 v5, 16, v47
    v_and_b32 v6, 0xffff0000, v47
    v_add_f32 v14, v14, v5
    v_add_f32 v15, v15, v6
    s_waitcnt vmcnt(11)
    v_lshlrev_b32 v5, 16, v48
    v_and_b32 v6, 0xffff0000, v48
    v_add_f32 v8, v8, v5
    v_add_f32 v9, v9, v6
    v_lshlrev_b32 v5, 16, v49
    v_and_b32 v6, 0xffff0000, v49
    v_add_f32 v10, v10, v5
    v_add_f32 v11, v11, v6
    v_lshlrev_b32 v5, 16, v50
    v_and_b32 v6, 0xffff0000, v50
    v_add_f32 v12, v12, v5
    v_add_f32 v13, v13, v6
    v_lshlrev_b32 v5, 16, v51
    v_and_b32 v6, 0xffff0000, v51
    v_add_f32 v14, v14, v5
    v_add_f32 v15, v15, v6
    s_waitcnt vmcnt(10)
    v_lshlrev_b32 v5, 16, v52
    v_and_b32 v6, 0xffff0000, v52
    v_add_f32 v8, v8, v5
    v_add_f32 v9, v9, v6
    v_lshlrev_b32 v5, 16, v53
    v_and_b32 v6, 0xffff0000, v53
    v_add_f32 v10, v10, v5
    v_add_f32 v11, v11, v6
    v_lshlrev_b32 v5, 16, v54
    v_and_b32 v6, 0xffff0000, v54
    v_add_f32 v12, v12, v5
    v_add_f32 v13, v13, v6
    v_lshlrev_b32 v5, 16, v55
    v_and_b32 v6, 0xffff0000, v55
    v_add_f32 v14, v14, v5
    v_add_f32 v15, v15, v6
    s_waitcnt vmcnt(9)
    v_lshlrev_b32 v5, 16, v56
    v_and_b32 v6, 0xffff0000, v56
    v_add_f32 v8, v8, v5
    v_add_f32 v9, v9, v6
    v_lshlrev_b32 v5, 16, v57
    v_and_b32 v6, 0xffff0000, v57
    v_add_f32 v10, v10, v5
    v_add_f32 v11, v11, v6
    v_lshlrev_b32 v5, 16, v58
    v_and_b32 v6, 0xffff0000, v58
    v_add_f32 v12, v12, v5
    v_add_f32 v13, v13, v6
    v_lshlrev_b32 v5, 16, v59
    v_and_b32 v6, 0xffff0000, v59
    v_add_f32 v14, v14, v5
    v_add_f32 v15, v15, v6
    s_waitcnt vmcnt(8)
    v_lshlrev_b32 v5, 16, v60
    v_and_b32 v6, 0xffff0000, v60
    v_add_f32 v8, v8, v5
    v_add_f32 v9, v9, v6
    v_lshlrev_b32 v5, 16, v61
    v_and_b32 v6, 0xffff0000, v61
    v_add_f32 v10, v10, v5
    v_add_f32 v11, v11, v6
    v_lshlrev_b32 v5, 16, v62
    v_and_b32 v6, 0xffff0000, v62
    v_add_f32 v12, v12, v5
    v_add_f32 v13, v13, v6
    v_lshlrev_b32 v5, 16, v63
    v_and_b32 v6, 0xffff0000, v63
    v_add_f32 v14, v14, v5
    v_add_f32 v15, v15, v6
    s_waitcnt vmcnt(7)
    v_lshlrev_b32 v5, 16, v64
    v_and_b32 v6, 0xffff0000, v64
    v_add_f32 v8, v8, v5
    v_add_f32 v9, v9, v6
    v_lshlrev_b32 v5, 16, v65
    v_and_b32 v6, 0xffff0000, v65
    v_add_f32 v10, v10, v5
    v_add_f32 v11, v11, v6
    v_lshlrev_b32 v5, 16, v66
    v_and_b32 v6, 0xffff0000, v66
    v_add_f32 v12, v12, v5
    v_add_f32 v13, v13, v6
    v_lshlrev_b32 v5, 16, v67
    v_and_b32 v6, 0xffff0000, v67
    v_add_f32 v14, v14, v5
    v_add_f32 v15, v15, v6
    s_waitcnt vmcnt(6)
    v_lshlrev_b32 v5, 16, v68
    v_and_b32 v6, 0xffff0000, v68
    v_add_f32 v8, v8, v5
    v_add_f32 v9, v9, v6
    v_lshlrev_b32 v5, 16, v69
    v_and_b32 v6, 0xffff0000, v69
    v_add_f32 v10, v10, v5
    v_add_f32 v11, v11, v6
    v_lshlrev_b32 v5, 16, v70
    v_and_b32 v6, 0xffff0000, v70
    v_add_f32 v12, v12, v5
    v_add_f32 v13, v13, v6
    v_lshlrev_b32 v5, 16, v71
    v_and_b32 v6, 0xffff0000, v71
    v_add_f32 v14, v14, v5
    v_add_f32 v15, v15, v6
    s_waitcnt vmcnt(5)
    v_lshlrev_b32 v5, 16, v72
    v_and_b32 v6, 0xffff0000, v72
    v_add_f32 v8, v8, v5
    v_add_f32 v9, v9, v6
    v_lshlrev_b32 v5, 16, v73
    v_and_b32 v6, 0xffff0000, v73
    v_add_f32 v10, v10, v5
    v_add_f32 v11, v11, v6
    v_lshlrev_b32 v5, 16, v74
    v_and_b32 v6, 0xffff0000, v74
    v_add_f32 v12, v12, v5
    v_add_f32 v13, v13, v6
    v_lshlrev_b32 v5, 16, v75
    v_and_b32 v6, 0xffff0000, v75
    v_add_f32 v14, v14, v5
    v_add_f32 v15, v15, v6
    s_waitcnt vmcnt(4)
    v_lshlrev_b32 v5, 16, v76
    v_and_b32 v6, 0xffff0000, v76
    v_add_f32 v8, v8, v5
    v_add_f32 v9, v9, v6
    v_lshlrev_b32 v5, 16, v77
    v_and_b32 v6, 0xffff0000, v77
    v_add_f32 v10, v10, v5
    v_add_f32 v11, v11, v6
    v_lshlrev_b32 v5, 16, v78
    v_and_b32 v6, 0xffff0000, v78
    v_add_f32 v12, v12, v5
    v_add_f32 v13, v13, v6
    v_lshlrev_b32 v5, 16, v79
    v_and_b32 v6, 0xffff0000, v79
    v_add_f32 v14, v14, v5
    v_add_f32 v15, v15, v6
    s_waitcnt vmcnt(3)
    v_lshlrev_b32 v5, 16, v80
    v_and_b32 v6, 0xffff0000, v80
    v_add_f32 v8, v8, v5
    v_add_f32 v9, v9, v6
    v_lshlrev_b32 v5, 16, v81
    v_and_b32 v6, 0xffff0000, v81
    v_add_f32 v10, v10, v5
    v_add_f32 v11, v11, v6
    v_lshlrev_b32 v5, 16, v82
    v_and_b32 v6, 0xffff0000, v82
    v_add_f32 v12, v12, v5
    v_add_f32 v13, v13, v6
    v_lshlrev_b32 v5, 16, v83
    v_and_b32 v6, 0xffff0000, v83
    v_add_f32 v14, v14, v5
    v_add_f32 v15, v15, v6
    s_waitcnt vmcnt(2)
    v_lshlrev_b32 v5, 16, v84
    v_and_b32 v6, 0xffff0000, v84
    v_add_f32 v8, v8, v5
    v_add_f32 v9, v9, v6
    v_lshlrev_b32 v5, 16, v85
    v_and_b32 v6, 0xffff0000, v85
    v_add_f32 v10, v10, v5
    v_add_f32 v11, v11, v6
    v_lshlrev_b32 v5, 16, v86
    v_and_b32 v6, 0xffff0000, v86
    v_add_f32 v12, v12, v5
    v_add_f32 v13, v13, v6
    v_lshlrev_b32 v5, 16, v87
    v_and_b32 v6, 0xffff0000, v87
    v_add_f32 v14, v14, v5
    v_add_f32 v15, v15, v6
    s_waitcnt vmcnt(1)
    v_lshlrev_b32 v5, 16, v88
    v_and_b32 v6, 0xffff0000, v88
    v_add_f32 v8, v8, v5
    v_add_f32 v9, v9, v6
    v_lshlrev_b32 v5, 16, v89
    v_and_b32 v6, 0xffff0000, v89
    v_add_f32 v10, v10, v5
    v_add_f32 v11, v11, v6
    v_lshlrev_b32 v5, 16, v90
    v_and_b32 v6, 0xffff0000, v90
    v_add_f32 v12, v12, v5
    v_add_f32 v13, v13, v6
    v_lshlrev_b32 v5, 16, v91
    v_and_b32 v6, 0xffff0000, v91
    v_add_f32 v14, v14, v5
    v_add_f32 v15, v15, v6
    s_waitcnt vmcnt(0)
    v_lshlrev_b32 v5, 16, v92
    v_and_b32 v6, 0xffff0000, v92
    v_add_f32 v8, v8, v5
    v_add_f32 v9, v9, v6
    v_lshlrev_b32 v5, 16, v93
    v_and_b32 v6, 0xffff0000, v93
    v_add_f32 v10, v10, v5
    v_add_f32 v11, v11, v6
    v_lshlrev_b32 v5, 16, v94
    v_and_b32 v6, 0xffff0000, v94
    v_add_f32 v12, v12, v5
    v_add_f32 v13, v13, v6
    v_lshlrev_b32 v5, 16, v95
    v_and_b32 v6, 0xffff0000, v95
    v_add_f32 v14, v14, v5
    v_add_f32 v15, v15, v6
    v_cvt_pk_bf16_f32 v16, v8, v9
    v_cvt_pk_bf16_f32 v17, v10, v11
    v_cvt_pk_bf16_f32 v18, v12, v13
    v_cvt_pk_bf16_f32 v19, v14, v15
    buffer_store_dwordx2 v[16:17], v3, s[48:51], s29 offen offset:0
    buffer_store_dwordx2 v[18:19], v3, s[48:51], s29 offen offset:16
    s_branch K2_DONE
    s_branch K2_END
K2A_SLOW0_0:
    s_nop 7
    s_nop 7
    v_mov_b32 v101, v100
    s_nop 1
    v_permlane32_swap_b32 v100, v101
    s_nop 1
    v_max_f32 v100, v100, v101
    v_max_f32 v100, 0, v100
    v_sub_f32 v101, 0, v100
    v_exp_f32 v101, v101
    v_sub_f32 v56, v56, v100
    v_sub_f32 v16, v16, v100
    v_mul_f32 v0, v0, v101
    v_sub_f32 v57, v57, v100
    v_sub_f32 v17, v17, v100
    v_mul_f32 v1, v1, v101
    v_sub_f32 v58, v58, v100
    v_sub_f32 v18, v18, v100
    v_mul_f32 v2, v2, v101
    v_sub_f32 v59, v59, v100
    v_sub_f32 v19, v19, v100
    v_mul_f32 v3, v3, v101
    v_sub_f32 v60, v60, v100
    v_sub_f32 v20, v20, v100
    v_mul_f32 v4, v4, v101
    v_sub_f32 v61, v61, v100
    v_sub_f32 v21, v21, v100
    v_mul_f32 v5, v5, v101
    v_sub_f32 v62, v62, v100
    v_sub_f32 v22, v22, v100
    v_mul_f32 v6, v6, v101
    v_sub_f32 v63, v63, v100
    v_sub_f32 v23, v23, v100
    v_mul_f32 v7, v7, v101
    v_sub_f32 v64, v64, v100
    v_sub_f32 v24, v24, v100
    v_mul_f32 v8, v8, v101
    v_sub_f32 v65, v65, v100
    v_sub_f32 v25, v25, v100
    v_mul_f32 v9, v9, v101
    v_sub_f32 v66, v66, v100
    v_sub_f32 v26, v26, v100
    v_mul_f32 v10, v10, v101
    v_sub_f32 v67, v67, v100
    v_sub_f32 v27, v27, v100
    v_mul_f32 v11, v11, v101
    v_sub_f32 v68, v68, v100
    v_sub_f32 v28, v28, v100
    v_mul_f32 v12, v12, v101
    v_sub_f32 v69, v69, v100
    v_sub_f32 v29, v29, v100
    v_mul_f32 v13, v13, v101
    v_sub_f32 v70, v70, v100
    v_sub_f32 v30, v30, v100
    v_mul_f32 v14, v14, v101
    v_sub_f32 v71, v71, v100
    v_sub_f32 v31, v31, v100
    v_mul_f32 v15, v15, v101
    s_nop 1
    s_branch K2A_BACK0_0
K2A_SLOW0_1:
    s_nop 7
    s_nop 7
    v_mov_b32 v101, v100
    s_nop 1
    v_permlane32_swap_b32 v100, v101
    s_nop 1
    v_max_f32 v100, v100, v101
    v_max_f32 v100, 0, v100
    v_sub_f32 v101, 0, v100
    v_exp_f32 v101, v101
    v_sub_f32 v40, v40, v100
    v_sub_f32 v16, v16, v100
    v_mul_f32 v0, v0, v101
    v_sub_f32 v41, v41, v100
    v_sub_f32 v17, v17, v100
    v_mul_f32 v1, v1, v101
    v_sub_f32 v42, v42, v100
    v_sub_f32 v18, v18, v100
    v_mul_f32 v2, v2, v101
    v_sub_f32 v43, v43, v100
    v_sub_f32 v19, v19, v100
    v_mul_f32 v3, v3, v101
    v_sub_f32 v44, v44, v100
    v_sub_f32 v20, v20, v100
    v_mul_f32 v4, v4, v101
    v_sub_f32 v45, v45, v100
    v_sub_f32 v21, v21, v100
    v_mul_f32 v5, v5, v101
    v_sub_f32 v46, v46, v100
    v_sub_f32 v22, v22, v100
    v_mul_f32 v6, v6, v101
    v_sub_f32 v47, v47, v100
    v_sub_f32 v23, v23, v100
    v_mul_f32 v7, v7, v101
    v_sub_f32 v48, v48, v100
    v_sub_f32 v24, v24, v100
    v_mul_f32 v8, v8, v101
    v_sub_f32 v49, v49, v100
    v_sub_f32 v25, v25, v100
    v_mul_f32 v9, v9, v101
    v_sub_f32 v50, v50, v100
    v_sub_f32 v26, v26, v100
    v_mul_f32 v10, v10, v101
    v_sub_f32 v51, v51, v100
    v_sub_f32 v27, v27, v100
    v_mul_f32 v11, v11, v101
    v_sub_f32 v52, v52, v100
    v_sub_f32 v28, v28, v100
    v_mul_f32 v12, v12, v101
    v_sub_f32 v53, v53, v100
    v_sub_f32 v29, v29, v100
    v_mul_f32 v13, v13, v101
    v_sub_f32 v54, v54, v100
    v_sub_f32 v30, v30, v100
    v_mul_f32 v14, v14, v101
    v_sub_f32 v55, v55, v100
    v_sub_f32 v31, v31, v100
    v_mul_f32 v15, v15, v101
    s_nop 1
    s_branch K2A_BACK0_1
K2A_SLOW1_0:
    s_nop 7
    s_nop 7
    v_mov_b32 v101, v100
    s_nop 1
    v_permlane32_swap_b32 v100, v101
    s_nop 1
    v_max_f32 v100, v100, v101
    v_max_f32 v100, 0, v100
    v_sub_f32 v101, 0, v100
    v_exp_f32 v101, v101
    v_sub_f32 v56, v56, v100
    v_sub_f32 v16, v16, v100
    v_mul_f32 v0, v0, v101
    v_sub_f32 v57, v57, v100
    v_sub_f32 v17, v17, v100
    v_mul_f32 v1, v1, v101
    v_sub_f32 v58, v58, v100
    v_sub_f32 v18, v18, v100
    v_mul_f32 v2, v2, v101
    v_sub_f32 v59, v59, v100
    v_sub_f32 v19, v19, v100
    v_mul_f32 v3, v3, v101
    v_sub_f32 v60, v60, v100
    v_sub_f32 v20, v20, v100
    v_mul_f32 v4, v4, v101
    v_sub_f32 v61, v61, v100
    v_sub_f32 v21, v21, v100
    v_mul_f32 v5, v5, v101
    v_sub_f32 v62, v62, v100
    v_sub_f32 v22, v22, v100
    v_mul_f32 v6, v6, v101
    v_sub_f32 v63, v63, v100
    v_sub_f32 v23, v23, v100
    v_mul_f32 v7, v7, v101
    v_sub_f32 v64, v64, v100
    v_sub_f32 v24, v24, v100
    v_mul_f32 v8, v8, v101
    v_sub_f32 v65, v65, v100
    v_sub_f32 v25, v25, v100
    v_mul_f32 v9, v9, v101
    v_sub_f32 v66, v66, v100
    v_sub_f32 v26, v26, v100
    v_mul_f32 v10, v10, v101
    v_sub_f32 v67, v67, v100
    v_sub_f32 v27, v27, v100
    v_mul_f32 v11, v11, v101
    v_sub_f32 v68, v68, v100
    v_sub_f32 v28, v28, v100
    v_mul_f32 v12, v12, v101
    v_sub_f32 v69, v69, v100
    v_sub_f32 v29, v29, v100
    v_mul_f32 v13, v13, v101
    v_sub_f32 v70, v70, v100
    v_sub_f32 v30, v30, v100
    v_mul_f32 v14, v14, v101
    v_sub_f32 v71, v71, v100
    v_sub_f32 v31, v31, v100
    v_mul_f32 v15, v15, v101
    s_nop 1
    s_branch K2A_BACK1_0
K2A_SLOW1_1:
    s_nop 7
    s_nop 7
    v_mov_b32 v101, v100
    s_nop 1
    v_permlane32_swap_b32 v100, v101
    s_nop 1
    v_max_f32 v100, v100, v101
    v_max_f32 v100, 0, v100
    v_sub_f32 v101, 0, v100
    v_exp_f32 v101, v101
    v_sub_f32 v40, v40, v100
    v_sub_f32 v16, v16, v100
    v_mul_f32 v0, v0, v101
    v_sub_f32 v41, v41, v100
    v_sub_f32 v17, v17, v100
    v_mul_f32 v1, v1, v101
    v_sub_f32 v42, v42, v100
    v_sub_f32 v18, v18, v100
    v_mul_f32 v2, v2, v101
    v_sub_f32 v43, v43, v100
    v_sub_f32 v19, v19, v100
    v_mul_f32 v3, v3, v101
    v_sub_f32 v44, v44, v100
    v_sub_f32 v20, v20, v100
    v_mul_f32 v4, v4, v101
    v_sub_f32 v45, v45, v100
    v_sub_f32 v21, v21, v100
    v_mul_f32 v5, v5, v101
    v_sub_f32 v46, v46, v100
    v_sub_f32 v22, v22, v100
    v_mul_f32 v6, v6, v101
    v_sub_f32 v47, v47, v100
    v_sub_f32 v23, v23, v100
    v_mul_f32 v7, v7, v101
    v_sub_f32 v48, v48, v100
    v_sub_f32 v24, v24, v100
    v_mul_f32 v8, v8, v101
    v_sub_f32 v49, v49, v100
    v_sub_f32 v25, v25, v100
    v_mul_f32 v9, v9, v101
    v_sub_f32 v50, v50, v100
    v_sub_f32 v26, v26, v100
    v_mul_f32 v10, v10, v101
    v_sub_f32 v51, v51, v100
    v_sub_f32 v27, v27, v100
    v_mul_f32 v11, v11, v101
    v_sub_f32 v52, v52, v100
    v_sub_f32 v28, v28, v100
    v_mul_f32 v12, v12, v101
    v_sub_f32 v53, v53, v100
    v_sub_f32 v29, v29, v100
    v_mul_f32 v13, v13, v101
    v_sub_f32 v54, v54, v100
    v_sub_f32 v30, v30, v100
    v_mul_f32 v14, v14, v101
    v_sub_f32 v55, v55, v100
    v_sub_f32 v31, v31, v100
    v_mul_f32 v15, v15, v101
    s_nop 1
    s_branch K2A_BACK1_1
K2A_SLOW2_0:
    s_nop 7
    s_nop 7
    v_mov_b32 v101, v100
    s_nop 1
    v_permlane32_swap_b32 v100, v101
    s_nop 1
    v_max_f32 v100, v100, v101
    v_max_f32 v100, 0, v100
    v_sub_f32 v101, 0, v100
    v_exp_f32 v101, v101
    v_sub_f32 v56, v56, v100
    v_sub_f32 v16, v16, v100
    v_mul_f32 v0, v0, v101
    v_sub_f32 v57, v57, v100
    v_sub_f32 v17, v17, v100
    v_mul_f32 v1, v1, v101
    v_sub_f32 v58, v58, v100
    v_sub_f32 v18, v18, v100
    v_mul_f32 v2, v2, v101
    v_sub_f32 v59, v59, v100
    v_sub_f32 v19, v19, v100
    v_mul_f32 v3, v3, v101
    v_sub_f32 v60, v60, v100
    v_sub_f32 v20, v20, v100
    v_mul_f32 v4, v4, v101
    v_sub_f32 v61, v61, v100
    v_sub_f32 v21, v21, v100
    v_mul_f32 v5, v5, v101
    v_sub_f32 v62, v62, v100
    v_sub_f32 v22, v22, v100
    v_mul_f32 v6, v6, v101
    v_sub_f32 v63, v63, v100
    v_sub_f32 v23, v23, v100
    v_mul_f32 v7, v7, v101
    v_sub_f32 v64, v64, v100
    v_sub_f32 v24, v24, v100
    v_mul_f32 v8, v8, v101
    v_sub_f32 v65, v65, v100
    v_sub_f32 v25, v25, v100
    v_mul_f32 v9, v9, v101
    v_sub_f32 v66, v66, v100
    v_sub_f32 v26, v26, v100
    v_mul_f32 v10, v10, v101
    v_sub_f32 v67, v67, v100
    v_sub_f32 v27, v27, v100
    v_mul_f32 v11, v11, v101
    v_sub_f32 v68, v68, v100
    v_sub_f32 v28, v28, v100
    v_mul_f32 v12, v12, v101
    v_sub_f32 v69, v69, v100
    v_sub_f32 v29, v29, v100
    v_mul_f32 v13, v13, v101
    v_sub_f32 v70, v70, v100
    v_sub_f32 v30, v30, v100
    v_mul_f32 v14, v14, v101
    v_sub_f32 v71, v71, v100
    v_sub_f32 v31, v31, v100
    v_mul_f32 v15, v15, v101
    s_nop 1
    s_branch K2A_BACK2_0
K2A_SLOW2_1:
    s_nop 7
    s_nop 7
    v_mov_b32 v101, v100
    s_nop 1
    v_permlane32_swap_b32 v100, v101
    s_nop 1
    v_max_f32 v100, v100, v101
    v_max_f32 v100, 0, v100
    v_sub_f32 v101, 0, v100
    v_exp_f32 v101, v101
    v_sub_f32 v40, v40, v100
    v_sub_f32 v16, v16, v100
    v_mul_f32 v0, v0, v101
    v_sub_f32 v41, v41, v100
    v_sub_f32 v17, v17, v100
    v_mul_f32 v1, v1, v101
    v_sub_f32 v42, v42, v100
    v_sub_f32 v18, v18, v100
    v_mul_f32 v2, v2, v101
    v_sub_f32 v43, v43, v100
    v_sub_f32 v19, v19, v100
    v_mul_f32 v3, v3, v101
    v_sub_f32 v44, v44, v100
    v_sub_f32 v20, v20, v100
    v_mul_f32 v4, v4, v101
    v_sub_f32 v45, v45, v100
    v_sub_f32 v21, v21, v100
    v_mul_f32 v5, v5, v101
    v_sub_f32 v46, v46, v100
    v_sub_f32 v22, v22, v100
    v_mul_f32 v6, v6, v101
    v_sub_f32 v47, v47, v100
    v_sub_f32 v23, v23, v100
    v_mul_f32 v7, v7, v101
    v_sub_f32 v48, v48, v100
    v_sub_f32 v24, v24, v100
    v_mul_f32 v8, v8, v101
    v_sub_f32 v49, v49, v100
    v_sub_f32 v25, v25, v100
    v_mul_f32 v9, v9, v101
    v_sub_f32 v50, v50, v100
    v_sub_f32 v26, v26, v100
    v_mul_f32 v10, v10, v101
    v_sub_f32 v51, v51, v100
    v_sub_f32 v27, v27, v100
    v_mul_f32 v11, v11, v101
    v_sub_f32 v52, v52, v100
    v_sub_f32 v28, v28, v100
    v_mul_f32 v12, v12, v101
    v_sub_f32 v53, v53, v100
    v_sub_f32 v29, v29, v100
    v_mul_f32 v13, v13, v101
    v_sub_f32 v54, v54, v100
    v_sub_f32 v30, v30, v100
    v_mul_f32 v14, v14, v101
    v_sub_f32 v55, v55, v100
    v_sub_f32 v31, v31, v100
    v_mul_f32 v15, v15, v101
    s_nop 1
    s_branch K2A_BACK2_1
K2A_SLOW3_0:
    s_nop 7
    s_nop 7
    v_mov_b32 v101, v100
    s_nop 1
    v_permlane32_swap_b32 v100, v101
    s_nop 1
    v_max_f32 v100, v100, v101
    v_max_f32 v100, 0, v100
    v_sub_f32 v101, 0, v100
    v_exp_f32 v101, v101
    v_sub_f32 v56, v56, v100
    v_sub_f32 v16, v16, v100
    v_mul_f32 v0, v0, v101
    v_sub_f32 v57, v57, v100
    v_sub_f32 v17, v17, v100
    v_mul_f32 v1, v1, v101
    v_sub_f32 v58, v58, v100
    v_sub_f32 v18, v18, v100
    v_mul_f32 v2, v2, v101
    v_sub_f32 v59, v59, v100
    v_sub_f32 v19, v19, v100
    v_mul_f32 v3, v3, v101
    v_sub_f32 v60, v60, v100
    v_sub_f32 v20, v20, v100
    v_mul_f32 v4, v4, v101
    v_sub_f32 v61, v61, v100
    v_sub_f32 v21, v21, v100
    v_mul_f32 v5, v5, v101
    v_sub_f32 v62, v62, v100
    v_sub_f32 v22, v22, v100
    v_mul_f32 v6, v6, v101
    v_sub_f32 v63, v63, v100
    v_sub_f32 v23, v23, v100
    v_mul_f32 v7, v7, v101
    v_sub_f32 v64, v64, v100
    v_sub_f32 v24, v24, v100
    v_mul_f32 v8, v8, v101
    v_sub_f32 v65, v65, v100
    v_sub_f32 v25, v25, v100
    v_mul_f32 v9, v9, v101
    v_sub_f32 v66, v66, v100
    v_sub_f32 v26, v26, v100
    v_mul_f32 v10, v10, v101
    v_sub_f32 v67, v67, v100
    v_sub_f32 v27, v27, v100
    v_mul_f32 v11, v11, v101
    v_sub_f32 v68, v68, v100
    v_sub_f32 v28, v28, v100
    v_mul_f32 v12, v12, v101
    v_sub_f32 v69, v69, v100
    v_sub_f32 v29, v29, v100
    v_mul_f32 v13, v13, v101
    v_sub_f32 v70, v70, v100
    v_sub_f32 v30, v30, v100
    v_mul_f32 v14, v14, v101
    v_sub_f32 v71, v71, v100
    v_sub_f32 v31, v31, v100
    v_mul_f32 v15, v15, v101
    s_nop 1
    s_branch K2A_BACK3_0
K2A_SLOW3_1:
    s_nop 7
    s_nop 7
    v_mov_b32 v101, v100
    s_nop 1
    v_permlane32_swap_b32 v100, v101
    s_nop 1
    v_max_f32 v100, v100, v101
    v_max_f32 v100, 0, v100
    v_sub_f32 v101, 0, v100
    v_exp_f32 v101, v101
    v_sub_f32 v40, v40, v100
    v_sub_f32 v16, v16, v100
    v_mul_f32 v0, v0, v101
    v_sub_f32 v41, v41, v100
    v_sub_f32 v17, v17, v100
    v_mul_f32 v1, v1, v101
    v_sub_f32 v42, v42, v100
    v_sub_f32 v18, v18, v100
    v_mul_f32 v2, v2, v101
    v_sub_f32 v43, v43, v100
    v_sub_f32 v19, v19, v100
    v_mul_f32 v3, v3, v101
    v_sub_f32 v44, v44, v100
    v_sub_f32 v20, v20, v100
    v_mul_f32 v4, v4, v101
    v_sub_f32 v45, v45, v100
    v_sub_f32 v21, v21, v100
    v_mul_f32 v5, v5, v101
    v_sub_f32 v46, v46, v100
    v_sub_f32 v22, v22, v100
    v_mul_f32 v6, v6, v101
    v_sub_f32 v47, v47, v100
    v_sub_f32 v23, v23, v100
    v_mul_f32 v7, v7, v101
    v_sub_f32 v48, v48, v100
    v_sub_f32 v24, v24, v100
    v_mul_f32 v8, v8, v101
    v_sub_f32 v49, v49, v100
    v_sub_f32 v25, v25, v100
    v_mul_f32 v9, v9, v101
    v_sub_f32 v50, v50, v100
    v_sub_f32 v26, v26, v100
    v_mul_f32 v10, v10, v101
    v_sub_f32 v51, v51, v100
    v_sub_f32 v27, v27, v100
    v_mul_f32 v11, v11, v101
    v_sub_f32 v52, v52, v100
    v_sub_f32 v28, v28, v100
    v_mul_f32 v12, v12, v101
    v_sub_f32 v53, v53, v100
    v_sub_f32 v29, v29, v100
    v_mul_f32 v13, v13, v101
    v_sub_f32 v54, v54, v100
    v_sub_f32 v30, v30, v100
    v_mul_f32 v14, v14, v101
    v_sub_f32 v55, v55, v100
    v_sub_f32 v31, v31, v100
    v_mul_f32 v15, v15, v101
    s_nop 1
    s_branch K2A_BACK3_1
K2_END:
    s_endpgm
.section .rodata,"a"
.p2align 6
.amdhsa_kernel k1_proj_kernel
  .amdhsa_next_free_vgpr 256
  .amdhsa_next_free_sgpr 100
  .amdhsa_accum_offset 256
  .amdhsa_group_segment_fixed_size 0
  .amdhsa_kernarg_size 104
  .amdhsa_user_sgpr_count 2
  .amdhsa_user_sgpr_kernarg_segment_ptr 1
  .amdhsa_system_sgpr_workgroup_id_x 1
.end_amdhsa_kernel
.text
.section .rodata,"a"
.p2align 6
.amdhsa_kernel k2_attn_kernel
  .amdhsa_next_free_vgpr 256
  .amdhsa_next_free_sgpr 96
  .amdhsa_accum_offset 256
  .amdhsa_group_segment_fixed_size 0
  .amdhsa_kernarg_size 104
  .amdhsa_user_sgpr_count 2
  .amdhsa_user_sgpr_kernarg_segment_ptr 1
  .amdhsa_system_sgpr_workgroup_id_x 1
.end_amdhsa_kernel
.text
```
